```python
import torch

def _softmax(x, axis=-1):
    return torch.softmax(x, dim=axis)

def _gelu(x):
    return torch.nn.functional.gelu(x, approximate='tanh')

def _silu(x):
    return torch.nn.functional.silu(x)

def _sigmoid(x):
    return torch.sigmoid(x)

def _layernorm(x, axis=-1, eps=1e-05):
    m = x.mean(dim=axis, keepdim=True)
    v = x.var(dim=axis, keepdim=True, unbiased=False)
    return (x - m) / torch.sqrt(v + eps)

def _scatter_add(tgt, idx, src, axis=0):
    return tgt.clone().index_add_(axis, idx, src)

def _segment_sum(src, seg, n):
    out = torch.zeros((n,) + src.shape[1:], dtype=src.dtype)
    return out.index_add_(0, seg, src)

def _pad(x, pw):
    flat = tuple((v for pair in reversed(pw) for v in pair))
    return torch.nn.functional.pad(x, flat)
kernel_name = 'sequential_preLN__mha_block__mixer_gmlp__prompt'

def setup_inputs():

    _w = lambda a: (lambda t: t.to(torch.bfloat16) if t.is_floating_point() else t)(torch.as_tensor(a))

    def _A_setup():
        B, S, D, H = (1, 2048, 1024, 32)
        return {'x': _w((lambda *s: torch.randn(*s, dtype=torch.bfloat16) * 0.05)(B, S, D)), 'wqkv': _w((lambda *s: torch.randn(*s, dtype=torch.bfloat16) * 0.05)(D, 3 * D)), 'wo': _w((lambda *s: torch.randn(*s, dtype=torch.bfloat16) * 0.05)(D, D))}
    _A_in = _A_setup()

    def _B_setup():
        B, S, D, F = (1, 2048, 1024, 3584)
        Fh = F // 2
        return {'x': _w((lambda *s: torch.randn(*s, dtype=torch.bfloat16) * 0.05)(B, S, D)), 'w_in': _w((lambda *s: torch.randn(*s, dtype=torch.bfloat16) * 1.6)(D, 2 * Fh)), 'w_sp': _w(0.01 * (lambda *s: torch.randn(*s, dtype=torch.bfloat16) * 1.6)(S, S)), 'b_sp': _w(1.0 + 0.01 * (lambda *s: torch.randn(*s, dtype=torch.bfloat16) * 0.05)(S)), 'w_out': _w((lambda *s: torch.randn(*s, dtype=torch.bfloat16) * 0.05)(Fh, D))}
    _B_in = _B_setup()
    return {'A_x': _A_in['x'], 'A_wqkv': _A_in['wqkv'], 'A_wo': _A_in['wo'], 'B_x': _B_in['x'], 'B_w_in': _B_in['w_in'], 'B_w_sp': _B_in['w_sp'], 'B_b_sp': _B_in['b_sp'], 'B_w_out': _B_in['w_out']}

def reference(A_x, A_wqkv, A_wo, B_x, B_w_in, B_w_sp, B_b_sp, B_w_out):

    def _A_ref(x, wqkv, wo):
        B, S, D = x.shape
        H = 32
        Dh = D // H
        qkv = (lambda x, *d: x.permute(*d))((x @ wqkv).reshape(B, S, 3, H, Dh), 2, 0, 3, 1, 4)
        q, k, v = (qkv[0], qkv[1], qkv[2])
        scores = torch.einsum('bhqd,bhkd->bhqk', q, k) * Dh ** (-0.5)
        p = _softmax(scores, axis=-1)
        o = torch.einsum('bhqk,bhkd->bhqd', p, v)
        return (lambda x, *d: x.permute(*d))(o, 0, 2, 1, 3).reshape(B, S, D) @ wo

    def _B_ref(x, w_in, w_sp, b_sp, w_out):
        B, S, D = x.shape
        F = w_in.shape[-1]
        Fh = F // 2
        z = _gelu(torch.einsum('bsd,df->bsf', x, w_in))
        z1 = z[..., :Fh].clone()
        z2 = _layernorm(z[..., Fh:], axis=-1)
        g = torch.einsum('ts,bsf->btf', w_sp, z2) + b_sp[None, :, None]
        return torch.einsum('bsf,fd->bsd', z1 * g, w_out)
    x = A_x
    h = x + _A_ref(_layernorm(x, axis=-1), A_wqkv, A_wo)
    h2 = h + _B_ref(_layernorm(h, axis=-1), B_w_in, B_w_sp, B_b_sp, B_w_out)
    return h2
```

```asm
; @launch grid=(256,1,1) block=(256,1,1) lds=163840
.amdgcn_target "amdgcn-amd-amdhsa--gfx950"
.text
.globl sequential_preLN__mha_block__mixer_gmlp__prompt_kernel
.p2align 8
.type sequential_preLN__mha_block__mixer_gmlp__prompt_kernel,@function
sequential_preLN__mha_block__mixer_gmlp__prompt_kernel:
 s_cmp_ge_u32 s2,256
 s_cbranch_scc1 .Lend
 s_load_dwordx2 s[4:5],s[0:1],0
 s_load_dwordx2 s[8:9],s[0:1],8
 s_load_dwordx2 s[12:13],s[0:1],80
 s_load_dwordx2 s[16:17],s[0:1],72
 s_load_dwordx2 s[20:21],s[0:1],16
 s_load_dwordx2 s[24:25],s[0:1],32
 s_load_dwordx2 s[28:29],s[0:1],40
 s_load_dwordx2 s[32:33],s[0:1],48
 s_load_dwordx2 s[36:37],s[0:1],56
 s_load_dwordx2 s[40:41],s[0:1],64
 v_lshrrev_b32 v14,6,v0
 v_and_b32 v12,63,v0
 v_readfirstlane_b32 s46,v14
 s_and_b32 s44,s2,3
 s_lshl_b32 s44,s44,2
 s_bfe_u32 s49,s2,131075
 s_add_u32 s44,s44,s49
 s_lshr_b32 s3,s2,5
 s_xor_b32 s3,s3,0
 s_mul_i32 s49,s49,4
 s_mul_i32 s50,s3,2
 s_add_u32 s49,s49,s50
 s_bfe_u32 s45,s2,65538
 s_mul_i32 s50,s45,1
 s_add_u32 s49,s49,s50
 s_and_b32 s49,s49,15
 s_lshl_b32 s49,s49,7
 s_mul_i32 s50,s49,3072
 s_lshl_b32 s45,s45,3
 s_add_u32 s45,s45,s3
 s_lshl_b32 s47,s44,2
 s_add_u32 s47,s47,s46
 s_lshl_b32 s51,s46,13
 v_lshrrev_b32 v14,3,v12
 v_lshrrev_b32 v15,4,v12
 v_xor_b32 v15,v15,v12
 v_and_b32 v15,7,v15
 v_and_b32 v252,4,v14
 v_add_u32 v252,v252,v14
 s_lshl_b32 s3,s47,5
 v_add_u32 v252,s3,v252
 v_lshlrev_b32 v252,11,v252
 v_lshl_add_u32 v188,v15,4,v252
 v_xor_b32 v189,64,v188
 v_add_u32 v189,31744,v189
 v_add_u32 v190,6144,v188
 v_add_u32 v191,6144,v189
 s_lshl_b32 s3,s46,4
 v_add_u32 v252,s3,v14
 v_mul_u32_u24 v252,6144,v252
 v_and_b32 v14,2,v14
 v_xor_b32 v14,v14,v12
 v_and_b32 v14,7,v14
 v_lshl_add_u32 v252,v14,4,v252
 s_lshl_b32 s3,s45,7
 s_add_u32 s3,s3,2048
 v_add_u32 v192,s3,v252
 v_xor_b32 v193,64,v192
 v_add_u32 v193,48128,v193
 v_xor_b32 v206,128,v192
 v_xor_b32 v207,128,v193
 v_xor_b32 v192,512,v192
 v_xor_b32 v193,512,v193
 s_mov_b32 s6,4194304
 s_mov_b32 s7,0x00020000
 s_mov_b32 s10,6291456
 s_mov_b32 s11,0x00020000
 s_mov_b32 s14,268435456
 s_mov_b32 s15,0x00020000
 s_cmp_eq_u32 s2,0
 s_cselect_b32 s52,0,0x80000000
 v_lshrrev_b32 v14,2,v0
 v_and_b32 v15,3,v0
 v_lshlrev_b32 v15,4,v15
 v_lshl_add_u32 v14,v14,11,v15
 v_add_u32 v14,s52,v14
 v_mov_b32 v244,0
 v_mov_b32 v245,0
 v_mov_b32 v246,0
 v_mov_b32 v247,0
 s_waitcnt lgkmcnt(0)
 buffer_store_dwordx4 v[244:247],v14,s[12:15],0 offen sc1
 s_add_u32 m0,s51,0
 s_nop 0
 buffer_load_dwordx4 v188,s[4:7],s49 offen lds
 buffer_load_dwordx4 v189,s[4:7],s49 offen offset:1024 lds
 buffer_load_dwordx4 v190,s[4:7],s49 offen offset:2048 lds
 buffer_load_dwordx4 v191,s[4:7],s49 offen offset:3072 lds
 s_add_u32 m0,s51,4096
 s_nop 0
 buffer_load_dwordx4 v192,s[8:11],s50 offen lds
 buffer_load_dwordx4 v193,s[8:11],s50 offen offset:1024 lds
 buffer_load_dwordx4 v206,s[8:11],s50 offen offset:2048 lds
 buffer_load_dwordx4 v207,s[8:11],s50 offen offset:3072 lds
 s_add_u32 s49,s49,128
 s_and_b32 s49,s49,2047
 s_mul_i32 s50,s49,3072
 s_getpc_b64 s[70:71]
.Lseq_pc_1:
 s_lshr_b32 s3,s2,3
 s_lshl_b32 s3,s3,12
 v_lshl_add_u32 v252,v0,4,s3
 v_min_u32 v252,.Lcodeend-.Lseq_pc_1-16,v252
 v_mov_b32 v253,s71
 v_add_co_u32 v252,vcc,s70,v252
 s_nop 1
 v_addc_co_u32 v253,vcc,0,v253,vcc
 global_load_dwordx4 v[228:231],v[252:253],off
 v_lshl_add_u32 v205,v0,2,s52
 s_mov_b32 s18,4
 s_mov_b32 s19,0x00020000
 s_mov_b32 s22,2097152
 s_mov_b32 s23,0x00020000
 s_mov_b32 s26,7340032
 s_mov_b32 s27,0x00020000
 s_mov_b32 s30,8388608
 s_mov_b32 s31,0x00020000
 s_mov_b32 s34,4096
 s_mov_b32 s35,0x00020000
 s_mov_b32 s38,3670016
 s_mov_b32 s39,0x00020000
 s_mov_b32 s42,4194304
 s_mov_b32 s43,0x00020000
 s_mov_b32 s48,20000
 v_lshlrev_b32 v0,4,v12
 v_mov_b32 v6,1
 v_mov_b32 v8,0x3f803f80
 v_mov_b32 v9,0x3f803f80
 v_mov_b32 v10,0x3f803f80
 v_mov_b32 v11,0x3f803f80
 v_and_b32 v248,15,v12
 v_lshrrev_b32 v249,4,v12
 v_lshrrev_b32 v250,1,v248
 v_xor_b32 v250,v250,v249
 v_lshlrev_b32 v250,4,v250
 v_lshl_add_u32 v250,v248,7,v250
 v_add_u32 v184,s51,v250
 v_xor_b32 v185,64,v184
 v_add_u32 v186,0x10000,v184
 v_add_u32 v187,0x10000,v185
 v_lshrrev_b32 v250,5,v12
 v_lshlrev_b32 v250,13,v250
 v_and_b32 v251,1,v249
 v_lshl_add_u32 v250,v251,10,v250
 v_lshl_add_u32 v250,v251,6,v250
 v_lshrrev_b32 v251,2,v248
 v_lshl_add_u32 v250,v251,7,v250
 v_lshrrev_b32 v251,3,v248
 v_lshl_add_u32 v250,v251,5,v250
 v_and_b32 v251,3,v248
 v_lshl_add_u32 v176,v251,3,v250
 v_xor_b32 v177,32,v176
 v_xor_b32 v178,64,v176
 v_xor_b32 v179,0x60,v176
 v_add_u32 v180,0x10000,v176
 v_add_u32 v181,0x10000,v177
 v_add_u32 v182,0x10000,v178
 v_add_u32 v183,0x10000,v179
 v_and_b32 v13,12,v248
 v_add_u32 v13,v13,v248
 s_bfe_u32 s57,s44,65538
 s_lshl_b32 s3,s46,1
 s_add_u32 s3,s3,s57
 s_and_b32 s58,s3,3
 s_lshl_b32 s58,s58,5
 v_xor_b32 v196,s58,v176
 s_lshr_b32 s3,s3,2
 s_lshl_b32 s3,s3,11
 s_lshr_b32 s58,s44,3
 s_lshl_b32 s60,s58,14
 s_add_u32 s3,s3,s60
 v_add_u32 v196,s3,v196
 v_add_u32 v197,0x10000,v196
 s_lshl_b32 s3,s46,5
 v_xor_b32 v198,s3,v176
 v_add_u32 v198,131072,v198
 s_lshl_b32 s3,s45,2
 s_add_u32 s3,s3,s46
 s_lshl_b32 s3,s3,2
 s_and_b32 s60,s44,3
 s_add_u32 s3,s3,s60
 s_lshl_b32 s3,s3,8
 v_add_u32 v201,s3,v0
 v_mov_b32 v251,0x80000000
 v_cmp_gt_u32 vcc,16,v12
 s_nop 1
 v_cndmask_b32 v201,v251,v201,vcc
 s_lshl_b32 s57,s57,1
 s_add_u32 s57,s57,s58
 s_lshl_b32 s57,s57,2
 s_add_u32 s61,s57,196608
 s_lshr_b32 s62,s44,2
 s_lshl_b32 s62,s62,2
 s_add_u32 s62,s62,262144
 s_lshl_b32 s3,s47,11
 v_mov_b32 v250,s3
 v_cmp_eq_u32 vcc,0,v12
 s_nop 1
 v_cndmask_b32 v3,v251,v250,vcc
 s_lshl_b32 s3,s45,2
 s_add_u32 s57,s3,s46
 s_lshl_b32 s57,s57,11
 v_mov_b32 v250,s57
 v_cndmask_b32 v5,v251,v250,vcc
 v_add_u32 v250,4,v250
 v_cmp_eq_u32 vcc,1,v12
 s_nop 1
 v_cndmask_b32 v195,v3,v250,vcc
 v_add_lshl_u32 v250,v12,s3,11
 s_cmp_eq_u32 s46,0
 s_cselect_b32 s3,4,0
 v_cmp_gt_u32 vcc,s3,v12
 s_nop 1
 v_cndmask_b32 v4,v251,v250,vcc
 s_lshl_b32 s63,s47,12
 s_add_u32 s63,s63,1048576
 s_lshl_b32 s3,s45,8
 s_add_u32 s56,s63,s3
 s_mov_b32 s64,0x22222222
 s_mov_b32 s65,0x22222222
 s_mov_b32 s66,0x44444444
 s_mov_b32 s67,0x44444444
 s_mov_b32 s68,0x88888888
 s_mov_b32 s69,0x88888888
 v_bfe_u32 v250,v12,2,2
 v_cmp_eq_u32 vcc,v249,v250
 v_and_b32 v250,0xf0,v0
 s_nop 0
 v_cndmask_b32 v199,v251,v250,vcc
 s_lshl_b32 s3,s46,10
 s_add_u32 s3,s3,159744
 v_lshl_add_u32 v194,v249,4,s3
 v_lshl_add_u32 v200,v248,2,s3
 v_lshrrev_b32 v250,5,v12
 v_lshl_add_u32 v200,v250,6,v200
 v_lshrrev_b32 v250,5,v12
 v_and_b32 v251,1,v249
 v_lshl_add_u32 v202,v250,5,v13
 v_lshl_add_u32 v202,v251,2,v202
 v_lshlrev_b32 v202,4,v202
 v_and_b32 v203,8,v248
 v_add_u32 v203,v203,v248
 v_lshl_add_u32 v203,v251,5,v203
 v_lshl_add_u32 v203,v250,6,v203
 v_lshlrev_b32 v203,4,v203
 v_lshl_add_u32 v204,v250,5,v248
 v_lshl_add_u32 v204,v251,6,v204
 s_lshl_b32 s3,s46,12
 s_add_u32 s3,s3,131072
 v_lshl_add_u32 v204,v204,4,s3
 v_subrev_u32 v252,2048,v192
 v_subrev_u32 v253,2048,v193
 v_xor_b32 v252,512,v252
 v_xor_b32 v253,512,v253
 s_mul_i32 s3,s44,393216
 s_add_u32 m0,s51,131072
 s_nop 0
 buffer_load_dwordx4 v252,s[8:11],s3 offen lds
 buffer_load_dwordx4 v253,s[8:11],s3 offen offset:1024 lds
 s_add_u32 m0,s51,32768
 s_nop 0
 buffer_load_dwordx4 v188,s[4:7],s49 offen lds
 buffer_load_dwordx4 v189,s[4:7],s49 offen offset:1024 lds
 buffer_load_dwordx4 v190,s[4:7],s49 offen offset:2048 lds
 buffer_load_dwordx4 v191,s[4:7],s49 offen offset:3072 lds
 s_add_u32 m0,s51,36864
 s_nop 0
 buffer_load_dwordx4 v192,s[8:11],s50 offen lds
 buffer_load_dwordx4 v193,s[8:11],s50 offen offset:1024 lds
 buffer_load_dwordx4 v206,s[8:11],s50 offen offset:2048 lds
 buffer_load_dwordx4 v207,s[8:11],s50 offen offset:3072 lds
 s_add_u32 s49,s49,128
 s_and_b32 s49,s49,2047
 s_mul_i32 s50,s49,3072
 s_waitcnt vmcnt(11)
 s_barrier
 ds_read_b128 a[0:3],v184
 ds_read_b128 a[4:7],v184 offset:2048
 ds_read_b64_tr_b16 v[16:17],v176 offset:4096
 ds_read_b64_tr_b16 v[18:19],v176 offset:4608
 ds_read_b64_tr_b16 v[20:21],v177 offset:4096
 ds_read_b64_tr_b16 v[22:23],v177 offset:4608
 ds_read_b64_tr_b16 v[24:25],v178 offset:4096
 ds_read_b64_tr_b16 v[26:27],v178 offset:4608
 ds_read_b64_tr_b16 v[28:29],v179 offset:4096
 ds_read_b64_tr_b16 v[30:31],v179 offset:4608
 ds_read_b64_tr_b16 v[32:33],v176 offset:6144
 ds_read_b64_tr_b16 v[34:35],v176 offset:6656
 ds_read_b64_tr_b16 v[36:37],v177 offset:6144
 ds_read_b64_tr_b16 v[38:39],v177 offset:6656
 s_waitcnt lgkmcnt(8)
 v_mfma_f32_16x16x32_bf16 v[80:83],v[16:19],a[0:3],0
 s_add_u32 m0,s51,65536
 buffer_store_dword v6,v205,s[16:19],0 offen sc1
 v_mfma_f32_16x16x32_bf16 v[88:91],v[16:19],a[4:7],0
 buffer_load_dwordx4 v188,s[4:7],s49 offen lds
 v_mfma_f32_16x16x32_bf16 v[84:87],v[20:23],a[0:3],0
 ds_read_b64_tr_b16 v[40:41],v178 offset:6144
 ds_read_b64_tr_b16 v[42:43],v178 offset:6656
 v_mfma_f32_16x16x32_bf16 v[92:95],v[20:23],a[4:7],0
 s_waitcnt lgkmcnt(6)
 ds_read_b64_tr_b16 v[44:45],v179 offset:6144
 ds_read_b64_tr_b16 v[46:47],v179 offset:6656
 v_mfma_f32_16x16x32_bf16 v[96:99],v[24:27],a[0:3],0
 ds_read_b64_tr_b16 v[248:249],v196 offset:4096
 ds_read_b64_tr_b16 v[250:251],v196 offset:4608
 v_mfma_f32_16x16x32_bf16 v[104:107],v[24:27],a[4:7],0
 buffer_load_dwordx4 v189,s[4:7],s49 offen offset:1024 lds
 ds_read_b128 a[8:11],v185
 v_mfma_f32_16x16x32_bf16 v[100:103],v[28:31],a[0:3],0
 ds_read_b128 a[12:15],v185 offset:2048
 ds_read_b64_tr_b16 v[48:49],v176 offset:20480
 v_mfma_f32_16x16x32_bf16 v[108:111],v[28:31],a[4:7],0
 ds_read_b64_tr_b16 v[50:51],v176 offset:20992
 ds_read_b64_tr_b16 v[52:53],v177 offset:20480
 ds_read_b64_tr_b16 v[54:55],v177 offset:20992
 v_mfma_f32_16x16x32_bf16 v[144:147],v[8:11],a[0:3],0
 s_waitcnt lgkmcnt(12)
 v_mfma_f32_16x16x32_bf16 v[112:115],a[0:3],v[32:35],0
 buffer_load_dwordx4 v190,s[4:7],s49 offen offset:2048 lds
 v_mfma_f32_16x16x32_bf16 v[116:119],a[4:7],v[32:35],0
 v_mfma_f32_16x16x32_bf16 v[148:151],a[0:3],a[0:3],0
 v_mfma_f32_16x16x32_bf16 v[120:123],a[0:3],v[36:39],0
 v_mfma_f32_16x16x32_bf16 v[152:155],v[8:11],a[4:7],0
 v_mfma_f32_16x16x32_bf16 v[124:127],a[4:7],v[36:39],0
 s_waitcnt lgkmcnt(8)
 ds_read_b64_tr_b16 v[56:57],v178 offset:20480
 ds_read_b64_tr_b16 v[58:59],v178 offset:20992
 ds_read_b64_tr_b16 v[60:61],v179 offset:20480
 ds_read_b64_tr_b16 v[62:63],v179 offset:20992
 v_mfma_f32_16x16x32_bf16 v[128:131],a[0:3],v[40:43],0
 buffer_load_dwordx4 v191,s[4:7],s49 offen offset:3072 lds
 v_mfma_f32_16x16x32_bf16 v[156:159],a[4:7],a[4:7],0
 v_mfma_f32_16x16x32_bf16 v[132:135],a[4:7],v[40:43],0
 s_waitcnt lgkmcnt(9)
 v_mfma_f32_16x16x32_bf16 v[144:147],v[8:11],a[8:11],v[144:147]
 v_mfma_f32_16x16x32_bf16 v[136:139],a[0:3],v[44:47],0
 s_add_u32 m0,s51,69632
 ds_read_b64_tr_b16 v[64:65],v176 offset:22528
 ds_read_b64_tr_b16 v[66:67],v176 offset:23040
 v_mfma_f32_16x16x32_bf16 v[140:143],a[4:7],v[44:47],0
 ds_read_b64_tr_b16 v[68:69],v177 offset:22528
 ds_read_b64_tr_b16 v[70:71],v177 offset:23040
 ds_read_b64_tr_b16 v[72:73],v178 offset:22528
 ds_read_b64_tr_b16 v[74:75],v178 offset:23040
 ds_read_b64_tr_b16 v[76:77],v179 offset:22528
 ds_read_b64_tr_b16 v[78:79],v179 offset:23040
 v_mfma_f32_16x16x32_bf16 v[148:151],a[8:11],a[8:11],v[148:151]
 s_waitcnt lgkmcnt(12)
 v_mfma_f32_16x16x32_bf16 v[80:83],v[48:51],a[8:11],v[80:83]
 buffer_load_dwordx4 v192,s[8:11],s50 offen lds
 v_mfma_f32_16x16x32_bf16 v[244:247],v[8:11],v[248:251],0
 v_mfma_f32_16x16x32_bf16 v[152:155],v[8:11],a[12:15],v[152:155]
 v_mfma_f32_16x16x32_bf16 v[88:91],v[48:51],a[12:15],v[88:91]
 v_mfma_f32_16x16x32_bf16 v[156:159],a[12:15],a[12:15],v[156:159]
 v_mfma_f32_16x16x32_bf16 v[84:87],v[52:55],a[8:11],v[84:87]
 s_add_u32 s49,s49,128
 buffer_load_dwordx4 v193,s[8:11],s50 offen offset:1024 lds
 v_mfma_f32_16x16x32_bf16 v[92:95],v[52:55],a[12:15],v[92:95]
 s_waitcnt lgkmcnt(8)
 v_cndmask_b32 v145,v148,v149,s[64:65]
 v_cndmask_b32 v145,v145,v150,s[66:67]
 v_mfma_f32_16x16x32_bf16 v[96:99],v[56:59],a[8:11],v[96:99]
 s_and_b32 s49,s49,2047
 v_cndmask_b32 v145,v145,v151,s[68:69]
 v_mov_b32 v146,v152
 v_mfma_f32_16x16x32_bf16 v[104:107],v[56:59],a[12:15],v[104:107]
 v_cndmask_b32 v147,v156,v157,s[64:65]
 v_cndmask_b32 v147,v147,v158,s[66:67]
 v_mfma_f32_16x16x32_bf16 v[100:103],v[60:63],a[8:11],v[100:103]
 buffer_load_dwordx4 v206,s[8:11],s50 offen offset:2048 lds
 s_cmp_eq_u32 s46,0
 s_cbranch_scc1 .Lvs0_0
 s_cmp_eq_u32 s46,1
 s_cbranch_scc1 .Lvs0_1
 s_cmp_eq_u32 s46,2
 s_cbranch_scc1 .Lvs0_2
 s_branch .Lvs0_3
.p2align 12
.Lvb0:
 v_mfma_f32_16x16x32_bf16 v[108:111],v[60:63],a[12:15],v[108:111]
 s_waitcnt vmcnt(8) lgkmcnt(0)
 s_barrier
 ds_read_b128 a[16:19],v184 offset:32768
 ds_read_b128 a[20:23],v184 offset:34816
 ds_read_b64_tr_b16 v[16:17],v176 offset:36864
 ds_read_b64_tr_b16 v[18:19],v176 offset:37376
 ds_read_b64_tr_b16 v[20:21],v177 offset:36864
 ds_read_b64_tr_b16 v[22:23],v177 offset:37376
 v_mfma_f32_16x16x32_bf16 v[112:115],a[8:11],v[64:67],v[112:115]
 buffer_load_dwordx4 v207,s[8:11],s50 offen offset:3072 lds
 v_mfma_f32_16x16x32_bf16 v[116:119],a[12:15],v[64:67],v[116:119]
 s_add_u32 m0,s51,98304
 v_cndmask_b32 v147,v147,v159,s[68:69]
 ds_read_b64_tr_b16 v[24:25],v178 offset:36864
 v_mfma_f32_16x16x32_bf16 v[120:123],a[8:11],v[68:71],v[120:123]
 s_mul_i32 s50,s49,3072
 ds_read_b64_tr_b16 v[26:27],v178 offset:37376
 ds_read_b64_tr_b16 v[28:29],v179 offset:36864
 v_mfma_f32_16x16x32_bf16 v[124:127],a[12:15],v[68:71],v[124:127]
 ds_read_b64_tr_b16 v[30:31],v179 offset:37376
 ds_read_b64_tr_b16 v[32:33],v176 offset:38912
 v_mfma_f32_16x16x32_bf16 v[128:131],a[8:11],v[72:75],v[128:131]
 buffer_load_dwordx4 v188,s[4:7],s49 offen lds
 v_mfma_f32_16x16x32_bf16 v[132:135],a[12:15],v[72:75],v[132:135]
 buffer_store_dwordx4 v[144:147],v199,s[12:15],s56 offen sc1
 v_mfma_f32_16x16x32_bf16 v[136:139],a[8:11],v[76:79],v[136:139]
 ds_read_b64_tr_b16 v[34:35],v176 offset:39424
 ds_read_b64_tr_b16 v[36:37],v177 offset:38912
 v_mfma_f32_16x16x32_bf16 v[140:143],a[12:15],v[76:79],v[140:143]
 s_waitcnt lgkmcnt(7)
 ds_read_b64_tr_b16 v[38:39],v177 offset:39424
 ds_read_b64_tr_b16 v[40:41],v178 offset:38912
 v_mfma_f32_16x16x32_bf16 v[80:83],v[16:19],a[16:19],v[80:83]
 buffer_load_dwordx4 v189,s[4:7],s49 offen offset:1024 lds
 v_mfma_f32_16x16x32_bf16 v[88:91],v[16:19],a[20:23],v[88:91]
 ds_read_b64_tr_b16 v[42:43],v178 offset:39424
 ds_read_b64_tr_b16 v[44:45],v179 offset:38912
 v_mfma_f32_16x16x32_bf16 v[84:87],v[20:23],a[16:19],v[84:87]
 ds_read_b64_tr_b16 v[46:47],v179 offset:39424
 ds_read_b64_tr_b16 v[248:249],v196 offset:36864
 v_mfma_f32_16x16x32_bf16 v[92:95],v[20:23],a[20:23],v[92:95]
 s_waitcnt lgkmcnt(9)
 ds_read_b64_tr_b16 v[250:251],v196 offset:37376
 ds_read_b128 a[24:27],v185 offset:32768
 v_mfma_f32_16x16x32_bf16 v[96:99],v[24:27],a[16:19],v[96:99]
 buffer_load_dwordx4 v190,s[4:7],s49 offen offset:2048 lds
 v_mfma_f32_16x16x32_bf16 v[104:107],v[24:27],a[20:23],v[104:107]
 ds_read_b64_tr_b16 v[232:233],v198
 ds_read_b64_tr_b16 v[234:235],v198 offset:512
 v_mfma_f32_16x16x32_bf16 v[100:103],v[28:31],a[16:19],v[100:103]
 ds_read_b128 a[28:31],v185 offset:34816
 ds_read_b64_tr_b16 v[48:49],v176 offset:53248
 v_mfma_f32_16x16x32_bf16 v[108:111],v[28:31],a[20:23],v[108:111]
 s_waitcnt lgkmcnt(11)
 ds_read_b64_tr_b16 v[50:51],v176 offset:53760
 ds_read_b64_tr_b16 v[52:53],v177 offset:53248
 ds_read_b64_tr_b16 v[54:55],v177 offset:53760
 v_mfma_f32_16x16x32_bf16 v[112:115],a[16:19],v[32:35],v[112:115]
 buffer_load_dwordx4 v191,s[4:7],s49 offen offset:3072 lds
 v_mfma_f32_16x16x32_bf16 v[116:119],a[20:23],v[32:35],v[116:119]
 s_add_u32 m0,s51,102400
 buffer_load_dword v7,off,s[16:19],0 sc1
 v_mfma_f32_16x16x32_bf16 v[120:123],a[16:19],v[36:39],v[120:123]
 s_add_u32 s49,s49,128
 ds_read_b64_tr_b16 v[56:57],v178 offset:53248
 ds_read_b64_tr_b16 v[58:59],v178 offset:53760
 v_mfma_f32_16x16x32_bf16 v[124:127],a[20:23],v[36:39],v[124:127]
 s_waitcnt lgkmcnt(12)
 ds_read_b64_tr_b16 v[60:61],v179 offset:53248
 ds_read_b64_tr_b16 v[62:63],v179 offset:53760
 v_mfma_f32_16x16x32_bf16 v[128:131],a[16:19],v[40:43],v[128:131]
 s_and_b32 s49,s49,2047
 buffer_load_dwordx4 v192,s[8:11],s50 offen lds
 v_mfma_f32_16x16x32_bf16 v[132:135],a[20:23],v[40:43],v[132:135]
 buffer_load_dwordx4 v193,s[8:11],s50 offen offset:1024 lds
 v_mfma_f32_16x16x32_bf16 v[136:139],a[16:19],v[44:47],v[136:139]
 s_waitcnt lgkmcnt(9)
 v_mfma_f32_16x16x32_bf16 v[236:239],v[8:11],v[232:235],0
 v_mfma_f32_16x16x32_bf16 v[140:143],a[20:23],v[44:47],v[140:143]
 s_waitcnt lgkmcnt(4)
 ds_read_b64_tr_b16 v[64:65],v176 offset:55296
 ds_read_b64_tr_b16 v[66:67],v176 offset:55808
 ds_read_b64_tr_b16 v[68:69],v177 offset:55296
 ds_read_b64_tr_b16 v[70:71],v177 offset:55808
 ds_read_b64_tr_b16 v[72:73],v178 offset:55296
 ds_read_b64_tr_b16 v[74:75],v178 offset:55808
 ds_read_b64_tr_b16 v[76:77],v179 offset:55296
 ds_read_b64_tr_b16 v[78:79],v179 offset:55808
 v_mfma_f32_16x16x32_bf16 v[80:83],v[48:51],a[24:27],v[80:83]
 ds_read_b64_tr_b16 v[232:233],v198 offset:16384
 ds_read_b64_tr_b16 v[234:235],v198 offset:16896
 v_mfma_f32_16x16x32_bf16 v[244:247],v[8:11],v[248:251],v[244:247]
 v_mfma_f32_16x16x32_bf16 v[88:91],v[48:51],a[28:31],v[88:91]
 buffer_load_dwordx4 v206,s[8:11],s50 offen offset:2048 lds
 v_mfma_f32_16x16x32_bf16 v[84:87],v[52:55],a[24:27],v[84:87]
 v_mfma_f32_16x16x32_bf16 v[92:95],v[52:55],a[28:31],v[92:95]
 s_waitcnt lgkmcnt(10)
 v_mfma_f32_16x16x32_bf16 v[96:99],v[56:59],a[24:27],v[96:99]
 buffer_load_dwordx4 v207,s[8:11],s50 offen offset:3072 lds
 v_mfma_f32_16x16x32_bf16 v[104:107],v[56:59],a[28:31],v[104:107]
 s_add_u32 m0,s51,0
 s_mul_i32 s50,s49,3072
 v_mfma_f32_16x16x32_bf16 v[100:103],v[60:63],a[24:27],v[100:103]
 v_mfma_f32_16x16x32_bf16 v[108:111],v[60:63],a[28:31],v[108:111]
 s_waitcnt vmcnt(10) lgkmcnt(2)
 s_barrier
 ds_read_b128 a[32:35],v186
 ds_read_b128 a[36:39],v186 offset:2048
 ds_read_b64_tr_b16 v[16:17],v180 offset:4096
 ds_read_b64_tr_b16 v[18:19],v180 offset:4608
 ds_read_b64_tr_b16 v[20:21],v181 offset:4096
 ds_read_b64_tr_b16 v[22:23],v181 offset:4608
 v_mfma_f32_16x16x32_bf16 v[112:115],a[24:27],v[64:67],v[112:115]
 s_waitcnt lgkmcnt(6)
 v_mfma_f32_16x16x32_bf16 v[236:239],v[8:11],v[232:235],v[236:239]
 v_mfma_f32_16x16x32_bf16 v[116:119],a[28:31],v[64:67],v[116:119]
 buffer_load_dwordx4 v188,s[4:7],s49 offen lds
 v_mfma_f32_16x16x32_bf16 v[120:123],a[24:27],v[68:71],v[120:123]
 ds_read_b64_tr_b16 v[24:25],v182 offset:4096
 ds_read_b64_tr_b16 v[26:27],v182 offset:4608
 v_mfma_f32_16x16x32_bf16 v[124:127],a[28:31],v[68:71],v[124:127]
 ds_read_b64_tr_b16 v[28:29],v183 offset:4096
 ds_read_b64_tr_b16 v[30:31],v183 offset:4608
 v_mfma_f32_16x16x32_bf16 v[128:131],a[24:27],v[72:75],v[128:131]
 buffer_load_dwordx4 v189,s[4:7],s49 offen offset:1024 lds
 v_mfma_f32_16x16x32_bf16 v[132:135],a[28:31],v[72:75],v[132:135]
 v_cvt_pk_bf16_f32 v237,v236,v236
 v_and_b32 v238,0xffff0000,v237
 v_mfma_f32_16x16x32_bf16 v[136:139],a[24:27],v[76:79],v[136:139]
 v_sub_f32 v238,v236,v238
 ds_read_b64_tr_b16 v[32:33],v180 offset:6144
 v_mfma_f32_16x16x32_bf16 v[140:143],a[28:31],v[76:79],v[140:143]
 s_waitcnt lgkmcnt(5)
 ds_read_b64_tr_b16 v[34:35],v180 offset:6656
 ds_read_b64_tr_b16 v[36:37],v181 offset:6144
 ds_read_b64_tr_b16 v[38:39],v181 offset:6656
 v_mfma_f32_16x16x32_bf16 v[80:83],v[16:19],a[32:35],v[80:83]
 v_cvt_pk_bf16_f32 v237,v236,v238
 ds_read_b64_tr_b16 v[40:41],v182 offset:6144
 v_mfma_f32_16x16x32_bf16 v[88:91],v[16:19],a[36:39],v[88:91]
 buffer_load_dwordx4 v190,s[4:7],s49 offen offset:2048 lds
 v_mfma_f32_16x16x32_bf16 v[84:87],v[20:23],a[32:35],v[84:87]
 buffer_store_dword v237,v201,s[12:15],s62 offen sc1
 v_mfma_f32_16x16x32_bf16 v[92:95],v[20:23],a[36:39],v[92:95]
 s_waitcnt lgkmcnt(5)
 ds_read_b64_tr_b16 v[42:43],v182 offset:6656
 ds_read_b64_tr_b16 v[44:45],v183 offset:6144
 ds_read_b64_tr_b16 v[46:47],v183 offset:6656
 v_mfma_f32_16x16x32_bf16 v[96:99],v[24:27],a[32:35],v[96:99]
 buffer_load_dwordx4 v191,s[4:7],s49 offen offset:3072 lds
 ds_read_b64_tr_b16 v[248:249],v197 offset:4096
 ds_read_b64_tr_b16 v[250:251],v197 offset:4608
 v_mfma_f32_16x16x32_bf16 v[104:107],v[24:27],a[36:39],v[104:107]
 s_add_u32 m0,s51,4096
 ds_read_b128 a[40:43],v187
 ds_read_b128 a[44:47],v187 offset:2048
 v_mfma_f32_16x16x32_bf16 v[100:103],v[28:31],a[32:35],v[100:103]
 s_add_u32 s49,s49,128
 ds_read_b64_tr_b16 v[48:49],v180 offset:20480
 ds_read_b64_tr_b16 v[50:51],v180 offset:20992
 v_mfma_f32_16x16x32_bf16 v[108:111],v[28:31],a[36:39],v[108:111]
 s_waitcnt lgkmcnt(10)
 ds_read_b64_tr_b16 v[52:53],v181 offset:20480
 ds_read_b64_tr_b16 v[54:55],v181 offset:20992
 v_mfma_f32_16x16x32_bf16 v[112:115],a[32:35],v[32:35],v[112:115]
 s_waitcnt vmcnt(9)
 buffer_load_dwordx4 v192,s[8:11],s50 offen lds
 v_readfirstlane_b32 s59,v7
 s_nop 0
 s_cmp_ge_u32 s59,1
 s_cbranch_scc0 .Lseq_slow_2
.Lseq_back_3:
 buffer_atomic_add v6,v3,s[12:15],0 offen sc1
 v_mfma_f32_16x16x32_bf16 v[116:119],a[36:39],v[32:35],v[116:119]
 s_and_b32 s49,s49,2047
 buffer_load_dwordx4 v193,s[8:11],s50 offen offset:1024 lds
 v_mfma_f32_16x16x32_bf16 v[120:123],a[32:35],v[36:39],v[120:123]
 ds_read_b64_tr_b16 v[56:57],v182 offset:20480
 ds_read_b64_tr_b16 v[58:59],v182 offset:20992
 v_mfma_f32_16x16x32_bf16 v[124:127],a[36:39],v[36:39],v[124:127]
 s_waitcnt lgkmcnt(10)
 ds_read_b64_tr_b16 v[60:61],v183 offset:20480
 ds_read_b64_tr_b16 v[62:63],v183 offset:20992
 v_mfma_f32_16x16x32_bf16 v[128:131],a[32:35],v[40:43],v[128:131]
 ds_read_b64_tr_b16 v[64:65],v180 offset:22528
 ds_read_b64_tr_b16 v[66:67],v180 offset:23040
 v_mfma_f32_16x16x32_bf16 v[132:135],a[36:39],v[40:43],v[132:135]
 buffer_load_dwordx4 v206,s[8:11],s50 offen offset:2048 lds
 v_mfma_f32_16x16x32_bf16 v[136:139],a[32:35],v[44:47],v[136:139]
 ds_read_b64_tr_b16 v[68:69],v181 offset:22528
 ds_read_b64_tr_b16 v[70:71],v181 offset:23040
 v_mfma_f32_16x16x32_bf16 v[140:143],a[36:39],v[44:47],v[140:143]
 s_waitcnt lgkmcnt(8)
 ds_read_b64_tr_b16 v[72:73],v182 offset:22528
 ds_read_b64_tr_b16 v[74:75],v182 offset:23040
 ds_read_b64_tr_b16 v[76:77],v183 offset:22528
 ds_read_b64_tr_b16 v[78:79],v183 offset:23040
 v_mfma_f32_16x16x32_bf16 v[80:83],v[48:51],a[40:43],v[80:83]
 v_mfma_f32_16x16x32_bf16 v[244:247],v[8:11],v[248:251],v[244:247]
 v_mfma_f32_16x16x32_bf16 v[88:91],v[48:51],a[44:47],v[88:91]
 buffer_load_dwordx4 v207,s[8:11],s50 offen offset:3072 lds
 v_mfma_f32_16x16x32_bf16 v[84:87],v[52:55],a[40:43],v[84:87]
 s_add_u32 m0,s51,32768
 s_mul_i32 s50,s49,3072
 v_mfma_f32_16x16x32_bf16 v[92:95],v[52:55],a[44:47],v[92:95]
 s_waitcnt lgkmcnt(8)
 v_mfma_f32_16x16x32_bf16 v[96:99],v[56:59],a[40:43],v[96:99]
 buffer_load_dwordx4 v188,s[4:7],s49 offen lds
 v_mfma_f32_16x16x32_bf16 v[104:107],v[56:59],a[44:47],v[104:107]
 v_mfma_f32_16x16x32_bf16 v[100:103],v[60:63],a[40:43],v[100:103]
 s_cmp_eq_u32 s46,0
 s_cbranch_scc1 .Lvs1_0
 s_cmp_eq_u32 s46,1
 s_cbranch_scc1 .Lvs1_1
 s_cmp_eq_u32 s46,2
 s_cbranch_scc1 .Lvs1_2
 s_branch .Lvs1_3
.Lvb1:
 v_mfma_f32_16x16x32_bf16 v[108:111],v[60:63],a[44:47],v[108:111]
 s_waitcnt vmcnt(11) lgkmcnt(0)
 s_barrier
 ds_read_b128 a[48:51],v186 offset:32768
 ds_read_b128 a[52:55],v186 offset:34816
 ds_read_b64_tr_b16 v[16:17],v180 offset:36864
 ds_read_b64_tr_b16 v[18:19],v180 offset:37376
 ds_read_b64_tr_b16 v[20:21],v181 offset:36864
 ds_read_b64_tr_b16 v[22:23],v181 offset:37376
 v_mfma_f32_16x16x32_bf16 v[112:115],a[40:43],v[64:67],v[112:115]
 buffer_load_dwordx4 v189,s[4:7],s49 offen offset:1024 lds
 v_mfma_f32_16x16x32_bf16 v[116:119],a[44:47],v[64:67],v[116:119]
 ds_read_b64_tr_b16 v[24:25],v182 offset:36864
 ds_read_b64_tr_b16 v[26:27],v182 offset:37376
 v_mfma_f32_16x16x32_bf16 v[120:123],a[40:43],v[68:71],v[120:123]
 ds_read_b64_tr_b16 v[28:29],v183 offset:36864
 ds_read_b64_tr_b16 v[30:31],v183 offset:37376
 v_mfma_f32_16x16x32_bf16 v[124:127],a[44:47],v[68:71],v[124:127]
 buffer_load_dwordx4 v190,s[4:7],s49 offen offset:2048 lds
 v_mfma_f32_16x16x32_bf16 v[128:131],a[40:43],v[72:75],v[128:131]
 ds_read_b64_tr_b16 v[32:33],v180 offset:38912
 ds_read_b64_tr_b16 v[34:35],v180 offset:39424
 v_mfma_f32_16x16x32_bf16 v[132:135],a[44:47],v[72:75],v[132:135]
 ds_read_b64_tr_b16 v[36:37],v181 offset:38912
 ds_read_b64_tr_b16 v[38:39],v181 offset:39424
 v_mfma_f32_16x16x32_bf16 v[136:139],a[40:43],v[76:79],v[136:139]
 buffer_load_dwordx4 v191,s[4:7],s49 offen offset:3072 lds
 v_mfma_f32_16x16x32_bf16 v[140:143],a[44:47],v[76:79],v[140:143]
 s_waitcnt lgkmcnt(8)
 ds_read_b64_tr_b16 v[40:41],v182 offset:38912
 ds_read_b64_tr_b16 v[42:43],v182 offset:39424
 v_mfma_f32_16x16x32_bf16 v[80:83],v[16:19],a[48:51],v[80:83]
 s_add_u32 m0,s51,36864
 ds_read_b64_tr_b16 v[44:45],v183 offset:38912
 ds_read_b64_tr_b16 v[46:47],v183 offset:39424
 v_mfma_f32_16x16x32_bf16 v[88:91],v[16:19],a[52:55],v[88:91]
 s_add_u32 s49,s49,128
 ds_read_b64_tr_b16 v[248:249],v197 offset:36864
 ds_read_b64_tr_b16 v[250:251],v197 offset:37376
 v_mfma_f32_16x16x32_bf16 v[84:87],v[20:23],a[48:51],v[84:87]
 s_and_b32 s49,s49,2047
 buffer_load_dwordx4 v192,s[8:11],s50 offen lds
 v_mfma_f32_16x16x32_bf16 v[92:95],v[20:23],a[52:55],v[92:95]
 s_waitcnt lgkmcnt(10)
 ds_read_b128 a[56:59],v187 offset:32768
 ds_read_b128 a[60:63],v187 offset:34816
 v_mfma_f32_16x16x32_bf16 v[96:99],v[24:27],a[48:51],v[96:99]
 ds_read_b64_tr_b16 v[48:49],v180 offset:53248
 ds_read_b64_tr_b16 v[50:51],v180 offset:53760
 v_mfma_f32_16x16x32_bf16 v[104:107],v[24:27],a[52:55],v[104:107]
 buffer_load_dwordx4 v193,s[8:11],s50 offen offset:1024 lds
 v_mfma_f32_16x16x32_bf16 v[100:103],v[28:31],a[48:51],v[100:103]
 ds_read_b64_tr_b16 v[52:53],v181 offset:53248
 ds_read_b64_tr_b16 v[54:55],v181 offset:53760
 v_mfma_f32_16x16x32_bf16 v[108:111],v[28:31],a[52:55],v[108:111]
 s_waitcnt lgkmcnt(12)
 ds_read_b64_tr_b16 v[56:57],v182 offset:53248
 ds_read_b64_tr_b16 v[58:59],v182 offset:53760
 v_mfma_f32_16x16x32_bf16 v[112:115],a[48:51],v[32:35],v[112:115]
 ds_read_b64_tr_b16 v[60:61],v183 offset:53248
 ds_read_b64_tr_b16 v[62:63],v183 offset:53760
 v_mfma_f32_16x16x32_bf16 v[116:119],a[52:55],v[32:35],v[116:119]
 buffer_load_dwordx4 v206,s[8:11],s50 offen offset:2048 lds
 v_mfma_f32_16x16x32_bf16 v[120:123],a[48:51],v[36:39],v[120:123]
 ds_read_b64_tr_b16 v[64:65],v180 offset:55296
 ds_read_b64_tr_b16 v[66:67],v180 offset:55808
 v_mfma_f32_16x16x32_bf16 v[124:127],a[52:55],v[36:39],v[124:127]
 s_waitcnt lgkmcnt(14)
 ds_read_b64_tr_b16 v[68:69],v181 offset:55296
 ds_read_b64_tr_b16 v[70:71],v181 offset:55808
 v_mfma_f32_16x16x32_bf16 v[128:131],a[48:51],v[40:43],v[128:131]
 buffer_load_dwordx4 v207,s[8:11],s50 offen offset:3072 lds
 v_mfma_f32_16x16x32_bf16 v[132:135],a[52:55],v[40:43],v[132:135]
 s_add_u32 m0,s51,65536
 ds_read_b64_tr_b16 v[72:73],v182 offset:55296
 ds_read_b64_tr_b16 v[74:75],v182 offset:55808
 v_mfma_f32_16x16x32_bf16 v[136:139],a[48:51],v[44:47],v[136:139]
 s_mul_i32 s50,s49,3072
 ds_read_b64_tr_b16 v[76:77],v183 offset:55296
 ds_read_b64_tr_b16 v[78:79],v183 offset:55808
 v_mfma_f32_16x16x32_bf16 v[140:143],a[52:55],v[44:47],v[140:143]
 s_waitcnt lgkmcnt(12)
 v_mfma_f32_16x16x32_bf16 v[80:83],v[48:51],a[56:59],v[80:83]
 v_mfma_f32_16x16x32_bf16 v[244:247],v[8:11],v[248:251],v[244:247]
 v_mfma_f32_16x16x32_bf16 v[88:91],v[48:51],a[60:63],v[88:91]
 buffer_load_dwordx4 v188,s[4:7],s49 offen lds
 v_mfma_f32_16x16x32_bf16 v[84:87],v[52:55],a[56:59],v[84:87]
 v_mfma_f32_16x16x32_bf16 v[92:95],v[52:55],a[60:63],v[92:95]
 s_waitcnt lgkmcnt(8)
 buffer_load_dwordx4 v189,s[4:7],s49 offen offset:1024 lds
 v_mfma_f32_16x16x32_bf16 v[96:99],v[56:59],a[56:59],v[96:99]
 s_nop 0
 v_cvt_pk_bf16_f32 v245,v244,v244
 v_and_b32 v246,0xffff0000,v245
 v_mfma_f32_16x16x32_bf16 v[104:107],v[56:59],a[60:63],v[104:107]
 v_sub_f32 v246,v244,v246
 v_cvt_pk_bf16_f32 v245,v244,v246
 v_mfma_f32_16x16x32_bf16 v[100:103],v[60:63],a[56:59],v[100:103]
 s_waitcnt vmcnt(10) lgkmcnt(0)
 s_barrier
 ds_read_b128 a[64:67],v184
 ds_read_b128 a[68:71],v184 offset:2048
 v_mfma_f32_16x16x32_bf16 v[108:111],v[60:63],a[60:63],v[108:111]
 ds_read_b64_tr_b16 v[16:17],v176 offset:4096
 ds_read_b64_tr_b16 v[18:19],v176 offset:4608
 ds_read_b64_tr_b16 v[20:21],v177 offset:4096
 ds_read_b64_tr_b16 v[22:23],v177 offset:4608
 v_mfma_f32_16x16x32_bf16 v[112:115],a[56:59],v[64:67],v[112:115]
 buffer_load_dwordx4 v190,s[4:7],s49 offen offset:2048 lds
 v_mfma_f32_16x16x32_bf16 v[116:119],a[60:63],v[64:67],v[116:119]
 ds_read_b64_tr_b16 v[24:25],v178 offset:4096
 ds_read_b64_tr_b16 v[26:27],v178 offset:4608
 v_mfma_f32_16x16x32_bf16 v[120:123],a[56:59],v[68:71],v[120:123]
 ds_read_b64_tr_b16 v[28:29],v179 offset:4096
 ds_read_b64_tr_b16 v[30:31],v179 offset:4608
 v_mfma_f32_16x16x32_bf16 v[124:127],a[60:63],v[68:71],v[124:127]
 buffer_load_dwordx4 v191,s[4:7],s49 offen offset:3072 lds
 v_mfma_f32_16x16x32_bf16 v[128:131],a[56:59],v[72:75],v[128:131]
 s_add_u32 m0,s51,69632
 buffer_store_dword v245,v201,s[12:15],s61 offen sc1
 v_mfma_f32_16x16x32_bf16 v[132:135],a[60:63],v[72:75],v[132:135]
 s_add_u32 s49,s49,128
 ds_read_b64_tr_b16 v[32:33],v176 offset:6144
 ds_read_b64_tr_b16 v[34:35],v176 offset:6656
 v_mfma_f32_16x16x32_bf16 v[136:139],a[56:59],v[76:79],v[136:139]
 s_and_b32 s49,s49,2047
 ds_read_b64_tr_b16 v[36:37],v177 offset:6144
 ds_read_b64_tr_b16 v[38:39],v177 offset:6656
 v_mfma_f32_16x16x32_bf16 v[140:143],a[60:63],v[76:79],v[140:143]
 s_waitcnt lgkmcnt(8)
 buffer_load_dwordx4 v192,s[8:11],s50 offen lds
 v_mfma_f32_16x16x32_bf16 v[80:83],v[16:19],a[64:67],v[80:83]
 ds_read_b64_tr_b16 v[40:41],v178 offset:6144
 ds_read_b64_tr_b16 v[42:43],v178 offset:6656
 v_mfma_f32_16x16x32_bf16 v[88:91],v[16:19],a[68:71],v[88:91]
 buffer_load_dwordx4 v193,s[8:11],s50 offen offset:1024 lds
 v_mfma_f32_16x16x32_bf16 v[84:87],v[20:23],a[64:67],v[84:87]
 ds_read_b64_tr_b16 v[44:45],v179 offset:6144
 ds_read_b64_tr_b16 v[46:47],v179 offset:6656
 v_mfma_f32_16x16x32_bf16 v[92:95],v[20:23],a[68:71],v[92:95]
 s_waitcnt lgkmcnt(8)
 ds_read_b128 a[72:75],v185
 ds_read_b128 a[76:79],v185 offset:2048
 v_mfma_f32_16x16x32_bf16 v[96:99],v[24:27],a[64:67],v[96:99]
 ds_read_b64_tr_b16 v[48:49],v176 offset:20480
 ds_read_b64_tr_b16 v[50:51],v176 offset:20992
 v_mfma_f32_16x16x32_bf16 v[104:107],v[24:27],a[68:71],v[104:107]
 buffer_load_dwordx4 v206,s[8:11],s50 offen offset:2048 lds
 v_mfma_f32_16x16x32_bf16 v[100:103],v[28:31],a[64:67],v[100:103]
 ds_read_b64_tr_b16 v[52:53],v177 offset:20480
 ds_read_b64_tr_b16 v[54:55],v177 offset:20992
 v_mfma_f32_16x16x32_bf16 v[108:111],v[28:31],a[68:71],v[108:111]
 s_waitcnt lgkmcnt(10)
 ds_read_b64_tr_b16 v[56:57],v178 offset:20480
 ds_read_b64_tr_b16 v[58:59],v178 offset:20992
 v_mfma_f32_16x16x32_bf16 v[112:115],a[64:67],v[32:35],v[112:115]
 buffer_load_dwordx4 v207,s[8:11],s50 offen offset:3072 lds
 v_mfma_f32_16x16x32_bf16 v[116:119],a[68:71],v[32:35],v[116:119]
 s_add_u32 m0,s51,98304
 ds_read_b64_tr_b16 v[60:61],v179 offset:20480
 ds_read_b64_tr_b16 v[62:63],v179 offset:20992
 v_mfma_f32_16x16x32_bf16 v[120:123],a[64:67],v[36:39],v[120:123]
 s_mul_i32 s50,s49,3072
 ds_read_b64_tr_b16 v[64:65],v176 offset:22528
 ds_read_b64_tr_b16 v[66:67],v176 offset:23040
 v_mfma_f32_16x16x32_bf16 v[124:127],a[68:71],v[36:39],v[124:127]
 s_waitcnt lgkmcnt(12)
 ds_read_b64_tr_b16 v[68:69],v177 offset:22528
 ds_read_b64_tr_b16 v[70:71],v177 offset:23040
 v_mfma_f32_16x16x32_bf16 v[128:131],a[64:67],v[40:43],v[128:131]
 buffer_load_dwordx4 v188,s[4:7],s49 offen lds
 v_mfma_f32_16x16x32_bf16 v[132:135],a[68:71],v[40:43],v[132:135]
 ds_read_b64_tr_b16 v[72:73],v178 offset:22528
 ds_read_b64_tr_b16 v[74:75],v178 offset:23040
 v_mfma_f32_16x16x32_bf16 v[136:139],a[64:67],v[44:47],v[136:139]
 ds_read_b64_tr_b16 v[76:77],v179 offset:22528
 ds_read_b64_tr_b16 v[78:79],v179 offset:23040
 v_mfma_f32_16x16x32_bf16 v[140:143],a[68:71],v[44:47],v[140:143]
 s_waitcnt lgkmcnt(12)
 buffer_load_dwordx4 v189,s[4:7],s49 offen offset:1024 lds
 v_mfma_f32_16x16x32_bf16 v[80:83],v[48:51],a[72:75],v[80:83]
 v_mfma_f32_16x16x32_bf16 v[88:91],v[48:51],a[76:79],v[88:91]
 v_mfma_f32_16x16x32_bf16 v[84:87],v[52:55],a[72:75],v[84:87]
 v_mfma_f32_16x16x32_bf16 v[92:95],v[52:55],a[76:79],v[92:95]
 s_waitcnt lgkmcnt(8)
 buffer_load_dwordx4 v190,s[4:7],s49 offen offset:2048 lds
 v_mfma_f32_16x16x32_bf16 v[96:99],v[56:59],a[72:75],v[96:99]
 v_mfma_f32_16x16x32_bf16 v[104:107],v[56:59],a[76:79],v[104:107]
 v_mfma_f32_16x16x32_bf16 v[100:103],v[60:63],a[72:75],v[100:103]
 s_waitcnt vmcnt(12) lgkmcnt(0)
 s_barrier
 ds_read_b128 a[80:83],v184 offset:32768
 ds_read_b128 a[84:87],v184 offset:34816
 v_mfma_f32_16x16x32_bf16 v[108:111],v[60:63],a[76:79],v[108:111]
 ds_read_b64_tr_b16 v[16:17],v176 offset:36864
 ds_read_b64_tr_b16 v[18:19],v176 offset:37376
 ds_read_b64_tr_b16 v[20:21],v177 offset:36864
 ds_read_b64_tr_b16 v[22:23],v177 offset:37376
 v_mfma_f32_16x16x32_bf16 v[112:115],a[72:75],v[64:67],v[112:115]
 buffer_load_dwordx4 v191,s[4:7],s49 offen offset:3072 lds
 v_mfma_f32_16x16x32_bf16 v[116:119],a[76:79],v[64:67],v[116:119]
 s_add_u32 m0,s51,102400
 ds_read_b64_tr_b16 v[24:25],v178 offset:36864
 ds_read_b64_tr_b16 v[26:27],v178 offset:37376
 v_mfma_f32_16x16x32_bf16 v[120:123],a[72:75],v[68:71],v[120:123]
 s_add_u32 s49,s49,128
 ds_read_b64_tr_b16 v[28:29],v179 offset:36864
 ds_read_b64_tr_b16 v[30:31],v179 offset:37376
 v_mfma_f32_16x16x32_bf16 v[124:127],a[76:79],v[68:71],v[124:127]
 buffer_load_dwordx4 v192,s[8:11],s50 offen lds
 v_mfma_f32_16x16x32_bf16 v[128:131],a[72:75],v[72:75],v[128:131]
 s_and_b32 s49,s49,2047
 ds_read_b64_tr_b16 v[32:33],v176 offset:38912
 ds_read_b64_tr_b16 v[34:35],v176 offset:39424
 v_mfma_f32_16x16x32_bf16 v[132:135],a[76:79],v[72:75],v[132:135]
 buffer_load_dwordx4 v193,s[8:11],s50 offen offset:1024 lds
 v_mfma_f32_16x16x32_bf16 v[136:139],a[72:75],v[76:79],v[136:139]
 ds_read_b64_tr_b16 v[36:37],v177 offset:38912
 ds_read_b64_tr_b16 v[38:39],v177 offset:39424
 v_mfma_f32_16x16x32_bf16 v[140:143],a[76:79],v[76:79],v[140:143]
 s_waitcnt lgkmcnt(8)
 ds_read_b64_tr_b16 v[40:41],v178 offset:38912
 ds_read_b64_tr_b16 v[42:43],v178 offset:39424
 v_mfma_f32_16x16x32_bf16 v[80:83],v[16:19],a[80:83],v[80:83]
 ds_read_b64_tr_b16 v[44:45],v179 offset:38912
 ds_read_b64_tr_b16 v[46:47],v179 offset:39424
 v_mfma_f32_16x16x32_bf16 v[88:91],v[16:19],a[84:87],v[88:91]
 buffer_load_dwordx4 v206,s[8:11],s50 offen offset:2048 lds
 v_mfma_f32_16x16x32_bf16 v[84:87],v[20:23],a[80:83],v[84:87]
 ds_read_b128 a[88:91],v185 offset:32768
 ds_read_b128 a[92:95],v185 offset:34816
 v_mfma_f32_16x16x32_bf16 v[92:95],v[20:23],a[84:87],v[92:95]
 s_waitcnt lgkmcnt(10)
 ds_read_b64_tr_b16 v[48:49],v176 offset:53248
 ds_read_b64_tr_b16 v[50:51],v176 offset:53760
 v_mfma_f32_16x16x32_bf16 v[96:99],v[24:27],a[80:83],v[96:99]
 buffer_load_dwordx4 v207,s[8:11],s50 offen offset:3072 lds
 v_mfma_f32_16x16x32_bf16 v[104:107],v[24:27],a[84:87],v[104:107]
 s_add_u32 m0,s51,0
 ds_read_b64_tr_b16 v[52:53],v177 offset:53248
 ds_read_b64_tr_b16 v[54:55],v177 offset:53760
 v_mfma_f32_16x16x32_bf16 v[100:103],v[28:31],a[80:83],v[100:103]
 s_mul_i32 s50,s49,3072
 ds_read_b64_tr_b16 v[56:57],v178 offset:53248
 ds_read_b64_tr_b16 v[58:59],v178 offset:53760
 v_mfma_f32_16x16x32_bf16 v[108:111],v[28:31],a[84:87],v[108:111]
 s_waitcnt lgkmcnt(12)
 ds_read_b64_tr_b16 v[60:61],v179 offset:53248
 ds_read_b64_tr_b16 v[62:63],v179 offset:53760
 v_mfma_f32_16x16x32_bf16 v[112:115],a[80:83],v[32:35],v[112:115]
 buffer_load_dwordx4 v188,s[4:7],s49 offen lds
 v_mfma_f32_16x16x32_bf16 v[116:119],a[84:87],v[32:35],v[116:119]
 ds_read_b64_tr_b16 v[64:65],v176 offset:55296
 ds_read_b64_tr_b16 v[66:67],v176 offset:55808
 v_mfma_f32_16x16x32_bf16 v[120:123],a[80:83],v[36:39],v[120:123]
 ds_read_b64_tr_b16 v[68:69],v177 offset:55296
 ds_read_b64_tr_b16 v[70:71],v177 offset:55808
 v_mfma_f32_16x16x32_bf16 v[124:127],a[84:87],v[36:39],v[124:127]
 s_waitcnt lgkmcnt(14)
 buffer_load_dwordx4 v189,s[4:7],s49 offen offset:1024 lds
 v_mfma_f32_16x16x32_bf16 v[128:131],a[80:83],v[40:43],v[128:131]
 ds_read_b64_tr_b16 v[72:73],v178 offset:55296
 ds_read_b64_tr_b16 v[74:75],v178 offset:55808
 v_mfma_f32_16x16x32_bf16 v[132:135],a[84:87],v[40:43],v[132:135]
 ds_read_b64_tr_b16 v[76:77],v179 offset:55296
 ds_read_b64_tr_b16 v[78:79],v179 offset:55808
 v_mfma_f32_16x16x32_bf16 v[136:139],a[80:83],v[44:47],v[136:139]
 v_mfma_f32_16x16x32_bf16 v[140:143],a[84:87],v[44:47],v[140:143]
 s_waitcnt lgkmcnt(12)
 buffer_load_dwordx4 v190,s[4:7],s49 offen offset:2048 lds
 v_mfma_f32_16x16x32_bf16 v[80:83],v[48:51],a[88:91],v[80:83]
 v_mfma_f32_16x16x32_bf16 v[88:91],v[48:51],a[92:95],v[88:91]
 v_mfma_f32_16x16x32_bf16 v[84:87],v[52:55],a[88:91],v[84:87]
 buffer_load_dwordx4 v191,s[4:7],s49 offen offset:3072 lds
 v_mfma_f32_16x16x32_bf16 v[92:95],v[52:55],a[92:95],v[92:95]
 s_add_u32 m0,s51,4096
 s_add_u32 s49,s49,128
 s_waitcnt lgkmcnt(8)
 v_mfma_f32_16x16x32_bf16 v[96:99],v[56:59],a[88:91],v[96:99]
 s_and_b32 s49,s49,2047
 v_mfma_f32_16x16x32_bf16 v[104:107],v[56:59],a[92:95],v[104:107]
 s_waitcnt vmcnt(12) lgkmcnt(0)
 s_barrier
 ds_read_b128 a[96:99],v186
 ds_read_b128 a[100:103],v186 offset:2048
 v_mfma_f32_16x16x32_bf16 v[100:103],v[60:63],a[88:91],v[100:103]
 ds_read_b64_tr_b16 v[16:17],v180 offset:4096
 ds_read_b64_tr_b16 v[18:19],v180 offset:4608
 v_mfma_f32_16x16x32_bf16 v[108:111],v[60:63],a[92:95],v[108:111]
 ds_read_b64_tr_b16 v[20:21],v181 offset:4096
 ds_read_b64_tr_b16 v[22:23],v181 offset:4608
 v_mfma_f32_16x16x32_bf16 v[112:115],a[88:91],v[64:67],v[112:115]
 buffer_load_dwordx4 v192,s[8:11],s50 offen lds
 v_mfma_f32_16x16x32_bf16 v[116:119],a[92:95],v[64:67],v[116:119]
 buffer_load_dwordx4 v193,s[8:11],s50 offen offset:1024 lds
 v_mfma_f32_16x16x32_bf16 v[120:123],a[88:91],v[68:71],v[120:123]
 ds_read_b64_tr_b16 v[24:25],v182 offset:4096
 ds_read_b64_tr_b16 v[26:27],v182 offset:4608
 v_mfma_f32_16x16x32_bf16 v[124:127],a[92:95],v[68:71],v[124:127]
 ds_read_b64_tr_b16 v[28:29],v183 offset:4096
 ds_read_b64_tr_b16 v[30:31],v183 offset:4608
 v_mfma_f32_16x16x32_bf16 v[128:131],a[88:91],v[72:75],v[128:131]
 ds_read_b64_tr_b16 v[32:33],v180 offset:6144
 ds_read_b64_tr_b16 v[34:35],v180 offset:6656
 v_mfma_f32_16x16x32_bf16 v[132:135],a[92:95],v[72:75],v[132:135]
 buffer_load_dwordx4 v206,s[8:11],s50 offen offset:2048 lds
 v_mfma_f32_16x16x32_bf16 v[136:139],a[88:91],v[76:79],v[136:139]
 ds_read_b64_tr_b16 v[36:37],v181 offset:6144
 ds_read_b64_tr_b16 v[38:39],v181 offset:6656
 v_mfma_f32_16x16x32_bf16 v[140:143],a[92:95],v[76:79],v[140:143]
 s_waitcnt lgkmcnt(8)
 buffer_atomic_add v6,v4,s[12:15],0 offen offset:4 sc1
 v_mfma_f32_16x16x32_bf16 v[80:83],v[16:19],a[96:99],v[80:83]
 buffer_load_dwordx4 v207,s[8:11],s50 offen offset:3072 lds
 v_mfma_f32_16x16x32_bf16 v[88:91],v[16:19],a[100:103],v[88:91]
 s_add_u32 m0,s51,32768
 ds_read_b64_tr_b16 v[40:41],v182 offset:6144
 ds_read_b64_tr_b16 v[42:43],v182 offset:6656
 v_mfma_f32_16x16x32_bf16 v[84:87],v[20:23],a[96:99],v[84:87]
 s_mul_i32 s50,s49,3072
 ds_read_b64_tr_b16 v[44:45],v183 offset:6144
 ds_read_b64_tr_b16 v[46:47],v183 offset:6656
 v_mfma_f32_16x16x32_bf16 v[92:95],v[20:23],a[100:103],v[92:95]
 s_waitcnt lgkmcnt(8)
 ds_read_b128 a[104:107],v187
 ds_read_b128 a[108:111],v187 offset:2048
 v_mfma_f32_16x16x32_bf16 v[96:99],v[24:27],a[96:99],v[96:99]
 s_branch .Lsk0
.Lvs0_0:
 s_branch .Lvb0
.Lsk0:
 buffer_load_dwordx4 v188,s[4:7],s49 offen lds
 v_mfma_f32_16x16x32_bf16 v[104:107],v[24:27],a[100:103],v[104:107]
 ds_read_b64_tr_b16 v[48:49],v180 offset:20480
 ds_read_b64_tr_b16 v[50:51],v180 offset:20992
 v_mfma_f32_16x16x32_bf16 v[100:103],v[28:31],a[96:99],v[100:103]
 ds_read_b64_tr_b16 v[52:53],v181 offset:20480
 ds_read_b64_tr_b16 v[54:55],v181 offset:20992
 v_mfma_f32_16x16x32_bf16 v[108:111],v[28:31],a[100:103],v[108:111]
 s_waitcnt lgkmcnt(10)
 buffer_load_dwordx4 v189,s[4:7],s49 offen offset:1024 lds
 v_mfma_f32_16x16x32_bf16 v[112:115],a[96:99],v[32:35],v[112:115]
 ds_read_b64_tr_b16 v[56:57],v182 offset:20480
 ds_read_b64_tr_b16 v[58:59],v182 offset:20992
 v_mfma_f32_16x16x32_bf16 v[116:119],a[100:103],v[32:35],v[116:119]
 ds_read_b64_tr_b16 v[60:61],v183 offset:20480
 ds_read_b64_tr_b16 v[62:63],v183 offset:20992
 v_mfma_f32_16x16x32_bf16 v[120:123],a[96:99],v[36:39],v[120:123]
 ds_read_b64_tr_b16 v[64:65],v180 offset:22528
 ds_read_b64_tr_b16 v[66:67],v180 offset:23040
 v_mfma_f32_16x16x32_bf16 v[124:127],a[100:103],v[36:39],v[124:127]
 s_waitcnt lgkmcnt(12)
 buffer_load_dwordx4 v190,s[4:7],s49 offen offset:2048 lds
 v_mfma_f32_16x16x32_bf16 v[128:131],a[96:99],v[40:43],v[128:131]
 ds_read_b64_tr_b16 v[68:69],v181 offset:22528
 ds_read_b64_tr_b16 v[70:71],v181 offset:23040
 v_mfma_f32_16x16x32_bf16 v[132:135],a[100:103],v[40:43],v[132:135]
 ds_read_b64_tr_b16 v[72:73],v182 offset:22528
 ds_read_b64_tr_b16 v[74:75],v182 offset:23040
 v_mfma_f32_16x16x32_bf16 v[136:139],a[96:99],v[44:47],v[136:139]
 ds_read_b64_tr_b16 v[76:77],v183 offset:22528
 ds_read_b64_tr_b16 v[78:79],v183 offset:23040
 v_mfma_f32_16x16x32_bf16 v[140:143],a[100:103],v[44:47],v[140:143]
 s_waitcnt lgkmcnt(12)
 buffer_load_dwordx4 v191,s[4:7],s49 offen offset:3072 lds
 v_mfma_f32_16x16x32_bf16 v[80:83],v[48:51],a[104:107],v[80:83]
 s_add_u32 m0,s51,36864
 s_add_u32 s49,s49,128
 s_and_b32 s49,s49,2047
 v_mfma_f32_16x16x32_bf16 v[88:91],v[48:51],a[108:111],v[88:91]
 v_mfma_f32_16x16x32_bf16 v[84:87],v[52:55],a[104:107],v[84:87]
 buffer_load_dwordx4 v192,s[8:11],s50 offen lds
 v_mfma_f32_16x16x32_bf16 v[92:95],v[52:55],a[108:111],v[92:95]
 s_waitcnt lgkmcnt(8)
 v_mfma_f32_16x16x32_bf16 v[96:99],v[56:59],a[104:107],v[96:99]
 v_mfma_f32_16x16x32_bf16 v[104:107],v[56:59],a[108:111],v[104:107]
 buffer_load_dwordx4 v193,s[8:11],s50 offen offset:1024 lds
 v_mfma_f32_16x16x32_bf16 v[100:103],v[60:63],a[104:107],v[100:103]
 s_waitcnt vmcnt(15) lgkmcnt(0)
 s_barrier
 ds_read_b128 a[112:115],v186 offset:32768
 ds_read_b128 a[116:119],v186 offset:34816
 v_mfma_f32_16x16x32_bf16 v[108:111],v[60:63],a[108:111],v[108:111]
 ds_read_b64_tr_b16 v[16:17],v180 offset:36864
 ds_read_b64_tr_b16 v[18:19],v180 offset:37376
 ds_read_b64_tr_b16 v[20:21],v181 offset:36864
 ds_read_b64_tr_b16 v[22:23],v181 offset:37376
 v_mfma_f32_16x16x32_bf16 v[112:115],a[104:107],v[64:67],v[112:115]
 ds_read_b64_tr_b16 v[24:25],v182 offset:36864
 ds_read_b64_tr_b16 v[26:27],v182 offset:37376
 v_mfma_f32_16x16x32_bf16 v[116:119],a[108:111],v[64:67],v[116:119]
 buffer_load_dwordx4 v206,s[8:11],s50 offen offset:2048 lds
 v_mfma_f32_16x16x32_bf16 v[120:123],a[104:107],v[68:71],v[120:123]
 ds_read_b64_tr_b16 v[28:29],v183 offset:36864
 ds_read_b64_tr_b16 v[30:31],v183 offset:37376
 v_mfma_f32_16x16x32_bf16 v[124:127],a[108:111],v[68:71],v[124:127]
 ds_read_b64_tr_b16 v[32:33],v180 offset:38912
 ds_read_b64_tr_b16 v[34:35],v180 offset:39424
 v_mfma_f32_16x16x32_bf16 v[128:131],a[104:107],v[72:75],v[128:131]
 buffer_load_dwordx4 v207,s[8:11],s50 offen offset:3072 lds
 v_mfma_f32_16x16x32_bf16 v[132:135],a[108:111],v[72:75],v[132:135]
 s_add_u32 m0,s51,65536
 ds_read_b64_tr_b16 v[36:37],v181 offset:38912
 ds_read_b64_tr_b16 v[38:39],v181 offset:39424
 v_mfma_f32_16x16x32_bf16 v[136:139],a[104:107],v[76:79],v[136:139]
 s_mul_i32 s50,s49,3072
 ds_read_b64_tr_b16 v[40:41],v182 offset:38912
 ds_read_b64_tr_b16 v[42:43],v182 offset:39424
 v_mfma_f32_16x16x32_bf16 v[140:143],a[108:111],v[76:79],v[140:143]
 s_waitcnt lgkmcnt(10)
 ds_read_b64_tr_b16 v[44:45],v183 offset:38912
 ds_read_b64_tr_b16 v[46:47],v183 offset:39424
 v_mfma_f32_16x16x32_bf16 v[80:83],v[16:19],a[112:115],v[80:83]
 buffer_load_dwordx4 v188,s[4:7],s49 offen lds
 v_mfma_f32_16x16x32_bf16 v[88:91],v[16:19],a[116:119],v[88:91]
 ds_read_b128 a[120:123],v187 offset:32768
 ds_read_b128 a[124:127],v187 offset:34816
 v_mfma_f32_16x16x32_bf16 v[84:87],v[20:23],a[112:115],v[84:87]
 ds_read_b64_tr_b16 v[48:49],v180 offset:53248
 ds_read_b64_tr_b16 v[50:51],v180 offset:53760
 v_mfma_f32_16x16x32_bf16 v[92:95],v[20:23],a[116:119],v[92:95]
 s_waitcnt lgkmcnt(12)
 buffer_load_dwordx4 v189,s[4:7],s49 offen offset:1024 lds
 v_mfma_f32_16x16x32_bf16 v[96:99],v[24:27],a[112:115],v[96:99]
 ds_read_b64_tr_b16 v[52:53],v181 offset:53248
 ds_read_b64_tr_b16 v[54:55],v181 offset:53760
 v_mfma_f32_16x16x32_bf16 v[104:107],v[24:27],a[116:119],v[104:107]
 ds_read_b64_tr_b16 v[56:57],v182 offset:53248
 ds_read_b64_tr_b16 v[58:59],v182 offset:53760
 v_mfma_f32_16x16x32_bf16 v[100:103],v[28:31],a[112:115],v[100:103]
 ds_read_b64_tr_b16 v[60:61],v183 offset:53248
 ds_read_b64_tr_b16 v[62:63],v183 offset:53760
 v_mfma_f32_16x16x32_bf16 v[108:111],v[28:31],a[116:119],v[108:111]
 s_waitcnt lgkmcnt(14)
 buffer_load_dwordx4 v190,s[4:7],s49 offen offset:2048 lds
 v_mfma_f32_16x16x32_bf16 v[112:115],a[112:115],v[32:35],v[112:115]
 ds_read_b64_tr_b16 v[64:65],v180 offset:55296
 ds_read_b64_tr_b16 v[66:67],v180 offset:55808
 v_mfma_f32_16x16x32_bf16 v[116:119],a[116:119],v[32:35],v[116:119]
 ds_read_b64_tr_b16 v[68:69],v181 offset:55296
 ds_read_b64_tr_b16 v[70:71],v181 offset:55808
 v_mfma_f32_16x16x32_bf16 v[120:123],a[112:115],v[36:39],v[120:123]
 buffer_load_dwordx4 v191,s[4:7],s49 offen offset:3072 lds
 v_mfma_f32_16x16x32_bf16 v[124:127],a[116:119],v[36:39],v[124:127]
 s_waitcnt lgkmcnt(14)
 ds_read_b64_tr_b16 v[72:73],v182 offset:55296
 ds_read_b64_tr_b16 v[74:75],v182 offset:55808
 v_mfma_f32_16x16x32_bf16 v[128:131],a[112:115],v[40:43],v[128:131]
 s_add_u32 m0,s51,69632
 ds_read_b64_tr_b16 v[76:77],v183 offset:55296
 ds_read_b64_tr_b16 v[78:79],v183 offset:55808
 v_mfma_f32_16x16x32_bf16 v[132:135],a[116:119],v[40:43],v[132:135]
 s_add_u32 s49,s49,128
 s_and_b32 s49,s49,2047
 v_mfma_f32_16x16x32_bf16 v[136:139],a[112:115],v[44:47],v[136:139]
 buffer_load_dwordx4 v192,s[8:11],s50 offen lds
 v_mfma_f32_16x16x32_bf16 v[140:143],a[116:119],v[44:47],v[140:143]
 s_waitcnt lgkmcnt(12)
 v_mfma_f32_16x16x32_bf16 v[80:83],v[48:51],a[120:123],v[80:83]
 v_mfma_f32_16x16x32_bf16 v[88:91],v[48:51],a[124:127],v[88:91]
 buffer_load_dwordx4 v193,s[8:11],s50 offen offset:1024 lds
 v_mfma_f32_16x16x32_bf16 v[84:87],v[52:55],a[120:123],v[84:87]
 v_mfma_f32_16x16x32_bf16 v[92:95],v[52:55],a[124:127],v[92:95]
 s_waitcnt lgkmcnt(8)
 v_mfma_f32_16x16x32_bf16 v[96:99],v[56:59],a[120:123],v[96:99]
 s_waitcnt vmcnt(14) lgkmcnt(0)
 s_barrier
 ds_read_b128 a[128:131],v184
 ds_read_b128 a[132:135],v184 offset:2048
 v_mfma_f32_16x16x32_bf16 v[104:107],v[56:59],a[124:127],v[104:107]
 buffer_load_dwordx4 v206,s[8:11],s50 offen offset:2048 lds
 v_mfma_f32_16x16x32_bf16 v[100:103],v[60:63],a[120:123],v[100:103]
 ds_read_b64_tr_b16 v[16:17],v176 offset:4096
 ds_read_b64_tr_b16 v[18:19],v176 offset:4608
 v_mfma_f32_16x16x32_bf16 v[108:111],v[60:63],a[124:127],v[108:111]
 ds_read_b64_tr_b16 v[20:21],v177 offset:4096
 ds_read_b64_tr_b16 v[22:23],v177 offset:4608
 v_mfma_f32_16x16x32_bf16 v[112:115],a[120:123],v[64:67],v[112:115]
 buffer_load_dwordx4 v207,s[8:11],s50 offen offset:3072 lds
 v_mfma_f32_16x16x32_bf16 v[116:119],a[124:127],v[64:67],v[116:119]
 s_add_u32 m0,s51,98304
 ds_read_b64_tr_b16 v[24:25],v178 offset:4096
 ds_read_b64_tr_b16 v[26:27],v178 offset:4608
 v_mfma_f32_16x16x32_bf16 v[120:123],a[120:123],v[68:71],v[120:123]
 s_mul_i32 s50,s49,3072
 ds_read_b64_tr_b16 v[28:29],v179 offset:4096
 ds_read_b64_tr_b16 v[30:31],v179 offset:4608
 v_mfma_f32_16x16x32_bf16 v[124:127],a[124:127],v[68:71],v[124:127]
 ds_read_b64_tr_b16 v[32:33],v176 offset:6144
 ds_read_b64_tr_b16 v[34:35],v176 offset:6656
 v_mfma_f32_16x16x32_bf16 v[128:131],a[120:123],v[72:75],v[128:131]
 buffer_load_dwordx4 v188,s[4:7],s49 offen lds
 v_mfma_f32_16x16x32_bf16 v[132:135],a[124:127],v[72:75],v[132:135]
 ds_read_b64_tr_b16 v[36:37],v177 offset:6144
 ds_read_b64_tr_b16 v[38:39],v177 offset:6656
 v_mfma_f32_16x16x32_bf16 v[136:139],a[120:123],v[76:79],v[136:139]
 ds_read_b64_tr_b16 v[40:41],v178 offset:6144
 ds_read_b64_tr_b16 v[42:43],v178 offset:6656
 v_mfma_f32_16x16x32_bf16 v[140:143],a[124:127],v[76:79],v[140:143]
 s_waitcnt lgkmcnt(10)
 buffer_load_dwordx4 v189,s[4:7],s49 offen offset:1024 lds
 v_mfma_f32_16x16x32_bf16 v[80:83],v[16:19],a[128:131],v[80:83]
 ds_read_b64_tr_b16 v[44:45],v179 offset:6144
 ds_read_b64_tr_b16 v[46:47],v179 offset:6656
 v_mfma_f32_16x16x32_bf16 v[88:91],v[16:19],a[132:135],v[88:91]
 ds_read_b128 a[136:139],v185
 ds_read_b128 a[140:143],v185 offset:2048
 v_mfma_f32_16x16x32_bf16 v[84:87],v[20:23],a[128:131],v[84:87]
 ds_read_b64_tr_b16 v[48:49],v176 offset:20480
 ds_read_b64_tr_b16 v[50:51],v176 offset:20992
 v_mfma_f32_16x16x32_bf16 v[92:95],v[20:23],a[132:135],v[92:95]
 s_waitcnt lgkmcnt(12)
 buffer_load_dwordx4 v190,s[4:7],s49 offen offset:2048 lds
 v_mfma_f32_16x16x32_bf16 v[96:99],v[24:27],a[128:131],v[96:99]
 ds_read_b64_tr_b16 v[52:53],v177 offset:20480
 ds_read_b64_tr_b16 v[54:55],v177 offset:20992
 v_mfma_f32_16x16x32_bf16 v[104:107],v[24:27],a[132:135],v[104:107]
 ds_read_b64_tr_b16 v[56:57],v178 offset:20480
 ds_read_b64_tr_b16 v[58:59],v178 offset:20992
 v_mfma_f32_16x16x32_bf16 v[100:103],v[28:31],a[128:131],v[100:103]
 buffer_load_dwordx4 v191,s[4:7],s49 offen offset:3072 lds
 v_mfma_f32_16x16x32_bf16 v[108:111],v[28:31],a[132:135],v[108:111]
 s_waitcnt lgkmcnt(12)
 ds_read_b64_tr_b16 v[60:61],v179 offset:20480
 ds_read_b64_tr_b16 v[62:63],v179 offset:20992
 v_mfma_f32_16x16x32_bf16 v[112:115],a[128:131],v[32:35],v[112:115]
 s_add_u32 m0,s51,102400
 ds_read_b64_tr_b16 v[64:65],v176 offset:22528
 ds_read_b64_tr_b16 v[66:67],v176 offset:23040
 v_mfma_f32_16x16x32_bf16 v[116:119],a[132:135],v[32:35],v[116:119]
 s_add_u32 s49,s49,128
 ds_read_b64_tr_b16 v[68:69],v177 offset:22528
 ds_read_b64_tr_b16 v[70:71],v177 offset:23040
 v_mfma_f32_16x16x32_bf16 v[120:123],a[128:131],v[36:39],v[120:123]
 s_and_b32 s49,s49,2047
 buffer_load_dwordx4 v192,s[8:11],s50 offen lds
 v_mfma_f32_16x16x32_bf16 v[124:127],a[132:135],v[36:39],v[124:127]
 s_waitcnt lgkmcnt(14)
 ds_read_b64_tr_b16 v[72:73],v178 offset:22528
 ds_read_b64_tr_b16 v[74:75],v178 offset:23040
 v_mfma_f32_16x16x32_bf16 v[128:131],a[128:131],v[40:43],v[128:131]
 ds_read_b64_tr_b16 v[76:77],v179 offset:22528
 ds_read_b64_tr_b16 v[78:79],v179 offset:23040
 v_mfma_f32_16x16x32_bf16 v[132:135],a[132:135],v[40:43],v[132:135]
 buffer_load_dwordx4 v193,s[8:11],s50 offen offset:1024 lds
 v_mfma_f32_16x16x32_bf16 v[136:139],a[128:131],v[44:47],v[136:139]
 v_mfma_f32_16x16x32_bf16 v[140:143],a[132:135],v[44:47],v[140:143]
 s_waitcnt lgkmcnt(12)
 v_mfma_f32_16x16x32_bf16 v[80:83],v[48:51],a[136:139],v[80:83]
 v_mfma_f32_16x16x32_bf16 v[88:91],v[48:51],a[140:143],v[88:91]
 buffer_load_dwordx4 v206,s[8:11],s50 offen offset:2048 lds
 v_mfma_f32_16x16x32_bf16 v[84:87],v[52:55],a[136:139],v[84:87]
 v_mfma_f32_16x16x32_bf16 v[92:95],v[52:55],a[140:143],v[92:95]
 s_waitcnt lgkmcnt(8)
 v_mfma_f32_16x16x32_bf16 v[96:99],v[56:59],a[136:139],v[96:99]
 s_waitcnt vmcnt(15) lgkmcnt(0)
 s_barrier
 buffer_load_dwordx4 v207,s[8:11],s50 offen offset:3072 lds
 v_mfma_f32_16x16x32_bf16 v[104:107],v[56:59],a[140:143],v[104:107]
 s_add_u32 m0,s51,0
 ds_read_b128 a[144:147],v184 offset:32768
 ds_read_b128 a[148:151],v184 offset:34816
 v_mfma_f32_16x16x32_bf16 v[100:103],v[60:63],a[136:139],v[100:103]
 s_mul_i32 s50,s49,3072
 ds_read_b64_tr_b16 v[16:17],v176 offset:36864
 ds_read_b64_tr_b16 v[18:19],v176 offset:37376
 v_mfma_f32_16x16x32_bf16 v[108:111],v[60:63],a[140:143],v[108:111]
 ds_read_b64_tr_b16 v[20:21],v177 offset:36864
 ds_read_b64_tr_b16 v[22:23],v177 offset:37376
 v_mfma_f32_16x16x32_bf16 v[112:115],a[136:139],v[64:67],v[112:115]
 buffer_load_dwordx4 v188,s[4:7],s49 offen lds
 v_mfma_f32_16x16x32_bf16 v[116:119],a[140:143],v[64:67],v[116:119]
 ds_read_b64_tr_b16 v[24:25],v178 offset:36864
 ds_read_b64_tr_b16 v[26:27],v178 offset:37376
 v_mfma_f32_16x16x32_bf16 v[120:123],a[136:139],v[68:71],v[120:123]
 ds_read_b64_tr_b16 v[28:29],v179 offset:36864
 ds_read_b64_tr_b16 v[30:31],v179 offset:37376
 v_mfma_f32_16x16x32_bf16 v[124:127],a[140:143],v[68:71],v[124:127]
 ds_read_b64_tr_b16 v[32:33],v176 offset:38912
 ds_read_b64_tr_b16 v[34:35],v176 offset:39424
 v_mfma_f32_16x16x32_bf16 v[128:131],a[136:139],v[72:75],v[128:131]
 buffer_load_dwordx4 v189,s[4:7],s49 offen offset:1024 lds
 v_mfma_f32_16x16x32_bf16 v[132:135],a[140:143],v[72:75],v[132:135]
 ds_read_b64_tr_b16 v[36:37],v177 offset:38912
 ds_read_b64_tr_b16 v[38:39],v177 offset:39424
 v_mfma_f32_16x16x32_bf16 v[136:139],a[136:139],v[76:79],v[136:139]
 ds_read_b64_tr_b16 v[40:41],v178 offset:38912
 ds_read_b64_tr_b16 v[42:43],v178 offset:39424
 v_mfma_f32_16x16x32_bf16 v[140:143],a[140:143],v[76:79],v[140:143]
 s_waitcnt lgkmcnt(10)
 ds_read_b64_tr_b16 v[44:45],v179 offset:38912
 ds_read_b64_tr_b16 v[46:47],v179 offset:39424
 v_mfma_f32_16x16x32_bf16 v[80:83],v[16:19],a[144:147],v[80:83]
 buffer_load_dwordx4 v190,s[4:7],s49 offen offset:2048 lds
 v_mfma_f32_16x16x32_bf16 v[88:91],v[16:19],a[148:151],v[88:91]
 ds_read_b128 a[152:155],v185 offset:32768
 ds_read_b128 a[156:159],v185 offset:34816
 v_mfma_f32_16x16x32_bf16 v[84:87],v[20:23],a[144:147],v[84:87]
 s_lshl_b32 s57,s45,12
 ds_read_b64_tr_b16 v[48:49],v176 offset:53248
 ds_read_b64_tr_b16 v[50:51],v176 offset:53760
 v_mfma_f32_16x16x32_bf16 v[92:95],v[20:23],a[148:151],v[92:95]
 s_waitcnt lgkmcnt(12)
 ds_read_b64_tr_b16 v[52:53],v177 offset:53248
 ds_read_b64_tr_b16 v[54:55],v177 offset:53760
 v_mfma_f32_16x16x32_bf16 v[96:99],v[24:27],a[144:147],v[96:99]
 v_mov_b32 v7,0
 buffer_atomic_add v7,v195,s[12:15],0 offen sc0 sc1
 v_mfma_f32_16x16x32_bf16 v[104:107],v[24:27],a[148:151],v[104:107]
 s_add_u32 s57,s57,196608
 buffer_load_dwordx4 v191,s[4:7],s49 offen offset:3072 lds
 v_mfma_f32_16x16x32_bf16 v[100:103],v[28:31],a[144:147],v[100:103]
 s_add_u32 m0,s51,4096
 ds_read_b64_tr_b16 v[56:57],v178 offset:53248
 ds_read_b64_tr_b16 v[58:59],v178 offset:53760
 v_mfma_f32_16x16x32_bf16 v[108:111],v[28:31],a[148:151],v[108:111]
 s_waitcnt lgkmcnt(12)
 ds_read_b64_tr_b16 v[60:61],v179 offset:53248
 ds_read_b64_tr_b16 v[62:63],v179 offset:53760
 v_mfma_f32_16x16x32_bf16 v[112:115],a[144:147],v[32:35],v[112:115]
 s_add_u32 s49,s49,128
 buffer_load_dwordx4 v192,s[8:11],s50 offen lds
 v_mfma_f32_16x16x32_bf16 v[116:119],a[148:151],v[32:35],v[116:119]
 s_and_b32 s49,s49,2047
 ds_read_b64_tr_b16 v[64:65],v176 offset:55296
 ds_read_b64_tr_b16 v[66:67],v176 offset:55808
 v_mfma_f32_16x16x32_bf16 v[120:123],a[144:147],v[36:39],v[120:123]
 ds_read_b64_tr_b16 v[68:69],v177 offset:55296
 ds_read_b64_tr_b16 v[70:71],v177 offset:55808
 v_mfma_f32_16x16x32_bf16 v[124:127],a[148:151],v[36:39],v[124:127]
 s_waitcnt lgkmcnt(14)
 ds_read_b64_tr_b16 v[72:73],v178 offset:55296
 ds_read_b64_tr_b16 v[74:75],v178 offset:55808
 v_mfma_f32_16x16x32_bf16 v[128:131],a[144:147],v[40:43],v[128:131]
 buffer_load_dwordx4 v193,s[8:11],s50 offen offset:1024 lds
 v_mfma_f32_16x16x32_bf16 v[132:135],a[148:151],v[40:43],v[132:135]
 ds_read_b64_tr_b16 v[76:77],v179 offset:55296
 ds_read_b64_tr_b16 v[78:79],v179 offset:55808
 v_mfma_f32_16x16x32_bf16 v[136:139],a[144:147],v[44:47],v[136:139]
 v_mfma_f32_16x16x32_bf16 v[140:143],a[148:151],v[44:47],v[140:143]
 s_waitcnt lgkmcnt(12)
 v_mfma_f32_16x16x32_bf16 v[80:83],v[48:51],a[152:155],v[80:83]
 buffer_load_dwordx4 v206,s[8:11],s50 offen offset:2048 lds
 v_mfma_f32_16x16x32_bf16 v[88:91],v[48:51],a[156:159],v[88:91]
 v_mfma_f32_16x16x32_bf16 v[84:87],v[52:55],a[152:155],v[84:87]
 v_mfma_f32_16x16x32_bf16 v[92:95],v[52:55],a[156:159],v[92:95]
 s_waitcnt lgkmcnt(8)
 v_mfma_f32_16x16x32_bf16 v[96:99],v[56:59],a[152:155],v[96:99]
 buffer_load_dwordx4 v207,s[8:11],s50 offen offset:3072 lds
 v_mfma_f32_16x16x32_bf16 v[104:107],v[56:59],a[156:159],v[104:107]
 s_waitcnt vmcnt(17) lgkmcnt(0)
 s_barrier
 ds_read_b128 a[160:163],v186
 ds_read_b128 a[164:167],v186 offset:2048
 v_mfma_f32_16x16x32_bf16 v[100:103],v[60:63],a[152:155],v[100:103]
 s_add_u32 m0,s51,32768
 ds_read_b64_tr_b16 v[16:17],v180 offset:4096
 ds_read_b64_tr_b16 v[18:19],v180 offset:4608
 v_mfma_f32_16x16x32_bf16 v[108:111],v[60:63],a[156:159],v[108:111]
 ds_read_b64_tr_b16 v[20:21],v181 offset:4096
 ds_read_b64_tr_b16 v[22:23],v181 offset:4608
 v_mfma_f32_16x16x32_bf16 v[112:115],a[152:155],v[64:67],v[112:115]
 s_mul_i32 s50,s49,3072
 buffer_load_dwordx4 v188,s[4:7],s49 offen lds
 v_mfma_f32_16x16x32_bf16 v[116:119],a[156:159],v[64:67],v[116:119]
 ds_read_b64_tr_b16 v[24:25],v182 offset:4096
 ds_read_b64_tr_b16 v[26:27],v182 offset:4608
 v_mfma_f32_16x16x32_bf16 v[120:123],a[152:155],v[68:71],v[120:123]
 ds_read_b64_tr_b16 v[28:29],v183 offset:4096
 ds_read_b64_tr_b16 v[30:31],v183 offset:4608
 v_mfma_f32_16x16x32_bf16 v[124:127],a[156:159],v[68:71],v[124:127]
 ds_read_b64_tr_b16 v[32:33],v180 offset:6144
 ds_read_b64_tr_b16 v[34:35],v180 offset:6656
 v_mfma_f32_16x16x32_bf16 v[128:131],a[152:155],v[72:75],v[128:131]
 buffer_load_dwordx4 v189,s[4:7],s49 offen offset:1024 lds
 v_mfma_f32_16x16x32_bf16 v[132:135],a[156:159],v[72:75],v[132:135]
 ds_read_b64_tr_b16 v[36:37],v181 offset:6144
 ds_read_b64_tr_b16 v[38:39],v181 offset:6656
 v_mfma_f32_16x16x32_bf16 v[136:139],a[152:155],v[76:79],v[136:139]
 ds_read_b64_tr_b16 v[40:41],v182 offset:6144
 ds_read_b64_tr_b16 v[42:43],v182 offset:6656
 v_mfma_f32_16x16x32_bf16 v[140:143],a[156:159],v[76:79],v[140:143]
 s_waitcnt lgkmcnt(10)
 ds_read_b64_tr_b16 v[44:45],v183 offset:6144
 ds_read_b64_tr_b16 v[46:47],v183 offset:6656
 v_mfma_f32_16x16x32_bf16 v[80:83],v[16:19],a[160:163],v[80:83]
 buffer_load_dwordx4 v190,s[4:7],s49 offen offset:2048 lds
 v_mfma_f32_16x16x32_bf16 v[88:91],v[16:19],a[164:167],v[88:91]
 ds_read_b128 a[168:171],v187
 ds_read_b128 a[172:175],v187 offset:2048
 v_mfma_f32_16x16x32_bf16 v[84:87],v[20:23],a[160:163],v[84:87]
 ds_read_b64_tr_b16 v[48:49],v180 offset:20480
 ds_read_b64_tr_b16 v[50:51],v180 offset:20992
 v_mfma_f32_16x16x32_bf16 v[92:95],v[20:23],a[164:167],v[92:95]
 s_waitcnt lgkmcnt(12)
 ds_read_b64_tr_b16 v[52:53],v181 offset:20480
 ds_read_b64_tr_b16 v[54:55],v181 offset:20992
 v_mfma_f32_16x16x32_bf16 v[96:99],v[24:27],a[160:163],v[96:99]
 buffer_load_dwordx4 v191,s[4:7],s49 offen offset:3072 lds
 v_mfma_f32_16x16x32_bf16 v[104:107],v[24:27],a[164:167],v[104:107]
 s_add_u32 m0,s51,36864
 ds_read_b64_tr_b16 v[56:57],v182 offset:20480
 ds_read_b64_tr_b16 v[58:59],v182 offset:20992
 v_mfma_f32_16x16x32_bf16 v[100:103],v[28:31],a[160:163],v[100:103]
 s_add_u32 s49,s49,128
 ds_read_b64_tr_b16 v[60:61],v183 offset:20480
 ds_read_b64_tr_b16 v[62:63],v183 offset:20992
 v_mfma_f32_16x16x32_bf16 v[108:111],v[28:31],a[164:167],v[108:111]
 s_waitcnt lgkmcnt(14)
 ds_read_b64_tr_b16 v[64:65],v180 offset:22528
 ds_read_b64_tr_b16 v[66:67],v180 offset:23040
 v_mfma_f32_16x16x32_bf16 v[112:115],a[160:163],v[32:35],v[112:115]
 s_and_b32 s49,s49,2047
 buffer_load_dwordx4 v192,s[8:11],s50 offen lds
 v_mfma_f32_16x16x32_bf16 v[116:119],a[164:167],v[32:35],v[116:119]
 ds_read_b64_tr_b16 v[68:69],v181 offset:22528
 ds_read_b64_tr_b16 v[70:71],v181 offset:23040
 v_mfma_f32_16x16x32_bf16 v[120:123],a[160:163],v[36:39],v[120:123]
 ds_read_b64_tr_b16 v[72:73],v182 offset:22528
 ds_read_b64_tr_b16 v[74:75],v182 offset:23040
 v_mfma_f32_16x16x32_bf16 v[124:127],a[164:167],v[36:39],v[124:127]
 s_waitcnt lgkmcnt(14)
 ds_read_b64_tr_b16 v[76:77],v183 offset:22528
 ds_read_b64_tr_b16 v[78:79],v183 offset:23040
 v_mfma_f32_16x16x32_bf16 v[128:131],a[160:163],v[40:43],v[128:131]
 buffer_load_dwordx4 v193,s[8:11],s50 offen offset:1024 lds
 v_mfma_f32_16x16x32_bf16 v[132:135],a[164:167],v[40:43],v[132:135]
 v_mfma_f32_16x16x32_bf16 v[136:139],a[160:163],v[44:47],v[136:139]
 v_mfma_f32_16x16x32_bf16 v[140:143],a[164:167],v[44:47],v[140:143]
 s_waitcnt lgkmcnt(12)
 v_mfma_f32_16x16x32_bf16 v[80:83],v[48:51],a[168:171],v[80:83]
 buffer_load_dwordx4 v206,s[8:11],s50 offen offset:2048 lds
 v_mfma_f32_16x16x32_bf16 v[88:91],v[48:51],a[172:175],v[88:91]
 v_mfma_f32_16x16x32_bf16 v[84:87],v[52:55],a[168:171],v[84:87]
 v_mfma_f32_16x16x32_bf16 v[92:95],v[52:55],a[172:175],v[92:95]
 s_waitcnt vmcnt(16) lgkmcnt(0)
 s_barrier
 ds_read_b128 a[176:179],v186 offset:32768
 v_mfma_f32_16x16x32_bf16 v[96:99],v[56:59],a[168:171],v[96:99]
 buffer_load_dwordx4 v207,s[8:11],s50 offen offset:3072 lds
 v_mfma_f32_16x16x32_bf16 v[104:107],v[56:59],a[172:175],v[104:107]
 s_add_u32 m0,s51,65536
 ds_read_b128 a[180:183],v186 offset:34816
 ds_read_b64_tr_b16 v[16:17],v180 offset:36864
 v_mfma_f32_16x16x32_bf16 v[100:103],v[60:63],a[168:171],v[100:103]
 s_mul_i32 s50,s49,3072
 ds_read_b64_tr_b16 v[18:19],v180 offset:37376
 ds_read_b64_tr_b16 v[20:21],v181 offset:36864
 v_mfma_f32_16x16x32_bf16 v[108:111],v[60:63],a[172:175],v[108:111]
 ds_read_b64_tr_b16 v[22:23],v181 offset:37376
 ds_read_b64_tr_b16 v[24:25],v182 offset:36864
 v_mfma_f32_16x16x32_bf16 v[112:115],a[168:171],v[64:67],v[112:115]
 buffer_load_dwordx4 v188,s[4:7],s49 offen lds
 v_mfma_f32_16x16x32_bf16 v[116:119],a[172:175],v[64:67],v[116:119]
 ds_read_b64_tr_b16 v[26:27],v182 offset:37376
 ds_read_b64_tr_b16 v[28:29],v183 offset:36864
 v_mfma_f32_16x16x32_bf16 v[120:123],a[168:171],v[68:71],v[120:123]
 ds_read_b64_tr_b16 v[30:31],v183 offset:37376
 ds_read_b64_tr_b16 v[32:33],v180 offset:38912
 v_mfma_f32_16x16x32_bf16 v[124:127],a[172:175],v[68:71],v[124:127]
 ds_read_b64_tr_b16 v[34:35],v180 offset:39424
 ds_read_b64_tr_b16 v[36:37],v181 offset:38912
 v_mfma_f32_16x16x32_bf16 v[128:131],a[168:171],v[72:75],v[128:131]
 buffer_load_dwordx4 v189,s[4:7],s49 offen offset:1024 lds
 v_mfma_f32_16x16x32_bf16 v[132:135],a[172:175],v[72:75],v[132:135]
 ds_read_b64_tr_b16 v[38:39],v181 offset:39424
 ds_read_b64_tr_b16 v[40:41],v182 offset:38912
 v_mfma_f32_16x16x32_bf16 v[136:139],a[168:171],v[76:79],v[136:139]
 ds_read_b64_tr_b16 v[42:43],v182 offset:39424
 ds_read_b64_tr_b16 v[44:45],v183 offset:38912
 v_mfma_f32_16x16x32_bf16 v[140:143],a[172:175],v[76:79],v[140:143]
 s_waitcnt lgkmcnt(11)
 ds_read_b64_tr_b16 v[46:47],v183 offset:39424
 ds_read_b128 a[184:187],v187 offset:32768
 v_mfma_f32_16x16x32_bf16 v[80:83],v[16:19],a[176:179],v[80:83]
 s_waitcnt vmcnt(15)
 v_readfirstlane_b32 s59,v7
 v_readlane_b32 s3,v7,1
 s_nop 0
 s_min_u32 s59,s59,s3
 s_cmp_ge_u32 s59,16
 s_cbranch_scc0 .Lseq_slow_4
.Lseq_back_5:
 v_mfma_f32_16x16x32_bf16 v[88:91],v[16:19],a[180:183],v[88:91]
 s_lshr_b32 s3,s46,1
 buffer_load_dwordx4 v[160:163],v0,s[12:15],s63 offen sc1
 v_mfma_f32_16x16x32_bf16 v[84:87],v[20:23],a[176:179],v[84:87]
 buffer_load_dwordx4 v190,s[4:7],s49 offen offset:2048 lds
 v_mfma_f32_16x16x32_bf16 v[92:95],v[20:23],a[180:183],v[92:95]
 s_waitcnt lgkmcnt(9)
 buffer_load_dwordx4 v[164:167],v0,s[12:15],s63 offen offset:1024 sc1
 v_mfma_f32_16x16x32_bf16 v[96:99],v[24:27],a[176:179],v[96:99]
 buffer_load_dwordx4 v191,s[4:7],s49 offen offset:3072 lds
 v_mfma_f32_16x16x32_bf16 v[104:107],v[24:27],a[180:183],v[104:107]
 s_add_u32 m0,s51,69632
 ds_read_b128 a[188:191],v187 offset:34816
 ds_read_b64_tr_b16 v[48:49],v180 offset:53248
 v_mfma_f32_16x16x32_bf16 v[100:103],v[28:31],a[176:179],v[100:103]
 s_add_u32 s49,s49,128
 buffer_load_dwordx4 v[168:171],v0,s[12:15],s63 offen offset:2048 sc1
 v_mfma_f32_16x16x32_bf16 v[108:111],v[28:31],a[180:183],v[108:111]
 s_waitcnt lgkmcnt(7)
 ds_read_b64_tr_b16 v[50:51],v180 offset:53760
 ds_read_b64_tr_b16 v[52:53],v181 offset:53248
 ds_read_b64_tr_b16 v[54:55],v181 offset:53760
 v_mfma_f32_16x16x32_bf16 v[112:115],a[176:179],v[32:35],v[112:115]
 s_and_b32 s49,s49,2047
 buffer_load_dwordx4 v192,s[8:11],s50 offen lds
 v_mfma_f32_16x16x32_bf16 v[116:119],a[180:183],v[32:35],v[116:119]
 buffer_load_dwordx4 v[172:175],v0,s[12:15],s63 offen offset:3072 sc1
 v_mfma_f32_16x16x32_bf16 v[120:123],a[176:179],v[36:39],v[120:123]
 ds_read_b64_tr_b16 v[56:57],v182 offset:53248
 ds_read_b64_tr_b16 v[58:59],v182 offset:53760
 v_mfma_f32_16x16x32_bf16 v[124:127],a[180:183],v[36:39],v[124:127]
 s_waitcnt lgkmcnt(8)
 ds_read_b64_tr_b16 v[60:61],v183 offset:53248
 ds_read_b64_tr_b16 v[62:63],v183 offset:53760
 v_mfma_f32_16x16x32_bf16 v[128:131],a[176:179],v[40:43],v[128:131]
 buffer_load_dwordx4 v[228:231],v0,s[12:15],s57 offen sc1
 v_mfma_f32_16x16x32_bf16 v[132:135],a[180:183],v[40:43],v[132:135]
 buffer_load_dwordx4 v193,s[8:11],s50 offen offset:1024 lds
 v_mfma_f32_16x16x32_bf16 v[136:139],a[176:179],v[44:47],v[136:139]
 ds_read_b64_tr_b16 v[64:65],v180 offset:55296
 ds_read_b64_tr_b16 v[66:67],v180 offset:55808
 v_mfma_f32_16x16x32_bf16 v[140:143],a[180:183],v[44:47],v[140:143]
 s_waitcnt lgkmcnt(6)
 ds_read_b64_tr_b16 v[68:69],v181 offset:55296
 ds_read_b64_tr_b16 v[70:71],v181 offset:55808
 ds_read_b64_tr_b16 v[72:73],v182 offset:55296
 ds_read_b64_tr_b16 v[74:75],v182 offset:55808
 ds_read_b64_tr_b16 v[76:77],v183 offset:55296
 ds_read_b64_tr_b16 v[78:79],v183 offset:55808
 v_mfma_f32_16x16x32_bf16 v[80:83],v[48:51],a[184:187],v[80:83]
 buffer_load_dwordx4 v[232:235],v0,s[12:15],s57 offen offset:1024 sc1
 v_mfma_f32_16x16x32_bf16 v[88:91],v[48:51],a[188:191],v[88:91]
 buffer_load_dwordx4 v206,s[8:11],s50 offen offset:2048 lds
 v_mfma_f32_16x16x32_bf16 v[84:87],v[52:55],a[184:187],v[84:87]
 buffer_load_dwordx4 v[236:239],v0,s[12:15],s57 offen offset:2048 sc1
 v_mfma_f32_16x16x32_bf16 v[92:95],v[52:55],a[188:191],v[92:95]
 s_waitcnt lgkmcnt(8)
 v_mfma_f32_16x16x32_bf16 v[96:99],v[56:59],a[184:187],v[96:99]
 buffer_load_dwordx4 v207,s[8:11],s50 offen offset:3072 lds
 v_mfma_f32_16x16x32_bf16 v[104:107],v[56:59],a[188:191],v[104:107]
 s_add_u32 m0,s51,98304
 buffer_load_dwordx4 v[240:243],v0,s[12:15],s57 offen offset:3072 sc1
 v_mfma_f32_16x16x32_bf16 v[100:103],v[60:63],a[184:187],v[100:103]
 s_mul_i32 s50,s49,3072
 v_mfma_f32_16x16x32_bf16 v[108:111],v[60:63],a[188:191],v[108:111]
 s_waitcnt vmcnt(24) lgkmcnt(0)
 s_barrier
 ds_read_b128 a[192:195],v184
 ds_read_b128 a[196:199],v184 offset:2048
 ds_read_b64_tr_b16 v[16:17],v176 offset:4096
 ds_read_b64_tr_b16 v[18:19],v176 offset:4608
 ds_read_b64_tr_b16 v[20:21],v177 offset:4096
 ds_read_b64_tr_b16 v[22:23],v177 offset:4608
 v_mfma_f32_16x16x32_bf16 v[112:115],a[184:187],v[64:67],v[112:115]
 buffer_load_dwordx4 v188,s[4:7],s49 offen lds
 v_mfma_f32_16x16x32_bf16 v[116:119],a[188:191],v[64:67],v[116:119]
 ds_read_b64_tr_b16 v[24:25],v178 offset:4096
 ds_read_b64_tr_b16 v[26:27],v178 offset:4608
 v_mfma_f32_16x16x32_bf16 v[120:123],a[184:187],v[68:71],v[120:123]
 ds_read_b64_tr_b16 v[28:29],v179 offset:4096
 ds_read_b64_tr_b16 v[30:31],v179 offset:4608
 v_mfma_f32_16x16x32_bf16 v[124:127],a[188:191],v[68:71],v[124:127]
 ds_read_b64_tr_b16 v[32:33],v176 offset:6144
 ds_read_b64_tr_b16 v[34:35],v176 offset:6656
 v_mfma_f32_16x16x32_bf16 v[128:131],a[184:187],v[72:75],v[128:131]
 buffer_load_dwordx4 v189,s[4:7],s49 offen offset:1024 lds
 v_mfma_f32_16x16x32_bf16 v[132:135],a[188:191],v[72:75],v[132:135]
 s_branch .Lsk1
.Lvs0_1:
 s_branch .Lvb0
.Lsk1:
 ds_read_b64_tr_b16 v[36:37],v177 offset:6144
 ds_read_b64_tr_b16 v[38:39],v177 offset:6656
 v_mfma_f32_16x16x32_bf16 v[136:139],a[184:187],v[76:79],v[136:139]
 ds_read_b64_tr_b16 v[40:41],v178 offset:6144
 ds_read_b64_tr_b16 v[42:43],v178 offset:6656
 v_mfma_f32_16x16x32_bf16 v[140:143],a[188:191],v[76:79],v[140:143]
 s_waitcnt lgkmcnt(10)
 ds_read_b64_tr_b16 v[44:45],v179 offset:6144
 ds_read_b64_tr_b16 v[46:47],v179 offset:6656
 v_mfma_f32_16x16x32_bf16 v[80:83],v[16:19],a[192:195],v[80:83]
 buffer_load_dwordx4 v190,s[4:7],s49 offen offset:2048 lds
 v_mfma_f32_16x16x32_bf16 v[88:91],v[16:19],a[196:199],v[88:91]
 ds_read_b128 a[200:203],v185
 ds_read_b128 a[204:207],v185 offset:2048
 v_mfma_f32_16x16x32_bf16 v[84:87],v[20:23],a[192:195],v[84:87]
 ds_read_b64_tr_b16 v[48:49],v176 offset:20480
 ds_read_b64_tr_b16 v[50:51],v176 offset:20992
 v_mfma_f32_16x16x32_bf16 v[92:95],v[20:23],a[196:199],v[92:95]
 s_waitcnt lgkmcnt(12)
 ds_read_b64_tr_b16 v[52:53],v177 offset:20480
 ds_read_b64_tr_b16 v[54:55],v177 offset:20992
 v_mfma_f32_16x16x32_bf16 v[96:99],v[24:27],a[192:195],v[96:99]
 buffer_load_dwordx4 v191,s[4:7],s49 offen offset:3072 lds
 v_mfma_f32_16x16x32_bf16 v[104:107],v[24:27],a[196:199],v[104:107]
 s_add_u32 m0,s51,102400
 ds_read_b64_tr_b16 v[56:57],v178 offset:20480
 ds_read_b64_tr_b16 v[58:59],v178 offset:20992
 v_mfma_f32_16x16x32_bf16 v[100:103],v[28:31],a[192:195],v[100:103]
 s_add_u32 s49,s49,128
 ds_read_b64_tr_b16 v[60:61],v179 offset:20480
 ds_read_b64_tr_b16 v[62:63],v179 offset:20992
 v_mfma_f32_16x16x32_bf16 v[108:111],v[28:31],a[196:199],v[108:111]
 s_waitcnt lgkmcnt(14)
 ds_read_b64_tr_b16 v[64:65],v176 offset:22528
 ds_read_b64_tr_b16 v[66:67],v176 offset:23040
 v_mfma_f32_16x16x32_bf16 v[112:115],a[192:195],v[32:35],v[112:115]
 s_and_b32 s49,s49,2047
 buffer_load_dwordx4 v192,s[8:11],s50 offen lds
 v_mfma_f32_16x16x32_bf16 v[116:119],a[196:199],v[32:35],v[116:119]
 ds_read_b64_tr_b16 v[68:69],v177 offset:22528
 ds_read_b64_tr_b16 v[70:71],v177 offset:23040
 v_mfma_f32_16x16x32_bf16 v[120:123],a[192:195],v[36:39],v[120:123]
 ds_read_b64_tr_b16 v[72:73],v178 offset:22528
 ds_read_b64_tr_b16 v[74:75],v178 offset:23040
 v_mfma_f32_16x16x32_bf16 v[124:127],a[196:199],v[36:39],v[124:127]
 s_waitcnt lgkmcnt(14)
 ds_read_b64_tr_b16 v[76:77],v179 offset:22528
 ds_read_b64_tr_b16 v[78:79],v179 offset:23040
 v_mfma_f32_16x16x32_bf16 v[128:131],a[192:195],v[40:43],v[128:131]
 buffer_load_dwordx4 v193,s[8:11],s50 offen offset:1024 lds
 v_mfma_f32_16x16x32_bf16 v[132:135],a[196:199],v[40:43],v[132:135]
 v_mfma_f32_16x16x32_bf16 v[136:139],a[192:195],v[44:47],v[136:139]
 v_mfma_f32_16x16x32_bf16 v[140:143],a[196:199],v[44:47],v[140:143]
 s_waitcnt lgkmcnt(12)
 v_mfma_f32_16x16x32_bf16 v[80:83],v[48:51],a[200:203],v[80:83]
 buffer_load_dwordx4 v206,s[8:11],s50 offen offset:2048 lds
 v_mfma_f32_16x16x32_bf16 v[88:91],v[48:51],a[204:207],v[88:91]
 v_xor_b32 v206,0x2000,v4
 v_mfma_f32_16x16x32_bf16 v[84:87],v[52:55],a[200:203],v[84:87]
 v_mfma_f32_16x16x32_bf16 v[92:95],v[52:55],a[204:207],v[92:95]
 s_waitcnt vmcnt(23) lgkmcnt(0)
 s_barrier
 ds_read_b128 a[208:211],v184 offset:32768
 v_mfma_f32_16x16x32_bf16 v[96:99],v[56:59],a[200:203],v[96:99]
 buffer_load_dwordx4 v207,s[8:11],s50 offen offset:3072 lds
 v_mfma_f32_16x16x32_bf16 v[104:107],v[56:59],a[204:207],v[104:107]
 s_mul_i32 s50,s49,3072
 ds_read_b128 a[212:215],v184 offset:34816
 ds_read_b64_tr_b16 v[16:17],v176 offset:36864
 v_mfma_f32_16x16x32_bf16 v[100:103],v[60:63],a[200:203],v[100:103]
 s_lshl_b32 s50,s3,8
 ds_read_b64_tr_b16 v[18:19],v176 offset:37376
 ds_read_b64_tr_b16 v[20:21],v177 offset:36864
 v_mfma_f32_16x16x32_bf16 v[108:111],v[60:63],a[204:207],v[108:111]
 ds_read_b64_tr_b16 v[22:23],v177 offset:37376
 s_add_u32 s49,s49,s50
 v_mfma_f32_16x16x32_bf16 v[112:115],a[200:203],v[64:67],v[112:115]
 s_and_b32 s49,s49,2047
 s_mul_i32 s50,s49,3072
 s_mul_i32 s3,s3,196608
 v_mfma_f32_16x16x32_bf16 v[116:119],a[204:207],v[64:67],v[116:119]
 s_add_u32 s3,s3,2048
 v_subrev_u32 v188,s3,v192
 v_xor_b32 v188,512,v188
 v_mfma_f32_16x16x32_bf16 v[120:123],a[200:203],v[68:71],v[120:123]
 s_add_u32 m0,s51,0
 s_nop 0
 buffer_load_dwordx4 v188,s[8:11],s50 offen lds
 v_mfma_f32_16x16x32_bf16 v[124:127],a[204:207],v[68:71],v[124:127]
 ds_read_b64_tr_b16 v[24:25],v178 offset:36864
 ds_read_b64_tr_b16 v[26:27],v178 offset:37376
 ds_read_b64_tr_b16 v[28:29],v179 offset:36864
 ds_read_b64_tr_b16 v[30:31],v179 offset:37376
 v_mfma_f32_16x16x32_bf16 v[128:131],a[200:203],v[72:75],v[128:131]
 s_add_u32 s49,s49,128
 s_waitcnt vmcnt(20)
 v_add_f32 v160,v160,v164
 v_subrev_u32 v189,s3,v193
 v_mfma_f32_16x16x32_bf16 v[132:135],a[204:207],v[72:75],v[132:135]
 s_and_b32 s49,s49,2047
 v_xor_b32 v189,512,v189
 v_add_f32 v161,v161,v165
 v_mfma_f32_16x16x32_bf16 v[136:139],a[200:203],v[76:79],v[136:139]
 buffer_load_dwordx4 v189,s[8:11],s50 offen offset:1024 lds
 v_mfma_f32_16x16x32_bf16 v[140:143],a[204:207],v[76:79],v[140:143]
 s_waitcnt lgkmcnt(4)
 ds_read_b64_tr_b16 v[32:33],v176 offset:38912
 ds_read_b64_tr_b16 v[34:35],v176 offset:39424
 ds_read_b64_tr_b16 v[36:37],v177 offset:38912
 ds_read_b64_tr_b16 v[38:39],v177 offset:39424
 v_mfma_f32_16x16x32_bf16 v[80:83],v[16:19],a[208:211],v[80:83]
 v_add_f32 v162,v162,v166
 v_add_f32 v163,v163,v167
 v_mfma_f32_16x16x32_bf16 v[88:91],v[16:19],a[212:215],v[88:91]
 v_add_u32 v190,194560,v188
 ds_read_b64_tr_b16 v[40:41],v178 offset:38912
 v_mfma_f32_16x16x32_bf16 v[84:87],v[20:23],a[208:211],v[84:87]
 buffer_load_dwordx4 v190,s[8:11],s50 offen offset:2048 lds
 v_mfma_f32_16x16x32_bf16 v[92:95],v[20:23],a[212:215],v[92:95]
 s_waitcnt lgkmcnt(5)
 ds_read_b64_tr_b16 v[42:43],v178 offset:39424
 ds_read_b64_tr_b16 v[44:45],v179 offset:38912
 ds_read_b64_tr_b16 v[46:47],v179 offset:39424
 v_mfma_f32_16x16x32_bf16 v[96:99],v[24:27],a[208:211],v[96:99]
 s_waitcnt vmcnt(18)
 v_add_f32 v168,v168,v172
 v_add_f32 v169,v169,v173
 v_mfma_f32_16x16x32_bf16 v[104:107],v[24:27],a[212:215],v[104:107]
 v_add_u32 v191,194560,v189
 v_add_f32 v170,v170,v174
 v_mfma_f32_16x16x32_bf16 v[100:103],v[28:31],a[208:211],v[100:103]
 buffer_load_dwordx4 v191,s[8:11],s50 offen offset:3072 lds
 v_mfma_f32_16x16x32_bf16 v[108:111],v[28:31],a[212:215],v[108:111]
 s_waitcnt lgkmcnt(4)
 ds_read_b128 a[216:219],v185 offset:32768
 ds_read_b128 a[220:223],v185 offset:34816
 ds_read_b64_tr_b16 v[48:49],v176 offset:53248
 ds_read_b64_tr_b16 v[50:51],v176 offset:53760
 ds_read_b64_tr_b16 v[52:53],v177 offset:53248
 ds_read_b64_tr_b16 v[54:55],v177 offset:53760
 v_mfma_f32_16x16x32_bf16 v[112:115],a[208:211],v[32:35],v[112:115]
 s_add_u32 m0,s51,4096
 v_add_f32 v171,v171,v175
 v_add_f32 v160,v160,v168
 v_mfma_f32_16x16x32_bf16 v[116:119],a[212:215],v[32:35],v[116:119]
 s_mul_i32 s50,s49,3072
 buffer_load_dwordx4 v188,s[8:11],s50 offen lds
 v_mfma_f32_16x16x32_bf16 v[120:123],a[208:211],v[36:39],v[120:123]
 s_add_u32 s49,s49,384
 v_add_f32 v161,v161,v169
 ds_read_b64_tr_b16 v[56:57],v178 offset:53248
 v_mfma_f32_16x16x32_bf16 v[124:127],a[212:215],v[36:39],v[124:127]
 s_waitcnt lgkmcnt(7)
 ds_read_b64_tr_b16 v[58:59],v178 offset:53760
 ds_read_b64_tr_b16 v[60:61],v179 offset:53248
 ds_read_b64_tr_b16 v[62:63],v179 offset:53760
 v_mfma_f32_16x16x32_bf16 v[128:131],a[208:211],v[40:43],v[128:131]
 s_and_b32 s49,s49,2047
 v_add_f32 v162,v162,v170
 v_add_f32 v163,v163,v171
 v_mfma_f32_16x16x32_bf16 v[132:135],a[212:215],v[40:43],v[132:135]
 buffer_load_dwordx4 v189,s[8:11],s50 offen offset:1024 lds
 v_mfma_f32_16x16x32_bf16 v[136:139],a[208:211],v[44:47],v[136:139]
 ds_read_b64_tr_b16 v[64:65],v176 offset:55296
 ds_read_b64_tr_b16 v[66:67],v176 offset:55808
 v_mfma_f32_16x16x32_bf16 v[140:143],a[212:215],v[44:47],v[140:143]
 s_waitcnt lgkmcnt(6)
 ds_read_b64_tr_b16 v[68:69],v177 offset:55296
 ds_read_b64_tr_b16 v[70:71],v177 offset:55808
 ds_read_b64_tr_b16 v[72:73],v178 offset:55296
 ds_read_b64_tr_b16 v[74:75],v178 offset:55808
 ds_read_b64_tr_b16 v[76:77],v179 offset:55296
 ds_read_b64_tr_b16 v[78:79],v179 offset:55808
 v_mfma_f32_16x16x32_bf16 v[80:83],v[48:51],a[216:219],v[80:83]
 v_permlane16_swap_b32 v160,v161
 v_permlane16_swap_b32 v162,v163
 v_mfma_f32_16x16x32_bf16 v[88:91],v[48:51],a[220:223],v[88:91]
 buffer_load_dwordx4 v190,s[8:11],s50 offen offset:2048 lds
 v_mfma_f32_16x16x32_bf16 v[84:87],v[52:55],a[216:219],v[84:87]
 v_add_f32 v160,v160,v161
 v_add_f32 v162,v162,v163
 v_mfma_f32_16x16x32_bf16 v[92:95],v[52:55],a[220:223],v[92:95]
 s_waitcnt lgkmcnt(8)
 v_permlane32_swap_b32 v160,v162
 v_add_f32 v160,v160,v162
 v_mfma_f32_16x16x32_bf16 v[96:99],v[56:59],a[216:219],v[96:99]
 buffer_load_dwordx4 v191,s[8:11],s50 offen offset:3072 lds
 v_mfma_f32_16x16x32_bf16 v[104:107],v[56:59],a[220:223],v[104:107]
 s_mul_i32 s50,s49,3072
 v_mul_f32 v162,0x3a800000,v160
 s_add_u32 m0,s51,32768
 v_mfma_f32_16x16x32_bf16 v[100:103],v[60:63],a[216:219],v[100:103]
 s_add_u32 s49,s49,128
 v_mul_f32 v160,0x3a800000,v160
 s_and_b32 s49,s49,2047
 v_mfma_f32_16x16x32_bf16 v[108:111],v[60:63],a[220:223],v[108:111]
 s_waitcnt vmcnt(17) lgkmcnt(0)
 s_barrier
 ds_read_b128 a[224:227],v186
 ds_read_b128 a[228:231],v186 offset:2048
 ds_read_b64_tr_b16 v[16:17],v180 offset:4096
 ds_read_b64_tr_b16 v[18:19],v180 offset:4608
 ds_read_b64_tr_b16 v[20:21],v181 offset:4096
 ds_read_b64_tr_b16 v[22:23],v181 offset:4608
 v_mfma_f32_16x16x32_bf16 v[112:115],a[216:219],v[64:67],v[112:115]
 buffer_load_dwordx4 v188,s[8:11],s50 offen lds
 v_mfma_f32_16x16x32_bf16 v[116:119],a[220:223],v[64:67],v[116:119]
 ds_read_b64_tr_b16 v[24:25],v182 offset:4096
 ds_read_b64_tr_b16 v[26:27],v182 offset:4608
 v_mfma_f32_16x16x32_bf16 v[120:123],a[216:219],v[68:71],v[120:123]
 ds_read_b64_tr_b16 v[28:29],v183 offset:4096
 ds_read_b64_tr_b16 v[30:31],v183 offset:4608
 v_mfma_f32_16x16x32_bf16 v[124:127],a[220:223],v[68:71],v[124:127]
 v_permlane16_swap_b32 v160,v162
 v_fma_f32 v162,-v160,v160,v162
 v_mfma_f32_16x16x32_bf16 v[128:131],a[216:219],v[72:75],v[128:131]
 buffer_load_dwordx4 v189,s[8:11],s50 offen offset:1024 lds
 v_mfma_f32_16x16x32_bf16 v[132:135],a[220:223],v[72:75],v[132:135]
 v_max_f32 v162,0,v162
 ds_read_b64_tr_b16 v[32:33],v180 offset:6144
 v_mfma_f32_16x16x32_bf16 v[136:139],a[216:219],v[76:79],v[136:139]
 ds_read_b64_tr_b16 v[34:35],v180 offset:6656
 ds_read_b64_tr_b16 v[36:37],v181 offset:6144
 v_mfma_f32_16x16x32_bf16 v[140:143],a[220:223],v[76:79],v[140:143]
 s_waitcnt lgkmcnt(7)
 ds_read_b64_tr_b16 v[38:39],v181 offset:6656
 v_add_f32 v162,0x3727c5ac,v162
 v_mfma_f32_16x16x32_bf16 v[80:83],v[16:19],a[224:227],v[80:83]
 v_rsq_f32 v161,v162
 v_mfma_f32_16x16x32_bf16 v[88:91],v[16:19],a[228:231],v[88:91]
 buffer_load_dwordx4 v190,s[8:11],s50 offen offset:2048 lds
 v_mfma_f32_16x16x32_bf16 v[84:87],v[20:23],a[224:227],v[84:87]
 v_cvt_pk_bf16_f32 v208,-v160,-v160
 ds_read_b64_tr_b16 v[40:41],v182 offset:6144
 v_mfma_f32_16x16x32_bf16 v[92:95],v[20:23],a[228:231],v[92:95]
 s_waitcnt lgkmcnt(5)
 ds_read_b64_tr_b16 v[42:43],v182 offset:6656
 ds_read_b64_tr_b16 v[44:45],v183 offset:6144
 ds_read_b64_tr_b16 v[46:47],v183 offset:6656
 v_mfma_f32_16x16x32_bf16 v[96:99],v[24:27],a[224:227],v[96:99]
 ds_write_b32 v200,v161
 v_mfma_f32_16x16x32_bf16 v[104:107],v[24:27],a[228:231],v[104:107]
 ds_read_b128 v[220:223],v194
 ds_read_b128 a[232:235],v187
 v_mfma_f32_16x16x32_bf16 v[100:103],v[28:31],a[224:227],v[100:103]
 buffer_load_dwordx4 v191,s[8:11],s50 offen offset:3072 lds
 v_mfma_f32_16x16x32_bf16 v[108:111],v[28:31],a[228:231],v[108:111]
 s_waitcnt lgkmcnt(7)
 ds_read_b128 a[236:239],v187 offset:2048
 ds_read_b64_tr_b16 v[48:49],v180 offset:20480
 ds_read_b64_tr_b16 v[50:51],v180 offset:20992
 ds_read_b64_tr_b16 v[52:53],v181 offset:20480
 ds_read_b64_tr_b16 v[54:55],v181 offset:20992
 v_mfma_f32_16x16x32_bf16 v[112:115],a[224:227],v[32:35],v[112:115]
 s_add_u32 m0,s51,36864
 ds_read_b128 v[224:227],v194 offset:64
 v_mov_b32 v217,v161
 v_mfma_f32_16x16x32_bf16 v[116:119],a[228:231],v[32:35],v[116:119]
 s_mul_i32 s50,s49,3072
 buffer_load_dwordx4 v188,s[8:11],s50 offen lds
 v_mfma_f32_16x16x32_bf16 v[120:123],a[224:227],v[36:39],v[120:123]
 s_add_u32 s49,s49,384
 v_mov_b32 v212,v208
 ds_read_b64_tr_b16 v[56:57],v182 offset:20480
 v_mfma_f32_16x16x32_bf16 v[124:127],a[228:231],v[36:39],v[124:127]
 s_waitcnt lgkmcnt(10)
 ds_read_b64_tr_b16 v[58:59],v182 offset:20992
 ds_read_b64_tr_b16 v[60:61],v183 offset:20480
 ds_read_b64_tr_b16 v[62:63],v183 offset:20992
 v_mfma_f32_16x16x32_bf16 v[128:131],a[224:227],v[40:43],v[128:131]
 s_and_b32 s49,s49,2047
 v_permlane32_swap_b32 v208,v212
 v_mov_b32 v219,v217
 v_mfma_f32_16x16x32_bf16 v[132:135],a[228:231],v[40:43],v[132:135]
 buffer_load_dwordx4 v189,s[8:11],s50 offen offset:1024 lds
 v_mfma_f32_16x16x32_bf16 v[136:139],a[224:227],v[44:47],v[136:139]
 v_permlane32_swap_b32 v217,v219
 ds_read_b64_tr_b16 v[64:65],v180 offset:22528
 v_mfma_f32_16x16x32_bf16 v[140:143],a[228:231],v[44:47],v[140:143]
 s_waitcnt lgkmcnt(6)
 ds_read_b64_tr_b16 v[66:67],v180 offset:23040
 ds_read_b64_tr_b16 v[68:69],v181 offset:22528
 ds_read_b64_tr_b16 v[70:71],v181 offset:23040
 ds_read_b64_tr_b16 v[72:73],v182 offset:22528
 ds_read_b64_tr_b16 v[74:75],v182 offset:23040
 ds_read_b64_tr_b16 v[76:77],v183 offset:22528
 ds_read_b64_tr_b16 v[78:79],v183 offset:23040
 v_mfma_f32_16x16x32_bf16 v[80:83],v[48:51],a[232:235],v[80:83]
 v_mov_b32 v209,v208
 v_mov_b32 v210,v208
 v_mfma_f32_16x16x32_bf16 v[88:91],v[48:51],a[236:239],v[88:91]
 buffer_load_dwordx4 v190,s[8:11],s50 offen offset:2048 lds
 v_mfma_f32_16x16x32_bf16 v[84:87],v[52:55],a[232:235],v[84:87]
 v_mov_b32 v211,v208
 v_mov_b32 v213,v212
 v_mfma_f32_16x16x32_bf16 v[92:95],v[52:55],a[236:239],v[92:95]
 s_waitcnt lgkmcnt(8)
 v_mov_b32 v214,v212
 v_xor_b32 v207,0x8000,v4
 v_mfma_f32_16x16x32_bf16 v[96:99],v[56:59],a[232:235],v[96:99]
 s_movk_i32 s61,448
 buffer_load_dwordx4 v191,s[8:11],s50 offen offset:3072 lds
 v_mfma_f32_16x16x32_bf16 v[104:107],v[56:59],a[236:239],v[104:107]
 s_cmp_lt_u32 s44,7
 s_cselect_b32 s61,238,s61
 v_mov_b32 v215,v212
 v_mfma_f32_16x16x32_bf16 v[100:103],v[60:63],a[232:235],v[100:103]
 s_mul_i32 s50,s49,3072
 s_add_u32 m0,s51,65536
 s_add_u32 s49,s49,128
 v_mfma_f32_16x16x32_bf16 v[108:111],v[60:63],a[236:239],v[108:111]
 s_waitcnt vmcnt(16) lgkmcnt(0)
 s_barrier
 ds_read_b128 a[240:243],v186 offset:32768
 ds_read_b128 a[244:247],v186 offset:34816
 ds_read_b64_tr_b16 v[16:17],v180 offset:36864
 ds_read_b64_tr_b16 v[18:19],v180 offset:37376
 ds_read_b64_tr_b16 v[20:21],v181 offset:36864
 ds_read_b64_tr_b16 v[22:23],v181 offset:37376
 v_mfma_f32_16x16x32_bf16 v[112:115],a[232:235],v[64:67],v[112:115]
 s_cmp_lt_u32 s44,4
 s_cselect_b32 s61,148,s61
 ds_read_b64_tr_b16 v[24:25],v182 offset:36864
 v_mfma_f32_16x16x32_bf16 v[116:119],a[236:239],v[64:67],v[116:119]
 s_add_u32 s61,s61,s44
 buffer_load_dwordx4 v188,s[8:11],s50 offen lds
 v_mfma_f32_16x16x32_bf16 v[120:123],a[232:235],v[68:71],v[120:123]
 s_and_b32 s49,s49,2047
 ds_read_b64_tr_b16 v[26:27],v182 offset:37376
 ds_read_b64_tr_b16 v[28:29],v183 offset:36864
 v_mfma_f32_16x16x32_bf16 v[124:127],a[236:239],v[68:71],v[124:127]
 ds_read_b64_tr_b16 v[30:31],v183 offset:37376
 ds_read_b64_tr_b16 v[32:33],v180 offset:38912
 v_mfma_f32_16x16x32_bf16 v[128:131],a[232:235],v[72:75],v[128:131]
 buffer_load_dwordx4 v189,s[8:11],s50 offen offset:1024 lds
 v_mfma_f32_16x16x32_bf16 v[132:135],a[236:239],v[72:75],v[132:135]
 ds_read_b64_tr_b16 v[34:35],v180 offset:39424
 ds_read_b64_tr_b16 v[36:37],v181 offset:38912
 v_mfma_f32_16x16x32_bf16 v[136:139],a[232:235],v[76:79],v[136:139]
 ds_read_b64_tr_b16 v[38:39],v181 offset:39424
 ds_read_b64_tr_b16 v[40:41],v182 offset:38912
 v_mfma_f32_16x16x32_bf16 v[140:143],a[236:239],v[76:79],v[140:143]
 s_waitcnt lgkmcnt(9)
 ds_read_b64_tr_b16 v[42:43],v182 offset:39424
 ds_read_b64_tr_b16 v[44:45],v183 offset:38912
 v_mfma_f32_16x16x32_bf16 v[80:83],v[16:19],a[240:243],v[80:83]
 buffer_load_dwordx4 v190,s[8:11],s50 offen offset:2048 lds
 v_mfma_f32_16x16x32_bf16 v[88:91],v[16:19],a[244:247],v[88:91]
 ds_read_b64_tr_b16 v[46:47],v183 offset:39424
 ds_read_b128 a[248:251],v187 offset:32768
 v_mfma_f32_16x16x32_bf16 v[84:87],v[20:23],a[240:243],v[84:87]
 ds_read_b128 a[252:255],v187 offset:34816
 ds_read_b64_tr_b16 v[48:49],v180 offset:53248
 v_mfma_f32_16x16x32_bf16 v[92:95],v[20:23],a[244:247],v[92:95]
 s_waitcnt lgkmcnt(11)
 ds_read_b64_tr_b16 v[50:51],v180 offset:53760
 ds_read_b64_tr_b16 v[52:53],v181 offset:53248
 v_mfma_f32_16x16x32_bf16 v[96:99],v[24:27],a[240:243],v[96:99]
 buffer_load_dwordx4 v191,s[8:11],s50 offen offset:3072 lds
 v_mfma_f32_16x16x32_bf16 v[104:107],v[24:27],a[244:247],v[104:107]
 s_add_u32 m0,s51,69632
 ds_read_b64_tr_b16 v[54:55],v181 offset:53760
 s_mul_i32 s50,s49,3072
 v_mfma_f32_16x16x32_bf16 v[100:103],v[28:31],a[240:243],v[100:103]
 s_add_u32 s49,s49,384
 ds_read_b64_tr_b16 v[56:57],v182 offset:53248
 ds_read_b64_tr_b16 v[58:59],v182 offset:53760
 v_mfma_f32_16x16x32_bf16 v[108:111],v[28:31],a[244:247],v[108:111]
 s_waitcnt lgkmcnt(12)
 ds_read_b64_tr_b16 v[60:61],v183 offset:53248
 ds_read_b64_tr_b16 v[62:63],v183 offset:53760
 v_mfma_f32_16x16x32_bf16 v[112:115],a[240:243],v[32:35],v[112:115]
 s_and_b32 s49,s49,2047
 buffer_load_dwordx4 v188,s[8:11],s50 offen lds
 v_mfma_f32_16x16x32_bf16 v[116:119],a[244:247],v[32:35],v[116:119]
 s_lshl_b32 s56,s45,12
 v_lshlrev_b32 v199,2,v12
 ds_read_b64_tr_b16 v[64:65],v180 offset:55296
 v_mfma_f32_16x16x32_bf16 v[120:123],a[240:243],v[36:39],v[120:123]
 s_add_u32 s56,s56,262144
 ds_read_b64_tr_b16 v[66:67],v180 offset:55808
 ds_read_b64_tr_b16 v[68:69],v181 offset:55296
 v_mfma_f32_16x16x32_bf16 v[124:127],a[244:247],v[36:39],v[124:127]
 s_waitcnt lgkmcnt(13)
 ds_read_b64_tr_b16 v[70:71],v181 offset:55808
 ds_read_b64_tr_b16 v[72:73],v182 offset:55296
 v_mfma_f32_16x16x32_bf16 v[128:131],a[240:243],v[40:43],v[128:131]
 buffer_load_dwordx4 v189,s[8:11],s50 offen offset:1024 lds
 v_mfma_f32_16x16x32_bf16 v[132:135],a[244:247],v[40:43],v[132:135]
 ds_read_b64_tr_b16 v[74:75],v182 offset:55808
 ds_read_b64_tr_b16 v[76:77],v183 offset:55296
 v_mfma_f32_16x16x32_bf16 v[136:139],a[240:243],v[44:47],v[136:139]
 ds_read_b64_tr_b16 v[78:79],v183 offset:55808
 v_mfma_f32_16x16x32_bf16 v[140:143],a[244:247],v[44:47],v[140:143]
 s_waitcnt lgkmcnt(12)
 v_mfma_f32_16x16x32_bf16 v[80:83],v[48:51],a[248:251],v[80:83]
 buffer_load_dwordx4 v190,s[8:11],s50 offen offset:2048 lds
 v_mfma_f32_16x16x32_bf16 v[88:91],v[48:51],a[252:255],v[88:91]
 v_mfma_f32_16x16x32_bf16 v[84:87],v[52:55],a[248:251],v[84:87]
 s_xor_b32 s57,s45,4
 s_lshl_b32 s57,s57,19
 s_lshl_b32 s3,s47,12
 s_add_u32 s57,s57,s3
 s_xor_b32 s3,s45,4
 s_lshl_b32 s3,s3,9
 s_add_u32 s61,s61,s3
 s_lshl_b32 s61,s61,2
 s_add_u32 s61,s61,s46
 s_lshl_b32 s61,s61,8
 s_add_u32 s61,s61,25165824
 buffer_store_dword v6,v199,s[12:15],s61 offen sc1
 v_mfma_f32_16x16x32_bf16 v[92:95],v[52:55],a[252:255],v[92:95]
 s_add_u32 s57,s57,8388608
 s_add_u32 s58,s57,262144
 s_waitcnt lgkmcnt(8)
 v_mfma_f32_16x16x32_bf16 v[96:99],v[56:59],a[248:251],v[96:99]
 buffer_load_dwordx4 v191,s[8:11],s50 offen offset:3072 lds
 v_mfma_f32_16x16x32_bf16 v[104:107],v[56:59],a[252:255],v[104:107]
 s_mul_i32 s50,s49,3072
 s_add_u32 m0,s51,98304
 s_add_u32 s49,s49,128
 v_mfma_f32_16x16x32_bf16 v[100:103],v[60:63],a[248:251],v[100:103]
 s_waitcnt vmcnt(17) lgkmcnt(0)
 s_barrier
 s_and_b32 s49,s49,2047
 ds_read_b64_tr_b16 v[16:17],v176
 v_mfma_f32_16x16x32_bf16 v[108:111],v[60:63],a[252:255],v[108:111]
 ds_read_b64_tr_b16 v[18:19],v176 offset:512
 ds_read_b64_tr_b16 v[20:21],v177
 v_mfma_f32_16x16x32_bf16 v[112:115],a[248:251],v[64:67],v[112:115]
 buffer_load_dwordx4 v188,s[8:11],s50 offen lds
 v_mfma_f32_16x16x32_bf16 v[116:119],a[252:255],v[64:67],v[116:119]
 ds_read_b64_tr_b16 v[22:23],v177 offset:512
 ds_read_b64_tr_b16 v[24:25],v178
 v_mfma_f32_16x16x32_bf16 v[120:123],a[248:251],v[68:71],v[120:123]
 buffer_load_dwordx4 v189,s[8:11],s50 offen offset:1024 lds
 v_mfma_f32_16x16x32_bf16 v[124:127],a[252:255],v[68:71],v[124:127]
 ds_read_b64_tr_b16 v[26:27],v178 offset:512
 ds_read_b64_tr_b16 v[28:29],v179
 v_mfma_f32_16x16x32_bf16 v[128:131],a[248:251],v[72:75],v[128:131]
 buffer_load_dwordx4 v190,s[8:11],s50 offen offset:2048 lds
 v_mfma_f32_16x16x32_bf16 v[132:135],a[252:255],v[72:75],v[132:135]
 ds_read_b64_tr_b16 v[30:31],v179 offset:512
 ds_read_b64_tr_b16 v[32:33],v176 offset:2048
 v_mfma_f32_16x16x32_bf16 v[136:139],a[248:251],v[76:79],v[136:139]
 buffer_load_dwordx4 v191,s[8:11],s50 offen offset:3072 lds
 v_mfma_f32_16x16x32_bf16 v[140:143],a[252:255],v[76:79],v[140:143]
 s_add_u32 m0,s51,102400
 s_mul_i32 s50,s49,3072
 ds_read_b64_tr_b16 v[34:35],v176 offset:2560
 v_mfma_f32_16x16x16_bf16 v[80:83],v[228:229],v[208:209],v[80:83]
 s_add_u32 s49,s49,384
 buffer_load_dwordx4 v188,s[8:11],s50 offen lds
 v_mfma_f32_16x16x16_bf16 v[88:91],v[228:229],v[212:213],v[88:91]
 s_and_b32 s49,s49,2047
 ds_read_b64_tr_b16 v[36:37],v177 offset:2048
 ds_read_b64_tr_b16 v[38:39],v177 offset:2560
 v_mfma_f32_16x16x16_bf16 v[84:87],v[230:231],v[208:209],v[84:87]
 buffer_load_dwordx4 v189,s[8:11],s50 offen offset:1024 lds
 v_mfma_f32_16x16x16_bf16 v[92:95],v[230:231],v[212:213],v[92:95]
 ds_read_b64_tr_b16 v[40:41],v178 offset:2048
 ds_read_b64_tr_b16 v[42:43],v178 offset:2560
 v_mfma_f32_16x16x16_bf16 v[96:99],v[232:233],v[208:209],v[96:99]
 buffer_load_dwordx4 v190,s[8:11],s50 offen offset:2048 lds
 v_mfma_f32_16x16x16_bf16 v[104:107],v[232:233],v[212:213],v[104:107]
 v_mul_f32 v80,v80,v217
 v_mul_f32 v81,v81,v217
 v_mfma_f32_16x16x16_bf16 v[100:103],v[234:235],v[208:209],v[100:103]
 v_mul_f32 v82,v82,v217
 v_mul_f32 v83,v83,v217
 v_mfma_f32_16x16x16_bf16 v[108:111],v[234:235],v[212:213],v[108:111]
 buffer_load_dwordx4 v191,s[8:11],s50 offen offset:3072 lds
 v_mfma_f32_16x16x16_bf16 v[112:115],v[208:209],v[236:237],v[112:115]
 s_mul_i32 s50,s49,3072
 v_mul_f32 v84,v84,v217
 v_mul_f32 v85,v85,v217
 v_mfma_f32_16x16x16_bf16 v[116:119],v[212:213],v[236:237],v[116:119]
 v_mul_f32 v86,v86,v217
 v_mul_f32 v87,v87,v217
 v_mfma_f32_16x16x16_bf16 v[120:123],v[208:209],v[238:239],v[120:123]
 v_cvt_pk_bf16_f32 v80,v80,v81
 v_cvt_pk_bf16_f32 v81,v82,v83
 v_mfma_f32_16x16x16_bf16 v[124:127],v[212:213],v[238:239],v[124:127]
 v_cvt_pk_bf16_f32 v82,v84,v85
 v_cvt_pk_bf16_f32 v83,v86,v87
 v_mul_f32 v88,v88,v219
 v_mul_f32 v89,v89,v219
 v_mfma_f32_16x16x16_bf16 v[128:131],v[208:209],v[240:241],v[128:131]
 v_mul_f32 v90,v90,v219
 v_mul_f32 v91,v91,v219
 v_mul_f32 v92,v92,v219
 v_mfma_f32_16x16x16_bf16 v[132:135],v[212:213],v[240:241],v[132:135]
 v_mul_f32 v93,v93,v219
 v_mul_f32 v94,v94,v219
 v_mul_f32 v95,v95,v219
 v_cvt_pk_bf16_f32 v88,v88,v89
 v_mfma_f32_16x16x16_bf16 v[136:139],v[208:209],v[242:243],v[136:139]
 v_cvt_pk_bf16_f32 v89,v90,v91
 v_cvt_pk_bf16_f32 v90,v92,v93
 v_cvt_pk_bf16_f32 v91,v94,v95
 v_mfma_f32_16x16x16_bf16 v[140:143],v[212:213],v[242:243],v[140:143]
 s_waitcnt lgkmcnt(10)
 v_permlane16_swap_b32 v80,v88
 v_permlane16_swap_b32 v81,v89
 v_permlane16_swap_b32 v82,v90
 v_permlane16_swap_b32 v83,v91
 v_mfma_f32_16x16x32_bf16 v[144:147],v[16:19],a[0:3],0
 buffer_store_dwordx4 v[80:83],v202,s[12:15],s57 offen sc1
 buffer_store_dwordx4 v[88:91],v202,s[12:15],s57 offen offset:1024 sc1
 v_mul_f32 v96,v96,v217
 v_mul_f32 v97,v97,v217
 v_mfma_f32_16x16x32_bf16 v[152:155],v[16:19],a[4:7],0
 v_mul_f32 v98,v98,v217
 v_mul_f32 v99,v99,v217
 v_mul_f32 v100,v100,v217
 v_mfma_f32_16x16x32_bf16 v[148:151],v[20:23],a[0:3],0
 v_mul_f32 v101,v101,v217
 v_mul_f32 v102,v102,v217
 v_mul_f32 v103,v103,v217
 v_cvt_pk_bf16_f32 v96,v96,v97
 v_mfma_f32_16x16x32_bf16 v[156:159],v[20:23],a[4:7],0
 s_waitcnt lgkmcnt(6)
 v_cvt_pk_bf16_f32 v97,v98,v99
 v_cvt_pk_bf16_f32 v98,v100,v101
 v_cvt_pk_bf16_f32 v99,v102,v103
 ds_read_b64_tr_b16 v[44:45],v179 offset:2048
 ds_read_b64_tr_b16 v[46:47],v179 offset:2560
 v_mfma_f32_16x16x32_bf16 v[160:163],v[24:27],a[0:3],0
 v_mul_f32 v104,v104,v219
 v_mul_f32 v105,v105,v219
 v_mul_f32 v106,v106,v219
 v_mul_f32 v107,v107,v219
 v_mfma_f32_16x16x32_bf16 v[168:171],v[24:27],a[4:7],0
 v_mul_f32 v108,v108,v219
 v_mul_f32 v109,v109,v219
 v_mul_f32 v110,v110,v219
 v_mfma_f32_16x16x32_bf16 v[164:167],v[28:31],a[0:3],0
 v_mul_f32 v111,v111,v219
 v_cvt_pk_bf16_f32 v104,v104,v105
 v_cvt_pk_bf16_f32 v105,v106,v107
 v_cvt_pk_bf16_f32 v106,v108,v109
 v_mfma_f32_16x16x32_bf16 v[172:175],v[28:31],a[4:7],0
 s_waitcnt lgkmcnt(4)
 v_cvt_pk_bf16_f32 v107,v110,v111
 v_permlane16_swap_b32 v96,v104
 v_permlane16_swap_b32 v97,v105
 ds_read_b64_tr_b16 v[48:49],v176 offset:4096
 ds_read_b64_tr_b16 v[50:51],v176 offset:4608
 ds_read_b64_tr_b16 v[52:53],v177 offset:4096
 ds_read_b64_tr_b16 v[54:55],v177 offset:4608
 v_mfma_f32_16x16x32_bf16 v[144:147],v[32:35],a[8:11],v[144:147]
 v_permlane16_swap_b32 v98,v106
 v_permlane16_swap_b32 v99,v107
 buffer_store_dwordx4 v[96:99],v202,s[12:15],s58 offen sc1
 buffer_store_dwordx4 v[104:107],v202,s[12:15],s58 offen offset:1024 sc1
 v_mfma_f32_16x16x32_bf16 v[152:155],v[32:35],a[12:15],v[152:155]
 s_xor_b32 s57,s57,2621440
 s_xor_b32 s58,s58,2621440
 v_mul_f32 v112,v112,v220
 v_mul_f32 v113,v113,v221
 v_mfma_f32_16x16x32_bf16 v[148:151],v[36:39],a[8:11],v[148:151]
 v_mul_f32 v114,v114,v222
 v_mul_f32 v115,v115,v223
 v_mul_f32 v116,v116,v224
 v_mfma_f32_16x16x32_bf16 v[156:159],v[36:39],a[12:15],v[156:159]
 s_waitcnt lgkmcnt(4)
 v_mul_f32 v117,v117,v225
 v_mul_f32 v118,v118,v226
 v_mul_f32 v119,v119,v227
 v_cvt_pk_bf16_f32 v112,v112,v113
 ds_read_b64_tr_b16 v[56:57],v178 offset:4096
 ds_read_b64_tr_b16 v[58:59],v178 offset:4608
 ds_read_b64_tr_b16 v[60:61],v179 offset:4096
 ds_read_b64_tr_b16 v[62:63],v179 offset:4608
 v_mfma_f32_16x16x32_bf16 v[160:163],v[40:43],a[8:11],v[160:163]
 v_cvt_pk_bf16_f32 v113,v114,v115
 v_cvt_pk_bf16_f32 v114,v116,v117
 v_cvt_pk_bf16_f32 v115,v118,v119
 v_mfma_f32_16x16x32_bf16 v[168:171],v[40:43],a[12:15],v[168:171]
 buffer_store_dwordx4 v[112:115],v203,s[12:15],s57 offen offset:2048 sc1
 v_mul_f32 v120,v120,v220
 v_mul_f32 v121,v121,v221
 v_mul_f32 v122,v122,v222
 v_mfma_f32_16x16x32_bf16 v[164:167],v[44:47],a[8:11],v[164:167]
 s_branch .Lsk2
.Lvs0_2:
 s_branch .Lvb0
.Lsk2:
 v_mul_f32 v123,v123,v223
 v_mul_f32 v124,v124,v224
 v_mul_f32 v125,v125,v225
 v_mfma_f32_16x16x32_bf16 v[172:175],v[44:47],a[12:15],v[172:175]
 s_waitcnt lgkmcnt(4)
 v_mul_f32 v126,v126,v226
 v_mul_f32 v127,v127,v227
 v_cvt_pk_bf16_f32 v120,v120,v121
 v_cvt_pk_bf16_f32 v121,v122,v123
 ds_read_b64_tr_b16 v[64:65],v176 offset:6144
 ds_read_b64_tr_b16 v[66:67],v176 offset:6656
 ds_read_b64_tr_b16 v[68:69],v177 offset:6144
 ds_read_b64_tr_b16 v[70:71],v177 offset:6656
 v_mfma_f32_16x16x32_bf16 v[144:147],v[48:51],a[16:19],v[144:147]
 v_cvt_pk_bf16_f32 v122,v124,v125
 v_cvt_pk_bf16_f32 v123,v126,v127
 buffer_store_dwordx4 v[120:123],v203,s[12:15],s57 offen offset:2176 sc1
 v_mul_f32 v128,v128,v220
 v_mul_f32 v129,v129,v221
 v_mul_f32 v130,v130,v222
 v_mul_f32 v131,v131,v223
 v_mul_f32 v132,v132,v224
 v_mul_f32 v133,v133,v225
 v_mul_f32 v134,v134,v226
 v_mul_f32 v135,v135,v227
 v_cvt_pk_bf16_f32 v128,v128,v129
 v_cvt_pk_bf16_f32 v129,v130,v131
 v_cvt_pk_bf16_f32 v130,v132,v133
 v_cvt_pk_bf16_f32 v131,v134,v135
 buffer_store_dwordx4 v[128:131],v203,s[12:15],s58 offen offset:2048 sc1
 v_mul_f32 v136,v136,v220
 v_mul_f32 v137,v137,v221
 v_mul_f32 v138,v138,v222
 v_mul_f32 v139,v139,v223
 v_mul_f32 v140,v140,v224
 v_mul_f32 v141,v141,v225
 v_mul_f32 v142,v142,v226
 v_mul_f32 v143,v143,v227
 v_cvt_pk_bf16_f32 v136,v136,v137
 v_cvt_pk_bf16_f32 v137,v138,v139
 v_cvt_pk_bf16_f32 v138,v140,v141
 v_cvt_pk_bf16_f32 v139,v142,v143
 buffer_store_dwordx4 v[136:139],v203,s[12:15],s58 offen offset:2176 sc1
 v_mfma_f32_16x16x32_bf16 v[152:155],v[48:51],a[20:23],v[152:155]
 ds_read_b64_tr_b16 v[72:73],v178 offset:6144
 ds_read_b64_tr_b16 v[74:75],v178 offset:6656
 v_mfma_f32_16x16x32_bf16 v[148:151],v[52:55],a[16:19],v[148:151]
 ds_read_b64_tr_b16 v[76:77],v179 offset:6144
 ds_read_b64_tr_b16 v[78:79],v179 offset:6656
 v_mfma_f32_16x16x32_bf16 v[156:159],v[52:55],a[20:23],v[156:159]
 s_waitcnt lgkmcnt(8)
 ds_read_b64_tr_b16 v[16:17],v176 offset:16384
 ds_read_b64_tr_b16 v[18:19],v176 offset:16896
 v_mfma_f32_16x16x32_bf16 v[160:163],v[56:59],a[16:19],v[160:163]
 ds_read_b64_tr_b16 v[20:21],v177 offset:16384
 ds_read_b64_tr_b16 v[22:23],v177 offset:16896
 v_mfma_f32_16x16x32_bf16 v[168:171],v[56:59],a[20:23],v[168:171]
 ds_read_b64_tr_b16 v[24:25],v178 offset:16384
 ds_read_b64_tr_b16 v[26:27],v178 offset:16896
 v_mfma_f32_16x16x32_bf16 v[164:167],v[60:63],a[16:19],v[164:167]
 ds_read_b64_tr_b16 v[28:29],v179 offset:16384
 ds_read_b64_tr_b16 v[30:31],v179 offset:16896
 v_mfma_f32_16x16x32_bf16 v[172:175],v[60:63],a[20:23],v[172:175]
 s_waitcnt lgkmcnt(12)
 ds_read_b64_tr_b16 v[32:33],v176 offset:18432
 ds_read_b64_tr_b16 v[34:35],v176 offset:18944
 v_mfma_f32_16x16x32_bf16 v[144:147],v[64:67],a[24:27],v[144:147]
 ds_read_b64_tr_b16 v[36:37],v177 offset:18432
 ds_read_b64_tr_b16 v[38:39],v177 offset:18944
 v_mfma_f32_16x16x32_bf16 v[152:155],v[64:67],a[28:31],v[152:155]
 ds_read_b64_tr_b16 v[40:41],v178 offset:18432
 ds_read_b64_tr_b16 v[42:43],v178 offset:18944
 v_mfma_f32_16x16x32_bf16 v[148:151],v[68:71],a[24:27],v[148:151]
 ds_read_b64_tr_b16 v[44:45],v179 offset:18432
 ds_read_b64_tr_b16 v[46:47],v179 offset:18944
 v_mfma_f32_16x16x32_bf16 v[156:159],v[68:71],a[28:31],v[156:159]
 s_waitcnt lgkmcnt(14)
 ds_read_b64_tr_b16 v[48:49],v176 offset:20480
 ds_read_b64_tr_b16 v[50:51],v176 offset:20992
 v_mfma_f32_16x16x32_bf16 v[160:163],v[72:75],a[24:27],v[160:163]
 buffer_load_dwordx4 v[228:231],v0,s[12:15],s56 offen sc1
 v_mfma_f32_16x16x32_bf16 v[168:171],v[72:75],a[28:31],v[168:171]
 ds_read_b64_tr_b16 v[52:53],v177 offset:20480
 ds_read_b64_tr_b16 v[54:55],v177 offset:20992
 v_mfma_f32_16x16x32_bf16 v[164:167],v[76:79],a[24:27],v[164:167]
 s_mul_i32 s54,s46,31744
 s_lshl_b32 s52,s54,4
 ds_read_b64_tr_b16 v[56:57],v178 offset:20480
 v_mfma_f32_16x16x32_bf16 v[172:175],v[76:79],a[28:31],v[172:175]
 s_waitcnt lgkmcnt(14)
 ds_read_b64_tr_b16 v[58:59],v178 offset:20992
 ds_read_b64_tr_b16 v[60:61],v179 offset:20480
 v_mfma_f32_16x16x32_bf16 v[144:147],v[16:19],a[32:35],v[144:147]
 s_and_b32 s60,s46,1
 buffer_load_dwordx4 v[232:235],v0,s[12:15],s56 offen offset:1024 sc1
 v_mfma_f32_16x16x32_bf16 v[152:155],v[16:19],a[36:39],v[152:155]
 s_and_b32 s61,s46,2
 ds_read_b64_tr_b16 v[62:63],v179 offset:20992
 v_mov_b32 v200,0xdddddddd
 v_mfma_f32_16x16x32_bf16 v[148:151],v[20:23],a[32:35],v[148:151]
 s_and_b32 s57,s45,1
 ds_read_b64_tr_b16 v[64:65],v176 offset:22528
 ds_read_b64_tr_b16 v[66:67],v176 offset:23040
 v_mfma_f32_16x16x32_bf16 v[156:159],v[20:23],a[36:39],v[156:159]
 s_waitcnt lgkmcnt(14)
 ds_read_b64_tr_b16 v[68:69],v177 offset:22528
 ds_read_b64_tr_b16 v[70:71],v177 offset:23040
 v_mfma_f32_16x16x32_bf16 v[160:163],v[24:27],a[32:35],v[160:163]
 s_lshl_b32 s55,s61,30
 buffer_load_dwordx4 v[236:239],v0,s[12:15],s56 offen offset:2048 sc1
 v_mfma_f32_16x16x32_bf16 v[168:171],v[24:27],a[36:39],v[168:171]
 ds_read_b64_tr_b16 v[72:73],v178 offset:22528
 ds_read_b64_tr_b16 v[74:75],v178 offset:23040
 v_mfma_f32_16x16x32_bf16 v[164:167],v[28:31],a[32:35],v[164:167]
 ds_read_b64_tr_b16 v[76:77],v179 offset:22528
 ds_read_b64_tr_b16 v[78:79],v179 offset:23040
 v_mfma_f32_16x16x32_bf16 v[172:175],v[28:31],a[36:39],v[172:175]
 v_mov_b32 v255,0x80000000
 v_cmp_gt_u32 vcc,2,v12
 v_mfma_f32_16x16x32_bf16 v[144:147],v[32:35],a[40:43],v[144:147]
 buffer_load_dwordx4 v[240:243],v0,s[12:15],s56 offen offset:3072 sc1
 v_mfma_f32_16x16x32_bf16 v[152:155],v[32:35],a[44:47],v[152:155]
 v_and_b32 v205,4,v12
 v_mul_u32_u24 v205,6,v205
 v_mfma_f32_16x16x32_bf16 v[148:151],v[36:39],a[40:43],v[148:151]
 v_and_b32 v254,3,v12
 v_and_b32 v203,0xf0,v0
 v_mfma_f32_16x16x32_bf16 v[156:159],v[36:39],a[44:47],v[156:159]
 s_waitcnt lgkmcnt(14)
 v_mov_b32 v251,0x80000000
 v_mov_b32 v80,0
 v_mfma_f32_16x16x32_bf16 v[160:163],v[40:43],a[40:43],v[160:163]
 v_mov_b32 v81,0
 v_mov_b32 v82,0
 v_mfma_f32_16x16x32_bf16 v[168:171],v[40:43],a[44:47],v[168:171]
 v_mov_b32 v83,0
 v_mov_b32 v84,0
 v_mfma_f32_16x16x32_bf16 v[164:167],v[44:47],a[40:43],v[164:167]
 s_waitcnt vmcnt(29) lgkmcnt(0)
 s_barrier
 ds_read_b64_tr_b16 v[16:17],v176 offset:32768
 ds_read_b64_tr_b16 v[18:19],v176 offset:33280
 v_mfma_f32_16x16x32_bf16 v[172:175],v[44:47],a[44:47],v[172:175]
 ds_read_b64_tr_b16 v[20:21],v177 offset:32768
 ds_read_b64_tr_b16 v[22:23],v177 offset:33280
 v_mfma_f32_16x16x32_bf16 v[144:147],v[48:51],a[48:51],v[144:147]
 ds_read_b64_tr_b16 v[24:25],v178 offset:32768
 ds_read_b64_tr_b16 v[26:27],v178 offset:33280
 v_mfma_f32_16x16x32_bf16 v[152:155],v[48:51],a[52:55],v[152:155]
 ds_read_b64_tr_b16 v[28:29],v179 offset:32768
 ds_read_b64_tr_b16 v[30:31],v179 offset:33280
 v_mfma_f32_16x16x32_bf16 v[148:151],v[52:55],a[48:51],v[148:151]
 ds_read_b64_tr_b16 v[32:33],v176 offset:34816
 ds_read_b64_tr_b16 v[34:35],v176 offset:35328
 v_mfma_f32_16x16x32_bf16 v[156:159],v[52:55],a[52:55],v[156:159]
 ds_read_b64_tr_b16 v[36:37],v177 offset:34816
 ds_read_b64_tr_b16 v[38:39],v177 offset:35328
 v_mfma_f32_16x16x32_bf16 v[160:163],v[56:59],a[48:51],v[160:163]
 ds_read_b64_tr_b16 v[40:41],v178 offset:34816
 ds_read_b64_tr_b16 v[42:43],v178 offset:35328
 v_mfma_f32_16x16x32_bf16 v[168:171],v[56:59],a[52:55],v[168:171]
 ds_read_b64_tr_b16 v[44:45],v179 offset:34816
 ds_read_b64_tr_b16 v[46:47],v179 offset:35328
 v_mfma_f32_16x16x32_bf16 v[164:167],v[60:63],a[48:51],v[164:167]
 ds_read_b64_tr_b16 v[48:49],v176 offset:36864
 ds_read_b64_tr_b16 v[50:51],v176 offset:37376
 v_mfma_f32_16x16x32_bf16 v[172:175],v[60:63],a[52:55],v[172:175]
 ds_read_b64_tr_b16 v[52:53],v177 offset:36864
 ds_read_b64_tr_b16 v[54:55],v177 offset:37376
 v_mfma_f32_16x16x32_bf16 v[144:147],v[64:67],a[56:59],v[144:147]
 ds_read_b64_tr_b16 v[56:57],v178 offset:36864
 ds_read_b64_tr_b16 v[58:59],v178 offset:37376
 v_mfma_f32_16x16x32_bf16 v[152:155],v[64:67],a[60:63],v[152:155]
 ds_read_b64_tr_b16 v[60:61],v179 offset:36864
 ds_read_b64_tr_b16 v[62:63],v179 offset:37376
 v_mfma_f32_16x16x32_bf16 v[148:151],v[68:71],a[56:59],v[148:151]
 ds_read_b64_tr_b16 v[64:65],v176 offset:38912
 ds_read_b64_tr_b16 v[66:67],v176 offset:39424
 v_mfma_f32_16x16x32_bf16 v[156:159],v[68:71],a[60:63],v[156:159]
 ds_read_b64_tr_b16 v[68:69],v177 offset:38912
 ds_read_b64_tr_b16 v[70:71],v177 offset:39424
 v_mfma_f32_16x16x32_bf16 v[160:163],v[72:75],a[56:59],v[160:163]
 v_mov_b32 v85,0
 v_mov_b32 v86,0
 v_mfma_f32_16x16x32_bf16 v[168:171],v[72:75],a[60:63],v[168:171]
 ds_read_b64_tr_b16 v[72:73],v178 offset:38912
 ds_read_b64_tr_b16 v[74:75],v178 offset:39424
 v_mfma_f32_16x16x32_bf16 v[164:167],v[76:79],a[56:59],v[164:167]
 v_mov_b32 v87,0
 v_mov_b32 v88,0
 v_mfma_f32_16x16x32_bf16 v[172:175],v[76:79],a[60:63],v[172:175]
 s_waitcnt lgkmcnt(14)
 ds_read_b64_tr_b16 v[76:77],v179 offset:38912
 ds_read_b64_tr_b16 v[78:79],v179 offset:39424
 v_mfma_f32_16x16x32_bf16 v[144:147],v[16:19],a[64:67],v[144:147]
 v_mov_b32 v89,0
 v_mov_b32 v90,0
 v_mfma_f32_16x16x32_bf16 v[152:155],v[16:19],a[68:71],v[152:155]
 ds_read_b64_tr_b16 v[16:17],v176 offset:49152
 ds_read_b64_tr_b16 v[18:19],v176 offset:49664
 v_mfma_f32_16x16x32_bf16 v[148:151],v[20:23],a[64:67],v[148:151]
 v_mov_b32 v91,0
 v_mov_b32 v92,0
 v_mfma_f32_16x16x32_bf16 v[156:159],v[20:23],a[68:71],v[156:159]
 ds_read_b64_tr_b16 v[20:21],v177 offset:49152
 ds_read_b64_tr_b16 v[22:23],v177 offset:49664
 v_mfma_f32_16x16x32_bf16 v[160:163],v[24:27],a[64:67],v[160:163]
 v_mov_b32 v93,0
 v_mov_b32 v94,0
 v_mfma_f32_16x16x32_bf16 v[168:171],v[24:27],a[68:71],v[168:171]
 ds_read_b64_tr_b16 v[24:25],v178 offset:49152
 ds_read_b64_tr_b16 v[26:27],v178 offset:49664
 v_mfma_f32_16x16x32_bf16 v[164:167],v[28:31],a[64:67],v[164:167]
 v_mov_b32 v95,0
 v_mov_b32 v96,0
 v_mfma_f32_16x16x32_bf16 v[172:175],v[28:31],a[68:71],v[172:175]
 ds_read_b64_tr_b16 v[28:29],v179 offset:49152
 ds_read_b64_tr_b16 v[30:31],v179 offset:49664
 v_mfma_f32_16x16x32_bf16 v[144:147],v[32:35],a[72:75],v[144:147]
 v_mov_b32 v97,0
 v_mov_b32 v98,0
 v_mfma_f32_16x16x32_bf16 v[152:155],v[32:35],a[76:79],v[152:155]
 ds_read_b64_tr_b16 v[32:33],v176 offset:51200
 ds_read_b64_tr_b16 v[34:35],v176 offset:51712
 v_mfma_f32_16x16x32_bf16 v[148:151],v[36:39],a[72:75],v[148:151]
 v_mov_b32 v99,0
 v_mov_b32 v100,0
 v_mfma_f32_16x16x32_bf16 v[156:159],v[36:39],a[76:79],v[156:159]
 ds_read_b64_tr_b16 v[36:37],v177 offset:51200
 ds_read_b64_tr_b16 v[38:39],v177 offset:51712
 v_mfma_f32_16x16x32_bf16 v[160:163],v[40:43],a[72:75],v[160:163]
 v_mov_b32 v101,0
 v_mov_b32 v102,0
 v_mfma_f32_16x16x32_bf16 v[168:171],v[40:43],a[76:79],v[168:171]
 ds_read_b64_tr_b16 v[40:41],v178 offset:51200
 ds_read_b64_tr_b16 v[42:43],v178 offset:51712
 v_mfma_f32_16x16x32_bf16 v[164:167],v[44:47],a[72:75],v[164:167]
 v_mul_f32 v217,0x3e8293ee,v217
 v_mul_f32 v219,0x3e8293ee,v219
 v_mfma_f32_16x16x32_bf16 v[172:175],v[44:47],a[76:79],v[172:175]
 s_waitcnt lgkmcnt(14)
 ds_read_b64_tr_b16 v[44:45],v179 offset:51200
 ds_read_b64_tr_b16 v[46:47],v179 offset:51712
 v_mfma_f32_16x16x32_bf16 v[144:147],v[48:51],a[80:83],v[144:147]
 v_mov_b32 v103,0
 v_mov_b32 v104,0
 v_mfma_f32_16x16x32_bf16 v[152:155],v[48:51],a[84:87],v[152:155]
 ds_read_b64_tr_b16 v[48:49],v176 offset:53248
 ds_read_b64_tr_b16 v[50:51],v176 offset:53760
 v_mfma_f32_16x16x32_bf16 v[148:151],v[52:55],a[80:83],v[148:151]
 v_mov_b32 v105,0
 v_mov_b32 v106,0
 v_mfma_f32_16x16x32_bf16 v[156:159],v[52:55],a[84:87],v[156:159]
 ds_read_b64_tr_b16 v[52:53],v177 offset:53248
 ds_read_b64_tr_b16 v[54:55],v177 offset:53760
 v_mfma_f32_16x16x32_bf16 v[160:163],v[56:59],a[80:83],v[160:163]
 v_mov_b32 v107,0
 v_mov_b32 v108,0
 v_mfma_f32_16x16x32_bf16 v[168:171],v[56:59],a[84:87],v[168:171]
 ds_read_b64_tr_b16 v[56:57],v178 offset:53248
 ds_read_b64_tr_b16 v[58:59],v178 offset:53760
 v_mfma_f32_16x16x32_bf16 v[164:167],v[60:63],a[80:83],v[164:167]
 v_mov_b32 v109,0
 v_mov_b32 v110,0
 v_mfma_f32_16x16x32_bf16 v[172:175],v[60:63],a[84:87],v[172:175]
 ds_read_b64_tr_b16 v[60:61],v179 offset:53248
 ds_read_b64_tr_b16 v[62:63],v179 offset:53760
 v_mfma_f32_16x16x32_bf16 v[144:147],v[64:67],a[88:91],v[144:147]
 v_mov_b32 v111,0
 v_mov_b32 v112,0
 v_mfma_f32_16x16x32_bf16 v[152:155],v[64:67],a[92:95],v[152:155]
 ds_read_b64_tr_b16 v[64:65],v176 offset:55296
 ds_read_b64_tr_b16 v[66:67],v176 offset:55808
 v_mfma_f32_16x16x32_bf16 v[148:151],v[68:71],a[88:91],v[148:151]
 v_mov_b32 v113,0
 v_mov_b32 v114,0
 v_mfma_f32_16x16x32_bf16 v[156:159],v[68:71],a[92:95],v[156:159]
 ds_read_b64_tr_b16 v[68:69],v177 offset:55296
 ds_read_b64_tr_b16 v[70:71],v177 offset:55808
 v_mfma_f32_16x16x32_bf16 v[160:163],v[72:75],a[88:91],v[160:163]
 v_mov_b32 v115,0
 v_mov_b32 v116,0
 v_mfma_f32_16x16x32_bf16 v[168:171],v[72:75],a[92:95],v[168:171]
 ds_read_b64_tr_b16 v[72:73],v178 offset:55296
 ds_read_b64_tr_b16 v[74:75],v178 offset:55808
 v_mfma_f32_16x16x32_bf16 v[164:167],v[76:79],a[88:91],v[164:167]
 v_mov_b32 v117,0
 v_mov_b32 v118,0
 v_mfma_f32_16x16x32_bf16 v[172:175],v[76:79],a[92:95],v[172:175]
 s_waitcnt lgkmcnt(14)
 ds_read_b64_tr_b16 v[76:77],v179 offset:55296
 ds_read_b64_tr_b16 v[78:79],v179 offset:55808
 v_mfma_f32_16x16x32_bf16 v[144:147],v[16:19],a[96:99],v[144:147]
 v_mov_b32 v119,0
 v_mov_b32 v120,0
 v_mfma_f32_16x16x32_bf16 v[152:155],v[16:19],a[100:103],v[152:155]
 v_mov_b32 v121,0
 v_mov_b32 v122,0
 v_mfma_f32_16x16x32_bf16 v[148:151],v[20:23],a[96:99],v[148:151]
 v_mov_b32 v123,0
 v_mov_b32 v124,0
 v_mfma_f32_16x16x32_bf16 v[156:159],v[20:23],a[100:103],v[156:159]
 v_mov_b32 v125,0
 v_mov_b32 v126,0
 v_mfma_f32_16x16x32_bf16 v[160:163],v[24:27],a[96:99],v[160:163]
 v_mov_b32 v127,0
 v_mov_b32 v128,0
 v_mfma_f32_16x16x32_bf16 v[168:171],v[24:27],a[100:103],v[168:171]
 v_mov_b32 v129,0
 v_mov_b32 v130,0
 v_mfma_f32_16x16x32_bf16 v[164:167],v[28:31],a[96:99],v[164:167]
 v_mov_b32 v131,0
 v_mov_b32 v132,0
 v_mfma_f32_16x16x32_bf16 v[172:175],v[28:31],a[100:103],v[172:175]
 s_waitcnt vmcnt(20) lgkmcnt(0)
 s_barrier
 ds_read_b64_tr_b16 v[16:17],v180
 v_mfma_f32_16x16x32_bf16 v[144:147],v[32:35],a[104:107],v[144:147]
 ds_read_b64_tr_b16 v[18:19],v180 offset:512
 ds_read_b64_tr_b16 v[20:21],v181
 v_mfma_f32_16x16x32_bf16 v[152:155],v[32:35],a[108:111],v[152:155]
 ds_read_b64_tr_b16 v[22:23],v181 offset:512
 ds_read_b64_tr_b16 v[24:25],v182
 v_mfma_f32_16x16x32_bf16 v[148:151],v[36:39],a[104:107],v[148:151]
 ds_read_b64_tr_b16 v[26:27],v182 offset:512
 ds_read_b64_tr_b16 v[28:29],v183
 v_mfma_f32_16x16x32_bf16 v[156:159],v[36:39],a[108:111],v[156:159]
 ds_read_b64_tr_b16 v[30:31],v183 offset:512
 ds_read_b64_tr_b16 v[32:33],v180 offset:2048
 v_mfma_f32_16x16x32_bf16 v[160:163],v[40:43],a[104:107],v[160:163]
 ds_read_b64_tr_b16 v[34:35],v180 offset:2560
 ds_read_b64_tr_b16 v[36:37],v181 offset:2048
 v_mfma_f32_16x16x32_bf16 v[168:171],v[40:43],a[108:111],v[168:171]
 ds_read_b64_tr_b16 v[38:39],v181 offset:2560
 ds_read_b64_tr_b16 v[40:41],v182 offset:2048
 v_mfma_f32_16x16x32_bf16 v[164:167],v[44:47],a[104:107],v[164:167]
 s_waitcnt vmcnt(4)
 s_barrier
 buffer_atomic_add v6,v207,s[12:15],0 offen offset:8 sc1
 buffer_atomic_add v6,v206,s[12:15],0 offen offset:8 sc1
 v_mfma_f32_16x16x32_bf16 v[172:175],v[44:47],a[108:111],v[172:175]
 ds_read_b64_tr_b16 v[42:43],v182 offset:2560
 ds_read_b64_tr_b16 v[44:45],v183 offset:2048
 v_mfma_f32_16x16x32_bf16 v[144:147],v[48:51],a[112:115],v[144:147]
 ds_read_b64_tr_b16 v[46:47],v183 offset:2560
 v_mov_b32 v133,0
 v_mfma_f32_16x16x32_bf16 v[152:155],v[48:51],a[116:119],v[152:155]
 ds_read_b64_tr_b16 v[48:49],v180 offset:4096
 ds_read_b64_tr_b16 v[50:51],v180 offset:4608
 v_mfma_f32_16x16x32_bf16 v[148:151],v[52:55],a[112:115],v[148:151]
 v_mov_b32 v134,0
 v_mov_b32 v135,0
 v_mfma_f32_16x16x32_bf16 v[156:159],v[52:55],a[116:119],v[156:159]
 ds_read_b64_tr_b16 v[52:53],v181 offset:4096
 ds_read_b64_tr_b16 v[54:55],v181 offset:4608
 v_mfma_f32_16x16x32_bf16 v[160:163],v[56:59],a[112:115],v[160:163]
 v_mov_b32 v136,0
 v_mov_b32 v137,0
 v_mfma_f32_16x16x32_bf16 v[168:171],v[56:59],a[116:119],v[168:171]
 ds_read_b64_tr_b16 v[56:57],v182 offset:4096
 ds_read_b64_tr_b16 v[58:59],v182 offset:4608
 v_mfma_f32_16x16x32_bf16 v[164:167],v[60:63],a[112:115],v[164:167]
 v_mov_b32 v138,0
 v_mov_b32 v139,0
 v_mfma_f32_16x16x32_bf16 v[172:175],v[60:63],a[116:119],v[172:175]
 ds_read_b64_tr_b16 v[60:61],v183 offset:4096
 ds_read_b64_tr_b16 v[62:63],v183 offset:4608
 v_mfma_f32_16x16x32_bf16 v[144:147],v[64:67],a[120:123],v[144:147]
 v_mov_b32 v140,0
 v_mov_b32 v141,0
 v_mfma_f32_16x16x32_bf16 v[152:155],v[64:67],a[124:127],v[152:155]
 ds_read_b64_tr_b16 v[64:65],v180 offset:6144
 ds_read_b64_tr_b16 v[66:67],v180 offset:6656
 v_mfma_f32_16x16x32_bf16 v[148:151],v[68:71],a[120:123],v[148:151]
 v_mov_b32 v142,0
 v_mov_b32 v143,0
 v_mfma_f32_16x16x32_bf16 v[156:159],v[68:71],a[124:127],v[156:159]
 ds_read_b64_tr_b16 v[68:69],v181 offset:6144
 ds_read_b64_tr_b16 v[70:71],v181 offset:6656
 v_mfma_f32_16x16x32_bf16 v[160:163],v[72:75],a[120:123],v[160:163]
 v_mov_b32 v185,0
 v_mov_b32 v186,0
 v_mfma_f32_16x16x32_bf16 v[168:171],v[72:75],a[124:127],v[168:171]
 ds_read_b64_tr_b16 v[72:73],v182 offset:6144
 ds_read_b64_tr_b16 v[74:75],v182 offset:6656
 v_mfma_f32_16x16x32_bf16 v[164:167],v[76:79],a[120:123],v[164:167]
 v_mov_b32 v187,0
 v_mov_b32 v188,0
 v_mfma_f32_16x16x32_bf16 v[172:175],v[76:79],a[124:127],v[172:175]
 s_waitcnt lgkmcnt(14)
 ds_read_b64_tr_b16 v[76:77],v183 offset:6144
 ds_read_b64_tr_b16 v[78:79],v183 offset:6656
 v_mfma_f32_16x16x32_bf16 v[144:147],v[16:19],a[128:131],v[144:147]
 v_mov_b32 v189,0
 v_mov_b32 v190,0
 v_mfma_f32_16x16x32_bf16 v[152:155],v[16:19],a[132:135],v[152:155]
 ds_read_b64_tr_b16 v[16:17],v180 offset:16384
 ds_read_b64_tr_b16 v[18:19],v180 offset:16896
 v_mfma_f32_16x16x32_bf16 v[148:151],v[20:23],a[128:131],v[148:151]
 v_mov_b32 v191,0
 v_mov_b32 v192,0
 v_mfma_f32_16x16x32_bf16 v[156:159],v[20:23],a[132:135],v[156:159]
 ds_read_b64_tr_b16 v[20:21],v181 offset:16384
 ds_read_b64_tr_b16 v[22:23],v181 offset:16896
 v_mfma_f32_16x16x32_bf16 v[160:163],v[24:27],a[128:131],v[160:163]
 v_mov_b32 v193,0
 v_mov_b32 v194,0
 v_mfma_f32_16x16x32_bf16 v[168:171],v[24:27],a[132:135],v[168:171]
 ds_read_b64_tr_b16 v[24:25],v182 offset:16384
 ds_read_b64_tr_b16 v[26:27],v182 offset:16896
 v_mfma_f32_16x16x32_bf16 v[164:167],v[28:31],a[128:131],v[164:167]
 v_mov_b32 v195,0
 v_mov_b32 v196,0
 v_mfma_f32_16x16x32_bf16 v[172:175],v[28:31],a[132:135],v[172:175]
 ds_read_b64_tr_b16 v[28:29],v183 offset:16384
 ds_read_b64_tr_b16 v[30:31],v183 offset:16896
 v_mfma_f32_16x16x32_bf16 v[144:147],v[32:35],a[136:139],v[144:147]
 v_mov_b32 v197,0
 v_mov_b32 v198,0
 v_mfma_f32_16x16x32_bf16 v[152:155],v[32:35],a[140:143],v[152:155]
 ds_read_b64_tr_b16 v[32:33],v180 offset:18432
 ds_read_b64_tr_b16 v[34:35],v180 offset:18944
 v_mfma_f32_16x16x32_bf16 v[148:151],v[36:39],a[136:139],v[148:151]
 v_mov_b32 v199,0
 v_mfma_f32_16x16x32_bf16 v[156:159],v[36:39],a[140:143],v[156:159]
 ds_read_b64_tr_b16 v[36:37],v181 offset:18432
 ds_read_b64_tr_b16 v[38:39],v181 offset:18944
 v_mfma_f32_16x16x32_bf16 v[160:163],v[40:43],a[136:139],v[160:163]
 v_mfma_f32_16x16x32_bf16 v[168:171],v[40:43],a[140:143],v[168:171]
 ds_read_b64_tr_b16 v[40:41],v182 offset:18432
 ds_read_b64_tr_b16 v[42:43],v182 offset:18944
 v_mfma_f32_16x16x32_bf16 v[164:167],v[44:47],a[136:139],v[164:167]
 v_mfma_f32_16x16x32_bf16 v[172:175],v[44:47],a[140:143],v[172:175]
 s_waitcnt lgkmcnt(14)
 ds_read_b64_tr_b16 v[44:45],v183 offset:18432
 ds_read_b64_tr_b16 v[46:47],v183 offset:18944
 v_mfma_f32_16x16x32_bf16 v[144:147],v[48:51],a[144:147],v[144:147]
 v_mfma_f32_16x16x32_bf16 v[152:155],v[48:51],a[148:151],v[152:155]
 ds_read_b64_tr_b16 v[48:49],v180 offset:20480
 ds_read_b64_tr_b16 v[50:51],v180 offset:20992
 v_mfma_f32_16x16x32_bf16 v[148:151],v[52:55],a[144:147],v[148:151]
 v_mfma_f32_16x16x32_bf16 v[156:159],v[52:55],a[148:151],v[156:159]
 ds_read_b64_tr_b16 v[52:53],v181 offset:20480
 ds_read_b64_tr_b16 v[54:55],v181 offset:20992
 v_mfma_f32_16x16x32_bf16 v[160:163],v[56:59],a[144:147],v[160:163]
 v_mfma_f32_16x16x32_bf16 v[168:171],v[56:59],a[148:151],v[168:171]
 ds_read_b64_tr_b16 v[56:57],v182 offset:20480
 ds_read_b64_tr_b16 v[58:59],v182 offset:20992
 v_mfma_f32_16x16x32_bf16 v[164:167],v[60:63],a[144:147],v[164:167]
 v_mfma_f32_16x16x32_bf16 v[172:175],v[60:63],a[148:151],v[172:175]
 ds_read_b64_tr_b16 v[60:61],v183 offset:20480
 ds_read_b64_tr_b16 v[62:63],v183 offset:20992
 v_mfma_f32_16x16x32_bf16 v[144:147],v[64:67],a[152:155],v[144:147]
 v_mfma_f32_16x16x32_bf16 v[152:155],v[64:67],a[156:159],v[152:155]
 ds_read_b64_tr_b16 v[64:65],v180 offset:22528
 ds_read_b64_tr_b16 v[66:67],v180 offset:23040
 v_mfma_f32_16x16x32_bf16 v[148:151],v[68:71],a[152:155],v[148:151]
 v_mfma_f32_16x16x32_bf16 v[156:159],v[68:71],a[156:159],v[156:159]
 ds_read_b64_tr_b16 v[68:69],v181 offset:22528
 ds_read_b64_tr_b16 v[70:71],v181 offset:23040
 v_mfma_f32_16x16x32_bf16 v[160:163],v[72:75],a[152:155],v[160:163]
 v_mfma_f32_16x16x32_bf16 v[168:171],v[72:75],a[156:159],v[168:171]
 ds_read_b64_tr_b16 v[72:73],v182 offset:22528
 ds_read_b64_tr_b16 v[74:75],v182 offset:23040
 v_mfma_f32_16x16x32_bf16 v[164:167],v[76:79],a[152:155],v[164:167]
 v_mfma_f32_16x16x32_bf16 v[172:175],v[76:79],a[156:159],v[172:175]
 s_waitcnt lgkmcnt(14)
 ds_read_b64_tr_b16 v[76:77],v183 offset:22528
 ds_read_b64_tr_b16 v[78:79],v183 offset:23040
 v_mfma_f32_16x16x32_bf16 v[144:147],v[16:19],a[160:163],v[144:147]
 s_and_b32 s3,s46,1
 s_lshl_b32 s53,s45,1
 s_add_u32 s53,s53,s3
 s_lshl_b32 s53,s53,1
 s_lshr_b32 s3,s46,1
 s_add_u32 s53,s53,s3
 s_sub_u32 s3,s54,s51
 s_add_u32 s3,s3,8192
 v_add_u32 v248,s3,v184
 v_xor_b32 v249,64,v248
 s_lshl_b32 s3,s61,1
 s_add_u32 s3,s3,s60
 s_lshl_b32 s3,s3,11
 s_add_u32 s3,s3,131072
 v_add_u32 v225,s3,v0
 v_xor_b32 v224,0x2000,v225
 s_lshl_b32 s3,s46,13
 s_add_u32 s3,s3,131072
 v_add_u32 v206,s3,v0
 v_xor_b32 v207,0x4000,v206
 s_lshl_b32 s3,s46,9
 s_add_u32 s3,s3,126976
 v_lshl_add_u32 v252,v12,2,s3
 v_xor_b32 v253,0x400,v252
 s_lshl_b32 s3,s44,2
 s_add_u32 s3,s3,s61
 s_lshl_b32 s3,s3,9
 s_add_u32 s3,s3,s60
 s_lshl_b32 s3,s3,2
 v_lshl_add_u32 v201,v12,11,s3
 s_lshl_b32 s3,s47,11
 v_lshl_add_u32 v202,v12,2,s3
 v_cndmask_b32 v201,v255,v201,vcc
 v_cndmask_b32 v202,v255,v202,vcc
 s_lshl_b32 s3,s45,2
 v_xor_b32 v205,s3,v205
 v_add_lshl_u32 v205,v254,v205,11
 v_cmp_gt_u32 vcc,8,v12
 s_nop 1
 v_cndmask_b32 v205,v255,v205,vcc
 v_bfe_u32 v254,v12,4,1
 v_lshl_add_u32 v203,v254,10,v203
 v_lshrrev_b32 v254,5,v12
 v_lshl_add_u32 v203,v254,8,v203
 v_lshrrev_b32 v254,4,v12
 s_lshl_b32 s3,s61,1
 s_sub_u32 s3,s3,s57
 v_add_u32 v254,s3,v254
 v_min_u32 v254,6,v254
 v_lshrrev_b32 v246,2,v254
 v_mul_u32_u24 v246,s60,v246
 s_lshl_b32 s57,s45,9
 s_add_u32 s57,s57,24583
 s_mul_i32 s3,s60,7
 s_sub_u32 s3,s57,s3
 v_add_u32 v244,s3,v254
 s_mul_i32 s3,s60,211
 s_sub_u32 s3,224,s3
 s_add_u32 s3,s3,s57
 v_add_u32 v254,s3,v254
 v_mul_u32_u24 v247,122,v246
 v_add_u32 v254,v247,v254
 s_mul_i32 s3,s60,3
 s_sub_u32 s3,7,s3
 v_sub_u32 v247,s3,v246
 v_lshl_add_u32 v245,v247,5,v254
 s_xor_b32 s3,s44,s45
 s_lshl_b32 s3,s3,1
 s_xor_b32 s57,s60,1
 s_and_b32 s57,s57,0
 s_or_b32 s57,s57,s3
 v_cmp_eq_u32 vcc,s57,0
 s_nop 1
 v_cndmask_b32 v254,v254,v244,vcc
 v_cndmask_b32 v247,v247,14,vcc
 s_cmp_eq_u32 s44,0
 s_cselect_b32 s57,s45,s44
 s_lshl_b32 s57,s57,1
 s_cmp_eq_u32 s3,0
 s_cselect_b32 s3,0,s57
 v_mad_u32_u24 v246,v247,s3,v254
 v_add_lshl_u32 v247,v247,v246,10
 v_lshlrev_b32 v246,10,v246
 s_nop 0
 v_readlane_b32 s64,v246,0
 v_readlane_b32 s65,v246,16
 v_readlane_b32 s66,v246,32
 v_readlane_b32 s67,v246,48
 v_readlane_b32 s68,v247,0
 v_readlane_b32 s69,v247,16
 v_readlane_b32 s62,v247,32
 v_readlane_b32 s63,v247,48
 s_lshr_b32 s3,s44,2
 s_lshl_b32 s3,s3,6
 s_and_b32 s57,s44,3
 s_add_u32 s3,s3,s57
 s_lshl_b32 s3,s3,2
 v_and_b32 v254,0xf0,v0
 v_lshl_add_u32 v245,v245,10,v254
 v_add_u32 v245,s3,v245
 s_lshl_b32 s3,s61,3
 s_sub_u32 s3,64,s3
 v_cmp_gt_u32 vcc,s3,v12
 s_nop 1
 v_cndmask_b32 v245,v255,v245,vcc
 v_add_u32 v244,s55,v0
 v_lshrrev_b32 v254,2,v12
 v_lshlrev_b32 v227,7,v254
 v_bfe_u32 v254,v12,3,2
 v_lshl_add_u32 v227,v254,5,v227
 v_and_b32 v254,3,v12
 v_lshl_add_u32 v227,v254,3,v227
 v_add_u32 v227,s54,v227
 v_lshrrev_b32 v254,3,v12
 v_and_b32 v255,4,v254
 v_add_u32 v255,v255,v254
 s_lshl_b32 s3,s47,5
 v_add_lshl_u32 v246,v255,s3,12
 v_lshrrev_b32 v255,4,v12
 v_xor_b32 v247,v255,v12
 v_and_b32 v247,7,v247
 v_lshl_add_u32 v246,v247,4,v246
 s_lshl_b32 s3,s45,8
 v_add_u32 v246,s3,v246
 v_xor_b32 v247,64,v246
 v_lshlrev_b32 v250,1,v255
 v_xor_b32 v250,v250,v12
 v_and_b32 v250,7,v250
 s_sub_u32 s3,8,s61
 v_cmp_gt_u32 vcc,s3,v250
 v_lshlrev_b32 v250,4,v250
 s_mul_i32 s3,s44,458752
 s_mul_i32 s57,s60,3584
 s_add_u32 s3,s3,s57
 s_mul_i32 s57,s45,224
 v_mfma_f32_16x16x32_bf16 v[152:155],v[16:19],a[164:167],v[152:155]
 s_add_u32 s3,s3,s57
 s_lshl_b32 s57,s61,6
 s_add_u32 s3,s3,s57
 v_mfma_f32_16x16x32_bf16 v[148:151],v[20:23],a[160:163],v[148:151]
 v_mov_b32 v7,0
 buffer_atomic_add v7,v5,s[12:15],0 offen offset:8 sc0 sc1
 v_mfma_f32_16x16x32_bf16 v[156:159],v[20:23],a[164:167],v[156:159]
 v_mul_u32_u24 v226,7168,v254
 v_add3_u32 v226,v226,v250,s3
 v_mfma_f32_16x16x32_bf16 v[160:163],v[24:27],a[160:163],v[160:163]
 s_lshl_b32 s57,s45,7
 v_cndmask_b32 v226,v251,v226,vcc
 v_lshl_add_u32 v250,v254,11,v250
 v_mfma_f32_16x16x32_bf16 v[168:171],v[24:27],a[164:167],v[168:171]
 s_lshl_b32 s3,s47,5
 v_add_u32 v250,s57,v250
 v_and_b32 v251,1,v255
 v_mfma_f32_16x16x32_bf16 v[164:167],v[28:31],a[160:163],v[164:167]
 s_branch .Lsk3
.Lvs0_3:
 s_branch .Lvb0
.Lsk3:
 s_lshl_b32 s53,s53,17
 v_lshlrev_b32 v251,5,v251
 v_lshrrev_b32 v255,1,v255
 v_mfma_f32_16x16x32_bf16 v[172:175],v[28:31],a[164:167],v[172:175]
 v_lshl_add_u32 v251,v255,4,v251
 v_add_lshl_u32 v255,v13,s3,11
 v_mfma_f32_16x16x32_bf16 v[144:147],v[32:35],a[168:171],v[144:147]
 s_waitcnt lgkmcnt(0)
 s_barrier
 v_add3_u32 v251,v251,v255,s57
 v_and_b32 v254,4,v12
 v_mfma_f32_16x16x32_bf16 v[152:155],v[32:35],a[172:175],v[152:155]
 s_add_u32 s53,s53,8388608
 v_cmp_eq_u32 vcc,0,v254
 s_nop 1
 v_cndmask_b32 v254,0,v8,vcc
 v_mfma_f32_16x16x32_bf16 v[148:151],v[36:39],a[168:171],v[148:151]
 v_cndmask_b32 v255,v8,0,vcc
 ds_read_b64_tr_b16 v[16:17],v180 offset:32768
 v_mfma_f32_16x16x32_bf16 v[156:159],v[36:39],a[172:175],v[156:159]
 ds_read_b64_tr_b16 v[18:19],v180 offset:33280
 ds_read_b64_tr_b16 v[20:21],v181 offset:32768
 v_mfma_f32_16x16x32_bf16 v[160:163],v[40:43],a[168:171],v[160:163]
 ds_read_b64_tr_b16 v[22:23],v181 offset:33280
 ds_read_b64_tr_b16 v[24:25],v182 offset:32768
 v_mfma_f32_16x16x32_bf16 v[168:171],v[40:43],a[172:175],v[168:171]
 ds_read_b64_tr_b16 v[26:27],v182 offset:33280
 ds_read_b64_tr_b16 v[28:29],v183 offset:32768
 v_mfma_f32_16x16x32_bf16 v[164:167],v[44:47],a[168:171],v[164:167]
 ds_read_b64_tr_b16 v[30:31],v183 offset:33280
 ds_read_b64_tr_b16 v[32:33],v180 offset:34816
 v_mfma_f32_16x16x32_bf16 v[172:175],v[44:47],a[172:175],v[172:175]
 ds_read_b64_tr_b16 v[34:35],v180 offset:35328
 ds_read_b64_tr_b16 v[36:37],v181 offset:34816
 v_mfma_f32_16x16x32_bf16 v[144:147],v[48:51],a[176:179],v[144:147]
 ds_read_b64_tr_b16 v[38:39],v181 offset:35328
 ds_read_b64_tr_b16 v[40:41],v182 offset:34816
 v_mfma_f32_16x16x32_bf16 v[152:155],v[48:51],a[180:183],v[152:155]
 ds_read_b64_tr_b16 v[42:43],v182 offset:35328
 ds_read_b64_tr_b16 v[44:45],v183 offset:34816
 v_mfma_f32_16x16x32_bf16 v[148:151],v[52:55],a[176:179],v[148:151]
 ds_read_b64_tr_b16 v[46:47],v183 offset:35328
 ds_read_b64_tr_b16 v[48:49],v180 offset:36864
 v_mfma_f32_16x16x32_bf16 v[156:159],v[52:55],a[180:183],v[156:159]
 ds_read_b64_tr_b16 v[50:51],v180 offset:37376
 ds_read_b64_tr_b16 v[52:53],v181 offset:36864
 v_mfma_f32_16x16x32_bf16 v[160:163],v[56:59],a[176:179],v[160:163]
 ds_read_b64_tr_b16 v[54:55],v181 offset:37376
 v_mov_b32 v184,0
 v_mfma_f32_16x16x32_bf16 v[168:171],v[56:59],a[180:183],v[168:171]
 ds_read_b64_tr_b16 v[56:57],v182 offset:36864
 ds_read_b64_tr_b16 v[58:59],v182 offset:37376
 v_mfma_f32_16x16x32_bf16 v[164:167],v[60:63],a[176:179],v[164:167]
 v_accvgpr_write_b32 a160,v254
 v_accvgpr_write_b32 a161,v254
 v_mfma_f32_16x16x32_bf16 v[172:175],v[60:63],a[180:183],v[172:175]
 ds_read_b64_tr_b16 v[60:61],v183 offset:36864
 ds_read_b64_tr_b16 v[62:63],v183 offset:37376
 v_mfma_f32_16x16x32_bf16 v[144:147],v[64:67],a[184:187],v[144:147]
 v_accvgpr_write_b32 a162,v255
 v_accvgpr_write_b32 a163,v255
 v_mfma_f32_16x16x32_bf16 v[152:155],v[64:67],a[188:191],v[152:155]
 ds_read_b64_tr_b16 v[64:65],v180 offset:38912
 ds_read_b64_tr_b16 v[66:67],v180 offset:39424
 v_mfma_f32_16x16x32_bf16 v[148:151],v[68:71],a[184:187],v[148:151]
 v_mfma_f32_16x16x32_bf16 v[156:159],v[68:71],a[188:191],v[156:159]
 ds_read_b64_tr_b16 v[68:69],v181 offset:38912
 ds_read_b64_tr_b16 v[70:71],v181 offset:39424
 v_mfma_f32_16x16x32_bf16 v[160:163],v[72:75],a[184:187],v[160:163]
 v_mfma_f32_16x16x32_bf16 v[168:171],v[72:75],a[188:191],v[168:171]
 ds_read_b64_tr_b16 v[72:73],v182 offset:38912
 ds_read_b64_tr_b16 v[74:75],v182 offset:39424
 v_mfma_f32_16x16x32_bf16 v[164:167],v[76:79],a[184:187],v[164:167]
 v_mfma_f32_16x16x32_bf16 v[172:175],v[76:79],a[188:191],v[172:175]
 s_waitcnt lgkmcnt(14)
 ds_read_b64_tr_b16 v[76:77],v183 offset:38912
 ds_read_b64_tr_b16 v[78:79],v183 offset:39424
 v_mfma_f32_16x16x32_bf16 v[144:147],v[16:19],a[192:195],v[144:147]
 v_mfma_f32_16x16x32_bf16 v[152:155],v[16:19],a[196:199],v[152:155]
 ds_read_b64_tr_b16 v[16:17],v180 offset:49152
 ds_read_b64_tr_b16 v[18:19],v180 offset:49664
 v_mfma_f32_16x16x32_bf16 v[148:151],v[20:23],a[192:195],v[148:151]
 v_mfma_f32_16x16x32_bf16 v[156:159],v[20:23],a[196:199],v[156:159]
 ds_read_b64_tr_b16 v[20:21],v181 offset:49152
 ds_read_b64_tr_b16 v[22:23],v181 offset:49664
 v_mfma_f32_16x16x32_bf16 v[160:163],v[24:27],a[192:195],v[160:163]
 v_mfma_f32_16x16x32_bf16 v[168:171],v[24:27],a[196:199],v[168:171]
 ds_read_b64_tr_b16 v[24:25],v182 offset:49152
 ds_read_b64_tr_b16 v[26:27],v182 offset:49664
 v_mfma_f32_16x16x32_bf16 v[164:167],v[28:31],a[192:195],v[164:167]
 s_waitcnt vmcnt(0)
 v_readfirstlane_b32 s59,v7
 s_nop 0
 s_cmp_ge_u32 s59,32
 s_cbranch_scc0 .Lseq_slow_6
.Lseq_back_7:
 v_mfma_f32_16x16x32_bf16 v[172:175],v[28:31],a[196:199],v[172:175]
 ds_read_b64_tr_b16 v[28:29],v183 offset:49152
 ds_read_b64_tr_b16 v[30:31],v183 offset:49664
 v_mfma_f32_16x16x32_bf16 v[144:147],v[32:35],a[200:203],v[144:147]
 v_mfma_f32_16x16x32_bf16 v[152:155],v[32:35],a[204:207],v[152:155]
 ds_read_b64_tr_b16 v[32:33],v180 offset:51200
 ds_read_b64_tr_b16 v[34:35],v180 offset:51712
 v_mfma_f32_16x16x32_bf16 v[148:151],v[36:39],a[200:203],v[148:151]
 v_mfma_f32_16x16x32_bf16 v[156:159],v[36:39],a[204:207],v[156:159]
 ds_read_b64_tr_b16 v[36:37],v181 offset:51200
 ds_read_b64_tr_b16 v[38:39],v181 offset:51712
 v_mfma_f32_16x16x32_bf16 v[160:163],v[40:43],a[200:203],v[160:163]
 buffer_load_dwordx4 a[0:3],v0,s[12:15],s53 offen sc1
 v_mfma_f32_16x16x32_bf16 v[168:171],v[40:43],a[204:207],v[168:171]
 ds_read_b64_tr_b16 v[40:41],v182 offset:51200
 ds_read_b64_tr_b16 v[42:43],v182 offset:51712
 v_mfma_f32_16x16x32_bf16 v[164:167],v[44:47],a[200:203],v[164:167]
 v_mfma_f32_16x16x32_bf16 v[172:175],v[44:47],a[204:207],v[172:175]
 s_waitcnt lgkmcnt(14)
 ds_read_b64_tr_b16 v[44:45],v183 offset:51200
 ds_read_b64_tr_b16 v[46:47],v183 offset:51712
 v_mfma_f32_16x16x32_bf16 v[144:147],v[48:51],a[208:211],v[144:147]
 buffer_load_dwordx4 a[4:7],v0,s[12:15],s53 offen offset:1024 sc1
 v_mfma_f32_16x16x32_bf16 v[152:155],v[48:51],a[212:215],v[152:155]
 ds_read_b64_tr_b16 v[48:49],v180 offset:53248
 ds_read_b64_tr_b16 v[50:51],v180 offset:53760
 v_mfma_f32_16x16x32_bf16 v[148:151],v[52:55],a[208:211],v[148:151]
 v_mfma_f32_16x16x32_bf16 v[156:159],v[52:55],a[212:215],v[156:159]
 ds_read_b64_tr_b16 v[52:53],v181 offset:53248
 ds_read_b64_tr_b16 v[54:55],v181 offset:53760
 v_mfma_f32_16x16x32_bf16 v[160:163],v[56:59],a[208:211],v[160:163]
 v_mfma_f32_16x16x32_bf16 v[168:171],v[56:59],a[212:215],v[168:171]
 buffer_load_dwordx4 a[8:11],v0,s[12:15],s53 offen offset:2048 sc1
 v_mfma_f32_16x16x32_bf16 v[164:167],v[60:63],a[208:211],v[164:167]
 ds_read_b64_tr_b16 v[56:57],v182 offset:53248
 ds_read_b64_tr_b16 v[58:59],v182 offset:53760
 v_mfma_f32_16x16x32_bf16 v[172:175],v[60:63],a[212:215],v[172:175]
 ds_read_b64_tr_b16 v[60:61],v183 offset:53248
 ds_read_b64_tr_b16 v[62:63],v183 offset:53760
 v_mfma_f32_16x16x32_bf16 v[144:147],v[64:67],a[216:219],v[144:147]
 v_mfma_f32_16x16x32_bf16 v[152:155],v[64:67],a[220:223],v[152:155]
 ds_read_b64_tr_b16 v[64:65],v180 offset:55296
 ds_read_b64_tr_b16 v[66:67],v180 offset:55808
 v_mfma_f32_16x16x32_bf16 v[148:151],v[68:71],a[216:219],v[148:151]
 buffer_load_dwordx4 a[12:15],v0,s[12:15],s53 offen offset:3072 sc1
 v_mfma_f32_16x16x32_bf16 v[156:159],v[68:71],a[220:223],v[156:159]
 s_add_u32 s53,s53,4096
 ds_read_b64_tr_b16 v[68:69],v181 offset:55296
 v_mfma_f32_16x16x32_bf16 v[160:163],v[72:75],a[216:219],v[160:163]
 ds_read_b64_tr_b16 v[70:71],v181 offset:55808
 v_mfma_f32_16x16x32_bf16 v[168:171],v[72:75],a[220:223],v[168:171]
 ds_read_b64_tr_b16 v[72:73],v182 offset:55296
 ds_read_b64_tr_b16 v[74:75],v182 offset:55808
 v_mfma_f32_16x16x32_bf16 v[164:167],v[76:79],a[216:219],v[164:167]
 v_mfma_f32_16x16x32_bf16 v[172:175],v[76:79],a[220:223],v[172:175]
 s_waitcnt lgkmcnt(14)
 buffer_load_dwordx4 a[16:19],v0,s[12:15],s53 offen sc1
 v_mfma_f32_16x16x32_bf16 v[144:147],v[16:19],a[224:227],v[144:147]
 ds_read_b64_tr_b16 v[76:77],v183 offset:55296
 ds_read_b64_tr_b16 v[78:79],v183 offset:55808
 v_mfma_f32_16x16x32_bf16 v[152:155],v[16:19],a[228:231],v[152:155]
 v_mfma_f32_16x16x32_bf16 v[148:151],v[20:23],a[224:227],v[148:151]
 v_mfma_f32_16x16x32_bf16 v[156:159],v[20:23],a[228:231],v[156:159]
 v_mfma_f32_16x16x32_bf16 v[160:163],v[24:27],a[224:227],v[160:163]
 buffer_load_dwordx4 a[20:23],v0,s[12:15],s53 offen offset:1024 sc1
 v_mfma_f32_16x16x32_bf16 v[168:171],v[24:27],a[228:231],v[168:171]
 v_mfma_f32_16x16x32_bf16 v[164:167],v[28:31],a[224:227],v[164:167]
 v_mfma_f32_16x16x32_bf16 v[172:175],v[28:31],a[228:231],v[172:175]
 v_mfma_f32_16x16x32_bf16 v[144:147],v[32:35],a[232:235],v[144:147]
 v_mfma_f32_16x16x32_bf16 v[152:155],v[32:35],a[236:239],v[152:155]
 buffer_load_dwordx4 a[24:27],v0,s[12:15],s53 offen offset:2048 sc1
 v_mfma_f32_16x16x32_bf16 v[148:151],v[36:39],a[232:235],v[148:151]
 v_mfma_f32_16x16x32_bf16 v[156:159],v[36:39],a[236:239],v[156:159]
 v_mfma_f32_16x16x32_bf16 v[160:163],v[40:43],a[232:235],v[160:163]
 v_mfma_f32_16x16x32_bf16 v[168:171],v[40:43],a[236:239],v[168:171]
 buffer_load_dwordx4 a[28:31],v0,s[12:15],s53 offen offset:3072 sc1
 v_mfma_f32_16x16x32_bf16 v[164:167],v[44:47],a[232:235],v[164:167]
 s_add_u32 s53,s53,4096
 v_mfma_f32_16x16x32_bf16 v[172:175],v[44:47],a[236:239],v[172:175]
 s_waitcnt lgkmcnt(12)
 v_mfma_f32_16x16x32_bf16 v[144:147],v[48:51],a[240:243],v[144:147]
 v_mfma_f32_16x16x32_bf16 v[152:155],v[48:51],a[244:247],v[152:155]
 v_mfma_f32_16x16x32_bf16 v[148:151],v[52:55],a[240:243],v[148:151]
 buffer_load_dwordx4 a[32:35],v0,s[12:15],s53 offen sc1
 v_mfma_f32_16x16x32_bf16 v[156:159],v[52:55],a[244:247],v[156:159]
 s_waitcnt lgkmcnt(8)
 v_mfma_f32_16x16x32_bf16 v[160:163],v[56:59],a[240:243],v[160:163]
 v_mfma_f32_16x16x32_bf16 v[168:171],v[56:59],a[244:247],v[168:171]
 v_mfma_f32_16x16x32_bf16 v[164:167],v[60:63],a[240:243],v[164:167]
 v_mfma_f32_16x16x32_bf16 v[172:175],v[60:63],a[244:247],v[172:175]
 s_waitcnt lgkmcnt(4)
 buffer_load_dwordx4 a[36:39],v0,s[12:15],s53 offen offset:1024 sc1
 v_mfma_f32_16x16x32_bf16 v[144:147],v[64:67],a[248:251],v[144:147]
 v_mfma_f32_16x16x32_bf16 v[152:155],v[64:67],a[252:255],v[152:155]
 v_mfma_f32_16x16x32_bf16 v[148:151],v[68:71],a[248:251],v[148:151]
 v_mfma_f32_16x16x32_bf16 v[156:159],v[68:71],a[252:255],v[156:159]
 s_waitcnt lgkmcnt(0)
 v_mfma_f32_16x16x32_bf16 v[160:163],v[72:75],a[248:251],v[160:163]
 buffer_load_dwordx4 a[40:43],v0,s[12:15],s53 offen offset:2048 sc1
 v_mfma_f32_16x16x32_bf16 v[168:171],v[72:75],a[252:255],v[168:171]
 v_mfma_f32_16x16x32_bf16 v[164:167],v[76:79],a[248:251],v[164:167]
 v_mfma_f32_16x16x32_bf16 v[172:175],v[76:79],a[252:255],v[172:175]
 v_mfma_f32_16x16x32_bf16 v[144:147],v[228:231],v[208:211],v[144:147]
 v_mfma_f32_16x16x32_bf16 v[152:155],v[228:231],v[212:215],v[152:155]
 buffer_load_dwordx4 a[44:47],v0,s[12:15],s53 offen offset:3072 sc1
 v_mfma_f32_16x16x32_bf16 v[148:151],v[232:235],v[208:211],v[148:151]
 s_add_u32 s53,s53,4096
 v_mfma_f32_16x16x32_bf16 v[156:159],v[232:235],v[212:215],v[156:159]
 v_mfma_f32_16x16x32_bf16 v[160:163],v[236:239],v[208:211],v[160:163]
 v_mfma_f32_16x16x32_bf16 v[168:171],v[236:239],v[212:215],v[168:171]
 v_mfma_f32_16x16x32_bf16 v[164:167],v[240:243],v[208:211],v[164:167]
 v_mfma_f32_16x16x32_bf16 v[172:175],v[240:243],v[212:215],v[172:175]
.Lq:
 v_mul_f32 v144,v144,v217
 v_mul_f32 v145,v145,v217
 v_mul_f32 v146,v146,v217
 v_mul_f32 v147,v147,v217
 v_mul_f32 v148,v148,v217
 v_mul_f32 v149,v149,v217
 v_mul_f32 v150,v150,v217
 v_mul_f32 v151,v151,v217
 v_cvt_pk_bf16_f32 v144,v144,v145
 v_cvt_pk_bf16_f32 v145,v146,v147
 v_cvt_pk_bf16_f32 v146,v148,v149
 v_cvt_pk_bf16_f32 v147,v150,v151
 ds_write_b128 v204,v[144:147]
 v_mul_f32 v152,v152,v219
 v_mul_f32 v153,v153,v219
 v_mul_f32 v154,v154,v219
 v_mul_f32 v155,v155,v219
 v_mul_f32 v156,v156,v219
 v_mul_f32 v157,v157,v219
 v_mul_f32 v158,v158,v219
 v_mul_f32 v159,v159,v219
 v_cvt_pk_bf16_f32 v152,v152,v153
 v_cvt_pk_bf16_f32 v153,v154,v155
 v_cvt_pk_bf16_f32 v154,v156,v157
 v_cvt_pk_bf16_f32 v155,v158,v159
 ds_write_b128 v204,v[152:155] offset:256
 v_mul_f32 v160,v160,v217
 v_mul_f32 v161,v161,v217
 v_mul_f32 v162,v162,v217
 v_mul_f32 v163,v163,v217
 v_mul_f32 v164,v164,v217
 v_mul_f32 v165,v165,v217
 v_mul_f32 v166,v166,v217
 v_mul_f32 v167,v167,v217
 v_cvt_pk_bf16_f32 v160,v160,v161
 v_cvt_pk_bf16_f32 v161,v162,v163
 v_cvt_pk_bf16_f32 v162,v164,v165
 v_cvt_pk_bf16_f32 v163,v166,v167
 ds_write_b128 v204,v[160:163] offset:2048
 v_mul_f32 v168,v168,v219
 v_mul_f32 v169,v169,v219
 v_mul_f32 v170,v170,v219
 v_mul_f32 v171,v171,v219
 v_mul_f32 v172,v172,v219
 v_mul_f32 v173,v173,v219
 v_mul_f32 v174,v174,v219
 v_mul_f32 v175,v175,v219
 v_cvt_pk_bf16_f32 v168,v168,v169
 v_cvt_pk_bf16_f32 v169,v170,v171
 v_cvt_pk_bf16_f32 v170,v172,v173
 v_cvt_pk_bf16_f32 v171,v174,v175
 ds_write_b128 v204,v[168:171] offset:2304
 s_waitcnt lgkmcnt(0)
 s_barrier
 ds_read_b128 a[128:131],v224
 ds_read_b128 a[132:135],v224 offset:1024
 ds_read_b128 a[136:139],v224 offset:4096
 ds_read_b128 a[140:143],v224 offset:5120
 ds_read_b128 a[144:147],v225
 ds_read_b128 a[148:151],v225 offset:1024
 ds_read_b128 a[152:155],v225 offset:4096
 ds_read_b128 a[156:159],v225 offset:5120
 s_waitcnt vmcnt(10) lgkmcnt(7)
 v_mfma_f32_32x32x16_bf16 v[144:159],a[0:3],a[128:131],0
 s_waitcnt lgkmcnt(6)
 v_mfma_f32_32x32x16_bf16 v[144:159],a[4:7],a[132:135],v[144:159]
 s_waitcnt lgkmcnt(5)
 v_mfma_f32_32x32x16_bf16 v[160:175],a[0:3],a[136:139],0
 s_waitcnt lgkmcnt(4)
 buffer_load_dwordx4 a[48:51],v0,s[12:15],s53 offen sc1
 s_nop 7
 v_exp_f32 v144,v144
 v_exp_f32 v145,v145
 v_exp_f32 v146,v146
 v_exp_f32 v147,v147
 v_exp_f32 v148,v148
 v_exp_f32 v149,v149
 v_exp_f32 v150,v150
 v_exp_f32 v151,v151
 v_mfma_f32_32x32x16_bf16 v[160:175],a[4:7],a[140:143],v[160:175]
 s_waitcnt vmcnt(10)
 v_exp_f32 v152,v152
 v_exp_f32 v153,v153
 v_exp_f32 v154,v154
 v_smfmac_f32_32x32x32_bf16 v[80:95],a[8:11],v[144:151],v200
 v_exp_f32 v155,v155
 v_exp_f32 v156,v156
 v_exp_f32 v157,v157
 v_smfmac_f32_16x16x64_bf16 v[184:187],a[160:163],v[144:151],v200
 s_waitcnt lgkmcnt(3)
 buffer_load_dwordx4 a[52:55],v0,s[12:15],s53 offen offset:1024 sc1
 v_exp_f32 v158,v158
 v_exp_f32 v159,v159
 v_mfma_f32_32x32x16_bf16 v[208:223],a[0:3],a[144:147],0
 s_waitcnt vmcnt(10)
 v_exp_f32 v160,v160
 v_exp_f32 v161,v161
 v_exp_f32 v162,v162
 v_smfmac_f32_32x32x32_bf16 v[80:95],a[12:15],v[152:159],v200
 v_exp_f32 v163,v163
 v_exp_f32 v164,v164
 v_exp_f32 v165,v165
 v_smfmac_f32_16x16x64_bf16 v[184:187],a[160:163],v[152:159],v200
 s_waitcnt lgkmcnt(2)
 buffer_load_dwordx4 a[56:59],v0,s[12:15],s53 offen offset:2048 sc1
 v_exp_f32 v166,v166
 v_exp_f32 v167,v167
 v_mfma_f32_32x32x16_bf16 v[208:223],a[4:7],a[148:151],v[208:223]
 v_exp_f32 v168,v168
 v_exp_f32 v169,v169
 v_exp_f32 v170,v170
 v_smfmac_f32_32x32x32_bf16 v[96:111],a[8:11],v[160:167],v200
 v_exp_f32 v171,v171
 v_exp_f32 v172,v172
 v_exp_f32 v173,v173
 v_smfmac_f32_16x16x64_bf16 v[188:191],a[160:163],v[160:167],v200
 s_waitcnt lgkmcnt(1)
 buffer_load_dwordx4 a[60:63],v0,s[12:15],s53 offen offset:3072 sc1
 v_exp_f32 v174,v174
 v_exp_f32 v175,v175
 v_mfma_f32_32x32x16_bf16 v[144:159],a[0:3],a[152:155],0
 s_add_u32 s53,s53,4096
 v_exp_f32 v208,v208
 v_exp_f32 v209,v209
 v_exp_f32 v210,v210
 v_smfmac_f32_32x32x32_bf16 v[96:111],a[12:15],v[168:175],v200
 v_exp_f32 v211,v211
 v_exp_f32 v212,v212
 v_exp_f32 v213,v213
 v_smfmac_f32_16x16x64_bf16 v[188:191],a[160:163],v[168:175],v200
 s_waitcnt lgkmcnt(0)
 buffer_load_dwordx4 a[64:67],v0,s[12:15],s53 offen sc1
 v_exp_f32 v214,v214
 v_exp_f32 v215,v215
 v_mfma_f32_32x32x16_bf16 v[144:159],a[4:7],a[156:159],v[144:159]
 v_exp_f32 v216,v216
 v_exp_f32 v217,v217
 v_exp_f32 v218,v218
 v_smfmac_f32_32x32x32_bf16 v[112:127],a[8:11],v[208:215],v200
 v_exp_f32 v219,v219
 v_exp_f32 v220,v220
 v_exp_f32 v221,v221
 v_smfmac_f32_16x16x64_bf16 v[192:195],a[160:163],v[208:215],v200
 s_waitcnt vmcnt(9)
 buffer_load_dwordx4 a[68:71],v0,s[12:15],s53 offen offset:1024 sc1
 v_exp_f32 v222,v222
 v_exp_f32 v223,v223
 v_mfma_f32_32x32x16_bf16 v[160:175],a[16:19],a[128:131],0
 v_exp_f32 v144,v144
 v_exp_f32 v145,v145
 v_exp_f32 v146,v146
 v_smfmac_f32_32x32x32_bf16 v[112:127],a[12:15],v[216:223],v200
 v_exp_f32 v147,v147
 v_exp_f32 v148,v148
 v_exp_f32 v149,v149
 v_smfmac_f32_16x16x64_bf16 v[192:195],a[160:163],v[216:223],v200
 buffer_load_dwordx4 a[72:75],v0,s[12:15],s53 offen offset:2048 sc1
 v_exp_f32 v150,v150
 v_exp_f32 v151,v151
 v_mfma_f32_32x32x16_bf16 v[160:175],a[20:23],a[132:135],v[160:175]
 v_exp_f32 v152,v152
 v_exp_f32 v153,v153
 v_exp_f32 v154,v154
 v_smfmac_f32_32x32x32_bf16 v[128:143],a[8:11],v[144:151],v200
 v_exp_f32 v155,v155
 v_exp_f32 v156,v156
 v_exp_f32 v157,v157
 v_smfmac_f32_16x16x64_bf16 v[196:199],a[160:163],v[144:151],v200
 buffer_load_dwordx4 a[76:79],v0,s[12:15],s53 offen offset:3072 sc1
 v_exp_f32 v158,v158
 v_exp_f32 v159,v159
 v_mfma_f32_32x32x16_bf16 v[208:223],a[16:19],a[136:139],0
 s_add_u32 s53,s53,4096
 v_exp_f32 v160,v160
 v_exp_f32 v161,v161
 v_exp_f32 v162,v162
 v_smfmac_f32_32x32x32_bf16 v[128:143],a[12:15],v[152:159],v200
 v_exp_f32 v163,v163
 v_exp_f32 v164,v164
 v_exp_f32 v165,v165
 v_smfmac_f32_16x16x64_bf16 v[196:199],a[160:163],v[152:159],v200
 buffer_load_dwordx4 a[80:83],v0,s[12:15],s53 offen sc1
 v_exp_f32 v166,v166
 v_exp_f32 v167,v167
 v_mfma_f32_32x32x16_bf16 v[208:223],a[20:23],a[140:143],v[208:223]
 v_exp_f32 v168,v168
 v_exp_f32 v169,v169
 v_exp_f32 v170,v170
 v_smfmac_f32_32x32x32_bf16 v[80:95],a[24:27],v[160:167],v200
 v_exp_f32 v171,v171
 v_exp_f32 v172,v172
 v_exp_f32 v173,v173
 v_smfmac_f32_16x16x64_bf16 v[184:187],a[160:163],v[160:167],v200
 buffer_load_dwordx4 a[84:87],v0,s[12:15],s53 offen offset:1024 sc1
 v_exp_f32 v174,v174
 v_exp_f32 v175,v175
 v_mfma_f32_32x32x16_bf16 v[144:159],a[16:19],a[144:147],0
 v_exp_f32 v208,v208
 v_exp_f32 v209,v209
 v_exp_f32 v210,v210
 v_smfmac_f32_32x32x32_bf16 v[80:95],a[28:31],v[168:175],v200
 v_exp_f32 v211,v211
 v_exp_f32 v212,v212
 v_exp_f32 v213,v213
 v_smfmac_f32_16x16x64_bf16 v[184:187],a[160:163],v[168:175],v200
 buffer_load_dwordx4 a[88:91],v0,s[12:15],s53 offen offset:2048 sc1
 v_exp_f32 v214,v214
 v_exp_f32 v215,v215
 v_mfma_f32_32x32x16_bf16 v[144:159],a[20:23],a[148:151],v[144:159]
 v_exp_f32 v216,v216
 v_exp_f32 v217,v217
 v_exp_f32 v218,v218
 v_smfmac_f32_32x32x32_bf16 v[96:111],a[24:27],v[208:215],v200
 v_exp_f32 v219,v219
 v_exp_f32 v220,v220
 v_exp_f32 v221,v221
 v_smfmac_f32_16x16x64_bf16 v[188:191],a[160:163],v[208:215],v200
 buffer_load_dwordx4 a[92:95],v0,s[12:15],s53 offen offset:3072 sc1
 v_exp_f32 v222,v222
 v_exp_f32 v223,v223
 v_mfma_f32_32x32x16_bf16 v[160:175],a[16:19],a[152:155],0
 s_add_u32 s53,s53,4096
 v_exp_f32 v144,v144
 v_exp_f32 v145,v145
 v_exp_f32 v146,v146
 v_smfmac_f32_32x32x32_bf16 v[96:111],a[28:31],v[216:223],v200
 v_exp_f32 v147,v147
 v_exp_f32 v148,v148
 v_exp_f32 v149,v149
 v_smfmac_f32_16x16x64_bf16 v[188:191],a[160:163],v[216:223],v200
 buffer_load_dwordx4 a[96:99],v0,s[12:15],s53 offen sc1
 v_exp_f32 v150,v150
 v_exp_f32 v151,v151
 v_mfma_f32_32x32x16_bf16 v[160:175],a[20:23],a[156:159],v[160:175]
 v_exp_f32 v152,v152
 v_exp_f32 v153,v153
 v_exp_f32 v154,v154
 v_smfmac_f32_32x32x32_bf16 v[112:127],a[24:27],v[144:151],v200
 v_exp_f32 v155,v155
 v_exp_f32 v156,v156
 v_exp_f32 v157,v157
 v_smfmac_f32_16x16x64_bf16 v[192:195],a[160:163],v[144:151],v200
 s_waitcnt vmcnt(13)
 buffer_load_dwordx4 a[100:103],v0,s[12:15],s53 offen offset:1024 sc1
 v_exp_f32 v158,v158
 v_exp_f32 v159,v159
 v_mfma_f32_32x32x16_bf16 v[208:223],a[32:35],a[128:131],0
 v_exp_f32 v160,v160
 v_exp_f32 v161,v161
 v_exp_f32 v162,v162
 v_smfmac_f32_32x32x32_bf16 v[112:127],a[28:31],v[152:159],v200
 v_exp_f32 v163,v163
 v_exp_f32 v164,v164
 v_exp_f32 v165,v165
 v_smfmac_f32_16x16x64_bf16 v[192:195],a[160:163],v[152:159],v200
 buffer_load_dwordx4 a[104:107],v0,s[12:15],s53 offen offset:2048 sc1
 v_exp_f32 v166,v166
 v_exp_f32 v167,v167
 v_mfma_f32_32x32x16_bf16 v[208:223],a[36:39],a[132:135],v[208:223]
 v_exp_f32 v168,v168
 v_exp_f32 v169,v169
 v_exp_f32 v170,v170
 v_smfmac_f32_32x32x32_bf16 v[128:143],a[24:27],v[160:167],v200
 v_exp_f32 v171,v171
 v_exp_f32 v172,v172
 v_exp_f32 v173,v173
 v_smfmac_f32_16x16x64_bf16 v[196:199],a[160:163],v[160:167],v200
 buffer_load_dwordx4 a[108:111],v0,s[12:15],s53 offen offset:3072 sc1
 v_exp_f32 v174,v174
 v_exp_f32 v175,v175
 v_mfma_f32_32x32x16_bf16 v[144:159],a[32:35],a[136:139],0
 s_add_u32 s53,s53,4096
 v_exp_f32 v208,v208
 v_exp_f32 v209,v209
 v_exp_f32 v210,v210
 v_smfmac_f32_32x32x32_bf16 v[128:143],a[28:31],v[168:175],v200
 v_exp_f32 v211,v211
 v_exp_f32 v212,v212
 v_exp_f32 v213,v213
 v_smfmac_f32_16x16x64_bf16 v[196:199],a[160:163],v[168:175],v200
 buffer_load_dwordx4 a[112:115],v0,s[12:15],s53 offen sc1
 v_exp_f32 v214,v214
 v_exp_f32 v215,v215
 v_mfma_f32_32x32x16_bf16 v[144:159],a[36:39],a[140:143],v[144:159]
 v_exp_f32 v216,v216
 v_exp_f32 v217,v217
 v_exp_f32 v218,v218
 v_smfmac_f32_32x32x32_bf16 v[80:95],a[40:43],v[208:215],v200
 v_exp_f32 v219,v219
 v_exp_f32 v220,v220
 v_exp_f32 v221,v221
 v_smfmac_f32_16x16x64_bf16 v[184:187],a[160:163],v[208:215],v200
 buffer_load_dwordx4 a[116:119],v0,s[12:15],s53 offen offset:1024 sc1
 v_exp_f32 v222,v222
 v_exp_f32 v223,v223
 v_mfma_f32_32x32x16_bf16 v[160:175],a[32:35],a[144:147],0
 s_lshl_b32 s3,s2,2
 v_exp_f32 v144,v144
 v_exp_f32 v145,v145
 v_exp_f32 v146,v146
 v_smfmac_f32_32x32x32_bf16 v[80:95],a[44:47],v[216:223],v200
 s_add_u32 s3,s3,s46
 s_mul_i32 s3,s3,16
 v_exp_f32 v147,v147
 v_exp_f32 v148,v148
 v_exp_f32 v149,v149
 v_smfmac_f32_16x16x64_bf16 v[184:187],a[160:163],v[216:223],v200
 buffer_load_dwordx4 a[120:123],v0,s[12:15],s53 offen offset:2048 sc1
 v_exp_f32 v150,v150
 v_exp_f32 v151,v151
 v_mfma_f32_32x32x16_bf16 v[160:175],a[36:39],a[148:151],v[160:175]
 v_exp_f32 v152,v152
 v_exp_f32 v153,v153
 v_exp_f32 v154,v154
 v_smfmac_f32_32x32x32_bf16 v[96:111],a[40:43],v[144:151],v200
 v_exp_f32 v155,v155
 v_exp_f32 v156,v156
 v_exp_f32 v157,v157
 v_smfmac_f32_16x16x64_bf16 v[188:191],a[160:163],v[144:151],v200
 buffer_load_dwordx4 a[124:127],v0,s[12:15],s53 offen offset:3072 sc1
 v_exp_f32 v158,v158
 v_exp_f32 v159,v159
 v_mfma_f32_32x32x16_bf16 v[208:223],a[32:35],a[152:155],0
 s_add_u32 s53,s53,4096
 v_exp_f32 v160,v160
 v_exp_f32 v161,v161
 v_exp_f32 v162,v162
 v_smfmac_f32_32x32x32_bf16 v[96:111],a[44:47],v[152:159],v200
 v_exp_f32 v163,v163
 v_exp_f32 v164,v164
 v_exp_f32 v165,v165
 v_smfmac_f32_16x16x64_bf16 v[188:191],a[160:163],v[152:159],v200
 buffer_load_dwordx4 a[0:3],v0,s[12:15],s53 offen sc1
 v_exp_f32 v166,v166
 v_exp_f32 v167,v167
 v_mfma_f32_32x32x16_bf16 v[208:223],a[36:39],a[156:159],v[208:223]
 v_exp_f32 v168,v168
 v_exp_f32 v169,v169
 v_exp_f32 v170,v170
 v_smfmac_f32_32x32x32_bf16 v[112:127],a[40:43],v[160:167],v200
 v_exp_f32 v171,v171
 v_exp_f32 v172,v172
 v_exp_f32 v173,v173
 v_smfmac_f32_16x16x64_bf16 v[192:195],a[160:163],v[160:167],v200
 s_waitcnt vmcnt(17)
 buffer_load_dwordx4 a[4:7],v0,s[12:15],s53 offen offset:1024 sc1
 v_exp_f32 v174,v174
 v_exp_f32 v175,v175
 v_mfma_f32_32x32x16_bf16 v[144:159],a[48:51],a[128:131],0
 v_exp_f32 v208,v208
 v_exp_f32 v209,v209
 v_exp_f32 v210,v210
 v_smfmac_f32_32x32x32_bf16 v[112:127],a[44:47],v[168:175],v200
 v_exp_f32 v211,v211
 v_exp_f32 v212,v212
 v_exp_f32 v213,v213
 v_smfmac_f32_16x16x64_bf16 v[192:195],a[160:163],v[168:175],v200
 buffer_load_dwordx4 a[8:11],v0,s[12:15],s53 offen offset:2048 sc1
 v_exp_f32 v214,v214
 v_exp_f32 v215,v215
 v_mfma_f32_32x32x16_bf16 v[144:159],a[52:55],a[132:135],v[144:159]
 v_exp_f32 v216,v216
 v_exp_f32 v217,v217
 v_exp_f32 v218,v218
 v_smfmac_f32_32x32x32_bf16 v[128:143],a[40:43],v[208:215],v200
 v_exp_f32 v219,v219
 v_exp_f32 v220,v220
 v_exp_f32 v221,v221
 v_smfmac_f32_16x16x64_bf16 v[196:199],a[160:163],v[208:215],v200
 buffer_load_dwordx4 a[12:15],v0,s[12:15],s53 offen offset:3072 sc1
 v_add_u32 v40,s3,v12
 v_lshlrev_b32 v40,7,v40
 v_cmp_gt_u32 vcc,16,v12
 s_nop 1
 v_cndmask_b32 v40,2.0,v40,vcc
 v_exp_f32 v222,v222
 v_exp_f32 v223,v223
 v_mfma_f32_32x32x16_bf16 v[160:175],a[48:51],a[136:139],0
 s_add_u32 s53,s53,4096
 v_exp_f32 v144,v144
 v_exp_f32 v145,v145
 v_exp_f32 v146,v146
 v_smfmac_f32_32x32x32_bf16 v[128:143],a[44:47],v[216:223],v200
 v_exp_f32 v147,v147
 v_exp_f32 v148,v148
 v_exp_f32 v149,v149
 v_smfmac_f32_16x16x64_bf16 v[196:199],a[160:163],v[216:223],v200
 buffer_load_dwordx4 a[16:19],v0,s[12:15],s53 offen sc1
 buffer_load_dword v40,v40,s[20:23],0 offen
 v_exp_f32 v150,v150
 v_exp_f32 v151,v151
 v_mfma_f32_32x32x16_bf16 v[160:175],a[52:55],a[140:143],v[160:175]
 v_exp_f32 v152,v152
 v_exp_f32 v153,v153
 v_exp_f32 v154,v154
 v_smfmac_f32_32x32x32_bf16 v[80:95],a[56:59],v[144:151],v200
 v_exp_f32 v155,v155
 v_exp_f32 v156,v156
 v_exp_f32 v157,v157
 v_smfmac_f32_16x16x64_bf16 v[184:187],a[160:163],v[144:151],v200
 buffer_load_dwordx4 a[20:23],v0,s[12:15],s53 offen offset:1024 sc1
 v_exp_f32 v158,v158
 v_exp_f32 v159,v159
 v_mfma_f32_32x32x16_bf16 v[208:223],a[48:51],a[144:147],0
 v_exp_f32 v160,v160
 v_exp_f32 v161,v161
 v_exp_f32 v162,v162
 v_smfmac_f32_32x32x32_bf16 v[80:95],a[60:63],v[152:159],v200
 v_exp_f32 v163,v163
 v_exp_f32 v164,v164
 v_exp_f32 v165,v165
 v_smfmac_f32_16x16x64_bf16 v[184:187],a[160:163],v[152:159],v200
 buffer_load_dwordx4 a[24:27],v0,s[12:15],s53 offen offset:2048 sc1
 v_exp_f32 v166,v166
 v_exp_f32 v167,v167
 v_mfma_f32_32x32x16_bf16 v[208:223],a[52:55],a[148:151],v[208:223]
 v_exp_f32 v168,v168
 v_exp_f32 v169,v169
 v_exp_f32 v170,v170
 v_smfmac_f32_32x32x32_bf16 v[96:111],a[56:59],v[160:167],v200
 v_exp_f32 v171,v171
 v_exp_f32 v172,v172
 v_exp_f32 v173,v173
 v_smfmac_f32_16x16x64_bf16 v[188:191],a[160:163],v[160:167],v200
 buffer_load_dwordx4 a[28:31],v0,s[12:15],s53 offen offset:3072 sc1
 v_exp_f32 v174,v174
 v_exp_f32 v175,v175
 v_mfma_f32_32x32x16_bf16 v[144:159],a[48:51],a[152:155],0
 s_add_u32 s53,s53,4096
 v_exp_f32 v208,v208
 v_exp_f32 v209,v209
 v_exp_f32 v210,v210
 v_smfmac_f32_32x32x32_bf16 v[96:111],a[60:63],v[168:175],v200
 s_add_u32 m0,s54,0
 s_mov_b32 s49,0
 v_exp_f32 v211,v211
 v_exp_f32 v212,v212
 v_exp_f32 v213,v213
 v_smfmac_f32_16x16x64_bf16 v[188:191],a[160:163],v[168:175],v200
 buffer_load_dwordx4 a[32:35],v0,s[12:15],s53 offen sc1
 v_exp_f32 v214,v214
 v_exp_f32 v215,v215
 v_mfma_f32_32x32x16_bf16 v[144:159],a[52:55],a[156:159],v[144:159]
 v_exp_f32 v216,v216
 v_exp_f32 v217,v217
 v_exp_f32 v218,v218
 v_smfmac_f32_32x32x32_bf16 v[112:127],a[56:59],v[208:215],v200
 v_exp_f32 v219,v219
 v_exp_f32 v220,v220
 v_exp_f32 v221,v221
 v_smfmac_f32_16x16x64_bf16 v[192:195],a[160:163],v[208:215],v200
 s_waitcnt vmcnt(22)
 buffer_load_dwordx4 a[36:39],v0,s[12:15],s53 offen offset:1024 sc1
 v_exp_f32 v222,v222
 v_exp_f32 v223,v223
 v_mfma_f32_32x32x16_bf16 v[160:175],a[64:67],a[128:131],0
 v_exp_f32 v144,v144
 v_exp_f32 v145,v145
 v_exp_f32 v146,v146
 v_smfmac_f32_32x32x32_bf16 v[112:127],a[60:63],v[216:223],v200
 v_exp_f32 v147,v147
 v_exp_f32 v148,v148
 v_exp_f32 v149,v149
 v_smfmac_f32_16x16x64_bf16 v[192:195],a[160:163],v[216:223],v200
 buffer_load_dwordx4 a[40:43],v0,s[12:15],s53 offen offset:2048 sc1
 v_exp_f32 v150,v150
 v_exp_f32 v151,v151
 v_mfma_f32_32x32x16_bf16 v[160:175],a[68:71],a[132:135],v[160:175]
 v_exp_f32 v152,v152
 v_exp_f32 v153,v153
 v_exp_f32 v154,v154
 v_smfmac_f32_32x32x32_bf16 v[128:143],a[56:59],v[144:151],v200
 s_branch .Lsk4
.Lvs1_0:
 s_branch .Lst8
.Lsk4:
 v_exp_f32 v155,v155
 v_exp_f32 v156,v156
 v_exp_f32 v157,v157
 v_smfmac_f32_16x16x64_bf16 v[196:199],a[160:163],v[144:151],v200
 buffer_load_dwordx4 a[44:47],v0,s[12:15],s53 offen offset:3072 sc1
 v_exp_f32 v158,v158
 v_exp_f32 v159,v159
 v_mfma_f32_32x32x16_bf16 v[208:223],a[64:67],a[136:139],0
 s_add_u32 s53,s53,4096
 v_exp_f32 v160,v160
 v_exp_f32 v161,v161
 v_exp_f32 v162,v162
 v_smfmac_f32_32x32x32_bf16 v[128:143],a[60:63],v[152:159],v200
 v_exp_f32 v163,v163
 v_exp_f32 v164,v164
 v_exp_f32 v165,v165
 v_smfmac_f32_16x16x64_bf16 v[196:199],a[160:163],v[152:159],v200
 buffer_load_dwordx4 v226,s[24:27],s49 offen lds
 v_exp_f32 v166,v166
 v_exp_f32 v167,v167
 v_mfma_f32_32x32x16_bf16 v[208:223],a[68:71],a[140:143],v[208:223]
 s_add_u32 m0,s54,1024
 v_exp_f32 v168,v168
 v_exp_f32 v169,v169
 v_exp_f32 v170,v170
 v_smfmac_f32_32x32x32_bf16 v[80:95],a[72:75],v[160:167],v200
 s_mov_b32 s49,57344
 v_exp_f32 v171,v171
 v_exp_f32 v172,v172
 v_exp_f32 v173,v173
 v_smfmac_f32_16x16x64_bf16 v[184:187],a[160:163],v[160:167],v200
 buffer_load_dwordx4 a[48:51],v0,s[12:15],s53 offen sc1
 v_exp_f32 v174,v174
 v_exp_f32 v175,v175
 v_mfma_f32_32x32x16_bf16 v[144:159],a[64:67],a[144:147],0
 v_exp_f32 v208,v208
 v_exp_f32 v209,v209
 v_exp_f32 v210,v210
 v_smfmac_f32_32x32x32_bf16 v[80:95],a[76:79],v[168:175],v200
 v_exp_f32 v211,v211
 v_exp_f32 v212,v212
 v_exp_f32 v213,v213
 v_smfmac_f32_16x16x64_bf16 v[184:187],a[160:163],v[168:175],v200
 v_exp_f32 v214,v214
 v_exp_f32 v215,v215
 v_mfma_f32_32x32x16_bf16 v[144:159],a[68:71],a[148:151],v[144:159]
 v_exp_f32 v216,v216
 v_exp_f32 v217,v217
 v_exp_f32 v218,v218
 v_smfmac_f32_32x32x32_bf16 v[96:111],a[72:75],v[208:215],v200
 v_exp_f32 v219,v219
 v_exp_f32 v220,v220
 v_exp_f32 v221,v221
 v_smfmac_f32_16x16x64_bf16 v[188:191],a[160:163],v[208:215],v200
 buffer_load_dwordx4 a[52:55],v0,s[12:15],s53 offen offset:1024 sc1
 v_exp_f32 v222,v222
 v_exp_f32 v223,v223
 v_mfma_f32_32x32x16_bf16 v[160:175],a[64:67],a[152:155],0
 v_exp_f32 v144,v144
 v_exp_f32 v145,v145
 v_exp_f32 v146,v146
 v_smfmac_f32_32x32x32_bf16 v[96:111],a[76:79],v[216:223],v200
 v_exp_f32 v147,v147
 v_exp_f32 v148,v148
 v_exp_f32 v149,v149
 v_smfmac_f32_16x16x64_bf16 v[188:191],a[160:163],v[216:223],v200
 buffer_load_dwordx4 v226,s[24:27],s49 offen lds
 v_exp_f32 v150,v150
 v_exp_f32 v151,v151
 v_mfma_f32_32x32x16_bf16 v[160:175],a[68:71],a[156:159],v[160:175]
 s_add_u32 m0,s54,2048
 v_exp_f32 v152,v152
 v_exp_f32 v153,v153
 v_exp_f32 v154,v154
 v_smfmac_f32_32x32x32_bf16 v[112:127],a[72:75],v[144:151],v200
 s_mov_b32 s49,114688
 v_exp_f32 v155,v155
 v_exp_f32 v156,v156
 v_exp_f32 v157,v157
 v_smfmac_f32_16x16x64_bf16 v[192:195],a[160:163],v[144:151],v200
 s_waitcnt vmcnt(25)
 buffer_load_dwordx4 a[56:59],v0,s[12:15],s53 offen offset:2048 sc1
 v_exp_f32 v158,v158
 v_exp_f32 v159,v159
 v_mfma_f32_32x32x16_bf16 v[208:223],a[80:83],a[128:131],0
 v_exp_f32 v160,v160
 v_exp_f32 v161,v161
 v_exp_f32 v162,v162
 v_smfmac_f32_32x32x32_bf16 v[112:127],a[76:79],v[152:159],v200
 v_exp_f32 v163,v163
 v_exp_f32 v164,v164
 v_exp_f32 v165,v165
 v_smfmac_f32_16x16x64_bf16 v[192:195],a[160:163],v[152:159],v200
 v_exp_f32 v166,v166
 v_exp_f32 v167,v167
 v_mfma_f32_32x32x16_bf16 v[208:223],a[84:87],a[132:135],v[208:223]
 v_exp_f32 v168,v168
 v_exp_f32 v169,v169
 v_exp_f32 v170,v170
 v_smfmac_f32_32x32x32_bf16 v[128:143],a[72:75],v[160:167],v200
 v_exp_f32 v171,v171
 v_exp_f32 v172,v172
 v_exp_f32 v173,v173
 v_smfmac_f32_16x16x64_bf16 v[196:199],a[160:163],v[160:167],v200
 buffer_load_dwordx4 a[60:63],v0,s[12:15],s53 offen offset:3072 sc1
 v_exp_f32 v174,v174
 v_exp_f32 v175,v175
 v_mfma_f32_32x32x16_bf16 v[144:159],a[80:83],a[136:139],0
 s_add_u32 s53,s53,4096
 v_exp_f32 v208,v208
 v_exp_f32 v209,v209
 v_exp_f32 v210,v210
 v_smfmac_f32_32x32x32_bf16 v[128:143],a[76:79],v[168:175],v200
 v_exp_f32 v211,v211
 v_exp_f32 v212,v212
 v_exp_f32 v213,v213
 v_smfmac_f32_16x16x64_bf16 v[196:199],a[160:163],v[168:175],v200
 buffer_load_dwordx4 v226,s[24:27],s49 offen lds
 v_exp_f32 v214,v214
 v_exp_f32 v215,v215
 v_mfma_f32_32x32x16_bf16 v[144:159],a[84:87],a[140:143],v[144:159]
 s_add_u32 m0,s54,3072
 v_exp_f32 v216,v216
 v_exp_f32 v217,v217
 v_exp_f32 v218,v218
 v_smfmac_f32_32x32x32_bf16 v[80:95],a[88:91],v[208:215],v200
 s_mov_b32 s49,172032
 v_exp_f32 v219,v219
 v_exp_f32 v220,v220
 v_exp_f32 v221,v221
 v_smfmac_f32_16x16x64_bf16 v[184:187],a[160:163],v[208:215],v200
 buffer_load_dwordx4 a[64:67],v0,s[12:15],s53 offen sc1
 v_exp_f32 v222,v222
 v_exp_f32 v223,v223
 v_mfma_f32_32x32x16_bf16 v[160:175],a[80:83],a[144:147],0
 v_exp_f32 v144,v144
 v_exp_f32 v145,v145
 v_exp_f32 v146,v146
 v_smfmac_f32_32x32x32_bf16 v[80:95],a[92:95],v[216:223],v200
 v_exp_f32 v147,v147
 v_exp_f32 v148,v148
 v_exp_f32 v149,v149
 v_smfmac_f32_16x16x64_bf16 v[184:187],a[160:163],v[216:223],v200
 v_exp_f32 v150,v150
 v_exp_f32 v151,v151
 v_mfma_f32_32x32x16_bf16 v[160:175],a[84:87],a[148:151],v[160:175]
 v_exp_f32 v152,v152
 v_exp_f32 v153,v153
 v_exp_f32 v154,v154
 v_smfmac_f32_32x32x32_bf16 v[96:111],a[88:91],v[144:151],v200
 v_exp_f32 v155,v155
 v_exp_f32 v156,v156
 v_exp_f32 v157,v157
 v_smfmac_f32_16x16x64_bf16 v[188:191],a[160:163],v[144:151],v200
 buffer_load_dwordx4 a[68:71],v0,s[12:15],s53 offen offset:1024 sc1
 v_exp_f32 v158,v158
 v_exp_f32 v159,v159
 v_mfma_f32_32x32x16_bf16 v[208:223],a[80:83],a[152:155],0
 v_exp_f32 v160,v160
 v_exp_f32 v161,v161
 v_exp_f32 v162,v162
 v_smfmac_f32_32x32x32_bf16 v[96:111],a[92:95],v[152:159],v200
 v_exp_f32 v163,v163
 v_exp_f32 v164,v164
 v_exp_f32 v165,v165
 v_smfmac_f32_16x16x64_bf16 v[188:191],a[160:163],v[152:159],v200
 buffer_load_dwordx4 v226,s[24:27],s49 offen lds
 v_exp_f32 v166,v166
 v_exp_f32 v167,v167
 v_mfma_f32_32x32x16_bf16 v[208:223],a[84:87],a[156:159],v[208:223]
 s_add_u32 m0,s54,4096
 v_exp_f32 v168,v168
 v_exp_f32 v169,v169
 v_exp_f32 v170,v170
 v_smfmac_f32_32x32x32_bf16 v[112:127],a[88:91],v[160:167],v200
 s_mov_b32 s49,229376
 v_exp_f32 v171,v171
 v_exp_f32 v172,v172
 v_exp_f32 v173,v173
 v_smfmac_f32_16x16x64_bf16 v[192:195],a[160:163],v[160:167],v200
 s_waitcnt vmcnt(27)
 buffer_load_dwordx4 a[72:75],v0,s[12:15],s53 offen offset:2048 sc1
 v_exp_f32 v174,v174
 v_exp_f32 v175,v175
 v_mfma_f32_32x32x16_bf16 v[144:159],a[96:99],a[128:131],0
 v_exp_f32 v208,v208
 v_exp_f32 v209,v209
 v_exp_f32 v210,v210
 v_smfmac_f32_32x32x32_bf16 v[112:127],a[92:95],v[168:175],v200
 v_exp_f32 v211,v211
 v_exp_f32 v212,v212
 v_exp_f32 v213,v213
 v_smfmac_f32_16x16x64_bf16 v[192:195],a[160:163],v[168:175],v200
 v_exp_f32 v214,v214
 v_exp_f32 v215,v215
 v_mfma_f32_32x32x16_bf16 v[144:159],a[100:103],a[132:135],v[144:159]
 v_exp_f32 v216,v216
 v_exp_f32 v217,v217
 v_exp_f32 v218,v218
 v_smfmac_f32_32x32x32_bf16 v[128:143],a[88:91],v[208:215],v200
 v_exp_f32 v219,v219
 v_exp_f32 v220,v220
 v_exp_f32 v221,v221
 v_smfmac_f32_16x16x64_bf16 v[196:199],a[160:163],v[208:215],v200
 buffer_load_dwordx4 a[76:79],v0,s[12:15],s53 offen offset:3072 sc1
 v_exp_f32 v222,v222
 v_exp_f32 v223,v223
 v_mfma_f32_32x32x16_bf16 v[160:175],a[96:99],a[136:139],0
 s_add_u32 s53,s53,4096
 v_exp_f32 v144,v144
 v_exp_f32 v145,v145
 v_exp_f32 v146,v146
 v_smfmac_f32_32x32x32_bf16 v[128:143],a[92:95],v[216:223],v200
 v_exp_f32 v147,v147
 v_exp_f32 v148,v148
 v_exp_f32 v149,v149
 v_smfmac_f32_16x16x64_bf16 v[196:199],a[160:163],v[216:223],v200
 buffer_load_dwordx4 v226,s[24:27],s49 offen lds
 v_exp_f32 v150,v150
 v_exp_f32 v151,v151
 v_mfma_f32_32x32x16_bf16 v[160:175],a[100:103],a[140:143],v[160:175]
 s_add_u32 m0,s54,5120
 v_exp_f32 v152,v152
 v_exp_f32 v153,v153
 v_exp_f32 v154,v154
 v_smfmac_f32_32x32x32_bf16 v[80:95],a[104:107],v[144:151],v200
 s_mov_b32 s49,286720
 v_exp_f32 v155,v155
 v_exp_f32 v156,v156
 v_exp_f32 v157,v157
 v_smfmac_f32_16x16x64_bf16 v[184:187],a[160:163],v[144:151],v200
 buffer_load_dwordx4 a[80:83],v0,s[12:15],s53 offen sc1
 v_exp_f32 v158,v158
 v_exp_f32 v159,v159
 v_mfma_f32_32x32x16_bf16 v[208:223],a[96:99],a[144:147],0
 v_exp_f32 v160,v160
 v_exp_f32 v161,v161
 v_exp_f32 v162,v162
 v_smfmac_f32_32x32x32_bf16 v[80:95],a[108:111],v[152:159],v200
 v_exp_f32 v163,v163
 v_exp_f32 v164,v164
 v_exp_f32 v165,v165
 v_smfmac_f32_16x16x64_bf16 v[184:187],a[160:163],v[152:159],v200
 v_exp_f32 v166,v166
 v_exp_f32 v167,v167
 v_mfma_f32_32x32x16_bf16 v[208:223],a[100:103],a[148:151],v[208:223]
 v_exp_f32 v168,v168
 v_exp_f32 v169,v169
 v_exp_f32 v170,v170
 v_smfmac_f32_32x32x32_bf16 v[96:111],a[104:107],v[160:167],v200
 v_exp_f32 v171,v171
 v_exp_f32 v172,v172
 v_exp_f32 v173,v173
 v_smfmac_f32_16x16x64_bf16 v[188:191],a[160:163],v[160:167],v200
 buffer_load_dwordx4 a[84:87],v0,s[12:15],s53 offen offset:1024 sc1
 v_exp_f32 v174,v174
 v_exp_f32 v175,v175
 v_mfma_f32_32x32x16_bf16 v[144:159],a[96:99],a[152:155],0
 v_exp_f32 v208,v208
 v_exp_f32 v209,v209
 v_exp_f32 v210,v210
 v_smfmac_f32_32x32x32_bf16 v[96:111],a[108:111],v[168:175],v200
 v_exp_f32 v211,v211
 v_exp_f32 v212,v212
 v_exp_f32 v213,v213
 v_smfmac_f32_16x16x64_bf16 v[188:191],a[160:163],v[168:175],v200
 buffer_load_dwordx4 v226,s[24:27],s49 offen lds
 v_exp_f32 v214,v214
 v_exp_f32 v215,v215
 v_mfma_f32_32x32x16_bf16 v[144:159],a[100:103],a[156:159],v[144:159]
 s_add_u32 m0,s54,6144
 v_exp_f32 v216,v216
 v_exp_f32 v217,v217
 v_exp_f32 v218,v218
 v_smfmac_f32_32x32x32_bf16 v[112:127],a[104:107],v[208:215],v200
 s_mov_b32 s49,344064
 v_exp_f32 v219,v219
 v_exp_f32 v220,v220
 v_exp_f32 v221,v221
 v_smfmac_f32_16x16x64_bf16 v[192:195],a[160:163],v[208:215],v200
 s_waitcnt vmcnt(29)
 buffer_load_dwordx4 a[88:91],v0,s[12:15],s53 offen offset:2048 sc1
 v_exp_f32 v222,v222
 v_exp_f32 v223,v223
 v_mfma_f32_32x32x16_bf16 v[160:175],a[112:115],a[128:131],0
 v_exp_f32 v144,v144
 v_exp_f32 v145,v145
 v_exp_f32 v146,v146
 v_smfmac_f32_32x32x32_bf16 v[112:127],a[108:111],v[216:223],v200
 v_exp_f32 v147,v147
 v_exp_f32 v148,v148
 v_exp_f32 v149,v149
 v_smfmac_f32_16x16x64_bf16 v[192:195],a[160:163],v[216:223],v200
 v_exp_f32 v150,v150
 v_exp_f32 v151,v151
 v_mfma_f32_32x32x16_bf16 v[160:175],a[116:119],a[132:135],v[160:175]
 v_exp_f32 v152,v152
 v_exp_f32 v153,v153
 v_exp_f32 v154,v154
 v_smfmac_f32_32x32x32_bf16 v[128:143],a[104:107],v[144:151],v200
 v_exp_f32 v155,v155
 v_exp_f32 v156,v156
 v_exp_f32 v157,v157
 v_smfmac_f32_16x16x64_bf16 v[196:199],a[160:163],v[144:151],v200
 buffer_load_dwordx4 a[92:95],v0,s[12:15],s53 offen offset:3072 sc1
 v_exp_f32 v158,v158
 v_exp_f32 v159,v159
 v_mfma_f32_32x32x16_bf16 v[208:223],a[112:115],a[136:139],0
 s_add_u32 s53,s53,4096
 v_exp_f32 v160,v160
 v_exp_f32 v161,v161
 v_exp_f32 v162,v162
 v_smfmac_f32_32x32x32_bf16 v[128:143],a[108:111],v[152:159],v200
 s_lshl_b32 s3,s2,2
 s_add_u32 s3,s3,s46
 v_exp_f32 v163,v163
 v_exp_f32 v164,v164
 v_exp_f32 v165,v165
 v_smfmac_f32_16x16x64_bf16 v[196:199],a[160:163],v[152:159],v200
 s_mul_i32 s3,s3,28
 buffer_load_dwordx4 v226,s[24:27],s49 offen lds
 v_exp_f32 v166,v166
 v_exp_f32 v167,v167
 v_mfma_f32_32x32x16_bf16 v[208:223],a[116:119],a[140:143],v[208:223]
 s_add_u32 m0,s54,7168
 v_exp_f32 v168,v168
 v_exp_f32 v169,v169
 v_exp_f32 v170,v170
 v_smfmac_f32_32x32x32_bf16 v[80:95],a[120:123],v[160:167],v200
 s_mov_b32 s49,401408
 v_exp_f32 v171,v171
 v_exp_f32 v172,v172
 v_exp_f32 v173,v173
 v_smfmac_f32_16x16x64_bf16 v[184:187],a[160:163],v[160:167],v200
 buffer_load_dwordx4 a[96:99],v0,s[12:15],s53 offen sc1
 v_exp_f32 v174,v174
 v_exp_f32 v175,v175
 v_mfma_f32_32x32x16_bf16 v[144:159],a[112:115],a[144:147],0
 v_exp_f32 v208,v208
 v_exp_f32 v209,v209
 v_exp_f32 v210,v210
 v_smfmac_f32_32x32x32_bf16 v[80:95],a[124:127],v[168:175],v200
 v_exp_f32 v211,v211
 v_exp_f32 v212,v212
 v_exp_f32 v213,v213
 v_smfmac_f32_16x16x64_bf16 v[184:187],a[160:163],v[168:175],v200
 v_exp_f32 v214,v214
 v_exp_f32 v215,v215
 v_mfma_f32_32x32x16_bf16 v[144:159],a[116:119],a[148:151],v[144:159]
 v_exp_f32 v216,v216
 v_exp_f32 v217,v217
 v_exp_f32 v218,v218
 v_smfmac_f32_32x32x32_bf16 v[96:111],a[120:123],v[208:215],v200
 v_exp_f32 v219,v219
 v_exp_f32 v220,v220
 v_exp_f32 v221,v221
 v_smfmac_f32_16x16x64_bf16 v[188:191],a[160:163],v[208:215],v200
 buffer_load_dwordx4 a[100:103],v0,s[12:15],s53 offen offset:1024 sc1
 v_exp_f32 v222,v222
 v_exp_f32 v223,v223
 v_mfma_f32_32x32x16_bf16 v[160:175],a[112:115],a[152:155],0
 v_exp_f32 v144,v144
 v_exp_f32 v145,v145
 v_exp_f32 v146,v146
 v_smfmac_f32_32x32x32_bf16 v[96:111],a[124:127],v[216:223],v200
 v_exp_f32 v147,v147
 v_exp_f32 v148,v148
 v_exp_f32 v149,v149
 v_smfmac_f32_16x16x64_bf16 v[188:191],a[160:163],v[216:223],v200
 buffer_load_dwordx4 v226,s[24:27],s49 offen lds
 v_exp_f32 v150,v150
 v_exp_f32 v151,v151
 v_mfma_f32_32x32x16_bf16 v[160:175],a[116:119],a[156:159],v[160:175]
 s_add_u32 m0,s54,8192
 v_exp_f32 v152,v152
 v_exp_f32 v153,v153
 v_exp_f32 v154,v154
 v_smfmac_f32_32x32x32_bf16 v[112:127],a[120:123],v[144:151],v200
 s_mov_b32 s49,0
 v_exp_f32 v155,v155
 v_exp_f32 v156,v156
 v_exp_f32 v157,v157
 v_smfmac_f32_16x16x64_bf16 v[192:195],a[160:163],v[144:151],v200
 s_waitcnt vmcnt(31)
 buffer_load_dwordx4 a[104:107],v0,s[12:15],s53 offen offset:2048 sc1
 v_add_u32 v41,s3,v12
 v_lshlrev_b32 v41,7,v41
 v_cmp_gt_u32 vcc,28,v12
 s_nop 1
 v_cndmask_b32 v41,2.0,v41,vcc
 v_exp_f32 v158,v158
 v_exp_f32 v159,v159
 v_mfma_f32_32x32x16_bf16 v[208:223],a[0:3],a[128:131],0
 v_exp_f32 v160,v160
 v_exp_f32 v161,v161
 v_exp_f32 v162,v162
 v_smfmac_f32_32x32x32_bf16 v[112:127],a[124:127],v[152:159],v200
 v_exp_f32 v163,v163
 v_exp_f32 v164,v164
 v_exp_f32 v165,v165
 v_smfmac_f32_16x16x64_bf16 v[192:195],a[160:163],v[152:159],v200
 buffer_load_dword v41,v41,s[36:39],0 offen
 v_exp_f32 v166,v166
 v_exp_f32 v167,v167
 v_mfma_f32_32x32x16_bf16 v[208:223],a[4:7],a[132:135],v[208:223]
 v_exp_f32 v168,v168
 v_exp_f32 v169,v169
 v_exp_f32 v170,v170
 v_smfmac_f32_32x32x32_bf16 v[128:143],a[120:123],v[160:167],v200
 v_exp_f32 v171,v171
 v_exp_f32 v172,v172
 v_exp_f32 v173,v173
 v_smfmac_f32_16x16x64_bf16 v[196:199],a[160:163],v[160:167],v200
 buffer_load_dwordx4 a[108:111],v0,s[12:15],s53 offen offset:3072 sc1
 v_exp_f32 v174,v174
 v_exp_f32 v175,v175
 v_mfma_f32_32x32x16_bf16 v[144:159],a[0:3],a[136:139],0
 s_add_u32 s53,s53,4096
 v_exp_f32 v208,v208
 v_exp_f32 v209,v209
 v_exp_f32 v210,v210
 v_smfmac_f32_32x32x32_bf16 v[128:143],a[124:127],v[168:175],v200
 v_exp_f32 v211,v211
 v_exp_f32 v212,v212
 v_exp_f32 v213,v213
 v_smfmac_f32_16x16x64_bf16 v[196:199],a[160:163],v[168:175],v200
 buffer_load_dwordx4 v246,s[28:31],s49 offen lds
 v_exp_f32 v214,v214
 v_exp_f32 v215,v215
 v_mfma_f32_32x32x16_bf16 v[144:159],a[4:7],a[140:143],v[144:159]
 s_add_u32 m0,s54,9216
 v_exp_f32 v216,v216
 v_exp_f32 v217,v217
 v_exp_f32 v218,v218
 v_smfmac_f32_32x32x32_bf16 v[80:95],a[8:11],v[208:215],v200
 s_mov_b32 s49,65536
 v_exp_f32 v219,v219
 v_exp_f32 v220,v220
 v_exp_f32 v221,v221
 v_smfmac_f32_16x16x64_bf16 v[184:187],a[160:163],v[208:215],v200
 buffer_load_dwordx4 a[112:115],v0,s[12:15],s53 offen sc1
 v_exp_f32 v222,v222
 v_exp_f32 v223,v223
 v_mfma_f32_32x32x16_bf16 v[160:175],a[0:3],a[144:147],0
 v_exp_f32 v144,v144
 v_exp_f32 v145,v145
 v_exp_f32 v146,v146
 v_smfmac_f32_32x32x32_bf16 v[80:95],a[12:15],v[216:223],v200
 v_exp_f32 v147,v147
 v_exp_f32 v148,v148
 v_exp_f32 v149,v149
 v_smfmac_f32_16x16x64_bf16 v[184:187],a[160:163],v[216:223],v200
 v_exp_f32 v150,v150
 v_exp_f32 v151,v151
 v_mfma_f32_32x32x16_bf16 v[160:175],a[4:7],a[148:151],v[160:175]
 v_exp_f32 v152,v152
 v_exp_f32 v153,v153
 v_exp_f32 v154,v154
 v_smfmac_f32_32x32x32_bf16 v[96:111],a[8:11],v[144:151],v200
 v_exp_f32 v155,v155
 v_exp_f32 v156,v156
 v_exp_f32 v157,v157
 v_smfmac_f32_16x16x64_bf16 v[188:191],a[160:163],v[144:151],v200
 buffer_load_dwordx4 a[116:119],v0,s[12:15],s53 offen offset:1024 sc1
 v_exp_f32 v158,v158
 v_exp_f32 v159,v159
 v_mfma_f32_32x32x16_bf16 v[208:223],a[0:3],a[152:155],0
 v_exp_f32 v160,v160
 v_exp_f32 v161,v161
 v_exp_f32 v162,v162
 v_smfmac_f32_32x32x32_bf16 v[96:111],a[12:15],v[152:159],v200
 v_exp_f32 v163,v163
 v_exp_f32 v164,v164
 v_exp_f32 v165,v165
 v_smfmac_f32_16x16x64_bf16 v[188:191],a[160:163],v[152:159],v200
 buffer_load_dwordx4 v247,s[28:31],s49 offen lds
 v_exp_f32 v166,v166
 v_exp_f32 v167,v167
 v_mfma_f32_32x32x16_bf16 v[208:223],a[4:7],a[156:159],v[208:223]
 s_add_u32 m0,s54,10240
 v_exp_f32 v168,v168
 v_exp_f32 v169,v169
 v_exp_f32 v170,v170
 v_smfmac_f32_32x32x32_bf16 v[112:127],a[8:11],v[160:167],v200
 s_mov_b32 s49,16384
 v_exp_f32 v171,v171
 v_exp_f32 v172,v172
 v_exp_f32 v173,v173
 v_smfmac_f32_16x16x64_bf16 v[192:195],a[160:163],v[160:167],v200
 s_waitcnt vmcnt(33)
 buffer_load_dwordx4 a[120:123],v0,s[12:15],s53 offen offset:2048 sc1
 v_exp_f32 v174,v174
 v_exp_f32 v175,v175
 v_mfma_f32_32x32x16_bf16 v[144:159],a[16:19],a[128:131],0
 v_exp_f32 v208,v208
 v_exp_f32 v209,v209
 v_exp_f32 v210,v210
 v_smfmac_f32_32x32x32_bf16 v[112:127],a[12:15],v[168:175],v200
 v_exp_f32 v211,v211
 v_exp_f32 v212,v212
 v_exp_f32 v213,v213
 v_smfmac_f32_16x16x64_bf16 v[192:195],a[160:163],v[168:175],v200
 v_exp_f32 v214,v214
 v_exp_f32 v215,v215
 v_mfma_f32_32x32x16_bf16 v[144:159],a[20:23],a[132:135],v[144:159]
 v_exp_f32 v216,v216
 v_exp_f32 v217,v217
 v_exp_f32 v218,v218
 v_smfmac_f32_32x32x32_bf16 v[128:143],a[8:11],v[208:215],v200
 v_exp_f32 v219,v219
 v_exp_f32 v220,v220
 v_exp_f32 v221,v221
 v_smfmac_f32_16x16x64_bf16 v[196:199],a[160:163],v[208:215],v200
 buffer_load_dwordx4 a[124:127],v0,s[12:15],s53 offen offset:3072 sc1
 v_exp_f32 v222,v222
 v_exp_f32 v223,v223
 v_mfma_f32_32x32x16_bf16 v[160:175],a[16:19],a[136:139],0
 s_add_u32 s53,s53,4096
 v_exp_f32 v144,v144
 v_exp_f32 v145,v145
 v_exp_f32 v146,v146
 v_smfmac_f32_32x32x32_bf16 v[128:143],a[12:15],v[216:223],v200
 v_exp_f32 v147,v147
 v_exp_f32 v148,v148
 v_exp_f32 v149,v149
 v_smfmac_f32_16x16x64_bf16 v[196:199],a[160:163],v[216:223],v200
 buffer_load_dwordx4 v246,s[28:31],s49 offen lds
 v_exp_f32 v150,v150
 v_exp_f32 v151,v151
 v_mfma_f32_32x32x16_bf16 v[160:175],a[20:23],a[140:143],v[160:175]
 s_add_u32 m0,s54,11264
 v_exp_f32 v152,v152
 v_exp_f32 v153,v153
 v_exp_f32 v154,v154
 v_smfmac_f32_32x32x32_bf16 v[80:95],a[24:27],v[144:151],v200
 s_mov_b32 s49,81920
 v_exp_f32 v155,v155
 v_exp_f32 v156,v156
 v_exp_f32 v157,v157
 v_smfmac_f32_16x16x64_bf16 v[184:187],a[160:163],v[144:151],v200
 buffer_load_dwordx4 a[0:3],v0,s[12:15],s53 offen sc1
 v_exp_f32 v158,v158
 v_exp_f32 v159,v159
 v_mfma_f32_32x32x16_bf16 v[208:223],a[16:19],a[144:147],0
 v_exp_f32 v160,v160
 v_exp_f32 v161,v161
 v_exp_f32 v162,v162
 v_smfmac_f32_32x32x32_bf16 v[80:95],a[28:31],v[152:159],v200
 v_exp_f32 v163,v163
 v_exp_f32 v164,v164
 v_exp_f32 v165,v165
 v_smfmac_f32_16x16x64_bf16 v[184:187],a[160:163],v[152:159],v200
 v_exp_f32 v166,v166
 v_exp_f32 v167,v167
 v_mfma_f32_32x32x16_bf16 v[208:223],a[20:23],a[148:151],v[208:223]
 v_exp_f32 v168,v168
 v_exp_f32 v169,v169
 v_exp_f32 v170,v170
 v_smfmac_f32_32x32x32_bf16 v[96:111],a[24:27],v[160:167],v200
 v_exp_f32 v171,v171
 v_exp_f32 v172,v172
 v_exp_f32 v173,v173
 v_smfmac_f32_16x16x64_bf16 v[188:191],a[160:163],v[160:167],v200
 buffer_load_dwordx4 a[4:7],v0,s[12:15],s53 offen offset:1024 sc1
 v_exp_f32 v174,v174
 v_exp_f32 v175,v175
 v_mfma_f32_32x32x16_bf16 v[144:159],a[16:19],a[152:155],0
 v_exp_f32 v208,v208
 v_exp_f32 v209,v209
 v_exp_f32 v210,v210
 v_smfmac_f32_32x32x32_bf16 v[96:111],a[28:31],v[168:175],v200
 v_exp_f32 v211,v211
 v_exp_f32 v212,v212
 v_exp_f32 v213,v213
 v_smfmac_f32_16x16x64_bf16 v[188:191],a[160:163],v[168:175],v200
 buffer_load_dwordx4 v247,s[28:31],s49 offen lds
 v_exp_f32 v214,v214
 v_exp_f32 v215,v215
 v_mfma_f32_32x32x16_bf16 v[144:159],a[20:23],a[156:159],v[144:159]
 s_add_u32 m0,s54,12288
 v_exp_f32 v216,v216
 v_exp_f32 v217,v217
 v_exp_f32 v218,v218
 v_smfmac_f32_32x32x32_bf16 v[112:127],a[24:27],v[208:215],v200
 s_mov_b32 s49,128
 v_exp_f32 v219,v219
 v_exp_f32 v220,v220
 v_exp_f32 v221,v221
 v_smfmac_f32_16x16x64_bf16 v[192:195],a[160:163],v[208:215],v200
 s_waitcnt vmcnt(35)
 buffer_load_dwordx4 a[8:11],v0,s[12:15],s53 offen offset:2048 sc1
 v_exp_f32 v222,v222
 v_exp_f32 v223,v223
 v_mfma_f32_32x32x16_bf16 v[160:175],a[32:35],a[128:131],0
 v_exp_f32 v144,v144
 v_exp_f32 v145,v145
 v_exp_f32 v146,v146
 v_smfmac_f32_32x32x32_bf16 v[112:127],a[28:31],v[216:223],v200
 v_exp_f32 v147,v147
 v_exp_f32 v148,v148
 v_exp_f32 v149,v149
 v_smfmac_f32_16x16x64_bf16 v[192:195],a[160:163],v[216:223],v200
 v_exp_f32 v150,v150
 v_exp_f32 v151,v151
 v_mfma_f32_32x32x16_bf16 v[160:175],a[36:39],a[132:135],v[160:175]
 v_exp_f32 v152,v152
 v_exp_f32 v153,v153
 v_exp_f32 v154,v154
 v_smfmac_f32_32x32x32_bf16 v[128:143],a[24:27],v[144:151],v200
 v_exp_f32 v155,v155
 v_exp_f32 v156,v156
 v_exp_f32 v157,v157
 v_smfmac_f32_16x16x64_bf16 v[196:199],a[160:163],v[144:151],v200
 buffer_load_dwordx4 a[12:15],v0,s[12:15],s53 offen offset:3072 sc1
 v_exp_f32 v158,v158
 v_exp_f32 v159,v159
 v_mfma_f32_32x32x16_bf16 v[208:223],a[32:35],a[136:139],0
 s_add_u32 s53,s53,4096
 v_exp_f32 v160,v160
 v_exp_f32 v161,v161
 v_exp_f32 v162,v162
 v_smfmac_f32_32x32x32_bf16 v[128:143],a[28:31],v[152:159],v200
 v_exp_f32 v163,v163
 v_exp_f32 v164,v164
 v_exp_f32 v165,v165
 v_smfmac_f32_16x16x64_bf16 v[196:199],a[160:163],v[152:159],v200
 buffer_load_dwordx4 v246,s[28:31],s49 offen lds
 v_exp_f32 v166,v166
 v_exp_f32 v167,v167
 v_mfma_f32_32x32x16_bf16 v[208:223],a[36:39],a[140:143],v[208:223]
 s_add_u32 m0,s54,13312
 v_exp_f32 v168,v168
 v_exp_f32 v169,v169
 v_exp_f32 v170,v170
 v_smfmac_f32_32x32x32_bf16 v[80:95],a[40:43],v[160:167],v200
 s_mov_b32 s49,65664
 v_exp_f32 v171,v171
 v_exp_f32 v172,v172
 v_exp_f32 v173,v173
 v_smfmac_f32_16x16x64_bf16 v[184:187],a[160:163],v[160:167],v200
 buffer_load_dwordx4 a[16:19],v0,s[12:15],s53 offen sc1
 v_exp_f32 v174,v174
 v_exp_f32 v175,v175
 v_mfma_f32_32x32x16_bf16 v[144:159],a[32:35],a[144:147],0
 v_exp_f32 v208,v208
 v_exp_f32 v209,v209
 v_exp_f32 v210,v210
 v_smfmac_f32_32x32x32_bf16 v[80:95],a[44:47],v[168:175],v200
 v_exp_f32 v211,v211
 v_exp_f32 v212,v212
 v_exp_f32 v213,v213
 v_smfmac_f32_16x16x64_bf16 v[184:187],a[160:163],v[168:175],v200
 v_exp_f32 v214,v214
 v_exp_f32 v215,v215
 v_mfma_f32_32x32x16_bf16 v[144:159],a[36:39],a[148:151],v[144:159]
 v_exp_f32 v216,v216
 v_exp_f32 v217,v217
 v_exp_f32 v218,v218
 v_smfmac_f32_32x32x32_bf16 v[96:111],a[40:43],v[208:215],v200
 v_exp_f32 v219,v219
 v_exp_f32 v220,v220
 v_exp_f32 v221,v221
 v_smfmac_f32_16x16x64_bf16 v[188:191],a[160:163],v[208:215],v200
 buffer_load_dwordx4 a[20:23],v0,s[12:15],s53 offen offset:1024 sc1
 v_exp_f32 v222,v222
 v_exp_f32 v223,v223
 v_mfma_f32_32x32x16_bf16 v[160:175],a[32:35],a[152:155],0
 v_exp_f32 v144,v144
 v_exp_f32 v145,v145
 v_exp_f32 v146,v146
 v_smfmac_f32_32x32x32_bf16 v[96:111],a[44:47],v[216:223],v200
 v_exp_f32 v147,v147
 v_exp_f32 v148,v148
 v_exp_f32 v149,v149
 v_smfmac_f32_16x16x64_bf16 v[188:191],a[160:163],v[216:223],v200
 buffer_load_dwordx4 v247,s[28:31],s49 offen lds
 v_exp_f32 v150,v150
 v_exp_f32 v151,v151
 v_mfma_f32_32x32x16_bf16 v[160:175],a[36:39],a[156:159],v[160:175]
 s_add_u32 m0,s54,14336
 v_exp_f32 v152,v152
 v_exp_f32 v153,v153
 v_exp_f32 v154,v154
 v_smfmac_f32_32x32x32_bf16 v[112:127],a[40:43],v[144:151],v200
 s_mov_b32 s49,16512
 v_exp_f32 v155,v155
 v_exp_f32 v156,v156
 v_exp_f32 v157,v157
 v_smfmac_f32_16x16x64_bf16 v[192:195],a[160:163],v[144:151],v200
 s_waitcnt vmcnt(35)
 buffer_load_dwordx4 a[24:27],v0,s[12:15],s53 offen offset:2048 sc1
 v_exp_f32 v158,v158
 v_exp_f32 v159,v159
 v_mfma_f32_32x32x16_bf16 v[208:223],a[48:51],a[128:131],0
 v_exp_f32 v160,v160
 v_exp_f32 v161,v161
 v_exp_f32 v162,v162
 v_smfmac_f32_32x32x32_bf16 v[112:127],a[44:47],v[152:159],v200
 v_exp_f32 v163,v163
 v_exp_f32 v164,v164
 v_exp_f32 v165,v165
 v_smfmac_f32_16x16x64_bf16 v[192:195],a[160:163],v[152:159],v200
 v_exp_f32 v166,v166
 v_exp_f32 v167,v167
 v_mfma_f32_32x32x16_bf16 v[208:223],a[52:55],a[132:135],v[208:223]
 v_exp_f32 v168,v168
 v_exp_f32 v169,v169
 v_exp_f32 v170,v170
 v_smfmac_f32_32x32x32_bf16 v[128:143],a[40:43],v[160:167],v200
 v_exp_f32 v171,v171
 v_exp_f32 v172,v172
 v_exp_f32 v173,v173
 v_smfmac_f32_16x16x64_bf16 v[196:199],a[160:163],v[160:167],v200
 buffer_load_dwordx4 a[28:31],v0,s[12:15],s53 offen offset:3072 sc1
 v_exp_f32 v174,v174
 v_exp_f32 v175,v175
 v_mfma_f32_32x32x16_bf16 v[144:159],a[48:51],a[136:139],0
 s_add_u32 s53,s53,4096
 v_exp_f32 v208,v208
 v_exp_f32 v209,v209
 v_exp_f32 v210,v210
 v_smfmac_f32_32x32x32_bf16 v[128:143],a[44:47],v[168:175],v200
 s_mul_i32 s57,s47,43
 s_lshr_b32 s57,s57,7
 v_exp_f32 v211,v211
 v_exp_f32 v212,v212
 v_exp_f32 v213,v213
 v_smfmac_f32_16x16x64_bf16 v[196:199],a[160:163],v[168:175],v200
 s_mul_i32 s58,s57,3
 s_sub_u32 s58,s47,s58
 buffer_load_dwordx4 v246,s[28:31],s49 offen lds
 v_exp_f32 v214,v214
 v_exp_f32 v215,v215
 v_mfma_f32_32x32x16_bf16 v[144:159],a[52:55],a[140:143],v[144:159]
 s_mul_i32 s56,s57,7
 v_exp_f32 v216,v216
 v_exp_f32 v217,v217
 v_exp_f32 v218,v218
 v_smfmac_f32_32x32x32_bf16 v[80:95],a[56:59],v[208:215],v200
 s_add_u32 s56,s56,s58
 s_and_b32 s51,s58,1
 v_exp_f32 v219,v219
 v_exp_f32 v220,v220
 v_exp_f32 v221,v221
 v_smfmac_f32_16x16x64_bf16 v[184:187],a[160:163],v[208:215],v200
 s_and_b32 s58,s58,2
 s_add_u32 s56,s56,s58
 buffer_load_dwordx4 a[32:35],v0,s[12:15],s53 offen sc1
 v_exp_f32 v222,v222
 v_exp_f32 v223,v223
 v_mfma_f32_32x32x16_bf16 v[160:175],a[48:51],a[144:147],0
 s_add_u32 s56,s56,2
 v_exp_f32 v144,v144
 v_exp_f32 v145,v145
 v_exp_f32 v146,v146
 v_smfmac_f32_32x32x32_bf16 v[80:95],a[60:63],v[216:223],v200
 s_add_u32 m0,s54,15360
 s_mov_b32 s49,82048
 v_exp_f32 v147,v147
 v_exp_f32 v148,v148
 v_exp_f32 v149,v149
 v_smfmac_f32_16x16x64_bf16 v[184:187],a[160:163],v[216:223],v200
 s_branch .Lsk5
.Lvs1_1:
 s_branch .Lvb1
.Lsk5:
 s_lshl_b32 s51,s51,14
 v_exp_f32 v150,v150
 v_exp_f32 v151,v151
 v_mfma_f32_32x32x16_bf16 v[160:175],a[52:55],a[148:151],v[160:175]
 v_exp_f32 v152,v152
 v_exp_f32 v153,v153
 v_exp_f32 v154,v154
 v_smfmac_f32_32x32x32_bf16 v[96:111],a[56:59],v[144:151],v200
 v_exp_f32 v155,v155
 v_exp_f32 v156,v156
 v_exp_f32 v157,v157
 v_smfmac_f32_16x16x64_bf16 v[188:191],a[160:163],v[144:151],v200
 buffer_load_dwordx4 a[36:39],v0,s[12:15],s53 offen offset:1024 sc1
 v_exp_f32 v158,v158
 v_exp_f32 v159,v159
 v_mfma_f32_32x32x16_bf16 v[208:223],a[48:51],a[152:155],0
 s_add_u32 s58,s47,24
 v_exp_f32 v160,v160
 v_exp_f32 v161,v161
 v_exp_f32 v162,v162
 v_smfmac_f32_32x32x32_bf16 v[96:111],a[60:63],v[152:159],v200
 s_lshl_b32 s56,s56,16
 s_bfe_u32 s57,s58,196609
 v_exp_f32 v163,v163
 v_exp_f32 v164,v164
 v_exp_f32 v165,v165
 v_smfmac_f32_16x16x64_bf16 v[188:191],a[160:163],v[152:159],v200
 s_mul_i32 s57,s57,7
 s_bfe_u32 s70,s58,65540
 buffer_load_dwordx4 v247,s[28:31],s49 offen lds
 v_exp_f32 v166,v166
 v_exp_f32 v167,v167
 v_mfma_f32_32x32x16_bf16 v[208:223],a[52:55],a[156:159],v[208:223]
 s_add_u32 s57,s57,s70
 v_exp_f32 v168,v168
 v_exp_f32 v169,v169
 v_exp_f32 v170,v170
 v_smfmac_f32_32x32x32_bf16 v[112:127],a[56:59],v[160:167],v200
 s_and_b32 s58,s58,1
 s_lshl2_add_u32 s57,s58,s57
 v_exp_f32 v171,v171
 v_exp_f32 v172,v172
 v_exp_f32 v173,v173
 v_smfmac_f32_16x16x64_bf16 v[192:195],a[160:163],v[160:167],v200
 s_lshl_b32 s57,s57,16
 buffer_load_dwordx4 a[40:43],v0,s[12:15],s53 offen offset:2048 sc1
 v_exp_f32 v174,v174
 v_exp_f32 v175,v175
 s_waitcnt vmcnt(36)
 v_mfma_f32_32x32x16_bf16 v[144:159],a[64:67],a[128:131],0
 s_xor_b32 s70,s45,6
 v_exp_f32 v208,v208
 v_exp_f32 v209,v209
 v_exp_f32 v210,v210
 v_smfmac_f32_32x32x32_bf16 v[112:127],a[60:63],v[168:175],v200
 v_exp_f32 v211,v211
 v_exp_f32 v212,v212
 v_exp_f32 v213,v213
 v_smfmac_f32_16x16x64_bf16 v[192:195],a[160:163],v[168:175],v200
 v_exp_f32 v214,v214
 v_exp_f32 v215,v215
 v_mfma_f32_32x32x16_bf16 v[144:159],a[68:71],a[132:135],v[144:159]
 v_exp_f32 v216,v216
 v_exp_f32 v217,v217
 v_exp_f32 v218,v218
 v_smfmac_f32_32x32x32_bf16 v[128:143],a[56:59],v[208:215],v200
 v_exp_f32 v219,v219
 v_exp_f32 v220,v220
 v_exp_f32 v221,v221
 v_smfmac_f32_16x16x64_bf16 v[196:199],a[160:163],v[208:215],v200
 buffer_load_dwordx4 a[44:47],v0,s[12:15],s53 offen offset:3072 sc1
 v_xor_b32 v44,768,v250
 v_exp_f32 v222,v222
 v_exp_f32 v223,v223
 v_mfma_f32_32x32x16_bf16 v[160:175],a[64:67],a[136:139],0
 s_add_u32 s53,s53,4096
 v_exp_f32 v144,v144
 v_exp_f32 v145,v145
 v_exp_f32 v146,v146
 v_smfmac_f32_32x32x32_bf16 v[128:143],a[60:63],v[216:223],v200
 s_cmp_lt_u32 s47,24
 s_cselect_b32 s56,s56,s57
 s_cselect_b32 s51,s51,0
 v_exp_f32 v147,v147
 v_exp_f32 v148,v148
 v_exp_f32 v149,v149
 v_smfmac_f32_16x16x64_bf16 v[196:199],a[160:163],v[216:223],v200
 s_add_u32 s57,s56,s51
 s_add_u32 s57,s57,16384
 v_exp_f32 v150,v150
 v_exp_f32 v151,v151
 v_mfma_f32_32x32x16_bf16 v[160:175],a[68:71],a[140:143],v[160:175]
 v_exp_f32 v152,v152
 v_exp_f32 v153,v153
 v_exp_f32 v154,v154
 v_smfmac_f32_32x32x32_bf16 v[80:95],a[72:75],v[144:151],v200
 v_exp_f32 v155,v155
 v_exp_f32 v156,v156
 v_exp_f32 v157,v157
 v_smfmac_f32_16x16x64_bf16 v[184:187],a[160:163],v[144:151],v200
 buffer_load_dwordx4 a[48:51],v0,s[12:15],s53 offen sc1
 v_exp_f32 v158,v158
 v_exp_f32 v159,v159
 v_mfma_f32_32x32x16_bf16 v[208:223],a[64:67],a[144:147],0
 v_exp_f32 v160,v160
 v_exp_f32 v161,v161
 v_exp_f32 v162,v162
 v_smfmac_f32_32x32x32_bf16 v[80:95],a[76:79],v[152:159],v200
 v_exp_f32 v163,v163
 v_exp_f32 v164,v164
 v_exp_f32 v165,v165
 v_smfmac_f32_16x16x64_bf16 v[184:187],a[160:163],v[152:159],v200
 v_xor_b32 v33,32,v227
 v_xor_b32 v34,64,v227
 v_xor_b32 v35,96,v227
 buffer_load_dwordx4 a[176:179],v44,s[36:39],s56 offen
 v_exp_f32 v166,v166
 v_exp_f32 v167,v167
 v_mfma_f32_32x32x16_bf16 v[208:223],a[68:71],a[148:151],v[208:223]
 v_exp_f32 v168,v168
 v_exp_f32 v169,v169
 v_exp_f32 v170,v170
 v_smfmac_f32_32x32x32_bf16 v[96:111],a[72:75],v[160:167],v200
 v_exp_f32 v171,v171
 v_exp_f32 v172,v172
 v_exp_f32 v173,v173
 v_smfmac_f32_16x16x64_bf16 v[188:191],a[160:163],v[160:167],v200
 buffer_load_dwordx4 a[52:55],v0,s[12:15],s53 offen offset:1024 sc1
 v_exp_f32 v174,v174
 v_exp_f32 v175,v175
 v_mfma_f32_32x32x16_bf16 v[144:159],a[64:67],a[152:155],0
 v_exp_f32 v208,v208
 v_exp_f32 v209,v209
 v_exp_f32 v210,v210
 v_smfmac_f32_32x32x32_bf16 v[96:111],a[76:79],v[168:175],v200
 v_exp_f32 v211,v211
 v_exp_f32 v212,v212
 v_exp_f32 v213,v213
 v_smfmac_f32_16x16x64_bf16 v[188:191],a[160:163],v[168:175],v200
 ds_read_b64_tr_b16 a[192:193],v227
 ds_read_b64_tr_b16 a[194:195],v227 offset:2048
 buffer_load_dwordx4 a[180:183],v44,s[36:39],s57 offen
 v_exp_f32 v214,v214
 v_exp_f32 v215,v215
 v_mfma_f32_32x32x16_bf16 v[144:159],a[68:71],a[156:159],v[144:159]
 s_sub_u32 s57,s56,s51
 v_exp_f32 v216,v216
 v_exp_f32 v217,v217
 v_exp_f32 v218,v218
 v_smfmac_f32_32x32x32_bf16 v[112:127],a[72:75],v[208:215],v200
 s_add_u32 s57,s57,32768
 v_exp_f32 v219,v219
 v_exp_f32 v220,v220
 v_exp_f32 v221,v221
 v_smfmac_f32_16x16x64_bf16 v[192:195],a[160:163],v[208:215],v200
 s_waitcnt vmcnt(35)
 buffer_load_dwordx4 a[56:59],v0,s[12:15],s53 offen offset:2048 sc1
 v_exp_f32 v222,v222
 v_exp_f32 v223,v223
 v_mfma_f32_32x32x16_bf16 v[160:175],a[80:83],a[128:131],0
 v_exp_f32 v144,v144
 v_exp_f32 v145,v145
 v_exp_f32 v146,v146
 v_smfmac_f32_32x32x32_bf16 v[112:127],a[76:79],v[216:223],v200
 s_waitcnt lgkmcnt(0)
 v_mfma_f32_16x16x32_bf16 v[16:19],v[8:11],a[192:195],0
 v_exp_f32 v147,v147
 v_exp_f32 v148,v148
 v_exp_f32 v149,v149
 v_smfmac_f32_16x16x64_bf16 v[192:195],a[160:163],v[216:223],v200
 ds_read_b64_tr_b16 a[196:197],v33
 ds_read_b64_tr_b16 a[198:199],v33 offset:2048
 v_exp_f32 v150,v150
 v_exp_f32 v151,v151
 v_mfma_f32_32x32x16_bf16 v[160:175],a[84:87],a[132:135],v[160:175]
 v_exp_f32 v152,v152
 v_exp_f32 v153,v153
 v_exp_f32 v154,v154
 v_smfmac_f32_32x32x32_bf16 v[128:143],a[72:75],v[144:151],v200
 v_exp_f32 v155,v155
 v_exp_f32 v156,v156
 v_exp_f32 v157,v157
 v_smfmac_f32_16x16x64_bf16 v[196:199],a[160:163],v[144:151],v200
 buffer_load_dwordx4 a[60:63],v0,s[12:15],s53 offen offset:3072 sc1
 v_exp_f32 v158,v158
 v_exp_f32 v159,v159
 v_mfma_f32_32x32x16_bf16 v[208:223],a[80:83],a[136:139],0
 s_add_u32 s53,s53,4096
 v_exp_f32 v160,v160
 v_exp_f32 v161,v161
 v_exp_f32 v162,v162
 v_smfmac_f32_32x32x32_bf16 v[128:143],a[76:79],v[152:159],v200
 s_waitcnt lgkmcnt(0)
 v_mfma_f32_16x16x32_bf16 v[20:23],v[8:11],a[196:199],0
 v_exp_f32 v163,v163
 v_exp_f32 v164,v164
 v_exp_f32 v165,v165
 v_smfmac_f32_16x16x64_bf16 v[196:199],a[160:163],v[152:159],v200
 ds_read_b64_tr_b16 a[200:201],v34
 ds_read_b64_tr_b16 a[202:203],v34 offset:2048
 buffer_load_dwordx4 a[184:187],v44,s[36:39],s57 offen
 v_exp_f32 v166,v166
 v_exp_f32 v167,v167
 v_mfma_f32_32x32x16_bf16 v[208:223],a[84:87],a[140:143],v[208:223]
 s_add_u32 s57,s56,49152
 v_exp_f32 v168,v168
 v_exp_f32 v169,v169
 v_exp_f32 v170,v170
 v_smfmac_f32_32x32x32_bf16 v[80:95],a[88:91],v[160:167],v200
 v_exp_f32 v171,v171
 v_exp_f32 v172,v172
 v_exp_f32 v173,v173
 v_smfmac_f32_16x16x64_bf16 v[184:187],a[160:163],v[160:167],v200
 buffer_load_dwordx4 a[64:67],v0,s[12:15],s53 offen sc1
 v_exp_f32 v174,v174
 v_exp_f32 v175,v175
 v_mfma_f32_32x32x16_bf16 v[144:159],a[80:83],a[144:147],0
 v_exp_f32 v208,v208
 v_exp_f32 v209,v209
 v_exp_f32 v210,v210
 v_smfmac_f32_32x32x32_bf16 v[80:95],a[92:95],v[168:175],v200
 s_waitcnt lgkmcnt(0)
 v_mfma_f32_16x16x32_bf16 v[24:27],v[8:11],a[200:203],0
 v_exp_f32 v211,v211
 v_exp_f32 v212,v212
 v_exp_f32 v213,v213
 v_smfmac_f32_16x16x64_bf16 v[184:187],a[160:163],v[168:175],v200
 ds_read_b64_tr_b16 a[204:205],v35
 ds_read_b64_tr_b16 a[206:207],v35 offset:2048
 buffer_load_dwordx4 a[188:191],v44,s[36:39],s57 offen
 v_exp_f32 v214,v214
 v_exp_f32 v215,v215
 v_mfma_f32_32x32x16_bf16 v[144:159],a[84:87],a[148:151],v[144:159]
 v_exp_f32 v216,v216
 v_exp_f32 v217,v217
 v_exp_f32 v218,v218
 v_smfmac_f32_32x32x32_bf16 v[96:111],a[88:91],v[208:215],v200
 v_exp_f32 v219,v219
 v_exp_f32 v220,v220
 v_exp_f32 v221,v221
 v_smfmac_f32_16x16x64_bf16 v[188:191],a[160:163],v[208:215],v200
 buffer_load_dwordx4 a[68:71],v0,s[12:15],s53 offen offset:1024 sc1
 v_exp_f32 v222,v222
 v_exp_f32 v223,v223
 v_mfma_f32_32x32x16_bf16 v[160:175],a[80:83],a[152:155],0
 s_add_u32 m0,s54,16384
 v_exp_f32 v144,v144
 v_exp_f32 v145,v145
 v_exp_f32 v146,v146
 v_smfmac_f32_32x32x32_bf16 v[96:111],a[92:95],v[216:223],v200
 s_waitcnt lgkmcnt(0)
 v_mfma_f32_16x16x32_bf16 v[28:31],v[8:11],a[204:207],0
 v_exp_f32 v147,v147
 v_exp_f32 v148,v148
 v_exp_f32 v149,v149
 v_smfmac_f32_16x16x64_bf16 v[188:191],a[160:163],v[216:223],v200
 s_add_u32 s49,s52,262144
 s_mul_i32 s56,s70,3
 s_waitcnt vmcnt(37)
 ds_read_b64_tr_b16 a[208:209],v227 offset:4096
 ds_read_b64_tr_b16 a[210:211],v227 offset:6144
 v_exp_f32 v150,v150
 v_exp_f32 v151,v151
 v_mfma_f32_32x32x16_bf16 v[160:175],a[84:87],a[156:159],v[160:175]
 s_add_u32 s56,s56,1
 v_exp_f32 v152,v152
 v_exp_f32 v153,v153
 v_exp_f32 v154,v154
 v_smfmac_f32_32x32x32_bf16 v[112:127],a[88:91],v[144:151],v200
 s_lshr_b32 s56,s56,1
 v_exp_f32 v155,v155
 v_exp_f32 v156,v156
 v_exp_f32 v157,v157
 v_smfmac_f32_16x16x64_bf16 v[192:195],a[160:163],v[144:151],v200
 s_waitcnt vmcnt(34)
 buffer_load_dwordx4 a[72:75],v0,s[12:15],s53 offen offset:2048 sc1
 v_exp_f32 v158,v158
 v_exp_f32 v159,v159
 v_mfma_f32_32x32x16_bf16 v[208:223],a[96:99],a[128:131],0
 v_exp_f32 v160,v160
 v_exp_f32 v161,v161
 v_exp_f32 v162,v162
 v_smfmac_f32_32x32x32_bf16 v[112:127],a[92:95],v[152:159],v200
 s_waitcnt lgkmcnt(0)
 v_mfma_f32_16x16x32_bf16 v[16:19],v[8:11],a[208:211],v[16:19]
 v_exp_f32 v163,v163
 v_exp_f32 v164,v164
 v_exp_f32 v165,v165
 v_smfmac_f32_16x16x64_bf16 v[192:195],a[160:163],v[152:159],v200
 ds_read_b64_tr_b16 a[212:213],v33 offset:4096
 ds_read_b64_tr_b16 a[214:215],v33 offset:6144
 v_exp_f32 v166,v166
 v_exp_f32 v167,v167
 v_mfma_f32_32x32x16_bf16 v[208:223],a[100:103],a[132:135],v[208:223]
 v_exp_f32 v168,v168
 v_exp_f32 v169,v169
 v_exp_f32 v170,v170
 v_smfmac_f32_32x32x32_bf16 v[128:143],a[88:91],v[160:167],v200
 v_exp_f32 v171,v171
 v_exp_f32 v172,v172
 v_exp_f32 v173,v173
 v_smfmac_f32_16x16x64_bf16 v[196:199],a[160:163],v[160:167],v200
 buffer_load_dwordx4 a[76:79],v0,s[12:15],s53 offen offset:3072 sc1
 v_exp_f32 v174,v174
 v_exp_f32 v175,v175
 v_mfma_f32_32x32x16_bf16 v[144:159],a[96:99],a[136:139],0
 s_add_u32 s53,s53,4096
 v_exp_f32 v208,v208
 v_exp_f32 v209,v209
 v_exp_f32 v210,v210
 v_smfmac_f32_32x32x32_bf16 v[128:143],a[92:95],v[168:175],v200
 s_cmp_lt_u32 s47,40
 s_cselect_b32 s58,24,40
 s_waitcnt lgkmcnt(0)
 v_mfma_f32_16x16x32_bf16 v[20:23],v[8:11],a[212:215],v[20:23]
 v_exp_f32 v211,v211
 v_exp_f32 v212,v212
 v_exp_f32 v213,v213
 v_smfmac_f32_16x16x64_bf16 v[196:199],a[160:163],v[168:175],v200
 ds_read_b64_tr_b16 a[216:217],v34 offset:4096
 ds_read_b64_tr_b16 a[218:219],v34 offset:6144
 buffer_load_dwordx4 v250,s[20:23],s49 offen lds
 v_exp_f32 v214,v214
 v_exp_f32 v215,v215
 v_mfma_f32_32x32x16_bf16 v[144:159],a[100:103],a[140:143],v[144:159]
 s_add_u32 s57,s58,s70
 v_exp_f32 v216,v216
 v_exp_f32 v217,v217
 v_exp_f32 v218,v218
 v_smfmac_f32_32x32x32_bf16 v[80:95],a[104:107],v[208:215],v200
 s_add_u32 m0,s54,17408
 s_add_u32 s49,s52,278528
 v_exp_f32 v219,v219
 v_exp_f32 v220,v220
 v_exp_f32 v221,v221
 v_smfmac_f32_16x16x64_bf16 v[184:187],a[160:163],v[208:215],v200
 buffer_load_dwordx4 a[80:83],v0,s[12:15],s53 offen sc1
 v_exp_f32 v222,v222
 v_exp_f32 v223,v223
 v_mfma_f32_32x32x16_bf16 v[160:175],a[96:99],a[144:147],0
 v_exp_f32 v144,v144
 v_exp_f32 v145,v145
 v_exp_f32 v146,v146
 v_smfmac_f32_32x32x32_bf16 v[80:95],a[108:111],v[216:223],v200
 s_cmp_lt_u32 s47,24
 s_cselect_b32 s58,0,s58
 s_cselect_b32 s56,s56,s57
 s_waitcnt lgkmcnt(0)
 v_mfma_f32_16x16x32_bf16 v[24:27],v[8:11],a[216:219],v[24:27]
 v_exp_f32 v147,v147
 v_exp_f32 v148,v148
 v_exp_f32 v149,v149
 v_smfmac_f32_16x16x64_bf16 v[184:187],a[160:163],v[216:223],v200
 ds_read_b64_tr_b16 a[220:221],v35 offset:4096
 ds_read_b64_tr_b16 a[222:223],v35 offset:6144
 buffer_load_dwordx4 v250,s[20:23],s49 offen lds
 v_exp_f32 v150,v150
 v_exp_f32 v151,v151
 v_mfma_f32_32x32x16_bf16 v[160:175],a[100:103],a[148:151],v[160:175]
 s_add_u32 m0,s54,18432
 v_exp_f32 v152,v152
 v_exp_f32 v153,v153
 v_exp_f32 v154,v154
 v_smfmac_f32_32x32x32_bf16 v[96:111],a[104:107],v[144:151],v200
 s_add_u32 s49,s52,294912
 v_exp_f32 v155,v155
 v_exp_f32 v156,v156
 v_exp_f32 v157,v157
 v_smfmac_f32_16x16x64_bf16 v[188:191],a[160:163],v[144:151],v200
 buffer_load_dwordx4 a[84:87],v0,s[12:15],s53 offen offset:1024 sc1
 v_exp_f32 v158,v158
 v_exp_f32 v159,v159
 v_mfma_f32_32x32x16_bf16 v[208:223],a[96:99],a[152:155],0
 v_exp_f32 v160,v160
 v_exp_f32 v161,v161
 v_exp_f32 v162,v162
 v_smfmac_f32_32x32x32_bf16 v[96:111],a[108:111],v[152:159],v200
 s_cmp_eq_u32 s47,s56
 s_cselect_b32 s57,s58,s47
 s_waitcnt lgkmcnt(0)
 v_mfma_f32_16x16x32_bf16 v[28:31],v[8:11],a[220:223],v[28:31]
 v_exp_f32 v163,v163
 v_exp_f32 v164,v164
 v_exp_f32 v165,v165
 v_smfmac_f32_16x16x64_bf16 v[188:191],a[160:163],v[152:159],v200
 v_exp_f32 v166,v166
 v_exp_f32 v167,v167
 v_mfma_f32_32x32x16_bf16 v[208:223],a[100:103],a[156:159],v[208:223]
 v_exp_f32 v168,v168
 v_exp_f32 v169,v169
 v_exp_f32 v170,v170
 v_smfmac_f32_32x32x32_bf16 v[112:127],a[104:107],v[160:167],v200
 v_exp_f32 v171,v171
 v_exp_f32 v172,v172
 v_exp_f32 v173,v173
 v_smfmac_f32_16x16x64_bf16 v[192:195],a[160:163],v[160:167],v200
 s_waitcnt vmcnt(34)
 buffer_load_dwordx4 a[88:91],v0,s[12:15],s53 offen offset:2048 sc1
 v_exp_f32 v174,v174
 v_exp_f32 v175,v175
 v_mfma_f32_32x32x16_bf16 v[144:159],a[112:115],a[128:131],0
 s_lshl_b32 s70,s70,6
 v_exp_f32 v208,v208
 v_exp_f32 v209,v209
 v_exp_f32 v210,v210
 v_smfmac_f32_32x32x32_bf16 v[112:127],a[108:111],v[168:175],v200
 s_cmp_eq_u32 s47,s58
 s_cselect_b32 s57,s56,s57
 v_exp_f32 v211,v211
 v_exp_f32 v212,v212
 v_exp_f32 v213,v213
 v_smfmac_f32_16x16x64_bf16 v[192:195],a[160:163],v[168:175],v200
 v_mov_b32_dpp v16,v20 quad_perm:[0,1,2,3] row_mask:0x2 bank_mask:0xf
 s_nop 1
 v_mov_b32_dpp v16,v24 quad_perm:[0,1,2,3] row_mask:0x4 bank_mask:0xf
 s_nop 1
 v_mov_b32_dpp v16,v28 quad_perm:[0,1,2,3] row_mask:0x8 bank_mask:0xf
 buffer_load_dwordx4 v250,s[20:23],s49 offen lds
 v_exp_f32 v214,v214
 v_exp_f32 v215,v215
 v_mfma_f32_32x32x16_bf16 v[144:159],a[116:119],a[132:135],v[144:159]
 s_add_u32 m0,s54,19456
 v_exp_f32 v216,v216
 v_exp_f32 v217,v217
 v_exp_f32 v218,v218
 v_smfmac_f32_32x32x32_bf16 v[128:143],a[104:107],v[208:215],v200
 s_add_u32 s49,s52,311296
 s_add_u32 s70,s70,s57
 v_exp_f32 v219,v219
 v_exp_f32 v220,v220
 v_exp_f32 v221,v221
 v_smfmac_f32_16x16x64_bf16 v[196:199],a[160:163],v[208:215],v200
 s_lshl_b32 s70,s70,12
 buffer_load_dwordx4 a[92:95],v0,s[12:15],s53 offen offset:3072 sc1
 v_exp_f32 v222,v222
 v_exp_f32 v223,v223
 v_mfma_f32_32x32x16_bf16 v[160:175],a[112:115],a[136:139],0
 s_add_u32 s53,s53,4096
 v_exp_f32 v144,v144
 v_exp_f32 v145,v145
 v_exp_f32 v146,v146
 v_smfmac_f32_32x32x32_bf16 v[128:143],a[108:111],v[216:223],v200
 v_exp_f32 v147,v147
 v_exp_f32 v148,v148
 v_exp_f32 v149,v149
 v_smfmac_f32_16x16x64_bf16 v[196:199],a[160:163],v[216:223],v200
 v_cvt_pk_bf16_f32 v17,v16,v16
 v_and_b32 v17,0xffff0000,v17
 v_sub_f32 v17,v16,v17
 v_cvt_pk_bf16_f32 v16,v16,v17
 buffer_load_dwordx4 v250,s[20:23],s49 offen lds
 v_exp_f32 v150,v150
 v_exp_f32 v151,v151
 v_mfma_f32_32x32x16_bf16 v[160:175],a[116:119],a[140:143],v[160:175]
 s_add_u32 m0,s54,20480
 v_exp_f32 v152,v152
 v_exp_f32 v153,v153
 v_exp_f32 v154,v154
 v_smfmac_f32_32x32x32_bf16 v[80:95],a[120:123],v[144:151],v200
 buffer_store_dwordx4 a[192:195],v0,s[12:15],s64 offen sc1
 buffer_store_dword v16,v245,s[12:15],0 offen sc1
 v_exp_f32 v155,v155
 v_exp_f32 v156,v156
 v_exp_f32 v157,v157
 v_smfmac_f32_16x16x64_bf16 v[184:187],a[160:163],v[144:151],v200
 s_add_u32 s49,s52,327680
 buffer_load_dwordx4 a[96:99],v0,s[12:15],s53 offen sc1
 v_exp_f32 v158,v158
 v_exp_f32 v159,v159
 v_mfma_f32_32x32x16_bf16 v[208:223],a[112:115],a[144:147],0
 v_exp_f32 v160,v160
 v_exp_f32 v161,v161
 v_exp_f32 v162,v162
 v_smfmac_f32_32x32x32_bf16 v[80:95],a[124:127],v[152:159],v200
 s_add_u32 s70,s70,62914560
 v_exp_f32 v163,v163
 v_exp_f32 v164,v164
 v_exp_f32 v165,v165
 v_smfmac_f32_16x16x64_bf16 v[184:187],a[160:163],v[152:159],v200
 v_exp_f32 v166,v166
 v_exp_f32 v167,v167
 v_mfma_f32_32x32x16_bf16 v[208:223],a[116:119],a[148:151],v[208:223]
 v_exp_f32 v168,v168
 v_exp_f32 v169,v169
 v_exp_f32 v170,v170
 v_smfmac_f32_32x32x32_bf16 v[96:111],a[120:123],v[160:167],v200
 v_exp_f32 v171,v171
 v_exp_f32 v172,v172
 v_exp_f32 v173,v173
 v_smfmac_f32_16x16x64_bf16 v[188:191],a[160:163],v[160:167],v200
 buffer_load_dwordx4 a[100:103],v0,s[12:15],s53 offen offset:1024 sc1
 v_exp_f32 v174,v174
 v_exp_f32 v175,v175
 v_mfma_f32_32x32x16_bf16 v[144:159],a[112:115],a[152:155],0
 v_exp_f32 v208,v208
 v_exp_f32 v209,v209
 v_exp_f32 v210,v210
 v_smfmac_f32_32x32x32_bf16 v[96:111],a[124:127],v[168:175],v200
 v_exp_f32 v211,v211
 v_exp_f32 v212,v212
 v_exp_f32 v213,v213
 v_smfmac_f32_16x16x64_bf16 v[188:191],a[160:163],v[168:175],v200
 s_waitcnt vmcnt(38)
 ds_read_b128 a[224:227],v248
 buffer_load_dwordx4 v250,s[20:23],s49 offen lds
 v_exp_f32 v214,v214
 v_exp_f32 v215,v215
 v_mfma_f32_32x32x16_bf16 v[144:159],a[116:119],a[156:159],v[144:159]
 s_add_u32 m0,s54,21504
 v_exp_f32 v216,v216
 v_exp_f32 v217,v217
 v_exp_f32 v218,v218
 v_smfmac_f32_32x32x32_bf16 v[112:127],a[120:123],v[208:215],v200
 buffer_store_dwordx4 a[196:199],v0,s[12:15],s65 offen sc1
 v_exp_f32 v219,v219
 v_exp_f32 v220,v220
 v_exp_f32 v221,v221
 v_smfmac_f32_16x16x64_bf16 v[192:195],a[160:163],v[208:215],v200
 s_add_u32 s49,s52,344064
 buffer_load_dwordx4 a[104:107],v0,s[12:15],s53 offen offset:2048 sc1
 v_exp_f32 v222,v222
 v_exp_f32 v223,v223
 s_waitcnt vmcnt(39)
 v_mfma_f32_32x32x16_bf16 v[160:175],a[0:3],a[128:131],0
 v_exp_f32 v144,v144
 v_exp_f32 v145,v145
 v_exp_f32 v146,v146
 v_smfmac_f32_32x32x32_bf16 v[112:127],a[124:127],v[216:223],v200
 v_exp_f32 v147,v147
 v_exp_f32 v148,v148
 v_exp_f32 v149,v149
 v_smfmac_f32_16x16x64_bf16 v[192:195],a[160:163],v[216:223],v200
 ds_read_b128 a[228:231],v248 offset:2048
 buffer_load_dwordx4 v250,s[20:23],s49 offen lds
 v_exp_f32 v150,v150
 v_exp_f32 v151,v151
 v_mfma_f32_32x32x16_bf16 v[160:175],a[4:7],a[132:135],v[160:175]
 s_add_u32 m0,s54,22528
 v_exp_f32 v152,v152
 v_exp_f32 v153,v153
 v_exp_f32 v154,v154
 v_smfmac_f32_32x32x32_bf16 v[128:143],a[120:123],v[144:151],v200
 s_add_u32 s49,s52,360448
 v_exp_f32 v155,v155
 v_exp_f32 v156,v156
 v_exp_f32 v157,v157
 v_smfmac_f32_16x16x64_bf16 v[196:199],a[160:163],v[144:151],v200
 buffer_load_dwordx4 a[108:111],v0,s[12:15],s53 offen offset:3072 sc1
 v_exp_f32 v158,v158
 v_exp_f32 v159,v159
 v_mfma_f32_32x32x16_bf16 v[208:223],a[0:3],a[136:139],0
 s_add_u32 s53,s53,4096
 v_exp_f32 v160,v160
 v_exp_f32 v161,v161
 v_exp_f32 v162,v162
 v_smfmac_f32_32x32x32_bf16 v[128:143],a[124:127],v[152:159],v200
 v_exp_f32 v163,v163
 v_exp_f32 v164,v164
 v_exp_f32 v165,v165
 v_smfmac_f32_16x16x64_bf16 v[196:199],a[160:163],v[152:159],v200
 ds_read_b128 a[232:235],v249
 v_exp_f32 v166,v166
 v_exp_f32 v167,v167
 v_mfma_f32_32x32x16_bf16 v[208:223],a[4:7],a[140:143],v[208:223]
 v_exp_f32 v168,v168
 v_exp_f32 v169,v169
 v_exp_f32 v170,v170
 v_smfmac_f32_32x32x32_bf16 v[80:95],a[8:11],v[160:167],v200
 v_exp_f32 v171,v171
 v_exp_f32 v172,v172
 v_exp_f32 v173,v173
 v_smfmac_f32_16x16x64_bf16 v[184:187],a[160:163],v[160:167],v200
 buffer_load_dwordx4 a[112:115],v0,s[12:15],s53 offen sc1
 v_exp_f32 v174,v174
 v_exp_f32 v175,v175
 v_mfma_f32_32x32x16_bf16 v[144:159],a[0:3],a[144:147],0
 v_exp_f32 v208,v208
 v_exp_f32 v209,v209
 v_exp_f32 v210,v210
 v_smfmac_f32_32x32x32_bf16 v[80:95],a[12:15],v[168:175],v200
 v_exp_f32 v211,v211
 v_exp_f32 v212,v212
 v_exp_f32 v213,v213
 v_smfmac_f32_16x16x64_bf16 v[184:187],a[160:163],v[168:175],v200
 ds_read_b128 a[236:239],v249 offset:2048
 buffer_load_dwordx4 v250,s[20:23],s49 offen lds
 v_exp_f32 v214,v214
 v_exp_f32 v215,v215
 v_mfma_f32_32x32x16_bf16 v[144:159],a[4:7],a[148:151],v[144:159]
 s_add_u32 m0,s54,23552
 v_exp_f32 v216,v216
 v_exp_f32 v217,v217
 v_exp_f32 v218,v218
 v_smfmac_f32_32x32x32_bf16 v[96:111],a[8:11],v[208:215],v200
 buffer_store_dwordx4 a[200:203],v0,s[12:15],s66 offen sc1
 v_exp_f32 v219,v219
 v_exp_f32 v220,v220
 v_exp_f32 v221,v221
 v_smfmac_f32_16x16x64_bf16 v[188:191],a[160:163],v[208:215],v200
 s_add_u32 s49,s52,376832
 buffer_load_dwordx4 a[116:119],v0,s[12:15],s53 offen offset:1024 sc1
 v_exp_f32 v222,v222
 v_exp_f32 v223,v223
 v_mfma_f32_32x32x16_bf16 v[160:175],a[0:3],a[152:155],0
 v_exp_f32 v144,v144
 v_exp_f32 v145,v145
 v_exp_f32 v146,v146
 v_smfmac_f32_32x32x32_bf16 v[96:111],a[12:15],v[216:223],v200
 v_exp_f32 v147,v147
 v_exp_f32 v148,v148
 v_exp_f32 v149,v149
 v_smfmac_f32_16x16x64_bf16 v[188:191],a[160:163],v[216:223],v200
 s_waitcnt vmcnt(35)
 ds_read_b128 a[240:243],v248 offset:4096
 buffer_load_dwordx4 v250,s[20:23],s49 offen lds
 v_exp_f32 v150,v150
 v_exp_f32 v151,v151
 v_mfma_f32_32x32x16_bf16 v[160:175],a[4:7],a[156:159],v[160:175]
 s_add_u32 m0,s54,24576
 v_exp_f32 v152,v152
 v_exp_f32 v153,v153
 v_exp_f32 v154,v154
 v_smfmac_f32_32x32x32_bf16 v[112:127],a[8:11],v[144:151],v200
 s_add_u32 s49,s52,393216
 v_exp_f32 v155,v155
 v_exp_f32 v156,v156
 v_exp_f32 v157,v157
 v_smfmac_f32_16x16x64_bf16 v[192:195],a[160:163],v[144:151],v200
 buffer_load_dwordx4 a[120:123],v0,s[12:15],s53 offen offset:2048 sc1
 v_exp_f32 v158,v158
 v_exp_f32 v159,v159
 v_mfma_f32_32x32x16_bf16 v[208:223],a[16:19],a[128:131],0
 v_exp_f32 v160,v160
 v_exp_f32 v161,v161
 v_exp_f32 v162,v162
 v_smfmac_f32_32x32x32_bf16 v[112:127],a[12:15],v[152:159],v200
 v_exp_f32 v163,v163
 v_exp_f32 v164,v164
 v_exp_f32 v165,v165
 v_smfmac_f32_16x16x64_bf16 v[192:195],a[160:163],v[152:159],v200
 ds_read_b128 a[244:247],v248 offset:6144
 v_exp_f32 v166,v166
 v_exp_f32 v167,v167
 v_mfma_f32_32x32x16_bf16 v[208:223],a[20:23],a[132:135],v[208:223]
 v_exp_f32 v168,v168
 v_exp_f32 v169,v169
 v_exp_f32 v170,v170
 v_smfmac_f32_32x32x32_bf16 v[128:143],a[8:11],v[160:167],v200
 buffer_store_dwordx4 a[204:207],v244,s[12:15],s67 offen sc1
 v_exp_f32 v171,v171
 v_exp_f32 v172,v172
 v_exp_f32 v173,v173
 v_smfmac_f32_16x16x64_bf16 v[196:199],a[160:163],v[160:167],v200
 buffer_load_dwordx4 a[124:127],v0,s[12:15],s53 offen offset:3072 sc1
 v_exp_f32 v174,v174
 v_exp_f32 v175,v175
 v_mfma_f32_32x32x16_bf16 v[144:159],a[16:19],a[136:139],0
 s_add_u32 s53,s53,4096
 v_exp_f32 v208,v208
 v_exp_f32 v209,v209
 v_exp_f32 v210,v210
 v_smfmac_f32_32x32x32_bf16 v[128:143],a[12:15],v[168:175],v200
 v_exp_f32 v211,v211
 v_exp_f32 v212,v212
 v_exp_f32 v213,v213
 v_smfmac_f32_16x16x64_bf16 v[196:199],a[160:163],v[168:175],v200
 ds_read_b128 a[248:251],v249 offset:4096
 buffer_load_dwordx4 v250,s[20:23],s49 offen lds
 v_exp_f32 v214,v214
 v_exp_f32 v215,v215
 v_mfma_f32_32x32x16_bf16 v[144:159],a[20:23],a[140:143],v[144:159]
 s_add_u32 m0,s54,25600
 v_exp_f32 v216,v216
 v_exp_f32 v217,v217
 v_exp_f32 v218,v218
 v_smfmac_f32_32x32x32_bf16 v[80:95],a[24:27],v[208:215],v200
 s_add_u32 s49,s52,409600
 v_exp_f32 v219,v219
 v_exp_f32 v220,v220
 v_exp_f32 v221,v221
 v_smfmac_f32_16x16x64_bf16 v[184:187],a[160:163],v[208:215],v200
 buffer_load_dwordx4 a[0:3],v0,s[12:15],s53 offen sc1
 v_exp_f32 v222,v222
 v_exp_f32 v223,v223
 v_mfma_f32_32x32x16_bf16 v[160:175],a[16:19],a[144:147],0
 v_exp_f32 v144,v144
 v_exp_f32 v145,v145
 v_exp_f32 v146,v146
 v_smfmac_f32_32x32x32_bf16 v[80:95],a[28:31],v[216:223],v200
 v_exp_f32 v147,v147
 v_exp_f32 v148,v148
 v_exp_f32 v149,v149
 v_smfmac_f32_16x16x64_bf16 v[184:187],a[160:163],v[216:223],v200
 ds_read_b128 a[252:255],v249 offset:6144
 buffer_load_dwordx4 v250,s[20:23],s49 offen lds
 v_exp_f32 v150,v150
 v_exp_f32 v151,v151
 v_mfma_f32_32x32x16_bf16 v[160:175],a[20:23],a[148:151],v[160:175]
 s_add_u32 m0,s54,26624
 v_exp_f32 v152,v152
 v_exp_f32 v153,v153
 v_exp_f32 v154,v154
 v_smfmac_f32_32x32x32_bf16 v[96:111],a[24:27],v[144:151],v200
 s_add_u32 s49,s52,425984
 v_exp_f32 v155,v155
 v_exp_f32 v156,v156
 v_exp_f32 v157,v157
 v_smfmac_f32_16x16x64_bf16 v[188:191],a[160:163],v[144:151],v200
 buffer_load_dwordx4 a[4:7],v0,s[12:15],s53 offen offset:1024 sc1
 v_exp_f32 v158,v158
 v_exp_f32 v159,v159
 v_mfma_f32_32x32x16_bf16 v[208:223],a[16:19],a[152:155],0
 v_exp_f32 v160,v160
 v_exp_f32 v161,v161
 v_exp_f32 v162,v162
 v_smfmac_f32_32x32x32_bf16 v[96:111],a[28:31],v[152:159],v200
 v_exp_f32 v163,v163
 v_exp_f32 v164,v164
 v_exp_f32 v165,v165
 v_smfmac_f32_16x16x64_bf16 v[188:191],a[160:163],v[152:159],v200
 v_exp_f32 v166,v166
 v_exp_f32 v167,v167
 v_mfma_f32_32x32x16_bf16 v[208:223],a[20:23],a[156:159],v[208:223]
 v_exp_f32 v168,v168
 v_exp_f32 v169,v169
 v_exp_f32 v170,v170
 v_smfmac_f32_32x32x32_bf16 v[112:127],a[24:27],v[160:167],v200
 buffer_store_dwordx4 a[208:211],v0,s[12:15],s68 offen sc1
 v_exp_f32 v171,v171
 v_exp_f32 v172,v172
 v_exp_f32 v173,v173
 v_smfmac_f32_16x16x64_bf16 v[192:195],a[160:163],v[160:167],v200
 s_waitcnt vmcnt(42)
 buffer_load_dwordx4 a[8:11],v0,s[12:15],s53 offen offset:2048 sc1
 v_exp_f32 v174,v174
 v_exp_f32 v175,v175
 v_mfma_f32_32x32x16_bf16 v[144:159],a[32:35],a[128:131],0
 v_exp_f32 v208,v208
 v_exp_f32 v209,v209
 v_exp_f32 v210,v210
 v_smfmac_f32_32x32x32_bf16 v[112:127],a[28:31],v[168:175],v200
 s_branch .Lsk6
.Lvs1_2:
 s_branch .Lvb1
.Lsk6:
 v_exp_f32 v211,v211
 v_exp_f32 v212,v212
 v_exp_f32 v213,v213
 v_smfmac_f32_16x16x64_bf16 v[192:195],a[160:163],v[168:175],v200
 buffer_load_dwordx4 v250,s[20:23],s49 offen lds
 v_exp_f32 v214,v214
 v_exp_f32 v215,v215
 v_mfma_f32_32x32x16_bf16 v[144:159],a[36:39],a[132:135],v[144:159]
 s_add_u32 m0,s54,27648
 v_exp_f32 v216,v216
 v_exp_f32 v217,v217
 v_exp_f32 v218,v218
 v_smfmac_f32_32x32x32_bf16 v[128:143],a[24:27],v[208:215],v200
 s_add_u32 s49,s52,442368
 v_exp_f32 v219,v219
 v_exp_f32 v220,v220
 v_exp_f32 v221,v221
 v_smfmac_f32_16x16x64_bf16 v[196:199],a[160:163],v[208:215],v200
 buffer_load_dwordx4 a[12:15],v0,s[12:15],s53 offen offset:3072 sc1
 v_exp_f32 v222,v222
 v_exp_f32 v223,v223
 v_mfma_f32_32x32x16_bf16 v[160:175],a[32:35],a[136:139],0
 s_add_u32 s53,s53,4096
 v_exp_f32 v144,v144
 v_exp_f32 v145,v145
 v_exp_f32 v146,v146
 v_smfmac_f32_32x32x32_bf16 v[128:143],a[28:31],v[216:223],v200
 v_exp_f32 v147,v147
 v_exp_f32 v148,v148
 v_exp_f32 v149,v149
 v_smfmac_f32_16x16x64_bf16 v[196:199],a[160:163],v[216:223],v200
 buffer_load_dwordx4 v250,s[20:23],s49 offen lds
 v_exp_f32 v150,v150
 v_exp_f32 v151,v151
 v_mfma_f32_32x32x16_bf16 v[160:175],a[36:39],a[140:143],v[160:175]
 s_add_u32 m0,s54,28672
 v_exp_f32 v152,v152
 v_exp_f32 v153,v153
 v_exp_f32 v154,v154
 v_smfmac_f32_32x32x32_bf16 v[80:95],a[40:43],v[144:151],v200
 buffer_store_dwordx4 a[212:215],v0,s[12:15],s69 offen sc1
 v_exp_f32 v155,v155
 v_exp_f32 v156,v156
 v_exp_f32 v157,v157
 v_smfmac_f32_16x16x64_bf16 v[184:187],a[160:163],v[144:151],v200
 s_add_u32 s49,s52,458752
 buffer_load_dwordx4 a[16:19],v0,s[12:15],s53 offen sc1
 v_exp_f32 v158,v158
 v_exp_f32 v159,v159
 v_mfma_f32_32x32x16_bf16 v[208:223],a[32:35],a[144:147],0
 v_exp_f32 v160,v160
 v_exp_f32 v161,v161
 v_exp_f32 v162,v162
 v_smfmac_f32_32x32x32_bf16 v[80:95],a[44:47],v[152:159],v200
 v_exp_f32 v163,v163
 v_exp_f32 v164,v164
 v_exp_f32 v165,v165
 v_smfmac_f32_16x16x64_bf16 v[184:187],a[160:163],v[152:159],v200
 v_exp_f32 v166,v166
 v_exp_f32 v167,v167
 v_mfma_f32_32x32x16_bf16 v[208:223],a[36:39],a[148:151],v[208:223]
 v_exp_f32 v168,v168
 v_exp_f32 v169,v169
 v_exp_f32 v170,v170
 v_smfmac_f32_32x32x32_bf16 v[96:111],a[40:43],v[160:167],v200
 v_exp_f32 v171,v171
 v_exp_f32 v172,v172
 v_exp_f32 v173,v173
 v_smfmac_f32_16x16x64_bf16 v[188:191],a[160:163],v[160:167],v200
 buffer_load_dwordx4 a[20:23],v0,s[12:15],s53 offen offset:1024 sc1
 v_exp_f32 v174,v174
 v_exp_f32 v175,v175
 v_mfma_f32_32x32x16_bf16 v[144:159],a[32:35],a[152:155],0
 v_exp_f32 v208,v208
 v_exp_f32 v209,v209
 v_exp_f32 v210,v210
 v_smfmac_f32_32x32x32_bf16 v[96:111],a[44:47],v[168:175],v200
 v_exp_f32 v211,v211
 v_exp_f32 v212,v212
 v_exp_f32 v213,v213
 v_smfmac_f32_16x16x64_bf16 v[188:191],a[160:163],v[168:175],v200
 buffer_load_dwordx4 v250,s[20:23],s49 offen lds
 v_exp_f32 v214,v214
 v_exp_f32 v215,v215
 v_mfma_f32_32x32x16_bf16 v[144:159],a[36:39],a[156:159],v[144:159]
 s_add_u32 m0,s54,29696
 v_exp_f32 v216,v216
 v_exp_f32 v217,v217
 v_exp_f32 v218,v218
 v_smfmac_f32_32x32x32_bf16 v[112:127],a[40:43],v[208:215],v200
 s_add_u32 s49,s52,475136
 v_exp_f32 v219,v219
 v_exp_f32 v220,v220
 v_exp_f32 v221,v221
 v_smfmac_f32_16x16x64_bf16 v[192:195],a[160:163],v[208:215],v200
 s_waitcnt vmcnt(44)
 buffer_load_dwordx4 a[24:27],v0,s[12:15],s53 offen offset:2048 sc1
 v_exp_f32 v222,v222
 v_exp_f32 v223,v223
 v_mfma_f32_32x32x16_bf16 v[160:175],a[48:51],a[128:131],0
 v_exp_f32 v144,v144
 v_exp_f32 v145,v145
 v_exp_f32 v146,v146
 v_smfmac_f32_32x32x32_bf16 v[112:127],a[44:47],v[216:223],v200
 v_exp_f32 v147,v147
 v_exp_f32 v148,v148
 v_exp_f32 v149,v149
 v_smfmac_f32_16x16x64_bf16 v[192:195],a[160:163],v[216:223],v200
 buffer_load_dwordx4 v250,s[20:23],s49 offen lds
 v_exp_f32 v150,v150
 v_exp_f32 v151,v151
 v_mfma_f32_32x32x16_bf16 v[160:175],a[52:55],a[132:135],v[160:175]
 s_add_u32 m0,s54,30720
 v_exp_f32 v152,v152
 v_exp_f32 v153,v153
 v_exp_f32 v154,v154
 v_smfmac_f32_32x32x32_bf16 v[128:143],a[40:43],v[144:151],v200
 buffer_store_dwordx4 a[216:219],v0,s[12:15],s62 offen sc1
 v_exp_f32 v155,v155
 v_exp_f32 v156,v156
 v_exp_f32 v157,v157
 v_smfmac_f32_16x16x64_bf16 v[196:199],a[160:163],v[144:151],v200
 s_add_u32 s49,s52,491520
 buffer_load_dwordx4 a[28:31],v0,s[12:15],s53 offen offset:3072 sc1
 v_exp_f32 v158,v158
 v_exp_f32 v159,v159
 v_mfma_f32_32x32x16_bf16 v[208:223],a[48:51],a[136:139],0
 s_add_u32 s53,s53,4096
 v_exp_f32 v160,v160
 v_exp_f32 v161,v161
 v_exp_f32 v162,v162
 v_smfmac_f32_32x32x32_bf16 v[128:143],a[44:47],v[152:159],v200
 v_exp_f32 v163,v163
 v_exp_f32 v164,v164
 v_exp_f32 v165,v165
 v_smfmac_f32_16x16x64_bf16 v[196:199],a[160:163],v[152:159],v200
 v_exp_f32 v166,v166
 v_exp_f32 v167,v167
 v_mfma_f32_32x32x16_bf16 v[208:223],a[52:55],a[140:143],v[208:223]
 v_exp_f32 v168,v168
 v_exp_f32 v169,v169
 v_exp_f32 v170,v170
 v_smfmac_f32_32x32x32_bf16 v[80:95],a[56:59],v[160:167],v200
 v_exp_f32 v171,v171
 v_exp_f32 v172,v172
 v_exp_f32 v173,v173
 v_smfmac_f32_16x16x64_bf16 v[184:187],a[160:163],v[160:167],v200
 buffer_load_dwordx4 a[32:35],v0,s[12:15],s53 offen sc1
 v_exp_f32 v174,v174
 v_exp_f32 v175,v175
 v_mfma_f32_32x32x16_bf16 v[144:159],a[48:51],a[144:147],0
 v_exp_f32 v208,v208
 v_exp_f32 v209,v209
 v_exp_f32 v210,v210
 v_smfmac_f32_32x32x32_bf16 v[80:95],a[60:63],v[168:175],v200
 v_exp_f32 v211,v211
 v_exp_f32 v212,v212
 v_exp_f32 v213,v213
 v_smfmac_f32_16x16x64_bf16 v[184:187],a[160:163],v[168:175],v200
 buffer_load_dwordx4 v250,s[20:23],s49 offen lds
 v_exp_f32 v214,v214
 v_exp_f32 v215,v215
 v_mfma_f32_32x32x16_bf16 v[144:159],a[52:55],a[148:151],v[144:159]
 s_add_u32 m0,s54,0
 v_exp_f32 v216,v216
 v_exp_f32 v217,v217
 v_exp_f32 v218,v218
 v_smfmac_f32_32x32x32_bf16 v[96:111],a[56:59],v[208:215],v200
 buffer_store_dwordx4 a[220:223],v244,s[12:15],s63 offen sc1
 v_exp_f32 v219,v219
 v_exp_f32 v220,v220
 v_exp_f32 v221,v221
 v_smfmac_f32_16x16x64_bf16 v[188:191],a[160:163],v[208:215],v200
 s_add_u32 s49,s52,0
 buffer_load_dwordx4 a[36:39],v0,s[12:15],s53 offen offset:1024 sc1
 v_exp_f32 v222,v222
 v_exp_f32 v223,v223
 v_mfma_f32_32x32x16_bf16 v[160:175],a[48:51],a[152:155],0
 s_lshl_b32 s50,s47,17
 v_exp_f32 v144,v144
 v_exp_f32 v145,v145
 v_exp_f32 v146,v146
 v_smfmac_f32_32x32x32_bf16 v[96:111],a[60:63],v[216:223],v200
 s_lshl_b32 s3,s45,13
 s_add_u32 s50,s50,s3
 v_exp_f32 v147,v147
 v_exp_f32 v148,v148
 v_exp_f32 v149,v149
 v_smfmac_f32_16x16x64_bf16 v[188:191],a[160:163],v[216:223],v200
 s_add_u32 s50,s50,33554432
 v_exp_f32 v150,v150
 v_exp_f32 v151,v151
 v_mfma_f32_32x32x16_bf16 v[160:175],a[52:55],a[156:159],v[160:175]
 v_exp_f32 v152,v152
 v_exp_f32 v153,v153
 v_exp_f32 v154,v154
 v_smfmac_f32_32x32x32_bf16 v[112:127],a[56:59],v[144:151],v200
 v_exp_f32 v155,v155
 v_exp_f32 v156,v156
 v_exp_f32 v157,v157
 v_smfmac_f32_16x16x64_bf16 v[192:195],a[160:163],v[144:151],v200
 s_waitcnt vmcnt(46)
 buffer_load_dwordx4 a[40:43],v0,s[12:15],s53 offen offset:2048 sc1
 v_exp_f32 v158,v158
 v_exp_f32 v159,v159
 v_mfma_f32_32x32x16_bf16 v[208:223],a[64:67],a[128:131],0
 v_exp_f32 v160,v160
 v_exp_f32 v161,v161
 v_exp_f32 v162,v162
 v_smfmac_f32_32x32x32_bf16 v[112:127],a[60:63],v[152:159],v200
 v_exp_f32 v163,v163
 v_exp_f32 v164,v164
 v_exp_f32 v165,v165
 v_smfmac_f32_16x16x64_bf16 v[192:195],a[160:163],v[152:159],v200
 buffer_load_dwordx4 v250,s[20:23],s49 offen lds
 v_exp_f32 v166,v166
 v_exp_f32 v167,v167
 v_mfma_f32_32x32x16_bf16 v[208:223],a[68:71],a[132:135],v[208:223]
 s_add_u32 m0,s54,1024
 v_exp_f32 v168,v168
 v_exp_f32 v169,v169
 v_exp_f32 v170,v170
 v_smfmac_f32_32x32x32_bf16 v[128:143],a[56:59],v[160:167],v200
 s_add_u32 s49,s52,16384
 v_exp_f32 v171,v171
 v_exp_f32 v172,v172
 v_exp_f32 v173,v173
 v_smfmac_f32_16x16x64_bf16 v[196:199],a[160:163],v[160:167],v200
 buffer_load_dwordx4 a[44:47],v0,s[12:15],s53 offen offset:3072 sc1
 v_exp_f32 v174,v174
 v_exp_f32 v175,v175
 v_mfma_f32_32x32x16_bf16 v[144:159],a[64:67],a[136:139],0
 s_add_u32 s53,s53,4096
 v_exp_f32 v208,v208
 v_exp_f32 v209,v209
 v_exp_f32 v210,v210
 v_smfmac_f32_32x32x32_bf16 v[128:143],a[60:63],v[168:175],v200
 v_exp_f32 v211,v211
 v_exp_f32 v212,v212
 v_exp_f32 v213,v213
 v_smfmac_f32_16x16x64_bf16 v[196:199],a[160:163],v[168:175],v200
 buffer_load_dwordx4 v250,s[20:23],s49 offen lds
 v_exp_f32 v214,v214
 v_exp_f32 v215,v215
 v_mfma_f32_32x32x16_bf16 v[144:159],a[68:71],a[140:143],v[144:159]
 s_add_u32 m0,s54,2048
 v_exp_f32 v216,v216
 v_exp_f32 v217,v217
 v_exp_f32 v218,v218
 v_smfmac_f32_32x32x32_bf16 v[80:95],a[72:75],v[208:215],v200
 s_waitcnt lgkmcnt(7)
 buffer_store_dwordx4 a[224:227],v0,s[12:15],s50 offen sc1
 v_exp_f32 v219,v219
 v_exp_f32 v220,v220
 v_exp_f32 v221,v221
 v_smfmac_f32_16x16x64_bf16 v[184:187],a[160:163],v[208:215],v200
 s_add_u32 s49,s52,32768
 buffer_load_dwordx4 a[48:51],v0,s[12:15],s53 offen sc1
 v_exp_f32 v222,v222
 v_exp_f32 v223,v223
 v_mfma_f32_32x32x16_bf16 v[160:175],a[64:67],a[144:147],0
 v_exp_f32 v144,v144
 v_exp_f32 v145,v145
 v_exp_f32 v146,v146
 v_smfmac_f32_32x32x32_bf16 v[80:95],a[76:79],v[216:223],v200
 v_exp_f32 v147,v147
 v_exp_f32 v148,v148
 v_exp_f32 v149,v149
 v_smfmac_f32_16x16x64_bf16 v[184:187],a[160:163],v[216:223],v200
 v_exp_f32 v150,v150
 v_exp_f32 v151,v151
 v_mfma_f32_32x32x16_bf16 v[160:175],a[68:71],a[148:151],v[160:175]
 v_exp_f32 v152,v152
 v_exp_f32 v153,v153
 v_exp_f32 v154,v154
 v_smfmac_f32_32x32x32_bf16 v[96:111],a[72:75],v[144:151],v200
 v_exp_f32 v155,v155
 v_exp_f32 v156,v156
 v_exp_f32 v157,v157
 v_smfmac_f32_16x16x64_bf16 v[188:191],a[160:163],v[144:151],v200
 buffer_load_dwordx4 a[52:55],v0,s[12:15],s53 offen offset:1024 sc1
 v_exp_f32 v158,v158
 v_exp_f32 v159,v159
 v_mfma_f32_32x32x16_bf16 v[208:223],a[64:67],a[152:155],0
 v_exp_f32 v160,v160
 v_exp_f32 v161,v161
 v_exp_f32 v162,v162
 v_smfmac_f32_32x32x32_bf16 v[96:111],a[76:79],v[152:159],v200
 v_exp_f32 v163,v163
 v_exp_f32 v164,v164
 v_exp_f32 v165,v165
 v_smfmac_f32_16x16x64_bf16 v[188:191],a[160:163],v[152:159],v200
 buffer_load_dwordx4 v250,s[20:23],s49 offen lds
 v_exp_f32 v166,v166
 v_exp_f32 v167,v167
 v_mfma_f32_32x32x16_bf16 v[208:223],a[68:71],a[156:159],v[208:223]
 s_add_u32 m0,s54,3072
 v_exp_f32 v168,v168
 v_exp_f32 v169,v169
 v_exp_f32 v170,v170
 v_smfmac_f32_32x32x32_bf16 v[112:127],a[72:75],v[160:167],v200
 s_waitcnt lgkmcnt(6)
 buffer_store_dwordx4 a[228:231],v0,s[12:15],s50 offen offset:1024 sc1
 v_exp_f32 v171,v171
 v_exp_f32 v172,v172
 v_exp_f32 v173,v173
 v_smfmac_f32_16x16x64_bf16 v[192:195],a[160:163],v[160:167],v200
 s_add_u32 s49,s52,49152
 buffer_load_dwordx4 a[56:59],v0,s[12:15],s53 offen offset:2048 sc1
 v_exp_f32 v174,v174
 v_exp_f32 v175,v175
 s_waitcnt vmcnt(49)
 v_mfma_f32_32x32x16_bf16 v[144:159],a[80:83],a[128:131],0
 v_exp_f32 v208,v208
 v_exp_f32 v209,v209
 v_exp_f32 v210,v210
 v_smfmac_f32_32x32x32_bf16 v[112:127],a[76:79],v[168:175],v200
 v_exp_f32 v211,v211
 v_exp_f32 v212,v212
 v_exp_f32 v213,v213
 v_smfmac_f32_16x16x64_bf16 v[192:195],a[160:163],v[168:175],v200
 buffer_load_dwordx4 v250,s[20:23],s49 offen lds
 v_exp_f32 v214,v214
 v_exp_f32 v215,v215
 v_mfma_f32_32x32x16_bf16 v[144:159],a[84:87],a[132:135],v[144:159]
 s_add_u32 m0,s54,4096
 v_exp_f32 v216,v216
 v_exp_f32 v217,v217
 v_exp_f32 v218,v218
 v_smfmac_f32_32x32x32_bf16 v[128:143],a[72:75],v[208:215],v200
 s_add_u32 s49,s52,65536
 v_exp_f32 v219,v219
 v_exp_f32 v220,v220
 v_exp_f32 v221,v221
 v_smfmac_f32_16x16x64_bf16 v[196:199],a[160:163],v[208:215],v200
 buffer_load_dwordx4 a[60:63],v0,s[12:15],s53 offen offset:3072 sc1
 v_exp_f32 v222,v222
 v_exp_f32 v223,v223
 v_mfma_f32_32x32x16_bf16 v[160:175],a[80:83],a[136:139],0
 s_add_u32 s53,s53,4096
 v_exp_f32 v144,v144
 v_exp_f32 v145,v145
 v_exp_f32 v146,v146
 v_smfmac_f32_32x32x32_bf16 v[128:143],a[76:79],v[216:223],v200
 v_exp_f32 v147,v147
 v_exp_f32 v148,v148
 v_exp_f32 v149,v149
 v_smfmac_f32_16x16x64_bf16 v[196:199],a[160:163],v[216:223],v200
 v_exp_f32 v150,v150
 v_exp_f32 v151,v151
 v_mfma_f32_32x32x16_bf16 v[160:175],a[84:87],a[140:143],v[160:175]
 v_exp_f32 v152,v152
 v_exp_f32 v153,v153
 v_exp_f32 v154,v154
 v_smfmac_f32_32x32x32_bf16 v[80:95],a[88:91],v[144:151],v200
 v_exp_f32 v155,v155
 v_exp_f32 v156,v156
 v_exp_f32 v157,v157
 v_smfmac_f32_16x16x64_bf16 v[184:187],a[160:163],v[144:151],v200
 buffer_load_dwordx4 a[64:67],v0,s[12:15],s53 offen sc1
 v_exp_f32 v158,v158
 v_exp_f32 v159,v159
 v_mfma_f32_32x32x16_bf16 v[208:223],a[80:83],a[144:147],0
 v_exp_f32 v160,v160
 v_exp_f32 v161,v161
 v_exp_f32 v162,v162
 v_smfmac_f32_32x32x32_bf16 v[80:95],a[92:95],v[152:159],v200
 v_exp_f32 v163,v163
 v_exp_f32 v164,v164
 v_exp_f32 v165,v165
 v_smfmac_f32_16x16x64_bf16 v[184:187],a[160:163],v[152:159],v200
 buffer_load_dwordx4 v250,s[20:23],s49 offen lds
 v_exp_f32 v166,v166
 v_exp_f32 v167,v167
 v_mfma_f32_32x32x16_bf16 v[208:223],a[84:87],a[148:151],v[208:223]
 s_add_u32 m0,s54,5120
 v_exp_f32 v168,v168
 v_exp_f32 v169,v169
 v_exp_f32 v170,v170
 v_smfmac_f32_32x32x32_bf16 v[96:111],a[88:91],v[160:167],v200
 s_waitcnt lgkmcnt(5)
 buffer_store_dwordx4 a[232:235],v0,s[12:15],s50 offen offset:2048 sc1
 v_exp_f32 v171,v171
 v_exp_f32 v172,v172
 v_exp_f32 v173,v173
 v_smfmac_f32_16x16x64_bf16 v[188:191],a[160:163],v[160:167],v200
 s_add_u32 s49,s52,81920
 buffer_load_dwordx4 a[68:71],v0,s[12:15],s53 offen offset:1024 sc1
 v_exp_f32 v174,v174
 v_exp_f32 v175,v175
 v_mfma_f32_32x32x16_bf16 v[144:159],a[80:83],a[152:155],0
 v_exp_f32 v208,v208
 v_exp_f32 v209,v209
 v_exp_f32 v210,v210
 v_smfmac_f32_32x32x32_bf16 v[96:111],a[92:95],v[168:175],v200
 v_exp_f32 v211,v211
 v_exp_f32 v212,v212
 v_exp_f32 v213,v213
 v_smfmac_f32_16x16x64_bf16 v[188:191],a[160:163],v[168:175],v200
 buffer_load_dwordx4 v250,s[20:23],s49 offen lds
 v_exp_f32 v214,v214
 v_exp_f32 v215,v215
 v_mfma_f32_32x32x16_bf16 v[144:159],a[84:87],a[156:159],v[144:159]
 s_add_u32 m0,s54,6144
 v_exp_f32 v216,v216
 v_exp_f32 v217,v217
 v_exp_f32 v218,v218
 v_smfmac_f32_32x32x32_bf16 v[112:127],a[88:91],v[208:215],v200
 s_add_u32 s49,s52,98304
 v_exp_f32 v219,v219
 v_exp_f32 v220,v220
 v_exp_f32 v221,v221
 v_smfmac_f32_16x16x64_bf16 v[192:195],a[160:163],v[208:215],v200
 s_waitcnt vmcnt(46)
 buffer_load_dwordx4 a[72:75],v0,s[12:15],s53 offen offset:2048 sc1
 v_exp_f32 v222,v222
 v_exp_f32 v223,v223
 v_mfma_f32_32x32x16_bf16 v[160:175],a[96:99],a[128:131],0
 v_exp_f32 v144,v144
 v_exp_f32 v145,v145
 v_exp_f32 v146,v146
 v_smfmac_f32_32x32x32_bf16 v[112:127],a[92:95],v[216:223],v200
 v_exp_f32 v147,v147
 v_exp_f32 v148,v148
 v_exp_f32 v149,v149
 v_smfmac_f32_16x16x64_bf16 v[192:195],a[160:163],v[216:223],v200
 v_exp_f32 v150,v150
 v_exp_f32 v151,v151
 v_mfma_f32_32x32x16_bf16 v[160:175],a[100:103],a[132:135],v[160:175]
 v_exp_f32 v152,v152
 v_exp_f32 v153,v153
 v_exp_f32 v154,v154
 v_smfmac_f32_32x32x32_bf16 v[128:143],a[88:91],v[144:151],v200
 s_waitcnt lgkmcnt(4)
 buffer_store_dwordx4 a[236:239],v0,s[12:15],s50 offen offset:3072 sc1
 v_exp_f32 v155,v155
 v_exp_f32 v156,v156
 v_exp_f32 v157,v157
 v_smfmac_f32_16x16x64_bf16 v[196:199],a[160:163],v[144:151],v200
 buffer_load_dwordx4 a[76:79],v0,s[12:15],s53 offen offset:3072 sc1
 v_exp_f32 v158,v158
 v_exp_f32 v159,v159
 v_mfma_f32_32x32x16_bf16 v[208:223],a[96:99],a[136:139],0
 s_add_u32 s53,s53,4096
 v_exp_f32 v160,v160
 v_exp_f32 v161,v161
 v_exp_f32 v162,v162
 v_smfmac_f32_32x32x32_bf16 v[128:143],a[92:95],v[152:159],v200
 s_add_u32 s50,s50,4096
 v_exp_f32 v163,v163
 v_exp_f32 v164,v164
 v_exp_f32 v165,v165
 v_smfmac_f32_16x16x64_bf16 v[196:199],a[160:163],v[152:159],v200
 buffer_load_dwordx4 v250,s[20:23],s49 offen lds
 v_exp_f32 v166,v166
 v_exp_f32 v167,v167
 v_mfma_f32_32x32x16_bf16 v[208:223],a[100:103],a[140:143],v[208:223]
 s_add_u32 m0,s54,7168
 v_exp_f32 v168,v168
 v_exp_f32 v169,v169
 v_exp_f32 v170,v170
 v_smfmac_f32_32x32x32_bf16 v[80:95],a[104:107],v[160:167],v200
 s_add_u32 s49,s52,114688
 v_exp_f32 v171,v171
 v_exp_f32 v172,v172
 v_exp_f32 v173,v173
 v_smfmac_f32_16x16x64_bf16 v[184:187],a[160:163],v[160:167],v200
 buffer_load_dwordx4 a[80:83],v0,s[12:15],s53 offen sc1
 v_exp_f32 v174,v174
 v_exp_f32 v175,v175
 v_mfma_f32_32x32x16_bf16 v[144:159],a[96:99],a[144:147],0
 v_exp_f32 v208,v208
 v_exp_f32 v209,v209
 v_exp_f32 v210,v210
 v_smfmac_f32_32x32x32_bf16 v[80:95],a[108:111],v[168:175],v200
 v_exp_f32 v211,v211
 v_exp_f32 v212,v212
 v_exp_f32 v213,v213
 v_smfmac_f32_16x16x64_bf16 v[184:187],a[160:163],v[168:175],v200
 buffer_load_dwordx4 v250,s[20:23],s49 offen lds
 v_exp_f32 v214,v214
 v_exp_f32 v215,v215
 v_mfma_f32_32x32x16_bf16 v[144:159],a[100:103],a[148:151],v[144:159]
 s_add_u32 m0,s54,8192
 v_exp_f32 v216,v216
 v_exp_f32 v217,v217
 v_exp_f32 v218,v218
 v_smfmac_f32_32x32x32_bf16 v[96:111],a[104:107],v[208:215],v200
 s_add_u32 s49,s52,131072
 v_exp_f32 v219,v219
 v_exp_f32 v220,v220
 v_exp_f32 v221,v221
 v_smfmac_f32_16x16x64_bf16 v[188:191],a[160:163],v[208:215],v200
 buffer_load_dwordx4 a[84:87],v0,s[12:15],s53 offen offset:1024 sc1
 v_exp_f32 v222,v222
 v_exp_f32 v223,v223
 v_mfma_f32_32x32x16_bf16 v[160:175],a[96:99],a[152:155],0
 v_exp_f32 v144,v144
 v_exp_f32 v145,v145
 v_exp_f32 v146,v146
 v_smfmac_f32_32x32x32_bf16 v[96:111],a[108:111],v[216:223],v200
 v_exp_f32 v147,v147
 v_exp_f32 v148,v148
 v_exp_f32 v149,v149
 v_smfmac_f32_16x16x64_bf16 v[188:191],a[160:163],v[216:223],v200
 v_exp_f32 v150,v150
 v_exp_f32 v151,v151
 v_mfma_f32_32x32x16_bf16 v[160:175],a[100:103],a[156:159],v[160:175]
 v_exp_f32 v152,v152
 v_exp_f32 v153,v153
 v_exp_f32 v154,v154
 v_smfmac_f32_32x32x32_bf16 v[112:127],a[104:107],v[144:151],v200
 s_waitcnt lgkmcnt(3)
 buffer_store_dwordx4 a[240:243],v0,s[12:15],s50 offen sc1
 v_exp_f32 v155,v155
 v_exp_f32 v156,v156
 v_exp_f32 v157,v157
 v_smfmac_f32_16x16x64_bf16 v[192:195],a[160:163],v[144:151],v200
 s_waitcnt vmcnt(46)
 buffer_load_dwordx4 a[88:91],v0,s[12:15],s53 offen offset:2048 sc1
 v_exp_f32 v158,v158
 v_exp_f32 v159,v159
 v_mfma_f32_32x32x16_bf16 v[208:223],a[112:115],a[128:131],0
 v_exp_f32 v160,v160
 v_exp_f32 v161,v161
 v_exp_f32 v162,v162
 v_smfmac_f32_32x32x32_bf16 v[112:127],a[108:111],v[152:159],v200
 v_exp_f32 v163,v163
 v_exp_f32 v164,v164
 v_exp_f32 v165,v165
 v_smfmac_f32_16x16x64_bf16 v[192:195],a[160:163],v[152:159],v200
 s_waitcnt lgkmcnt(0)
 buffer_load_dwordx4 v250,s[20:23],s49 offen lds
 v_exp_f32 v166,v166
 v_exp_f32 v167,v167
 v_mfma_f32_32x32x16_bf16 v[208:223],a[116:119],a[132:135],v[208:223]
 s_add_u32 m0,s54,9216
 v_exp_f32 v168,v168
 v_exp_f32 v169,v169
 v_exp_f32 v170,v170
 v_smfmac_f32_32x32x32_bf16 v[128:143],a[104:107],v[160:167],v200
 s_add_u32 s49,s52,147456
 v_exp_f32 v171,v171
 v_exp_f32 v172,v172
 v_exp_f32 v173,v173
 v_smfmac_f32_16x16x64_bf16 v[196:199],a[160:163],v[160:167],v200
 buffer_load_dwordx4 a[92:95],v0,s[12:15],s53 offen offset:3072 sc1
 v_exp_f32 v174,v174
 v_exp_f32 v175,v175
 v_mfma_f32_32x32x16_bf16 v[144:159],a[112:115],a[136:139],0
 s_add_u32 s53,s53,4096
 v_exp_f32 v208,v208
 v_exp_f32 v209,v209
 v_exp_f32 v210,v210
 v_smfmac_f32_32x32x32_bf16 v[128:143],a[108:111],v[168:175],v200
 v_exp_f32 v211,v211
 v_exp_f32 v212,v212
 v_exp_f32 v213,v213
 v_smfmac_f32_16x16x64_bf16 v[196:199],a[160:163],v[168:175],v200
 buffer_load_dwordx4 v250,s[20:23],s49 offen lds
 v_exp_f32 v214,v214
 v_exp_f32 v215,v215
 v_mfma_f32_32x32x16_bf16 v[144:159],a[116:119],a[140:143],v[144:159]
 s_add_u32 m0,s54,10240
 v_exp_f32 v216,v216
 v_exp_f32 v217,v217
 v_exp_f32 v218,v218
 v_smfmac_f32_32x32x32_bf16 v[80:95],a[120:123],v[208:215],v200
 buffer_store_dwordx4 a[244:247],v0,s[12:15],s50 offen offset:1024 sc1
 v_exp_f32 v219,v219
 v_exp_f32 v220,v220
 v_exp_f32 v221,v221
 v_smfmac_f32_16x16x64_bf16 v[184:187],a[160:163],v[208:215],v200
 s_add_u32 s49,s52,163840
 buffer_load_dwordx4 a[96:99],v0,s[12:15],s53 offen sc1
 v_exp_f32 v222,v222
 v_exp_f32 v223,v223
 v_mfma_f32_32x32x16_bf16 v[160:175],a[112:115],a[144:147],0
 v_exp_f32 v144,v144
 v_exp_f32 v145,v145
 v_exp_f32 v146,v146
 v_smfmac_f32_32x32x32_bf16 v[80:95],a[124:127],v[216:223],v200
 v_exp_f32 v147,v147
 v_exp_f32 v148,v148
 v_exp_f32 v149,v149
 v_smfmac_f32_16x16x64_bf16 v[184:187],a[160:163],v[216:223],v200
 v_exp_f32 v150,v150
 v_exp_f32 v151,v151
 v_mfma_f32_32x32x16_bf16 v[160:175],a[116:119],a[148:151],v[160:175]
 v_exp_f32 v152,v152
 v_exp_f32 v153,v153
 v_exp_f32 v154,v154
 v_smfmac_f32_32x32x32_bf16 v[96:111],a[120:123],v[144:151],v200
 v_exp_f32 v155,v155
 v_exp_f32 v156,v156
 v_exp_f32 v157,v157
 v_smfmac_f32_16x16x64_bf16 v[188:191],a[160:163],v[144:151],v200
 buffer_load_dwordx4 a[100:103],v0,s[12:15],s53 offen offset:1024 sc1
 v_exp_f32 v158,v158
 v_exp_f32 v159,v159
 v_mfma_f32_32x32x16_bf16 v[208:223],a[112:115],a[152:155],0
 v_exp_f32 v160,v160
 v_exp_f32 v161,v161
 v_exp_f32 v162,v162
 v_smfmac_f32_32x32x32_bf16 v[96:111],a[124:127],v[152:159],v200
 v_exp_f32 v163,v163
 v_exp_f32 v164,v164
 v_exp_f32 v165,v165
 v_smfmac_f32_16x16x64_bf16 v[188:191],a[160:163],v[152:159],v200
 buffer_load_dwordx4 v250,s[20:23],s49 offen lds
 v_exp_f32 v166,v166
 v_exp_f32 v167,v167
 v_mfma_f32_32x32x16_bf16 v[208:223],a[116:119],a[156:159],v[208:223]
 s_add_u32 m0,s54,11264
 v_exp_f32 v168,v168
 v_exp_f32 v169,v169
 v_exp_f32 v170,v170
 v_smfmac_f32_32x32x32_bf16 v[112:127],a[120:123],v[160:167],v200
 s_add_u32 s49,s52,180224
 v_exp_f32 v171,v171
 v_exp_f32 v172,v172
 v_exp_f32 v173,v173
 v_smfmac_f32_16x16x64_bf16 v[192:195],a[160:163],v[160:167],v200
 s_waitcnt vmcnt(46)
 buffer_load_dwordx4 a[104:107],v0,s[12:15],s53 offen offset:2048 sc1
 v_exp_f32 v174,v174
 v_exp_f32 v175,v175
 v_mfma_f32_32x32x16_bf16 v[144:159],a[0:3],a[128:131],0
 v_exp_f32 v208,v208
 v_exp_f32 v209,v209
 v_exp_f32 v210,v210
 v_smfmac_f32_32x32x32_bf16 v[112:127],a[124:127],v[168:175],v200
 v_exp_f32 v211,v211
 v_exp_f32 v212,v212
 v_exp_f32 v213,v213
 v_smfmac_f32_16x16x64_bf16 v[192:195],a[160:163],v[168:175],v200
 buffer_load_dwordx4 v250,s[20:23],s49 offen lds
 v_exp_f32 v214,v214
 v_exp_f32 v215,v215
 v_mfma_f32_32x32x16_bf16 v[144:159],a[4:7],a[132:135],v[144:159]
 s_add_u32 m0,s54,12288
 v_exp_f32 v216,v216
 v_exp_f32 v217,v217
 v_exp_f32 v218,v218
 v_smfmac_f32_32x32x32_bf16 v[128:143],a[120:123],v[208:215],v200
 buffer_store_dwordx4 a[248:251],v0,s[12:15],s50 offen offset:2048 sc1
 v_exp_f32 v219,v219
 v_exp_f32 v220,v220
 v_exp_f32 v221,v221
 v_smfmac_f32_16x16x64_bf16 v[196:199],a[160:163],v[208:215],v200
 s_add_u32 s49,s52,196608
 buffer_load_dwordx4 a[108:111],v0,s[12:15],s53 offen offset:3072 sc1
 v_exp_f32 v222,v222
 v_exp_f32 v223,v223
 v_mfma_f32_32x32x16_bf16 v[160:175],a[0:3],a[136:139],0
 s_add_u32 s53,s53,4096
 v_exp_f32 v144,v144
 v_exp_f32 v145,v145
 v_exp_f32 v146,v146
 v_smfmac_f32_32x32x32_bf16 v[128:143],a[124:127],v[216:223],v200
 v_exp_f32 v147,v147
 v_exp_f32 v148,v148
 v_exp_f32 v149,v149
 v_smfmac_f32_16x16x64_bf16 v[196:199],a[160:163],v[216:223],v200
 v_exp_f32 v150,v150
 v_exp_f32 v151,v151
 v_mfma_f32_32x32x16_bf16 v[160:175],a[4:7],a[140:143],v[160:175]
 v_exp_f32 v152,v152
 v_exp_f32 v153,v153
 v_exp_f32 v154,v154
 v_smfmac_f32_32x32x32_bf16 v[80:95],a[8:11],v[144:151],v200
 v_exp_f32 v155,v155
 v_exp_f32 v156,v156
 v_exp_f32 v157,v157
 v_smfmac_f32_16x16x64_bf16 v[184:187],a[160:163],v[144:151],v200
 buffer_load_dwordx4 a[112:115],v0,s[12:15],s53 offen sc1
 v_exp_f32 v158,v158
 v_exp_f32 v159,v159
 v_mfma_f32_32x32x16_bf16 v[208:223],a[0:3],a[144:147],0
 v_exp_f32 v160,v160
 v_exp_f32 v161,v161
 v_exp_f32 v162,v162
 v_smfmac_f32_32x32x32_bf16 v[80:95],a[12:15],v[152:159],v200
 v_exp_f32 v163,v163
 v_exp_f32 v164,v164
 v_exp_f32 v165,v165
 v_smfmac_f32_16x16x64_bf16 v[184:187],a[160:163],v[152:159],v200
 buffer_load_dwordx4 v250,s[20:23],s49 offen lds
 v_exp_f32 v166,v166
 v_exp_f32 v167,v167
 v_mfma_f32_32x32x16_bf16 v[208:223],a[4:7],a[148:151],v[208:223]
 s_add_u32 m0,s54,13312
 v_exp_f32 v168,v168
 v_exp_f32 v169,v169
 v_exp_f32 v170,v170
 v_smfmac_f32_32x32x32_bf16 v[96:111],a[8:11],v[160:167],v200
 buffer_store_dwordx4 a[252:255],v0,s[12:15],s50 offen offset:3072 sc1
 v_exp_f32 v171,v171
 v_exp_f32 v172,v172
 v_exp_f32 v173,v173
 v_smfmac_f32_16x16x64_bf16 v[188:191],a[160:163],v[160:167],v200
 s_add_u32 s49,s52,212992
 buffer_load_dwordx4 a[116:119],v0,s[12:15],s53 offen offset:1024 sc1
 v_exp_f32 v174,v174
 v_exp_f32 v175,v175
 v_mfma_f32_32x32x16_bf16 v[144:159],a[0:3],a[152:155],0
 v_exp_f32 v208,v208
 v_exp_f32 v209,v209
 v_exp_f32 v210,v210
 v_smfmac_f32_32x32x32_bf16 v[96:111],a[12:15],v[168:175],v200
 v_exp_f32 v211,v211
 v_exp_f32 v212,v212
 v_exp_f32 v213,v213
 v_smfmac_f32_16x16x64_bf16 v[188:191],a[160:163],v[168:175],v200
 buffer_load_dwordx4 v250,s[20:23],s49 offen lds
 v_exp_f32 v214,v214
 v_exp_f32 v215,v215
 v_mfma_f32_32x32x16_bf16 v[144:159],a[4:7],a[156:159],v[144:159]
 s_add_u32 m0,s54,14336
 v_exp_f32 v216,v216
 v_exp_f32 v217,v217
 v_exp_f32 v218,v218
 v_smfmac_f32_32x32x32_bf16 v[112:127],a[8:11],v[208:215],v200
 s_add_u32 s49,s52,229376
 v_exp_f32 v219,v219
 v_exp_f32 v220,v220
 v_exp_f32 v221,v221
 v_smfmac_f32_16x16x64_bf16 v[192:195],a[160:163],v[208:215],v200
 s_waitcnt vmcnt(46)
 buffer_load_dwordx4 a[120:123],v0,s[12:15],s53 offen offset:2048 sc1
 v_exp_f32 v222,v222
 v_exp_f32 v223,v223
 v_mfma_f32_32x32x16_bf16 v[160:175],a[16:19],a[128:131],0
 v_exp_f32 v144,v144
 v_exp_f32 v145,v145
 v_exp_f32 v146,v146
 v_smfmac_f32_32x32x32_bf16 v[112:127],a[12:15],v[216:223],v200
 v_exp_f32 v147,v147
 v_exp_f32 v148,v148
 v_exp_f32 v149,v149
 v_smfmac_f32_16x16x64_bf16 v[192:195],a[160:163],v[216:223],v200
 v_exp_f32 v150,v150
 v_exp_f32 v151,v151
 v_mfma_f32_32x32x16_bf16 v[160:175],a[20:23],a[132:135],v[160:175]
 v_exp_f32 v152,v152
 v_exp_f32 v153,v153
 v_exp_f32 v154,v154
 v_smfmac_f32_32x32x32_bf16 v[128:143],a[8:11],v[144:151],v200
 s_branch .Lsk7
.Lvs1_3:
 s_branch .Lvb1
.Lsk7:
 v_exp_f32 v155,v155
 v_exp_f32 v156,v156
 v_exp_f32 v157,v157
 v_smfmac_f32_16x16x64_bf16 v[196:199],a[160:163],v[144:151],v200
 buffer_load_dwordx4 a[124:127],v0,s[12:15],s53 offen offset:3072 sc1
 v_exp_f32 v158,v158
 v_exp_f32 v159,v159
 v_mfma_f32_32x32x16_bf16 v[208:223],a[16:19],a[136:139],0
 s_add_u32 s53,s53,4096
 v_exp_f32 v160,v160
 v_exp_f32 v161,v161
 v_exp_f32 v162,v162
 v_smfmac_f32_32x32x32_bf16 v[128:143],a[12:15],v[152:159],v200
 v_exp_f32 v163,v163
 v_exp_f32 v164,v164
 v_exp_f32 v165,v165
 v_smfmac_f32_16x16x64_bf16 v[196:199],a[160:163],v[152:159],v200
 buffer_load_dwordx4 v250,s[20:23],s49 offen lds
 v_exp_f32 v166,v166
 v_exp_f32 v167,v167
 v_mfma_f32_32x32x16_bf16 v[208:223],a[20:23],a[140:143],v[208:223]
 s_add_u32 m0,s54,15360
 v_exp_f32 v168,v168
 v_exp_f32 v169,v169
 v_exp_f32 v170,v170
 v_smfmac_f32_32x32x32_bf16 v[80:95],a[24:27],v[160:167],v200
 buffer_store_dwordx4 a[176:179],v0,s[12:15],s70 offen sc1
 v_exp_f32 v171,v171
 v_exp_f32 v172,v172
 v_exp_f32 v173,v173
 v_smfmac_f32_16x16x64_bf16 v[184:187],a[160:163],v[160:167],v200
 s_add_u32 s49,s52,245760
 v_exp_f32 v174,v174
 v_exp_f32 v175,v175
 v_mfma_f32_32x32x16_bf16 v[144:159],a[16:19],a[144:147],0
 v_exp_f32 v208,v208
 v_exp_f32 v209,v209
 v_exp_f32 v210,v210
 v_smfmac_f32_32x32x32_bf16 v[80:95],a[28:31],v[168:175],v200
 v_exp_f32 v211,v211
 v_exp_f32 v212,v212
 v_exp_f32 v213,v213
 v_smfmac_f32_16x16x64_bf16 v[184:187],a[160:163],v[168:175],v200
 buffer_load_dwordx4 v250,s[20:23],s49 offen lds
 v_exp_f32 v214,v214
 v_exp_f32 v215,v215
 v_mfma_f32_32x32x16_bf16 v[144:159],a[20:23],a[148:151],v[144:159]
 v_exp_f32 v216,v216
 v_exp_f32 v217,v217
 v_exp_f32 v218,v218
 v_smfmac_f32_32x32x32_bf16 v[96:111],a[24:27],v[208:215],v200
 buffer_store_dwordx4 a[180:183],v0,s[12:15],s70 offen offset:1024 sc1
 v_exp_f32 v219,v219
 v_exp_f32 v220,v220
 v_exp_f32 v221,v221
 v_smfmac_f32_16x16x64_bf16 v[188:191],a[160:163],v[208:215],v200
 v_exp_f32 v222,v222
 v_exp_f32 v223,v223
 v_mfma_f32_32x32x16_bf16 v[160:175],a[16:19],a[152:155],0
 v_exp_f32 v144,v144
 v_exp_f32 v145,v145
 v_exp_f32 v146,v146
 v_smfmac_f32_32x32x32_bf16 v[96:111],a[28:31],v[216:223],v200
 v_exp_f32 v147,v147
 v_exp_f32 v148,v148
 v_exp_f32 v149,v149
 v_smfmac_f32_16x16x64_bf16 v[188:191],a[160:163],v[216:223],v200
 v_exp_f32 v150,v150
 v_exp_f32 v151,v151
 v_mfma_f32_32x32x16_bf16 v[160:175],a[20:23],a[156:159],v[160:175]
 v_exp_f32 v152,v152
 v_exp_f32 v153,v153
 v_exp_f32 v154,v154
 v_smfmac_f32_32x32x32_bf16 v[112:127],a[24:27],v[144:151],v200
 buffer_store_dwordx4 a[184:187],v0,s[12:15],s70 offen offset:2048 sc1
 v_exp_f32 v155,v155
 v_exp_f32 v156,v156
 v_exp_f32 v157,v157
 v_smfmac_f32_16x16x64_bf16 v[192:195],a[160:163],v[144:151],v200
 s_waitcnt vmcnt(46)
 v_exp_f32 v158,v158
 v_exp_f32 v159,v159
 v_mfma_f32_32x32x16_bf16 v[208:223],a[32:35],a[128:131],0
 v_exp_f32 v160,v160
 v_exp_f32 v161,v161
 v_exp_f32 v162,v162
 v_smfmac_f32_32x32x32_bf16 v[112:127],a[28:31],v[152:159],v200
 v_exp_f32 v163,v163
 v_exp_f32 v164,v164
 v_exp_f32 v165,v165
 v_smfmac_f32_16x16x64_bf16 v[192:195],a[160:163],v[152:159],v200
 v_exp_f32 v166,v166
 v_exp_f32 v167,v167
 v_mfma_f32_32x32x16_bf16 v[208:223],a[36:39],a[132:135],v[208:223]
 v_exp_f32 v168,v168
 v_exp_f32 v169,v169
 v_exp_f32 v170,v170
 v_smfmac_f32_32x32x32_bf16 v[128:143],a[24:27],v[160:167],v200
 buffer_store_dwordx4 a[188:191],v0,s[12:15],s70 offen offset:3072 sc1
 v_exp_f32 v171,v171
 v_exp_f32 v172,v172
 v_exp_f32 v173,v173
 v_smfmac_f32_16x16x64_bf16 v[196:199],a[160:163],v[160:167],v200
 v_exp_f32 v174,v174
 v_exp_f32 v175,v175
 v_mfma_f32_32x32x16_bf16 v[144:159],a[32:35],a[136:139],0
 v_exp_f32 v208,v208
 v_exp_f32 v209,v209
 v_exp_f32 v210,v210
 v_smfmac_f32_32x32x32_bf16 v[128:143],a[28:31],v[168:175],v200
 v_exp_f32 v211,v211
 v_exp_f32 v212,v212
 v_exp_f32 v213,v213
 v_smfmac_f32_16x16x64_bf16 v[196:199],a[160:163],v[168:175],v200
 v_exp_f32 v214,v214
 v_exp_f32 v215,v215
 v_mfma_f32_32x32x16_bf16 v[144:159],a[36:39],a[140:143],v[144:159]
 v_exp_f32 v216,v216
 v_exp_f32 v217,v217
 v_exp_f32 v218,v218
 v_smfmac_f32_32x32x32_bf16 v[80:95],a[40:43],v[208:215],v200
 v_exp_f32 v219,v219
 v_exp_f32 v220,v220
 v_exp_f32 v221,v221
 v_smfmac_f32_16x16x64_bf16 v[184:187],a[160:163],v[208:215],v200
 v_exp_f32 v222,v222
 v_exp_f32 v223,v223
 v_mfma_f32_32x32x16_bf16 v[160:175],a[32:35],a[144:147],0
 s_nop 0
 v_exp_f32 v144,v144
 v_exp_f32 v145,v145
 v_exp_f32 v146,v146
 v_smfmac_f32_32x32x32_bf16 v[80:95],a[44:47],v[216:223],v200
 v_exp_f32 v147,v147
 v_exp_f32 v148,v148
 v_exp_f32 v149,v149
 v_smfmac_f32_16x16x64_bf16 v[184:187],a[160:163],v[216:223],v200
 v_exp_f32 v150,v150
 v_exp_f32 v151,v151
 v_mfma_f32_32x32x16_bf16 v[160:175],a[36:39],a[148:151],v[160:175]
 v_exp_f32 v152,v152
 v_exp_f32 v153,v153
 v_exp_f32 v154,v154
 v_smfmac_f32_32x32x32_bf16 v[96:111],a[40:43],v[144:151],v200
 v_exp_f32 v155,v155
 v_exp_f32 v156,v156
 v_exp_f32 v157,v157
 v_smfmac_f32_16x16x64_bf16 v[188:191],a[160:163],v[144:151],v200
 v_exp_f32 v158,v158
 v_exp_f32 v159,v159
 v_mfma_f32_32x32x16_bf16 v[208:223],a[32:35],a[152:155],0
 s_nop 0
 v_exp_f32 v160,v160
 v_exp_f32 v161,v161
 v_exp_f32 v162,v162
 v_smfmac_f32_32x32x32_bf16 v[96:111],a[44:47],v[152:159],v200
 v_exp_f32 v163,v163
 v_exp_f32 v164,v164
 v_exp_f32 v165,v165
 v_smfmac_f32_16x16x64_bf16 v[188:191],a[160:163],v[152:159],v200
 v_exp_f32 v166,v166
 v_exp_f32 v167,v167
 v_mfma_f32_32x32x16_bf16 v[208:223],a[36:39],a[156:159],v[208:223]
 v_exp_f32 v168,v168
 v_exp_f32 v169,v169
 v_exp_f32 v170,v170
 v_smfmac_f32_32x32x32_bf16 v[112:127],a[40:43],v[160:167],v200
 v_exp_f32 v171,v171
 v_exp_f32 v172,v172
 v_exp_f32 v173,v173
 v_smfmac_f32_16x16x64_bf16 v[192:195],a[160:163],v[160:167],v200
 s_waitcnt vmcnt(38)
 v_exp_f32 v174,v174
 v_exp_f32 v175,v175
 v_mfma_f32_32x32x16_bf16 v[144:159],a[48:51],a[128:131],0
 s_movk_i32 s49,8192
 v_exp_f32 v208,v208
 v_exp_f32 v209,v209
 v_exp_f32 v210,v210
 v_smfmac_f32_32x32x32_bf16 v[112:127],a[44:47],v[168:175],v200
 v_exp_f32 v211,v211
 v_exp_f32 v212,v212
 v_exp_f32 v213,v213
 v_smfmac_f32_16x16x64_bf16 v[192:195],a[160:163],v[168:175],v200
 v_exp_f32 v214,v214
 v_exp_f32 v215,v215
 v_mfma_f32_32x32x16_bf16 v[144:159],a[52:55],a[132:135],v[144:159]
 v_exp_f32 v216,v216
 v_exp_f32 v217,v217
 v_exp_f32 v218,v218
 v_smfmac_f32_32x32x32_bf16 v[128:143],a[40:43],v[208:215],v200
 s_waitcnt vmcnt(0)
 buffer_atomic_add v6,v205,s[12:15],0 offen offset:20 sc1
 v_exp_f32 v219,v219
 v_exp_f32 v220,v220
 v_exp_f32 v221,v221
 v_smfmac_f32_16x16x64_bf16 v[196:199],a[160:163],v[208:215],v200
 v_exp_f32 v222,v222
 v_exp_f32 v223,v223
 v_mfma_f32_32x32x16_bf16 v[160:175],a[48:51],a[136:139],0
 v_exp_f32 v144,v144
 v_exp_f32 v145,v145
 v_exp_f32 v146,v146
 v_smfmac_f32_32x32x32_bf16 v[128:143],a[44:47],v[216:223],v200
 v_exp_f32 v147,v147
 v_exp_f32 v148,v148
 v_exp_f32 v149,v149
 v_smfmac_f32_16x16x64_bf16 v[196:199],a[160:163],v[216:223],v200
 buffer_load_dwordx4 v[64:67],v251,s[4:7],0 offen
 v_exp_f32 v150,v150
 v_exp_f32 v151,v151
 v_mfma_f32_32x32x16_bf16 v[160:175],a[52:55],a[140:143],v[160:175]
 v_exp_f32 v152,v152
 v_exp_f32 v153,v153
 v_exp_f32 v154,v154
 v_smfmac_f32_32x32x32_bf16 v[80:95],a[56:59],v[144:151],v200
 v_exp_f32 v155,v155
 v_exp_f32 v156,v156
 v_exp_f32 v157,v157
 v_smfmac_f32_16x16x64_bf16 v[184:187],a[160:163],v[144:151],v200
 v_exp_f32 v158,v158
 v_exp_f32 v159,v159
 v_mfma_f32_32x32x16_bf16 v[208:223],a[48:51],a[144:147],0
 s_nop 0
 v_exp_f32 v160,v160
 v_exp_f32 v161,v161
 v_exp_f32 v162,v162
 v_smfmac_f32_32x32x32_bf16 v[80:95],a[60:63],v[152:159],v200
 v_exp_f32 v163,v163
 v_exp_f32 v164,v164
 v_exp_f32 v165,v165
 v_smfmac_f32_16x16x64_bf16 v[184:187],a[160:163],v[152:159],v200
 buffer_load_dwordx4 v[68:71],v251,s[4:7],s49 offen
 v_exp_f32 v166,v166
 v_exp_f32 v167,v167
 v_mfma_f32_32x32x16_bf16 v[208:223],a[52:55],a[148:151],v[208:223]
 s_movk_i32 s49,8192
 v_exp_f32 v168,v168
 v_exp_f32 v169,v169
 v_exp_f32 v170,v170
 v_smfmac_f32_32x32x32_bf16 v[96:111],a[56:59],v[160:167],v200
 v_exp_f32 v171,v171
 v_exp_f32 v172,v172
 v_exp_f32 v173,v173
 v_smfmac_f32_16x16x64_bf16 v[188:191],a[160:163],v[160:167],v200
 v_exp_f32 v174,v174
 v_exp_f32 v175,v175
 v_mfma_f32_32x32x16_bf16 v[144:159],a[48:51],a[152:155],0
 v_exp_f32 v208,v208
 v_exp_f32 v209,v209
 v_exp_f32 v210,v210
 v_smfmac_f32_32x32x32_bf16 v[96:111],a[60:63],v[168:175],v200
 v_exp_f32 v211,v211
 v_exp_f32 v212,v212
 v_exp_f32 v213,v213
 v_smfmac_f32_16x16x64_bf16 v[188:191],a[160:163],v[168:175],v200
 buffer_load_dwordx4 v[72:75],v251,s[4:7],0 offen offset:64
 v_exp_f32 v214,v214
 v_exp_f32 v215,v215
 v_mfma_f32_32x32x16_bf16 v[144:159],a[52:55],a[156:159],v[144:159]
 v_exp_f32 v216,v216
 v_exp_f32 v217,v217
 v_exp_f32 v218,v218
 v_smfmac_f32_32x32x32_bf16 v[112:127],a[56:59],v[208:215],v200
 v_exp_f32 v219,v219
 v_exp_f32 v220,v220
 v_exp_f32 v221,v221
 v_smfmac_f32_16x16x64_bf16 v[192:195],a[160:163],v[208:215],v200
 v_exp_f32 v222,v222
 v_exp_f32 v223,v223
 v_mfma_f32_32x32x16_bf16 v[160:175],a[64:67],a[128:131],0
 s_nop 0
 v_exp_f32 v144,v144
 v_exp_f32 v145,v145
 v_exp_f32 v146,v146
 v_smfmac_f32_32x32x32_bf16 v[112:127],a[60:63],v[216:223],v200
 v_exp_f32 v147,v147
 v_exp_f32 v148,v148
 v_exp_f32 v149,v149
 v_smfmac_f32_16x16x64_bf16 v[192:195],a[160:163],v[216:223],v200
 buffer_load_dwordx4 v[76:79],v251,s[4:7],s49 offen offset:64
 v_exp_f32 v150,v150
 v_exp_f32 v151,v151
 v_mfma_f32_32x32x16_bf16 v[160:175],a[68:71],a[132:135],v[160:175]
 v_exp_f32 v152,v152
 v_exp_f32 v153,v153
 v_exp_f32 v154,v154
 v_smfmac_f32_32x32x32_bf16 v[128:143],a[56:59],v[144:151],v200
 v_exp_f32 v155,v155
 v_exp_f32 v156,v156
 v_exp_f32 v157,v157
 v_smfmac_f32_16x16x64_bf16 v[196:199],a[160:163],v[144:151],v200
 v_exp_f32 v158,v158
 v_exp_f32 v159,v159
 v_mfma_f32_32x32x16_bf16 v[208:223],a[64:67],a[136:139],0
 s_nop 0
 v_exp_f32 v160,v160
 v_exp_f32 v161,v161
 v_exp_f32 v162,v162
 v_smfmac_f32_32x32x32_bf16 v[128:143],a[60:63],v[152:159],v200
 v_exp_f32 v163,v163
 v_exp_f32 v164,v164
 v_exp_f32 v165,v165
 v_smfmac_f32_16x16x64_bf16 v[196:199],a[160:163],v[152:159],v200
 v_exp_f32 v166,v166
 v_exp_f32 v167,v167
 v_mfma_f32_32x32x16_bf16 v[208:223],a[68:71],a[140:143],v[208:223]
 v_exp_f32 v168,v168
 v_exp_f32 v169,v169
 v_exp_f32 v170,v170
 v_smfmac_f32_32x32x32_bf16 v[80:95],a[72:75],v[160:167],v200
 v_exp_f32 v171,v171
 v_exp_f32 v172,v172
 v_exp_f32 v173,v173
 v_smfmac_f32_16x16x64_bf16 v[184:187],a[160:163],v[160:167],v200
 v_exp_f32 v174,v174
 v_exp_f32 v175,v175
 v_mfma_f32_32x32x16_bf16 v[144:159],a[64:67],a[144:147],0
 s_nop 0
 v_exp_f32 v208,v208
 v_exp_f32 v209,v209
 v_exp_f32 v210,v210
 v_smfmac_f32_32x32x32_bf16 v[80:95],a[76:79],v[168:175],v200
 v_exp_f32 v211,v211
 v_exp_f32 v212,v212
 v_exp_f32 v213,v213
 v_smfmac_f32_16x16x64_bf16 v[184:187],a[160:163],v[168:175],v200
 v_exp_f32 v214,v214
 v_exp_f32 v215,v215
 v_mfma_f32_32x32x16_bf16 v[144:159],a[68:71],a[148:151],v[144:159]
 v_exp_f32 v216,v216
 v_exp_f32 v217,v217
 v_exp_f32 v218,v218
 v_smfmac_f32_32x32x32_bf16 v[96:111],a[72:75],v[208:215],v200
 v_exp_f32 v219,v219
 v_exp_f32 v220,v220
 v_exp_f32 v221,v221
 v_smfmac_f32_16x16x64_bf16 v[188:191],a[160:163],v[208:215],v200
 v_exp_f32 v222,v222
 v_exp_f32 v223,v223
 v_mfma_f32_32x32x16_bf16 v[160:175],a[64:67],a[152:155],0
 s_nop 0
 v_exp_f32 v144,v144
 v_exp_f32 v145,v145
 v_exp_f32 v146,v146
 v_smfmac_f32_32x32x32_bf16 v[96:111],a[76:79],v[216:223],v200
 v_exp_f32 v147,v147
 v_exp_f32 v148,v148
 v_exp_f32 v149,v149
 v_smfmac_f32_16x16x64_bf16 v[188:191],a[160:163],v[216:223],v200
 v_exp_f32 v150,v150
 v_exp_f32 v151,v151
 v_mfma_f32_32x32x16_bf16 v[160:175],a[68:71],a[156:159],v[160:175]
 v_exp_f32 v152,v152
 v_exp_f32 v153,v153
 v_exp_f32 v154,v154
 v_smfmac_f32_32x32x32_bf16 v[112:127],a[72:75],v[144:151],v200
 v_exp_f32 v155,v155
 v_exp_f32 v156,v156
 v_exp_f32 v157,v157
 v_smfmac_f32_16x16x64_bf16 v[192:195],a[160:163],v[144:151],v200
 v_exp_f32 v158,v158
 v_exp_f32 v159,v159
 v_mfma_f32_32x32x16_bf16 v[208:223],a[80:83],a[128:131],0
 s_nop 0
 v_exp_f32 v160,v160
 v_exp_f32 v161,v161
 v_exp_f32 v162,v162
 v_smfmac_f32_32x32x32_bf16 v[112:127],a[76:79],v[152:159],v200
 v_exp_f32 v163,v163
 v_exp_f32 v164,v164
 v_exp_f32 v165,v165
 v_smfmac_f32_16x16x64_bf16 v[192:195],a[160:163],v[152:159],v200
 v_exp_f32 v166,v166
 v_exp_f32 v167,v167
 v_mfma_f32_32x32x16_bf16 v[208:223],a[84:87],a[132:135],v[208:223]
 v_exp_f32 v168,v168
 v_exp_f32 v169,v169
 v_exp_f32 v170,v170
 v_smfmac_f32_32x32x32_bf16 v[128:143],a[72:75],v[160:167],v200
 v_exp_f32 v171,v171
 v_exp_f32 v172,v172
 v_exp_f32 v173,v173
 v_smfmac_f32_16x16x64_bf16 v[196:199],a[160:163],v[160:167],v200
 v_exp_f32 v174,v174
 v_exp_f32 v175,v175
 v_mfma_f32_32x32x16_bf16 v[144:159],a[80:83],a[136:139],0
 s_nop 0
 v_exp_f32 v208,v208
 v_exp_f32 v209,v209
 v_exp_f32 v210,v210
 v_smfmac_f32_32x32x32_bf16 v[128:143],a[76:79],v[168:175],v200
 v_exp_f32 v211,v211
 v_exp_f32 v212,v212
 v_exp_f32 v213,v213
 v_smfmac_f32_16x16x64_bf16 v[196:199],a[160:163],v[168:175],v200
 v_exp_f32 v214,v214
 v_exp_f32 v215,v215
 v_mfma_f32_32x32x16_bf16 v[144:159],a[84:87],a[140:143],v[144:159]
 v_exp_f32 v216,v216
 v_exp_f32 v217,v217
 v_exp_f32 v218,v218
 v_smfmac_f32_32x32x32_bf16 v[80:95],a[88:91],v[208:215],v200
 v_exp_f32 v219,v219
 v_exp_f32 v220,v220
 v_exp_f32 v221,v221
 v_smfmac_f32_16x16x64_bf16 v[184:187],a[160:163],v[208:215],v200
 v_exp_f32 v222,v222
 v_exp_f32 v223,v223
 v_mfma_f32_32x32x16_bf16 v[160:175],a[80:83],a[144:147],0
 s_nop 0
 v_exp_f32 v144,v144
 v_exp_f32 v145,v145
 v_exp_f32 v146,v146
 v_smfmac_f32_32x32x32_bf16 v[80:95],a[92:95],v[216:223],v200
 v_exp_f32 v147,v147
 v_exp_f32 v148,v148
 v_exp_f32 v149,v149
 v_smfmac_f32_16x16x64_bf16 v[184:187],a[160:163],v[216:223],v200
 v_exp_f32 v150,v150
 v_exp_f32 v151,v151
 v_mfma_f32_32x32x16_bf16 v[160:175],a[84:87],a[148:151],v[160:175]
 v_exp_f32 v152,v152
 v_exp_f32 v153,v153
 v_exp_f32 v154,v154
 v_smfmac_f32_32x32x32_bf16 v[96:111],a[88:91],v[144:151],v200
 v_exp_f32 v155,v155
 v_exp_f32 v156,v156
 v_exp_f32 v157,v157
 v_smfmac_f32_16x16x64_bf16 v[188:191],a[160:163],v[144:151],v200
 v_exp_f32 v158,v158
 v_exp_f32 v159,v159
 v_mfma_f32_32x32x16_bf16 v[208:223],a[80:83],a[152:155],0
 s_lshl_b32 s57,s44,2
 v_exp_f32 v160,v160
 v_exp_f32 v161,v161
 v_exp_f32 v162,v162
 v_smfmac_f32_32x32x32_bf16 v[96:111],a[92:95],v[152:159],v200
 s_add_u32 s57,s57,s61
 s_lshl_b32 s57,s57,5
 v_exp_f32 v163,v163
 v_exp_f32 v164,v164
 v_exp_f32 v165,v165
 v_smfmac_f32_16x16x64_bf16 v[188:191],a[160:163],v[152:159],v200
 s_lshl_b32 s3,s45,1
 s_add_u32 s3,s3,s60
 s_add_u32 s57,s57,s3
 s_lshl_b32 s57,s57,11
 v_exp_f32 v166,v166
 v_exp_f32 v167,v167
 v_mfma_f32_32x32x16_bf16 v[208:223],a[84:87],a[156:159],v[208:223]
 s_add_u32 s57,s57,16777216
 v_exp_f32 v168,v168
 v_exp_f32 v169,v169
 v_exp_f32 v170,v170
 v_smfmac_f32_32x32x32_bf16 v[112:127],a[88:91],v[160:167],v200
 v_exp_f32 v171,v171
 v_exp_f32 v172,v172
 v_exp_f32 v173,v173
 v_smfmac_f32_16x16x64_bf16 v[192:195],a[160:163],v[160:167],v200
 v_exp_f32 v174,v174
 v_exp_f32 v175,v175
 v_mfma_f32_32x32x16_bf16 v[144:159],a[96:99],a[128:131],0
 v_exp_f32 v208,v208
 v_exp_f32 v209,v209
 v_exp_f32 v210,v210
 v_smfmac_f32_32x32x32_bf16 v[112:127],a[92:95],v[168:175],v200
 v_exp_f32 v211,v211
 v_exp_f32 v212,v212
 v_exp_f32 v213,v213
 v_smfmac_f32_16x16x64_bf16 v[192:195],a[160:163],v[168:175],v200
 v_exp_f32 v214,v214
 v_exp_f32 v215,v215
 v_mfma_f32_32x32x16_bf16 v[144:159],a[100:103],a[132:135],v[144:159]
 v_exp_f32 v216,v216
 v_exp_f32 v217,v217
 v_exp_f32 v218,v218
 v_smfmac_f32_32x32x32_bf16 v[128:143],a[88:91],v[208:215],v200
 v_mov_b32 v7,0
 buffer_atomic_add v7,v5,s[12:15],0 offen offset:20 sc0 sc1
 v_exp_f32 v219,v219
 v_exp_f32 v220,v220
 v_exp_f32 v221,v221
 v_smfmac_f32_16x16x64_bf16 v[196:199],a[160:163],v[208:215],v200
 v_exp_f32 v222,v222
 v_exp_f32 v223,v223
 v_mfma_f32_32x32x16_bf16 v[160:175],a[96:99],a[136:139],0
 v_exp_f32 v144,v144
 v_exp_f32 v145,v145
 v_exp_f32 v146,v146
 v_smfmac_f32_32x32x32_bf16 v[128:143],a[92:95],v[216:223],v200
 s_add_u32 s58,s57,65536
 v_exp_f32 v147,v147
 v_exp_f32 v148,v148
 v_exp_f32 v149,v149
 v_smfmac_f32_16x16x64_bf16 v[196:199],a[160:163],v[216:223],v200
 v_exp_f32 v150,v150
 v_exp_f32 v151,v151
 v_mfma_f32_32x32x16_bf16 v[160:175],a[100:103],a[140:143],v[160:175]
 v_exp_f32 v152,v152
 v_exp_f32 v153,v153
 v_exp_f32 v154,v154
 v_smfmac_f32_32x32x32_bf16 v[80:95],a[104:107],v[144:151],v200
 v_exp_f32 v155,v155
 v_exp_f32 v156,v156
 v_exp_f32 v157,v157
 v_smfmac_f32_16x16x64_bf16 v[184:187],a[160:163],v[144:151],v200
 v_exp_f32 v158,v158
 v_exp_f32 v159,v159
 v_mfma_f32_32x32x16_bf16 v[208:223],a[112:115],a[128:131],0
 s_nop 0
 v_exp_f32 v160,v160
 v_exp_f32 v161,v161
 v_exp_f32 v162,v162
 v_smfmac_f32_32x32x32_bf16 v[80:95],a[108:111],v[152:159],v200
 v_exp_f32 v163,v163
 v_exp_f32 v164,v164
 v_exp_f32 v165,v165
 v_smfmac_f32_16x16x64_bf16 v[184:187],a[160:163],v[152:159],v200
 v_exp_f32 v166,v166
 v_exp_f32 v167,v167
 v_mfma_f32_32x32x16_bf16 v[208:223],a[116:119],a[132:135],v[208:223]
 v_exp_f32 v168,v168
 v_exp_f32 v169,v169
 v_exp_f32 v170,v170
 v_smfmac_f32_32x32x32_bf16 v[96:111],a[104:107],v[160:167],v200
 v_exp_f32 v171,v171
 v_exp_f32 v172,v172
 v_exp_f32 v173,v173
 v_smfmac_f32_16x16x64_bf16 v[188:191],a[160:163],v[160:167],v200
 v_exp_f32 v174,v174
 v_exp_f32 v175,v175
 v_mfma_f32_32x32x16_bf16 v[144:159],a[112:115],a[136:139],0
 s_nop 0
 v_exp_f32 v208,v208
 v_exp_f32 v209,v209
 v_exp_f32 v210,v210
 v_smfmac_f32_32x32x32_bf16 v[96:111],a[108:111],v[168:175],v200
 v_exp_f32 v211,v211
 v_exp_f32 v212,v212
 v_exp_f32 v213,v213
 v_smfmac_f32_16x16x64_bf16 v[188:191],a[160:163],v[168:175],v200
 v_exp_f32 v214,v214
 v_exp_f32 v215,v215
 v_mfma_f32_32x32x16_bf16 v[144:159],a[116:119],a[140:143],v[144:159]
 v_exp_f32 v216,v216
 v_exp_f32 v217,v217
 v_exp_f32 v218,v218
 v_smfmac_f32_32x32x32_bf16 v[80:95],a[120:123],v[208:215],v200
 v_exp_f32 v219,v219
 v_exp_f32 v220,v220
 v_exp_f32 v221,v221
 v_smfmac_f32_16x16x64_bf16 v[184:187],a[160:163],v[208:215],v200
 v_exp_f32 v222,v222
 v_exp_f32 v223,v223
 v_mfma_f32_32x32x16_bf16 v[160:175],a[96:99],a[144:147],0
 s_nop 0
 v_exp_f32 v144,v144
 v_exp_f32 v145,v145
 v_exp_f32 v146,v146
 v_smfmac_f32_32x32x32_bf16 v[80:95],a[124:127],v[216:223],v200
 v_exp_f32 v147,v147
 v_exp_f32 v148,v148
 v_exp_f32 v149,v149
 v_smfmac_f32_16x16x64_bf16 v[184:187],a[160:163],v[216:223],v200
 v_exp_f32 v150,v150
 v_exp_f32 v151,v151
 v_mfma_f32_32x32x16_bf16 v[160:175],a[100:103],a[148:151],v[160:175]
 v_exp_f32 v152,v152
 v_exp_f32 v153,v153
 v_exp_f32 v154,v154
 v_smfmac_f32_32x32x32_bf16 v[96:111],a[120:123],v[144:151],v200
 v_exp_f32 v155,v155
 v_exp_f32 v156,v156
 v_exp_f32 v157,v157
 v_smfmac_f32_16x16x64_bf16 v[188:191],a[160:163],v[144:151],v200
 s_nop 4
 ds_write_b128 v206,v[80:83]
 v_exp_f32 v158,v158
 v_exp_f32 v159,v159
 v_mfma_f32_32x32x16_bf16 v[208:223],a[96:99],a[152:155],0
 v_exp_f32 v160,v160
 v_exp_f32 v161,v161
 v_exp_f32 v162,v162
 v_smfmac_f32_32x32x32_bf16 v[96:111],a[124:127],v[152:159],v200
 v_exp_f32 v163,v163
 v_exp_f32 v164,v164
 v_exp_f32 v165,v165
 v_smfmac_f32_16x16x64_bf16 v[188:191],a[160:163],v[152:159],v200
 ds_write_b128 v206,v[84:87] offset:1024
 v_exp_f32 v166,v166
 v_exp_f32 v167,v167
 v_mfma_f32_32x32x16_bf16 v[208:223],a[100:103],a[156:159],v[208:223]
 v_exp_f32 v168,v168
 v_exp_f32 v169,v169
 v_exp_f32 v170,v170
 v_smfmac_f32_32x32x32_bf16 v[112:127],a[104:107],v[160:167],v200
 ds_write_b32 v252,v184
 v_exp_f32 v171,v171
 v_exp_f32 v172,v172
 v_exp_f32 v173,v173
 v_smfmac_f32_16x16x64_bf16 v[192:195],a[160:163],v[160:167],v200
 ds_write_b128 v206,v[88:91] offset:2048
 s_nop 1
 ds_write_b128 v206,v[96:99] offset:4096
 v_exp_f32 v174,v174
 v_exp_f32 v175,v175
 v_mfma_f32_32x32x16_bf16 v[144:159],a[112:115],a[144:147],0
 v_exp_f32 v208,v208
 v_exp_f32 v209,v209
 v_exp_f32 v210,v210
 v_smfmac_f32_32x32x32_bf16 v[112:127],a[108:111],v[168:175],v200
 v_exp_f32 v211,v211
 v_exp_f32 v212,v212
 v_exp_f32 v213,v213
 v_smfmac_f32_16x16x64_bf16 v[192:195],a[160:163],v[168:175],v200
 ds_write_b128 v206,v[92:95] offset:3072
 ds_write_b128 v206,v[100:103] offset:5120
 v_exp_f32 v214,v214
 v_exp_f32 v215,v215
 v_mfma_f32_32x32x16_bf16 v[144:159],a[116:119],a[148:151],v[144:159]
 v_exp_f32 v216,v216
 v_exp_f32 v217,v217
 v_exp_f32 v218,v218
 v_smfmac_f32_32x32x32_bf16 v[128:143],a[104:107],v[208:215],v200
 ds_write_b32 v252,v188 offset:256
 v_exp_f32 v219,v219
 v_exp_f32 v220,v220
 v_exp_f32 v221,v221
 v_smfmac_f32_16x16x64_bf16 v[196:199],a[160:163],v[208:215],v200
 ds_write_b128 v206,v[104:107] offset:6144
 v_exp_f32 v222,v222
 v_exp_f32 v223,v223
 v_mfma_f32_32x32x16_bf16 v[160:175],a[112:115],a[152:155],0
 v_exp_f32 v144,v144
 v_exp_f32 v145,v145
 v_exp_f32 v146,v146
 v_smfmac_f32_32x32x32_bf16 v[128:143],a[108:111],v[216:223],v200
 v_exp_f32 v147,v147
 v_exp_f32 v148,v148
 v_exp_f32 v149,v149
 v_smfmac_f32_16x16x64_bf16 v[196:199],a[160:163],v[216:223],v200
 ds_write_b128 v206,v[108:111] offset:7168
 v_exp_f32 v150,v150
 v_exp_f32 v151,v151
 v_mfma_f32_32x32x16_bf16 v[160:175],a[116:119],a[156:159],v[160:175]
 v_exp_f32 v152,v152
 v_exp_f32 v153,v153
 v_exp_f32 v154,v154
 v_smfmac_f32_32x32x32_bf16 v[112:127],a[120:123],v[144:151],v200
 s_waitcnt vmcnt(0)
 v_readfirstlane_b32 s59,v7
 s_nop 0
 s_cmp_ge_u32 s59,128
 s_cbranch_scc0 .Lseq_slow_8
.Lseq_back_9:
 v_exp_f32 v155,v155
 v_exp_f32 v156,v156
 v_exp_f32 v157,v157
 v_smfmac_f32_16x16x64_bf16 v[192:195],a[160:163],v[144:151],v200
 v_exp_f32 v158,v158
 v_exp_f32 v159,v159
 s_nop 0
 v_exp_f32 v160,v160
 v_exp_f32 v161,v161
 v_exp_f32 v162,v162
 v_smfmac_f32_32x32x32_bf16 v[112:127],a[124:127],v[152:159],v200
 s_waitcnt lgkmcnt(0)
 s_barrier
 v_exp_f32 v163,v163
 v_exp_f32 v164,v164
 v_exp_f32 v165,v165
 v_smfmac_f32_16x16x64_bf16 v[192:195],a[160:163],v[152:159],v200
 ds_read_b128 v[80:83],v207
 ds_read_b128 v[84:87],v207 offset:1024
 ds_read_b128 v[88:91],v207 offset:2048
 v_exp_f32 v166,v166
 v_exp_f32 v167,v167
 s_nop 0
 v_exp_f32 v168,v168
 v_exp_f32 v169,v169
 v_exp_f32 v170,v170
 v_smfmac_f32_32x32x32_bf16 v[128:143],a[120:123],v[160:167],v200
 ds_read_b128 v[92:95],v207 offset:3072
 ds_read_b128 v[96:99],v207 offset:4096
 v_exp_f32 v171,v171
 v_exp_f32 v172,v172
 v_exp_f32 v173,v173
 v_smfmac_f32_16x16x64_bf16 v[196:199],a[160:163],v[160:167],v200
 ds_read_b128 v[100:103],v207 offset:5120
 ds_read_b128 v[104:107],v207 offset:6144
 ds_read_b128 v[108:111],v207 offset:7168
 ds_read_b32 v184,v253
 ds_read_b32 v188,v253 offset:256
 v_exp_f32 v174,v174
 v_exp_f32 v175,v175
 s_nop 1
 v_smfmac_f32_32x32x32_bf16 v[128:143],a[124:127],v[168:175],v200
 v_smfmac_f32_16x16x64_bf16 v[196:199],a[160:163],v[168:175],v200
 s_waitcnt lgkmcnt(0)
 v_add_f32 v192,v192,v184
 v_rcp_f32 v194,v192
 v_pk_add_f32 v[112:113],v[112:113],v[80:81]
 v_pk_add_f32 v[114:115],v[114:115],v[82:83]
 v_pk_add_f32 v[116:117],v[116:117],v[84:85]
 v_pk_add_f32 v[118:119],v[118:119],v[86:87]
 v_pk_add_f32 v[120:121],v[120:121],v[88:89]
 v_pk_add_f32 v[122:123],v[122:123],v[90:91]
 v_pk_add_f32 v[124:125],v[124:125],v[92:93]
 v_pk_add_f32 v[126:127],v[126:127],v[94:95]
 v_pk_mul_f32 v[112:113],v[112:113],v[194:195] op_sel_hi:[1,0]
 v_pk_mul_f32 v[114:115],v[114:115],v[194:195] op_sel_hi:[1,0]
 v_pk_mul_f32 v[116:117],v[116:117],v[194:195] op_sel_hi:[1,0]
 v_pk_mul_f32 v[118:119],v[118:119],v[194:195] op_sel_hi:[1,0]
 v_pk_mul_f32 v[120:121],v[120:121],v[194:195] op_sel_hi:[1,0]
 v_pk_mul_f32 v[122:123],v[122:123],v[194:195] op_sel_hi:[1,0]
 v_pk_mul_f32 v[124:125],v[124:125],v[194:195] op_sel_hi:[1,0]
 v_pk_mul_f32 v[126:127],v[126:127],v[194:195] op_sel_hi:[1,0]
 v_cvt_pk_bf16_f32 v80,v112,v113
 v_cvt_pk_bf16_f32 v81,v114,v115
 v_cvt_pk_bf16_f32 v82,v116,v117
 v_cvt_pk_bf16_f32 v83,v118,v119
 buffer_store_dwordx4 v[80:83],v203,s[12:15],s57 offen sc1
 v_cvt_pk_bf16_f32 v84,v120,v121
 v_cvt_pk_bf16_f32 v85,v122,v123
 v_cvt_pk_bf16_f32 v86,v124,v125
 v_cvt_pk_bf16_f32 v87,v126,v127
 buffer_store_dwordx4 v[84:87],v203,s[12:15],s57 offen offset:512 sc1
 v_add_f32 v196,v196,v188
 v_rcp_f32 v198,v196
 v_pk_add_f32 v[128:129],v[128:129],v[96:97]
 v_pk_add_f32 v[130:131],v[130:131],v[98:99]
 v_pk_add_f32 v[132:133],v[132:133],v[100:101]
 v_pk_add_f32 v[134:135],v[134:135],v[102:103]
 v_pk_add_f32 v[136:137],v[136:137],v[104:105]
 v_pk_add_f32 v[138:139],v[138:139],v[106:107]
 v_pk_add_f32 v[140:141],v[140:141],v[108:109]
 v_pk_add_f32 v[142:143],v[142:143],v[110:111]
 v_pk_mul_f32 v[128:129],v[128:129],v[198:199] op_sel_hi:[1,0]
 v_pk_mul_f32 v[130:131],v[130:131],v[198:199] op_sel_hi:[1,0]
 v_pk_mul_f32 v[132:133],v[132:133],v[198:199] op_sel_hi:[1,0]
 v_pk_mul_f32 v[134:135],v[134:135],v[198:199] op_sel_hi:[1,0]
 v_pk_mul_f32 v[136:137],v[136:137],v[198:199] op_sel_hi:[1,0]
 v_pk_mul_f32 v[138:139],v[138:139],v[198:199] op_sel_hi:[1,0]
 v_pk_mul_f32 v[140:141],v[140:141],v[198:199] op_sel_hi:[1,0]
 v_pk_mul_f32 v[142:143],v[142:143],v[198:199] op_sel_hi:[1,0]
 v_cvt_pk_bf16_f32 v96,v128,v129
 v_cvt_pk_bf16_f32 v97,v130,v131
 v_cvt_pk_bf16_f32 v98,v132,v133
 v_cvt_pk_bf16_f32 v99,v134,v135
 buffer_store_dwordx4 v[96:99],v203,s[12:15],s58 offen sc1
 v_cvt_pk_bf16_f32 v100,v136,v137
 v_cvt_pk_bf16_f32 v101,v138,v139
 v_cvt_pk_bf16_f32 v102,v140,v141
 v_cvt_pk_bf16_f32 v103,v142,v143
 buffer_store_dwordx4 v[100:103],v203,s[12:15],s58 offen offset:512 sc1
 s_barrier
 s_add_u32 s3,s46,124
 s_lshl_b32 m0,s3,10
 s_lshl_b32 s49,s3,14
 v_subrev_u32 v176,s54,v227
 s_mul_i32 s54,s46,7168
 s_branch .Lsk8
.Lst8:
 s_branch .Lvb1
.Lsk8:
 buffer_load_dwordx4 v250,s[20:23],s49 offen lds
 s_lshl_b32 s63,s45,19
 s_add_u32 s63,s63,s54
 s_add_u32 s63,s63,25165824
 s_mov_b32 s50,s63
 s_lshr_b32 s62,s54,1
 s_min_u32 s62,s62,10240
 s_add_u32 m0,s54,131072
 s_nop 0
 buffer_load_dwordx4 v0,s[12:15],s50 offen sc1 lds
 buffer_load_dwordx4 v0,s[12:15],s50 offen offset:1024 sc1 lds
 buffer_load_dwordx4 v0,s[12:15],s50 offen offset:2048 sc1 lds
 buffer_load_dwordx4 v0,s[12:15],s50 offen offset:3072 sc1 lds
 s_add_u32 s50,s50,4096
 s_add_u32 m0,s54,135168
 s_nop 0
 buffer_load_dwordx4 v0,s[12:15],s50 offen sc1 lds
 buffer_load_dwordx4 v0,s[12:15],s50 offen offset:1024 sc1 lds
 buffer_load_dwordx4 v0,s[12:15],s50 offen offset:2048 sc1 lds
 s_add_u32 s50,s50,24576
 v_pk_mul_f32 v[144:145],v[112:113],0
 v_pk_fma_f32 v[144:145],v[114:115],0,v[144:145]
 v_pk_fma_f32 v[144:145],v[116:117],0,v[144:145]
 v_pk_fma_f32 v[144:145],v[118:119],0,v[144:145]
 v_pk_fma_f32 v[144:145],v[120:121],0,v[144:145]
 v_pk_fma_f32 v[144:145],v[122:123],0,v[144:145]
 v_pk_fma_f32 v[144:145],v[124:125],0,v[144:145]
 v_pk_fma_f32 v[144:145],v[126:127],0,v[144:145]
 v_pk_fma_f32 v[144:145],v[128:129],0,v[144:145]
 v_pk_fma_f32 v[144:145],v[130:131],0,v[144:145]
 v_pk_fma_f32 v[144:145],v[132:133],0,v[144:145]
 v_pk_fma_f32 v[144:145],v[134:135],0,v[144:145]
 v_pk_fma_f32 v[144:145],v[136:137],0,v[144:145]
 v_pk_fma_f32 v[144:145],v[138:139],0,v[144:145]
 v_pk_fma_f32 v[144:145],v[140:141],0,v[144:145]
 v_pk_fma_f32 v[144:145],v[142:143],0,v[144:145]
 v_add_f32 v144,v144,v145
 v_add_f32 v145,v144,v192
 v_add_f32 v145,v145,v196
 v_min_f32 v146,v192,v196
 v_cmp_ngt_f32 vcc,0x5f800000,v145
 s_nop 0
 s_mov_b64 s[70:71],vcc
 v_cmp_nlt_f32 vcc,0x30800000,v146
 s_nop 0
 s_or_b64 vcc,vcc,s[70:71]
 s_cbranch_vccnz .Lseq_fb_10
.Lseq_fbk_11:
 v_permlane16_swap_b32 v64,v66
 v_permlane16_swap_b32 v65,v67
 v_permlane16_swap_b32 v68,v70
 v_permlane16_swap_b32 v69,v71
 v_permlane16_swap_b32 v72,v74
 v_permlane16_swap_b32 v73,v75
 v_permlane16_swap_b32 v76,v78
 v_permlane16_swap_b32 v77,v79
 v_xor_b32 v177,32,v176
 v_xor_b32 v178,64,v176
 v_xor_b32 v179,96,v176
 v_add_u32 v180,0x10000,v176
 v_add_u32 v181,0x10000,v177
 v_add_u32 v182,0x10000,v178
 v_add_u32 v183,0x10000,v179
 v_lshlrev_b32 v224,16,v64
 v_and_b32 v225,0xffff0000,v64
 v_lshlrev_b32 v226,16,v65
 v_and_b32 v227,0xffff0000,v65
 v_lshlrev_b32 v228,16,v66
 v_and_b32 v229,0xffff0000,v66
 v_lshlrev_b32 v230,16,v67
 v_and_b32 v231,0xffff0000,v67
 v_lshlrev_b32 v232,16,v68
 v_and_b32 v233,0xffff0000,v68
 v_lshlrev_b32 v234,16,v69
 v_and_b32 v235,0xffff0000,v69
 v_lshlrev_b32 v236,16,v70
 v_and_b32 v237,0xffff0000,v70
 v_lshlrev_b32 v238,16,v71
 v_and_b32 v239,0xffff0000,v71
 v_lshlrev_b32 v240,16,v72
 v_and_b32 v241,0xffff0000,v72
 v_lshlrev_b32 v242,16,v73
 v_and_b32 v243,0xffff0000,v73
 v_lshlrev_b32 v244,16,v74
 v_and_b32 v245,0xffff0000,v74
 v_lshlrev_b32 v246,16,v75
 v_and_b32 v247,0xffff0000,v75
 v_lshlrev_b32 v248,16,v76
 v_and_b32 v249,0xffff0000,v76
 v_lshlrev_b32 v250,16,v77
 v_and_b32 v251,0xffff0000,v77
 v_lshlrev_b32 v252,16,v78
 v_and_b32 v253,0xffff0000,v78
 v_lshlrev_b32 v254,16,v79
 v_and_b32 v255,0xffff0000,v79
 ds_read_b64_tr_b16 v[16:17],v176
 ds_read_b64_tr_b16 v[18:19],v176 offset:2048
 ds_read_b64_tr_b16 v[20:21],v177
 ds_read_b64_tr_b16 v[22:23],v177 offset:2048
 ds_read_b64_tr_b16 v[24:25],v178
 ds_read_b64_tr_b16 v[26:27],v178 offset:2048
 ds_read_b64_tr_b16 v[28:29],v179
 ds_read_b64_tr_b16 v[30:31],v179 offset:2048
 ds_read_b64_tr_b16 v[32:33],v176 offset:4096
 ds_read_b64_tr_b16 v[34:35],v176 offset:6144
 ds_read_b64_tr_b16 v[36:37],v177 offset:4096
 ds_read_b64_tr_b16 v[38:39],v177 offset:6144
 ds_read_b64_tr_b16 v[40:41],v178 offset:4096
 ds_read_b64_tr_b16 v[42:43],v178 offset:6144
 ds_read_b64_tr_b16 v[44:45],v179 offset:4096
 ds_read_b64_tr_b16 v[46:47],v179 offset:6144
 ds_read_b64_tr_b16 v[48:49],v176 offset:8192
 ds_read_b64_tr_b16 v[50:51],v176 offset:10240
 ds_read_b64_tr_b16 v[52:53],v177 offset:8192
 ds_read_b64_tr_b16 v[54:55],v177 offset:10240
 ds_read_b64_tr_b16 v[56:57],v178 offset:8192
 ds_read_b64_tr_b16 v[58:59],v178 offset:10240
 ds_read_b64_tr_b16 v[60:61],v179 offset:8192
 ds_read_b64_tr_b16 v[62:63],v179 offset:10240
 ds_read_b64_tr_b16 v[64:65],v176 offset:12288
 ds_read_b64_tr_b16 v[66:67],v176 offset:14336
 ds_read_b64_tr_b16 v[68:69],v177 offset:12288
 ds_read_b64_tr_b16 v[70:71],v177 offset:14336
 ds_read_b64_tr_b16 v[72:73],v178 offset:12288
 ds_read_b64_tr_b16 v[74:75],v178 offset:14336
 ds_read_b64_tr_b16 v[76:77],v179 offset:12288
 ds_read_b64_tr_b16 v[78:79],v179 offset:14336
 v_add_u32 v1,0x10000,v0
 v_add_u32 v2,0x20000,v0
 s_mov_b32 s64,0x22222222
 s_mov_b32 s65,0x22222222
 s_mov_b32 s66,0x44444444
 s_mov_b32 s67,0x44444444
 s_mov_b32 s68,0x88888888
 s_mov_b32 s69,0x88888888
 v_lshrrev_b32 v188,4,v12
 v_bfe_u32 v189,v12,2,2
 v_cmp_eq_u32 vcc,v188,v189
 v_and_b32 v188,0xf0,v0
 s_nop 0
 v_cndmask_b32 v184,2.0,v188,vcc
 s_lshl_b32 s53,s47,16
 s_lshl_b32 s3,s45,12
 s_add_u32 s56,s53,s3
 s_add_u32 s56,s56,20971520
 s_add_u32 s53,s53,16777216
 s_lshl_b32 s57,s47,12
 s_add_u32 s57,s57,524288
 s_lshl_b32 s3,s45,8
 s_add_u32 s58,s57,s3
.Lwo:
 s_cmp_eq_u32 s46,0
 s_cbranch_scc1 .Lvs2_0
 s_cmp_eq_u32 s46,1
 s_cbranch_scc1 .Lvs2_1
 s_cmp_eq_u32 s46,2
 s_cbranch_scc1 .Lvs2_2
 s_branch .Lvs2_3
.Lvb2:
 s_waitcnt vmcnt(8)
 buffer_atomic_add v6,v201,s[12:15],0 offen offset:12 sc1
.Lseq_spin_16:
 v_mov_b32 v7,0
 buffer_atomic_add v7,v202,s[12:15],0 offen offset:12 sc0 sc1
 s_waitcnt vmcnt(0)
 v_readfirstlane_b32 s59,v7
 v_readlane_b32 s3,v7,1
 s_nop 0
 s_min_u32 s59,s59,s3
 s_cmp_ge_u32 s59,16
 s_cbranch_scc1 .Lseq_ok_17
 s_sub_u32 s48,s48,1
 s_cmp_gt_i32 s48,0
 s_cbranch_scc1 .Lseq_spin_16
.Lseq_ok_17:
 buffer_load_dwordx4 a[0:3],v0,s[12:15],s53 offen sc1
 buffer_load_dwordx4 a[4:7],v0,s[12:15],s53 offen offset:1024 sc1
 buffer_load_dwordx4 a[8:11],v0,s[12:15],s53 offen offset:2048 sc1
 buffer_load_dwordx4 a[12:15],v0,s[12:15],s53 offen offset:3072 sc1
 s_add_u32 s53,s53,4096
 buffer_load_dwordx4 a[16:19],v0,s[12:15],s53 offen sc1
 buffer_load_dwordx4 a[20:23],v0,s[12:15],s53 offen offset:1024 sc1
 buffer_load_dwordx4 a[24:27],v0,s[12:15],s53 offen offset:2048 sc1
 buffer_load_dwordx4 a[28:31],v0,s[12:15],s53 offen offset:3072 sc1
 s_add_u32 s53,s53,4096
 buffer_load_dwordx4 a[32:35],v0,s[12:15],s53 offen sc1
 buffer_load_dwordx4 a[36:39],v0,s[12:15],s53 offen offset:1024 sc1
 buffer_load_dwordx4 a[40:43],v0,s[12:15],s53 offen offset:2048 sc1
 buffer_load_dwordx4 a[44:47],v0,s[12:15],s53 offen offset:3072 sc1
 s_add_u32 s53,s53,4096
 buffer_load_dwordx4 a[48:51],v0,s[12:15],s53 offen sc1
 buffer_load_dwordx4 a[52:55],v0,s[12:15],s53 offen offset:1024 sc1
 s_waitcnt vmcnt(12) lgkmcnt(14)
 v_mfma_f32_16x16x32_bf16 v[224:227],v[16:19],a[0:3],v[224:227]
 s_add_u32 m0,s54,0
 buffer_load_dwordx4 a[56:59],v0,s[12:15],s53 offen offset:2048 sc1
 v_mfma_f32_16x16x32_bf16 v[232:235],v[16:19],a[4:7],v[232:235]
 ds_read_b64_tr_b16 v[16:17],v176 offset:16384
 ds_read_b64_tr_b16 v[18:19],v176 offset:18432
 v_mfma_f32_16x16x32_bf16 v[228:231],v[20:23],a[0:3],v[228:231]
 v_mfma_f32_16x16x32_bf16 v[236:239],v[20:23],a[4:7],v[236:239]
 ds_read_b64_tr_b16 v[20:21],v177 offset:16384
 ds_read_b64_tr_b16 v[22:23],v177 offset:18432
 v_mfma_f32_16x16x32_bf16 v[240:243],v[24:27],a[0:3],v[240:243]
 buffer_load_dwordx4 a[60:63],v0,s[12:15],s53 offen offset:3072 sc1
 v_mfma_f32_16x16x32_bf16 v[248:251],v[24:27],a[4:7],v[248:251]
 s_add_u32 s53,s53,4096
 ds_read_b64_tr_b16 v[24:25],v178 offset:16384
 ds_read_b64_tr_b16 v[26:27],v178 offset:18432
 v_mfma_f32_16x16x32_bf16 v[244:247],v[28:31],a[0:3],v[244:247]
 v_mfma_f32_16x16x32_bf16 v[252:255],v[28:31],a[4:7],v[252:255]
 s_waitcnt vmcnt(12)
 ds_read_b64_tr_b16 v[28:29],v179 offset:16384
 ds_read_b64_tr_b16 v[30:31],v179 offset:18432
 v_mfma_f32_16x16x32_bf16 v[224:227],v[32:35],a[8:11],v[224:227]
 buffer_load_dwordx4 a[64:67],v0,s[12:15],s53 offen sc1
 v_mfma_f32_16x16x32_bf16 v[232:235],v[32:35],a[12:15],v[232:235]
 ds_read_b64_tr_b16 v[32:33],v176 offset:20480
 ds_read_b64_tr_b16 v[34:35],v176 offset:22528
 v_mfma_f32_16x16x32_bf16 v[228:231],v[36:39],a[8:11],v[228:231]
 v_mfma_f32_16x16x32_bf16 v[236:239],v[36:39],a[12:15],v[236:239]
 ds_read_b64_tr_b16 v[36:37],v177 offset:20480
 ds_read_b64_tr_b16 v[38:39],v177 offset:22528
 v_mfma_f32_16x16x32_bf16 v[240:243],v[40:43],a[8:11],v[240:243]
 buffer_load_dwordx4 a[68:71],v0,s[12:15],s53 offen offset:1024 sc1
 v_mfma_f32_16x16x32_bf16 v[248:251],v[40:43],a[12:15],v[248:251]
 ds_read_b64_tr_b16 v[40:41],v178 offset:20480
 ds_read_b64_tr_b16 v[42:43],v178 offset:22528
 v_mfma_f32_16x16x32_bf16 v[244:247],v[44:47],a[8:11],v[244:247]
 v_mfma_f32_16x16x32_bf16 v[252:255],v[44:47],a[12:15],v[252:255]
 s_waitcnt vmcnt(12) lgkmcnt(14)
 ds_read_b64_tr_b16 v[44:45],v179 offset:20480
 ds_read_b64_tr_b16 v[46:47],v179 offset:22528
 v_mfma_f32_16x16x32_bf16 v[224:227],v[48:51],a[16:19],v[224:227]
 buffer_load_dwordx4 a[72:75],v0,s[12:15],s53 offen offset:2048 sc1
 v_mfma_f32_16x16x32_bf16 v[232:235],v[48:51],a[20:23],v[232:235]
 ds_read_b64_tr_b16 v[48:49],v176 offset:24576
 ds_read_b64_tr_b16 v[50:51],v176 offset:26624
 v_mfma_f32_16x16x32_bf16 v[228:231],v[52:55],a[16:19],v[228:231]
 v_mfma_f32_16x16x32_bf16 v[236:239],v[52:55],a[20:23],v[236:239]
 ds_read_b64_tr_b16 v[52:53],v177 offset:24576
 ds_read_b64_tr_b16 v[54:55],v177 offset:26624
 v_mfma_f32_16x16x32_bf16 v[240:243],v[56:59],a[16:19],v[240:243]
 buffer_load_dwordx4 a[76:79],v0,s[12:15],s53 offen offset:3072 sc1
 v_mfma_f32_16x16x32_bf16 v[248:251],v[56:59],a[20:23],v[248:251]
 s_add_u32 s53,s53,4096
 ds_read_b64_tr_b16 v[56:57],v178 offset:24576
 ds_read_b64_tr_b16 v[58:59],v178 offset:26624
 v_mfma_f32_16x16x32_bf16 v[244:247],v[60:63],a[16:19],v[244:247]
 v_mfma_f32_16x16x32_bf16 v[252:255],v[60:63],a[20:23],v[252:255]
 s_waitcnt vmcnt(12)
 ds_read_b64_tr_b16 v[60:61],v179 offset:24576
 ds_read_b64_tr_b16 v[62:63],v179 offset:26624
 v_mfma_f32_16x16x32_bf16 v[224:227],v[64:67],a[24:27],v[224:227]
 buffer_load_dwordx4 a[80:83],v0,s[12:15],s53 offen sc1
 v_mfma_f32_16x16x32_bf16 v[232:235],v[64:67],a[28:31],v[232:235]
 ds_read_b64_tr_b16 v[64:65],v176 offset:28672
 ds_read_b64_tr_b16 v[66:67],v176 offset:30720
 v_mfma_f32_16x16x32_bf16 v[228:231],v[68:71],a[24:27],v[228:231]
 v_mfma_f32_16x16x32_bf16 v[236:239],v[68:71],a[28:31],v[236:239]
 ds_read_b64_tr_b16 v[68:69],v177 offset:28672
 ds_read_b64_tr_b16 v[70:71],v177 offset:30720
 v_mfma_f32_16x16x32_bf16 v[240:243],v[72:75],a[24:27],v[240:243]
 buffer_load_dwordx4 a[84:87],v0,s[12:15],s53 offen offset:1024 sc1
 v_mfma_f32_16x16x32_bf16 v[248:251],v[72:75],a[28:31],v[248:251]
 ds_read_b64_tr_b16 v[72:73],v178 offset:28672
 ds_read_b64_tr_b16 v[74:75],v178 offset:30720
 v_mfma_f32_16x16x32_bf16 v[244:247],v[76:79],a[24:27],v[244:247]
 v_mfma_f32_16x16x32_bf16 v[252:255],v[76:79],a[28:31],v[252:255]
 s_waitcnt vmcnt(12) lgkmcnt(14)
 ds_read_b64_tr_b16 v[76:77],v179 offset:28672
 ds_read_b64_tr_b16 v[78:79],v179 offset:30720
 v_mfma_f32_16x16x32_bf16 v[224:227],v[16:19],a[32:35],v[224:227]
 buffer_load_dwordx4 a[88:91],v0,s[12:15],s53 offen offset:2048 sc1
 v_mfma_f32_16x16x32_bf16 v[232:235],v[16:19],a[36:39],v[232:235]
 ds_read_b64_tr_b16 v[16:17],v176 offset:32768
 ds_read_b64_tr_b16 v[18:19],v176 offset:34816
 v_mfma_f32_16x16x32_bf16 v[228:231],v[20:23],a[32:35],v[228:231]
 v_mfma_f32_16x16x32_bf16 v[236:239],v[20:23],a[36:39],v[236:239]
 ds_read_b64_tr_b16 v[20:21],v177 offset:32768
 ds_read_b64_tr_b16 v[22:23],v177 offset:34816
 v_mfma_f32_16x16x32_bf16 v[240:243],v[24:27],a[32:35],v[240:243]
 buffer_load_dwordx4 a[92:95],v0,s[12:15],s53 offen offset:3072 sc1
 v_mfma_f32_16x16x32_bf16 v[248:251],v[24:27],a[36:39],v[248:251]
 s_add_u32 s53,s53,4096
 ds_read_b64_tr_b16 v[24:25],v178 offset:32768
 ds_read_b64_tr_b16 v[26:27],v178 offset:34816
 v_mfma_f32_16x16x32_bf16 v[244:247],v[28:31],a[32:35],v[244:247]
 v_mfma_f32_16x16x32_bf16 v[252:255],v[28:31],a[36:39],v[252:255]
 s_waitcnt vmcnt(12)
 ds_read_b64_tr_b16 v[28:29],v179 offset:32768
 ds_read_b64_tr_b16 v[30:31],v179 offset:34816
 v_mfma_f32_16x16x32_bf16 v[224:227],v[32:35],a[40:43],v[224:227]
 buffer_load_dwordx4 a[96:99],v0,s[12:15],s53 offen sc1
 v_mfma_f32_16x16x32_bf16 v[232:235],v[32:35],a[44:47],v[232:235]
 ds_read_b64_tr_b16 v[32:33],v176 offset:36864
 ds_read_b64_tr_b16 v[34:35],v176 offset:38912
 v_mfma_f32_16x16x32_bf16 v[228:231],v[36:39],a[40:43],v[228:231]
 v_mfma_f32_16x16x32_bf16 v[236:239],v[36:39],a[44:47],v[236:239]
 ds_read_b64_tr_b16 v[36:37],v177 offset:36864
 ds_read_b64_tr_b16 v[38:39],v177 offset:38912
 v_mfma_f32_16x16x32_bf16 v[240:243],v[40:43],a[40:43],v[240:243]
 buffer_load_dwordx4 a[100:103],v0,s[12:15],s53 offen offset:1024 sc1
 v_mfma_f32_16x16x32_bf16 v[248:251],v[40:43],a[44:47],v[248:251]
 ds_read_b64_tr_b16 v[40:41],v178 offset:36864
 ds_read_b64_tr_b16 v[42:43],v178 offset:38912
 v_mfma_f32_16x16x32_bf16 v[244:247],v[44:47],a[40:43],v[244:247]
 v_mfma_f32_16x16x32_bf16 v[252:255],v[44:47],a[44:47],v[252:255]
 s_waitcnt vmcnt(12) lgkmcnt(14)
 ds_read_b64_tr_b16 v[44:45],v179 offset:36864
 ds_read_b64_tr_b16 v[46:47],v179 offset:38912
 v_mfma_f32_16x16x32_bf16 v[224:227],v[48:51],a[48:51],v[224:227]
 buffer_load_dwordx4 a[104:107],v0,s[12:15],s53 offen offset:2048 sc1
 v_mfma_f32_16x16x32_bf16 v[232:235],v[48:51],a[52:55],v[232:235]
 ds_read_b64_tr_b16 v[48:49],v176 offset:40960
 ds_read_b64_tr_b16 v[50:51],v176 offset:43008
 v_mfma_f32_16x16x32_bf16 v[228:231],v[52:55],a[48:51],v[228:231]
 v_mfma_f32_16x16x32_bf16 v[236:239],v[52:55],a[52:55],v[236:239]
 ds_read_b64_tr_b16 v[52:53],v177 offset:40960
 ds_read_b64_tr_b16 v[54:55],v177 offset:43008
 v_mfma_f32_16x16x32_bf16 v[240:243],v[56:59],a[48:51],v[240:243]
 buffer_load_dwordx4 a[108:111],v0,s[12:15],s53 offen offset:3072 sc1
 v_mfma_f32_16x16x32_bf16 v[248:251],v[56:59],a[52:55],v[248:251]
 s_add_u32 s53,s53,4096
 ds_read_b64_tr_b16 v[56:57],v178 offset:40960
 ds_read_b64_tr_b16 v[58:59],v178 offset:43008
 v_mfma_f32_16x16x32_bf16 v[244:247],v[60:63],a[48:51],v[244:247]
 v_mfma_f32_16x16x32_bf16 v[252:255],v[60:63],a[52:55],v[252:255]
 s_waitcnt vmcnt(12)
 ds_read_b64_tr_b16 v[60:61],v179 offset:40960
 ds_read_b64_tr_b16 v[62:63],v179 offset:43008
 v_mfma_f32_16x16x32_bf16 v[224:227],v[64:67],a[56:59],v[224:227]
 buffer_load_dwordx4 a[112:115],v0,s[12:15],s53 offen sc1
 v_mfma_f32_16x16x32_bf16 v[232:235],v[64:67],a[60:63],v[232:235]
 ds_read_b64_tr_b16 v[64:65],v176 offset:45056
 ds_read_b64_tr_b16 v[66:67],v176 offset:47104
 v_mfma_f32_16x16x32_bf16 v[228:231],v[68:71],a[56:59],v[228:231]
 v_mfma_f32_16x16x32_bf16 v[236:239],v[68:71],a[60:63],v[236:239]
 ds_read_b64_tr_b16 v[68:69],v177 offset:45056
 ds_read_b64_tr_b16 v[70:71],v177 offset:47104
 v_mfma_f32_16x16x32_bf16 v[240:243],v[72:75],a[56:59],v[240:243]
 buffer_load_dwordx4 a[116:119],v0,s[12:15],s53 offen offset:1024 sc1
 v_mfma_f32_16x16x32_bf16 v[248:251],v[72:75],a[60:63],v[248:251]
 ds_read_b64_tr_b16 v[72:73],v178 offset:45056
 ds_read_b64_tr_b16 v[74:75],v178 offset:47104
 v_mfma_f32_16x16x32_bf16 v[244:247],v[76:79],a[56:59],v[244:247]
 v_mfma_f32_16x16x32_bf16 v[252:255],v[76:79],a[60:63],v[252:255]
 s_waitcnt vmcnt(12) lgkmcnt(14)
 ds_read_b64_tr_b16 v[76:77],v179 offset:45056
 ds_read_b64_tr_b16 v[78:79],v179 offset:47104
 v_mfma_f32_16x16x32_bf16 v[224:227],v[16:19],a[64:67],v[224:227]
 buffer_load_dwordx4 a[120:123],v0,s[12:15],s53 offen offset:2048 sc1
 v_mfma_f32_16x16x32_bf16 v[232:235],v[16:19],a[68:71],v[232:235]
 ds_read_b64_tr_b16 v[16:17],v176 offset:49152
 ds_read_b64_tr_b16 v[18:19],v176 offset:51200
 v_mfma_f32_16x16x32_bf16 v[228:231],v[20:23],a[64:67],v[228:231]
 v_mfma_f32_16x16x32_bf16 v[236:239],v[20:23],a[68:71],v[236:239]
 ds_read_b64_tr_b16 v[20:21],v177 offset:49152
 ds_read_b64_tr_b16 v[22:23],v177 offset:51200
 v_mfma_f32_16x16x32_bf16 v[240:243],v[24:27],a[64:67],v[240:243]
 buffer_load_dwordx4 a[124:127],v0,s[12:15],s53 offen offset:3072 sc1
 v_mfma_f32_16x16x32_bf16 v[248:251],v[24:27],a[68:71],v[248:251]
 s_add_u32 s53,s53,4096
 ds_read_b64_tr_b16 v[24:25],v178 offset:49152
 ds_read_b64_tr_b16 v[26:27],v178 offset:51200
 v_mfma_f32_16x16x32_bf16 v[244:247],v[28:31],a[64:67],v[244:247]
 v_mfma_f32_16x16x32_bf16 v[252:255],v[28:31],a[68:71],v[252:255]
 s_waitcnt vmcnt(12)
 ds_read_b64_tr_b16 v[28:29],v179 offset:49152
 ds_read_b64_tr_b16 v[30:31],v179 offset:51200
 v_mfma_f32_16x16x32_bf16 v[224:227],v[32:35],a[72:75],v[224:227]
 buffer_load_dwordx4 a[128:131],v0,s[12:15],s53 offen sc1
 v_mfma_f32_16x16x32_bf16 v[232:235],v[32:35],a[76:79],v[232:235]
 ds_read_b64_tr_b16 v[32:33],v176 offset:53248
 ds_read_b64_tr_b16 v[34:35],v176 offset:55296
 v_mfma_f32_16x16x32_bf16 v[228:231],v[36:39],a[72:75],v[228:231]
 v_mfma_f32_16x16x32_bf16 v[236:239],v[36:39],a[76:79],v[236:239]
 ds_read_b64_tr_b16 v[36:37],v177 offset:53248
 ds_read_b64_tr_b16 v[38:39],v177 offset:55296
 v_mfma_f32_16x16x32_bf16 v[240:243],v[40:43],a[72:75],v[240:243]
 buffer_load_dwordx4 a[132:135],v0,s[12:15],s53 offen offset:1024 sc1
 v_mfma_f32_16x16x32_bf16 v[248:251],v[40:43],a[76:79],v[248:251]
 ds_read_b64_tr_b16 v[40:41],v178 offset:53248
 ds_read_b64_tr_b16 v[42:43],v178 offset:55296
 v_mfma_f32_16x16x32_bf16 v[244:247],v[44:47],a[72:75],v[244:247]
 v_mfma_f32_16x16x32_bf16 v[252:255],v[44:47],a[76:79],v[252:255]
 s_waitcnt vmcnt(12) lgkmcnt(14)
 ds_read_b64_tr_b16 v[44:45],v179 offset:53248
 ds_read_b64_tr_b16 v[46:47],v179 offset:55296
 v_mfma_f32_16x16x32_bf16 v[224:227],v[48:51],a[80:83],v[224:227]
 buffer_load_dwordx4 a[136:139],v0,s[12:15],s53 offen offset:2048 sc1
 v_mfma_f32_16x16x32_bf16 v[232:235],v[48:51],a[84:87],v[232:235]
 ds_read_b64_tr_b16 v[48:49],v176 offset:57344
 ds_read_b64_tr_b16 v[50:51],v176 offset:59392
 v_mfma_f32_16x16x32_bf16 v[228:231],v[52:55],a[80:83],v[228:231]
 v_mfma_f32_16x16x32_bf16 v[236:239],v[52:55],a[84:87],v[236:239]
 ds_read_b64_tr_b16 v[52:53],v177 offset:57344
 ds_read_b64_tr_b16 v[54:55],v177 offset:59392
 v_mfma_f32_16x16x32_bf16 v[240:243],v[56:59],a[80:83],v[240:243]
 buffer_load_dwordx4 a[140:143],v0,s[12:15],s53 offen offset:3072 sc1
 v_mfma_f32_16x16x32_bf16 v[248:251],v[56:59],a[84:87],v[248:251]
 s_add_u32 s53,s53,4096
 ds_read_b64_tr_b16 v[56:57],v178 offset:57344
 ds_read_b64_tr_b16 v[58:59],v178 offset:59392
 v_mfma_f32_16x16x32_bf16 v[244:247],v[60:63],a[80:83],v[244:247]
 v_mfma_f32_16x16x32_bf16 v[252:255],v[60:63],a[84:87],v[252:255]
 s_waitcnt vmcnt(12)
 ds_read_b64_tr_b16 v[60:61],v179 offset:57344
 ds_read_b64_tr_b16 v[62:63],v179 offset:59392
 v_mfma_f32_16x16x32_bf16 v[224:227],v[64:67],a[88:91],v[224:227]
 buffer_load_dwordx4 a[144:147],v0,s[12:15],s53 offen sc1
 v_mfma_f32_16x16x32_bf16 v[232:235],v[64:67],a[92:95],v[232:235]
 ds_read_b64_tr_b16 v[64:65],v176 offset:61440
 ds_read_b64_tr_b16 v[66:67],v176 offset:63488
 v_mfma_f32_16x16x32_bf16 v[228:231],v[68:71],a[88:91],v[228:231]
 v_mfma_f32_16x16x32_bf16 v[236:239],v[68:71],a[92:95],v[236:239]
 ds_read_b64_tr_b16 v[68:69],v177 offset:61440
 ds_read_b64_tr_b16 v[70:71],v177 offset:63488
 v_mfma_f32_16x16x32_bf16 v[240:243],v[72:75],a[88:91],v[240:243]
 buffer_load_dwordx4 a[148:151],v0,s[12:15],s53 offen offset:1024 sc1
 v_mfma_f32_16x16x32_bf16 v[248:251],v[72:75],a[92:95],v[248:251]
 ds_read_b64_tr_b16 v[72:73],v178 offset:61440
 ds_read_b64_tr_b16 v[74:75],v178 offset:63488
 v_mfma_f32_16x16x32_bf16 v[244:247],v[76:79],a[88:91],v[244:247]
 v_mfma_f32_16x16x32_bf16 v[252:255],v[76:79],a[92:95],v[252:255]
 s_waitcnt vmcnt(12) lgkmcnt(14)
 ds_read_b64_tr_b16 v[76:77],v179 offset:61440
 ds_read_b64_tr_b16 v[78:79],v179 offset:63488
 v_mfma_f32_16x16x32_bf16 v[224:227],v[16:19],a[96:99],v[224:227]
 buffer_load_dwordx4 a[152:155],v0,s[12:15],s53 offen offset:2048 sc1
 v_mfma_f32_16x16x32_bf16 v[232:235],v[16:19],a[100:103],v[232:235]
 ds_read_b64_tr_b16 v[16:17],v180
 ds_read_b64_tr_b16 v[18:19],v180 offset:2048
 v_mfma_f32_16x16x32_bf16 v[228:231],v[20:23],a[96:99],v[228:231]
 v_mfma_f32_16x16x32_bf16 v[236:239],v[20:23],a[100:103],v[236:239]
 ds_read_b64_tr_b16 v[20:21],v181
 ds_read_b64_tr_b16 v[22:23],v181 offset:2048
 v_mfma_f32_16x16x32_bf16 v[240:243],v[24:27],a[96:99],v[240:243]
 buffer_load_dwordx4 a[156:159],v0,s[12:15],s53 offen offset:3072 sc1
 v_mfma_f32_16x16x32_bf16 v[248:251],v[24:27],a[100:103],v[248:251]
 s_add_u32 s53,s53,4096
 ds_read_b64_tr_b16 v[24:25],v182
 ds_read_b64_tr_b16 v[26:27],v182 offset:2048
 v_mfma_f32_16x16x32_bf16 v[244:247],v[28:31],a[96:99],v[244:247]
 v_mfma_f32_16x16x32_bf16 v[252:255],v[28:31],a[100:103],v[252:255]
 s_waitcnt vmcnt(12)
 ds_read_b64_tr_b16 v[28:29],v183
 ds_read_b64_tr_b16 v[30:31],v183 offset:2048
 v_mfma_f32_16x16x32_bf16 v[224:227],v[32:35],a[104:107],v[224:227]
 buffer_load_dwordx4 a[160:163],v0,s[12:15],s53 offen sc1
 v_mfma_f32_16x16x32_bf16 v[232:235],v[32:35],a[108:111],v[232:235]
 ds_read_b64_tr_b16 v[32:33],v180 offset:4096
 ds_read_b64_tr_b16 v[34:35],v180 offset:6144
 v_mfma_f32_16x16x32_bf16 v[228:231],v[36:39],a[104:107],v[228:231]
 v_mfma_f32_16x16x32_bf16 v[236:239],v[36:39],a[108:111],v[236:239]
 ds_read_b64_tr_b16 v[36:37],v181 offset:4096
 ds_read_b64_tr_b16 v[38:39],v181 offset:6144
 v_mfma_f32_16x16x32_bf16 v[240:243],v[40:43],a[104:107],v[240:243]
 buffer_load_dwordx4 a[164:167],v0,s[12:15],s53 offen offset:1024 sc1
 v_mfma_f32_16x16x32_bf16 v[248:251],v[40:43],a[108:111],v[248:251]
 ds_read_b64_tr_b16 v[40:41],v182 offset:4096
 ds_read_b64_tr_b16 v[42:43],v182 offset:6144
 v_mfma_f32_16x16x32_bf16 v[244:247],v[44:47],a[104:107],v[244:247]
 v_mfma_f32_16x16x32_bf16 v[252:255],v[44:47],a[108:111],v[252:255]
 s_waitcnt vmcnt(12) lgkmcnt(14)
 ds_read_b64_tr_b16 v[44:45],v183 offset:4096
 ds_read_b64_tr_b16 v[46:47],v183 offset:6144
 v_mfma_f32_16x16x32_bf16 v[224:227],v[48:51],a[112:115],v[224:227]
 buffer_load_dwordx4 a[168:171],v0,s[12:15],s53 offen offset:2048 sc1
 v_mfma_f32_16x16x32_bf16 v[232:235],v[48:51],a[116:119],v[232:235]
 ds_read_b64_tr_b16 v[48:49],v180 offset:8192
 ds_read_b64_tr_b16 v[50:51],v180 offset:10240
 v_mfma_f32_16x16x32_bf16 v[228:231],v[52:55],a[112:115],v[228:231]
 v_mfma_f32_16x16x32_bf16 v[236:239],v[52:55],a[116:119],v[236:239]
 ds_read_b64_tr_b16 v[52:53],v181 offset:8192
 ds_read_b64_tr_b16 v[54:55],v181 offset:10240
 v_mfma_f32_16x16x32_bf16 v[240:243],v[56:59],a[112:115],v[240:243]
 buffer_load_dwordx4 a[172:175],v0,s[12:15],s53 offen offset:3072 sc1
 v_mfma_f32_16x16x32_bf16 v[248:251],v[56:59],a[116:119],v[248:251]
 s_add_u32 s53,s53,4096
 ds_read_b64_tr_b16 v[56:57],v182 offset:8192
 ds_read_b64_tr_b16 v[58:59],v182 offset:10240
 v_mfma_f32_16x16x32_bf16 v[244:247],v[60:63],a[112:115],v[244:247]
 v_mfma_f32_16x16x32_bf16 v[252:255],v[60:63],a[116:119],v[252:255]
 s_waitcnt vmcnt(12)
 ds_read_b64_tr_b16 v[60:61],v183 offset:8192
 ds_read_b64_tr_b16 v[62:63],v183 offset:10240
 v_mfma_f32_16x16x32_bf16 v[224:227],v[64:67],a[120:123],v[224:227]
 buffer_load_dwordx4 a[176:179],v0,s[12:15],s53 offen sc1
 v_mfma_f32_16x16x32_bf16 v[232:235],v[64:67],a[124:127],v[232:235]
 ds_read_b64_tr_b16 v[64:65],v180 offset:12288
 ds_read_b64_tr_b16 v[66:67],v180 offset:14336
 v_mfma_f32_16x16x32_bf16 v[228:231],v[68:71],a[120:123],v[228:231]
 v_mfma_f32_16x16x32_bf16 v[236:239],v[68:71],a[124:127],v[236:239]
 ds_read_b64_tr_b16 v[68:69],v181 offset:12288
 ds_read_b64_tr_b16 v[70:71],v181 offset:14336
 v_mfma_f32_16x16x32_bf16 v[240:243],v[72:75],a[120:123],v[240:243]
 buffer_load_dwordx4 a[180:183],v0,s[12:15],s53 offen offset:1024 sc1
 v_mfma_f32_16x16x32_bf16 v[248:251],v[72:75],a[124:127],v[248:251]
 ds_read_b64_tr_b16 v[72:73],v182 offset:12288
 ds_read_b64_tr_b16 v[74:75],v182 offset:14336
 v_mfma_f32_16x16x32_bf16 v[244:247],v[76:79],a[120:123],v[244:247]
 v_mfma_f32_16x16x32_bf16 v[252:255],v[76:79],a[124:127],v[252:255]
 s_waitcnt vmcnt(12) lgkmcnt(14)
 ds_read_b64_tr_b16 v[76:77],v183 offset:12288
 ds_read_b64_tr_b16 v[78:79],v183 offset:14336
 v_mfma_f32_16x16x32_bf16 v[224:227],v[16:19],a[128:131],v[224:227]
 buffer_load_dwordx4 a[184:187],v0,s[12:15],s53 offen offset:2048 sc1
 v_mfma_f32_16x16x32_bf16 v[232:235],v[16:19],a[132:135],v[232:235]
 ds_read_b64_tr_b16 v[16:17],v180 offset:16384
 ds_read_b64_tr_b16 v[18:19],v180 offset:18432
 v_mfma_f32_16x16x32_bf16 v[228:231],v[20:23],a[128:131],v[228:231]
 v_mfma_f32_16x16x32_bf16 v[236:239],v[20:23],a[132:135],v[236:239]
 ds_read_b64_tr_b16 v[20:21],v181 offset:16384
 ds_read_b64_tr_b16 v[22:23],v181 offset:18432
 v_mfma_f32_16x16x32_bf16 v[240:243],v[24:27],a[128:131],v[240:243]
 buffer_load_dwordx4 a[188:191],v0,s[12:15],s53 offen offset:3072 sc1
 v_mfma_f32_16x16x32_bf16 v[248:251],v[24:27],a[132:135],v[248:251]
 s_add_u32 s53,s53,4096
 ds_read_b64_tr_b16 v[24:25],v182 offset:16384
 ds_read_b64_tr_b16 v[26:27],v182 offset:18432
 v_mfma_f32_16x16x32_bf16 v[244:247],v[28:31],a[128:131],v[244:247]
 v_mfma_f32_16x16x32_bf16 v[252:255],v[28:31],a[132:135],v[252:255]
 s_waitcnt vmcnt(12)
 ds_read_b64_tr_b16 v[28:29],v183 offset:16384
 ds_read_b64_tr_b16 v[30:31],v183 offset:18432
 v_mfma_f32_16x16x32_bf16 v[224:227],v[32:35],a[136:139],v[224:227]
 buffer_load_dwordx4 a[192:195],v0,s[12:15],s53 offen sc1
 v_mfma_f32_16x16x32_bf16 v[232:235],v[32:35],a[140:143],v[232:235]
 ds_read_b64_tr_b16 v[32:33],v180 offset:20480
 ds_read_b64_tr_b16 v[34:35],v180 offset:22528
 v_mfma_f32_16x16x32_bf16 v[228:231],v[36:39],a[136:139],v[228:231]
 v_mfma_f32_16x16x32_bf16 v[236:239],v[36:39],a[140:143],v[236:239]
 ds_read_b64_tr_b16 v[36:37],v181 offset:20480
 ds_read_b64_tr_b16 v[38:39],v181 offset:22528
 v_mfma_f32_16x16x32_bf16 v[240:243],v[40:43],a[136:139],v[240:243]
 buffer_load_dwordx4 a[196:199],v0,s[12:15],s53 offen offset:1024 sc1
 v_mfma_f32_16x16x32_bf16 v[248:251],v[40:43],a[140:143],v[248:251]
 ds_read_b64_tr_b16 v[40:41],v182 offset:20480
 ds_read_b64_tr_b16 v[42:43],v182 offset:22528
 v_mfma_f32_16x16x32_bf16 v[244:247],v[44:47],a[136:139],v[244:247]
 v_mfma_f32_16x16x32_bf16 v[252:255],v[44:47],a[140:143],v[252:255]
 s_waitcnt vmcnt(12) lgkmcnt(14)
 ds_read_b64_tr_b16 v[44:45],v183 offset:20480
 ds_read_b64_tr_b16 v[46:47],v183 offset:22528
 v_mfma_f32_16x16x32_bf16 v[224:227],v[48:51],a[144:147],v[224:227]
 buffer_load_dwordx4 a[200:203],v0,s[12:15],s53 offen offset:2048 sc1
 v_mfma_f32_16x16x32_bf16 v[232:235],v[48:51],a[148:151],v[232:235]
 ds_read_b64_tr_b16 v[48:49],v180 offset:24576
 ds_read_b64_tr_b16 v[50:51],v180 offset:26624
 v_mfma_f32_16x16x32_bf16 v[228:231],v[52:55],a[144:147],v[228:231]
 v_mfma_f32_16x16x32_bf16 v[236:239],v[52:55],a[148:151],v[236:239]
 ds_read_b64_tr_b16 v[52:53],v181 offset:24576
 ds_read_b64_tr_b16 v[54:55],v181 offset:26624
 v_mfma_f32_16x16x32_bf16 v[240:243],v[56:59],a[144:147],v[240:243]
 buffer_load_dwordx4 a[204:207],v0,s[12:15],s53 offen offset:3072 sc1
 v_mfma_f32_16x16x32_bf16 v[248:251],v[56:59],a[148:151],v[248:251]
 s_add_u32 s53,s53,4096
 ds_read_b64_tr_b16 v[56:57],v182 offset:24576
 ds_read_b64_tr_b16 v[58:59],v182 offset:26624
 v_mfma_f32_16x16x32_bf16 v[244:247],v[60:63],a[144:147],v[244:247]
 s_branch .Lsk9
.Lvs2_0:
 s_branch .Lst13
.Lsk9:
 v_mfma_f32_16x16x32_bf16 v[252:255],v[60:63],a[148:151],v[252:255]
 s_waitcnt vmcnt(12)
 ds_read_b64_tr_b16 v[60:61],v183 offset:24576
 ds_read_b64_tr_b16 v[62:63],v183 offset:26624
 v_mfma_f32_16x16x32_bf16 v[224:227],v[64:67],a[152:155],v[224:227]
 buffer_load_dwordx4 a[208:211],v0,s[12:15],s53 offen sc1
 v_mfma_f32_16x16x32_bf16 v[232:235],v[64:67],a[156:159],v[232:235]
 ds_read_b64_tr_b16 v[64:65],v180 offset:28672
 ds_read_b64_tr_b16 v[66:67],v180 offset:30720
 v_mfma_f32_16x16x32_bf16 v[228:231],v[68:71],a[152:155],v[228:231]
 v_mfma_f32_16x16x32_bf16 v[236:239],v[68:71],a[156:159],v[236:239]
 ds_read_b64_tr_b16 v[68:69],v181 offset:28672
 ds_read_b64_tr_b16 v[70:71],v181 offset:30720
 v_mfma_f32_16x16x32_bf16 v[240:243],v[72:75],a[152:155],v[240:243]
 buffer_load_dwordx4 a[212:215],v0,s[12:15],s53 offen offset:1024 sc1
 v_mfma_f32_16x16x32_bf16 v[248:251],v[72:75],a[156:159],v[248:251]
 ds_read_b64_tr_b16 v[72:73],v182 offset:28672
 ds_read_b64_tr_b16 v[74:75],v182 offset:30720
 v_mfma_f32_16x16x32_bf16 v[244:247],v[76:79],a[152:155],v[244:247]
 v_mfma_f32_16x16x32_bf16 v[252:255],v[76:79],a[156:159],v[252:255]
 s_waitcnt vmcnt(12) lgkmcnt(14)
 ds_read_b64_tr_b16 v[76:77],v183 offset:28672
 ds_read_b64_tr_b16 v[78:79],v183 offset:30720
 v_mfma_f32_16x16x32_bf16 v[224:227],v[16:19],a[160:163],v[224:227]
 buffer_load_dwordx4 a[216:219],v0,s[12:15],s53 offen offset:2048 sc1
 v_mfma_f32_16x16x32_bf16 v[232:235],v[16:19],a[164:167],v[232:235]
 v_mfma_f32_16x16x32_bf16 v[228:231],v[20:23],a[160:163],v[228:231]
 v_mfma_f32_16x16x32_bf16 v[236:239],v[20:23],a[164:167],v[236:239]
 v_mfma_f32_16x16x32_bf16 v[240:243],v[24:27],a[160:163],v[240:243]
 buffer_load_dwordx4 a[220:223],v0,s[12:15],s53 offen offset:3072 sc1
 v_mfma_f32_16x16x32_bf16 v[248:251],v[24:27],a[164:167],v[248:251]
 s_add_u32 s53,s53,4096
 v_mfma_f32_16x16x32_bf16 v[244:247],v[28:31],a[160:163],v[244:247]
 v_mfma_f32_16x16x32_bf16 v[252:255],v[28:31],a[164:167],v[252:255]
 s_waitcnt lgkmcnt(0) vmcnt(12)
 s_barrier
 ds_read_b64_tr_b16 v[16:17],v180 offset:32768
 v_mfma_f32_16x16x32_bf16 v[224:227],v[32:35],a[168:171],v[224:227]
 buffer_load_dwordx4 a[224:227],v0,s[12:15],s53 offen sc1
 v_mfma_f32_16x16x32_bf16 v[232:235],v[32:35],a[172:175],v[232:235]
 ds_read_b64_tr_b16 v[18:19],v180 offset:34816
 ds_read_b64_tr_b16 v[20:21],v181 offset:32768
 v_mfma_f32_16x16x32_bf16 v[228:231],v[36:39],a[168:171],v[228:231]
 ds_read_b64_tr_b16 v[22:23],v181 offset:34816
 ds_read_b64_tr_b16 v[24:25],v182 offset:32768
 v_mfma_f32_16x16x32_bf16 v[236:239],v[36:39],a[172:175],v[236:239]
 ds_read_b64_tr_b16 v[26:27],v182 offset:34816
 ds_read_b64_tr_b16 v[28:29],v183 offset:32768
 v_mfma_f32_16x16x32_bf16 v[240:243],v[40:43],a[168:171],v[240:243]
 buffer_load_dwordx4 a[228:231],v0,s[12:15],s53 offen offset:1024 sc1
 v_mfma_f32_16x16x32_bf16 v[248:251],v[40:43],a[172:175],v[248:251]
 ds_read_b64_tr_b16 v[30:31],v183 offset:34816
 ds_read_b64_tr_b16 v[32:33],v180 offset:36864
 v_mfma_f32_16x16x32_bf16 v[244:247],v[44:47],a[168:171],v[244:247]
 ds_read_b64_tr_b16 v[34:35],v180 offset:38912
 ds_read_b64_tr_b16 v[36:37],v181 offset:36864
 v_mfma_f32_16x16x32_bf16 v[252:255],v[44:47],a[172:175],v[252:255]
 s_waitcnt vmcnt(12)
 ds_read_b64_tr_b16 v[38:39],v181 offset:38912
 ds_read_b64_tr_b16 v[40:41],v182 offset:36864
 v_mfma_f32_16x16x32_bf16 v[224:227],v[48:51],a[176:179],v[224:227]
 buffer_load_dwordx4 a[232:235],v0,s[12:15],s53 offen offset:2048 sc1
 v_mfma_f32_16x16x32_bf16 v[232:235],v[48:51],a[180:183],v[232:235]
 ds_read_b64_tr_b16 v[42:43],v182 offset:38912
 ds_read_b64_tr_b16 v[44:45],v183 offset:36864
 v_mfma_f32_16x16x32_bf16 v[228:231],v[52:55],a[176:179],v[228:231]
 ds_read_b64_tr_b16 v[46:47],v183 offset:38912
 ds_read_b64_tr_b16 v[48:49],v180 offset:40960
 v_mfma_f32_16x16x32_bf16 v[236:239],v[52:55],a[180:183],v[236:239]
 ds_read_b64_tr_b16 v[50:51],v180 offset:43008
 ds_read_b64_tr_b16 v[52:53],v181 offset:40960
 v_mfma_f32_16x16x32_bf16 v[240:243],v[56:59],a[176:179],v[240:243]
 buffer_load_dwordx4 a[236:239],v0,s[12:15],s53 offen offset:3072 sc1
 v_mfma_f32_16x16x32_bf16 v[248:251],v[56:59],a[180:183],v[248:251]
 s_add_u32 s53,s53,4096
 ds_read_b64_tr_b16 v[54:55],v181 offset:43008
 ds_read_b64_tr_b16 v[56:57],v182 offset:40960
 v_mfma_f32_16x16x32_bf16 v[244:247],v[60:63],a[176:179],v[244:247]
 ds_read_b64_tr_b16 v[58:59],v182 offset:43008
 v_mfma_f32_16x16x32_bf16 v[252:255],v[60:63],a[180:183],v[252:255]
 s_waitcnt vmcnt(12)
 ds_read_b64_tr_b16 v[60:61],v183 offset:40960
 ds_read_b64_tr_b16 v[62:63],v183 offset:43008
 v_mfma_f32_16x16x32_bf16 v[224:227],v[64:67],a[184:187],v[224:227]
 buffer_load_dwordx4 a[240:243],v0,s[12:15],s53 offen sc1
 v_mfma_f32_16x16x32_bf16 v[232:235],v[64:67],a[188:191],v[232:235]
 ds_read_b64_tr_b16 v[64:65],v180 offset:45056
 ds_read_b64_tr_b16 v[66:67],v180 offset:47104
 v_mfma_f32_16x16x32_bf16 v[228:231],v[68:71],a[184:187],v[228:231]
 v_mfma_f32_16x16x32_bf16 v[236:239],v[68:71],a[188:191],v[236:239]
 ds_read_b64_tr_b16 v[68:69],v181 offset:45056
 ds_read_b64_tr_b16 v[70:71],v181 offset:47104
 v_mfma_f32_16x16x32_bf16 v[240:243],v[72:75],a[184:187],v[240:243]
 buffer_load_dwordx4 a[244:247],v0,s[12:15],s53 offen offset:1024 sc1
 v_mfma_f32_16x16x32_bf16 v[248:251],v[72:75],a[188:191],v[248:251]
 ds_read_b64_tr_b16 v[72:73],v182 offset:45056
 ds_read_b64_tr_b16 v[74:75],v182 offset:47104
 v_mfma_f32_16x16x32_bf16 v[244:247],v[76:79],a[184:187],v[244:247]
 v_mfma_f32_16x16x32_bf16 v[252:255],v[76:79],a[188:191],v[252:255]
 s_waitcnt vmcnt(12) lgkmcnt(14)
 ds_read_b64_tr_b16 v[76:77],v183 offset:45056
 ds_read_b64_tr_b16 v[78:79],v183 offset:47104
 v_mfma_f32_16x16x32_bf16 v[224:227],v[16:19],a[192:195],v[224:227]
 buffer_load_dwordx4 a[248:251],v0,s[12:15],s53 offen offset:2048 sc1
 v_mfma_f32_16x16x32_bf16 v[232:235],v[16:19],a[196:199],v[232:235]
 ds_read_b64_tr_b16 v[16:17],v180 offset:49152
 ds_read_b64_tr_b16 v[18:19],v180 offset:51200
 v_mfma_f32_16x16x32_bf16 v[228:231],v[20:23],a[192:195],v[228:231]
 v_mfma_f32_16x16x32_bf16 v[236:239],v[20:23],a[196:199],v[236:239]
 ds_read_b64_tr_b16 v[20:21],v181 offset:49152
 ds_read_b64_tr_b16 v[22:23],v181 offset:51200
 v_mfma_f32_16x16x32_bf16 v[240:243],v[24:27],a[192:195],v[240:243]
 buffer_load_dwordx4 a[252:255],v0,s[12:15],s53 offen offset:3072 sc1
 v_mfma_f32_16x16x32_bf16 v[248:251],v[24:27],a[196:199],v[248:251]
 s_add_u32 s53,s53,4096
 ds_read_b64_tr_b16 v[24:25],v182 offset:49152
 ds_read_b64_tr_b16 v[26:27],v182 offset:51200
 v_mfma_f32_16x16x32_bf16 v[244:247],v[28:31],a[192:195],v[244:247]
 v_mfma_f32_16x16x32_bf16 v[252:255],v[28:31],a[196:199],v[252:255]
 s_waitcnt vmcnt(12)
 ds_read_b64_tr_b16 v[28:29],v183 offset:49152
 ds_read_b64_tr_b16 v[30:31],v183 offset:51200
 v_mfma_f32_16x16x32_bf16 v[224:227],v[32:35],a[200:203],v[224:227]
 buffer_load_dwordx4 v0,s[12:15],s50 offen sc1 lds
 v_mfma_f32_16x16x32_bf16 v[232:235],v[32:35],a[204:207],v[232:235]
 ds_read_b64_tr_b16 v[32:33],v180 offset:53248
 ds_read_b64_tr_b16 v[34:35],v180 offset:55296
 v_mfma_f32_16x16x32_bf16 v[228:231],v[36:39],a[200:203],v[228:231]
 v_mfma_f32_16x16x32_bf16 v[236:239],v[36:39],a[204:207],v[236:239]
 ds_read_b64_tr_b16 v[36:37],v181 offset:53248
 ds_read_b64_tr_b16 v[38:39],v181 offset:55296
 v_mfma_f32_16x16x32_bf16 v[240:243],v[40:43],a[200:203],v[240:243]
 buffer_load_dwordx4 v0,s[12:15],s50 offen offset:1024 sc1 lds
 v_mfma_f32_16x16x32_bf16 v[248:251],v[40:43],a[204:207],v[248:251]
 ds_read_b64_tr_b16 v[40:41],v182 offset:53248
 ds_read_b64_tr_b16 v[42:43],v182 offset:55296
 v_mfma_f32_16x16x32_bf16 v[244:247],v[44:47],a[200:203],v[244:247]
 v_mfma_f32_16x16x32_bf16 v[252:255],v[44:47],a[204:207],v[252:255]
 s_waitcnt vmcnt(12) lgkmcnt(14)
 ds_read_b64_tr_b16 v[44:45],v183 offset:53248
 ds_read_b64_tr_b16 v[46:47],v183 offset:55296
 v_mfma_f32_16x16x32_bf16 v[224:227],v[48:51],a[208:211],v[224:227]
 buffer_load_dwordx4 v0,s[12:15],s50 offen offset:2048 sc1 lds
 v_mfma_f32_16x16x32_bf16 v[232:235],v[48:51],a[212:215],v[232:235]
 ds_read_b64_tr_b16 v[48:49],v180 offset:57344
 ds_read_b64_tr_b16 v[50:51],v180 offset:59392
 v_mfma_f32_16x16x32_bf16 v[228:231],v[52:55],a[208:211],v[228:231]
 v_mfma_f32_16x16x32_bf16 v[236:239],v[52:55],a[212:215],v[236:239]
 ds_read_b64_tr_b16 v[52:53],v181 offset:57344
 ds_read_b64_tr_b16 v[54:55],v181 offset:59392
 v_mfma_f32_16x16x32_bf16 v[240:243],v[56:59],a[208:211],v[240:243]
 buffer_load_dwordx4 v0,s[12:15],s50 offen offset:3072 sc1 lds
 v_mfma_f32_16x16x32_bf16 v[248:251],v[56:59],a[212:215],v[248:251]
 s_add_u32 s50,s50,4096
 s_add_u32 m0,s54,4096
 ds_read_b64_tr_b16 v[56:57],v182 offset:57344
 v_mfma_f32_16x16x32_bf16 v[244:247],v[60:63],a[208:211],v[244:247]
 ds_read_b64_tr_b16 v[58:59],v182 offset:59392
 v_mfma_f32_16x16x32_bf16 v[252:255],v[60:63],a[212:215],v[252:255]
 s_waitcnt vmcnt(12)
 ds_read_b64_tr_b16 v[60:61],v183 offset:57344
 ds_read_b64_tr_b16 v[62:63],v183 offset:59392
 v_mfma_f32_16x16x32_bf16 v[224:227],v[64:67],a[216:219],v[224:227]
 buffer_load_dwordx4 v0,s[12:15],s50 offen sc1 lds
 v_mfma_f32_16x16x32_bf16 v[232:235],v[64:67],a[220:223],v[232:235]
 ds_read_b64_tr_b16 v[64:65],v180 offset:61440
 ds_read_b64_tr_b16 v[66:67],v180 offset:63488
 v_mfma_f32_16x16x32_bf16 v[228:231],v[68:71],a[216:219],v[228:231]
 v_mfma_f32_16x16x32_bf16 v[236:239],v[68:71],a[220:223],v[236:239]
 ds_read_b64_tr_b16 v[68:69],v181 offset:61440
 ds_read_b64_tr_b16 v[70:71],v181 offset:63488
 v_mfma_f32_16x16x32_bf16 v[240:243],v[72:75],a[216:219],v[240:243]
 buffer_load_dwordx4 v0,s[12:15],s50 offen offset:1024 sc1 lds
 v_mfma_f32_16x16x32_bf16 v[248:251],v[72:75],a[220:223],v[248:251]
 ds_read_b64_tr_b16 v[72:73],v182 offset:61440
 ds_read_b64_tr_b16 v[74:75],v182 offset:63488
 v_mfma_f32_16x16x32_bf16 v[244:247],v[76:79],a[216:219],v[244:247]
 v_mfma_f32_16x16x32_bf16 v[252:255],v[76:79],a[220:223],v[252:255]
 s_waitcnt vmcnt(12) lgkmcnt(14)
 ds_read_b64_tr_b16 v[76:77],v183 offset:61440
 ds_read_b64_tr_b16 v[78:79],v183 offset:63488
 v_mfma_f32_16x16x32_bf16 v[224:227],v[16:19],a[224:227],v[224:227]
 buffer_load_dwordx4 v0,s[12:15],s50 offen offset:2048 sc1 lds
 v_mfma_f32_16x16x32_bf16 v[232:235],v[16:19],a[228:231],v[232:235]
 s_add_u32 s50,s50,24576
 v_mfma_f32_16x16x32_bf16 v[228:231],v[20:23],a[224:227],v[228:231]
 v_mfma_f32_16x16x32_bf16 v[236:239],v[20:23],a[228:231],v[236:239]
 v_mfma_f32_16x16x32_bf16 v[240:243],v[24:27],a[224:227],v[240:243]
 v_mfma_f32_16x16x32_bf16 v[248:251],v[24:27],a[228:231],v[248:251]
 v_mfma_f32_16x16x32_bf16 v[244:247],v[28:31],a[224:227],v[244:247]
 v_mfma_f32_16x16x32_bf16 v[252:255],v[28:31],a[228:231],v[252:255]
 s_waitcnt lgkmcnt(0) vmcnt(11)
 s_barrier
 v_mfma_f32_16x16x32_bf16 v[224:227],v[32:35],a[232:235],v[224:227]
 v_mfma_f32_16x16x32_bf16 v[232:235],v[32:35],a[236:239],v[232:235]
 v_mfma_f32_16x16x32_bf16 v[228:231],v[36:39],a[232:235],v[228:231]
 v_mfma_f32_16x16x32_bf16 v[236:239],v[36:39],a[236:239],v[236:239]
 v_mfma_f32_16x16x32_bf16 v[240:243],v[40:43],a[232:235],v[240:243]
 v_mfma_f32_16x16x32_bf16 v[248:251],v[40:43],a[236:239],v[248:251]
 v_mfma_f32_16x16x32_bf16 v[244:247],v[44:47],a[232:235],v[244:247]
 v_mfma_f32_16x16x32_bf16 v[252:255],v[44:47],a[236:239],v[252:255]
 s_waitcnt vmcnt(9)
 v_mfma_f32_16x16x32_bf16 v[224:227],v[48:51],a[240:243],v[224:227]
 v_mfma_f32_16x16x32_bf16 v[232:235],v[48:51],a[244:247],v[232:235]
 v_mfma_f32_16x16x32_bf16 v[228:231],v[52:55],a[240:243],v[228:231]
 v_mfma_f32_16x16x32_bf16 v[236:239],v[52:55],a[244:247],v[236:239]
 v_mfma_f32_16x16x32_bf16 v[240:243],v[56:59],a[240:243],v[240:243]
 v_mfma_f32_16x16x32_bf16 v[248:251],v[56:59],a[244:247],v[248:251]
 v_mfma_f32_16x16x32_bf16 v[244:247],v[60:63],a[240:243],v[244:247]
 v_mfma_f32_16x16x32_bf16 v[252:255],v[60:63],a[244:247],v[252:255]
 s_waitcnt vmcnt(7)
 v_mfma_f32_16x16x32_bf16 v[224:227],v[64:67],a[248:251],v[224:227]
 v_mfma_f32_16x16x32_bf16 v[232:235],v[64:67],a[252:255],v[232:235]
 v_mfma_f32_16x16x32_bf16 v[228:231],v[68:71],a[248:251],v[228:231]
 v_mfma_f32_16x16x32_bf16 v[236:239],v[68:71],a[252:255],v[236:239]
 v_mfma_f32_16x16x32_bf16 v[240:243],v[72:75],a[248:251],v[240:243]
 s_nop 3
 v_cvt_pk_bf16_f32 v224,v224,v225
 v_cvt_pk_bf16_f32 v225,v226,v227
 v_mfma_f32_16x16x32_bf16 v[248:251],v[72:75],a[252:255],v[248:251]
 v_cvt_pk_bf16_f32 v232,v232,v233
 v_cvt_pk_bf16_f32 v233,v234,v235
 v_mfma_f32_16x16x32_bf16 v[244:247],v[76:79],a[248:251],v[244:247]
 v_cvt_pk_bf16_f32 v226,v228,v229
 v_cvt_pk_bf16_f32 v227,v230,v231
 v_mfma_f32_16x16x32_bf16 v[252:255],v[76:79],a[252:255],v[252:255]
 buffer_store_dwordx4 v[224:227],v0,s[12:15],s56 offen sc1
 v_cvt_pk_bf16_f32 v234,v236,v237
 v_cvt_pk_bf16_f32 v235,v238,v239
 buffer_store_dwordx4 v[232:235],v0,s[12:15],s56 offen offset:1024 sc1
 v_mfma_f32_16x16x32_bf16 v[192:195],v[224:227],v[224:227],0
 v_cvt_pk_bf16_f32 v240,v240,v241
 v_cvt_pk_bf16_f32 v241,v242,v243
 v_mfma_f32_16x16x32_bf16 v[188:191],v[8:11],v[224:227],0
 v_cvt_pk_bf16_f32 v242,v244,v245
 v_cvt_pk_bf16_f32 v243,v246,v247
 buffer_store_dwordx4 v[240:243],v0,s[12:15],s56 offen offset:2048 sc1
 v_mfma_f32_16x16x32_bf16 v[200:203],v[232:235],v[232:235],0
 v_cvt_pk_bf16_f32 v248,v248,v249
 v_cvt_pk_bf16_f32 v249,v250,v251
 v_mfma_f32_16x16x32_bf16 v[196:199],v[8:11],v[232:235],0
 v_cvt_pk_bf16_f32 v250,v252,v253
 v_cvt_pk_bf16_f32 v251,v254,v255
 buffer_store_dwordx4 v[248:251],v0,s[12:15],s56 offen offset:3072 sc1
 v_mfma_f32_16x16x32_bf16 v[192:195],v[240:243],v[240:243],v[192:195]
 v_accvgpr_write_b32 a0,v224
 v_accvgpr_write_b32 a1,v225
 v_mfma_f32_16x16x32_bf16 v[188:191],v[8:11],v[240:243],v[188:191]
 v_accvgpr_write_b32 a2,v226
 v_accvgpr_write_b32 a3,v227
 v_mfma_f32_16x16x32_bf16 v[200:203],v[248:251],v[248:251],v[200:203]
 v_accvgpr_write_b32 a4,v232
 v_accvgpr_write_b32 a5,v233
 v_mfma_f32_16x16x32_bf16 v[196:199],v[8:11],v[248:251],v[196:199]
 v_accvgpr_write_b32 a6,v234
 v_accvgpr_write_b32 a7,v235
 ds_read_b128 v[16:19],v2
 ds_read_b128 v[20:23],v2 offset:1024
 ds_read_b128 v[24:27],v2 offset:2048
 ds_read_b128 v[28:31],v2 offset:3072
 v_cndmask_b32 v189,v192,v193,s[64:65]
 v_cndmask_b32 v189,v189,v194,s[66:67]
 v_cndmask_b32 v189,v189,v195,s[68:69]
 v_cndmask_b32 v191,v200,v201,s[64:65]
 v_cndmask_b32 v191,v191,v202,s[66:67]
 v_cndmask_b32 v191,v191,v203,s[68:69]
 v_mov_b32 v190,v196
 buffer_store_dwordx4 v[188:191],v184,s[12:15],s58 offen sc1
 v_accvgpr_write_b32 a8,v240
 v_accvgpr_write_b32 a9,v241
 v_accvgpr_write_b32 a10,v242
 v_accvgpr_write_b32 a11,v243
 v_accvgpr_write_b32 a12,v248
 v_accvgpr_write_b32 a13,v249
 v_accvgpr_write_b32 a14,v250
 v_accvgpr_write_b32 a15,v251
 ds_read_b128 v[32:35],v2 offset:4096
 ds_read_b128 v[36:39],v2 offset:5120
 s_waitcnt lgkmcnt(4)
 v_mfma_f32_16x16x32_bf16 v[80:83],a[0:3],v[16:19],0
 s_add_u32 m0,s54,28672
 s_nop 0
 buffer_load_dwordx4 v0,s[12:15],s50 offen sc1 lds
 v_mfma_f32_16x16x32_bf16 v[84:87],a[4:7],v[16:19],0
 s_lshl_b32 s68,s47,16
 ds_read_b128 v[40:43],v2 offset:6144
 ds_read_b128 v[44:47],v2 offset:7168
 v_mfma_f32_16x16x32_bf16 v[88:91],a[0:3],v[20:23],0
 s_add_u32 s68,s68,20971520
 buffer_load_dwordx4 v0,s[12:15],s50 offen offset:1024 sc1 lds
 v_mfma_f32_16x16x32_bf16 v[92:95],a[4:7],v[20:23],0
 s_waitcnt lgkmcnt(4)
 ds_read_b128 v[48:51],v2 offset:8192
 ds_read_b128 v[52:55],v2 offset:9216
 v_mfma_f32_16x16x32_bf16 v[96:99],a[0:3],v[24:27],0
 s_lshl_b32 s3,s46,10
 ds_read_b128 v[56:59],v2 offset:10240
 ds_read_b128 v[60:63],v2 offset:11264
 v_mfma_f32_16x16x32_bf16 v[100:103],a[4:7],v[24:27],0
 s_add_u32 s3,s3,159744
 buffer_load_dwordx4 v0,s[12:15],s50 offen offset:2048 sc1 lds
 v_mfma_f32_16x16x32_bf16 v[104:107],a[0:3],v[28:31],0
 s_lshl_b32 s55,s46,10
 ds_read_b128 v[64:67],v2 offset:12288
 ds_read_b128 v[68:71],v2 offset:13312
 v_mfma_f32_16x16x32_bf16 v[108:111],a[4:7],v[28:31],0
 s_waitcnt lgkmcnt(8)
 buffer_load_dwordx4 v0,s[12:15],s50 offen offset:3072 sc1 lds
 v_mfma_f32_16x16x32_bf16 v[112:115],a[0:3],v[32:35],0
 s_add_u32 s50,s50,4096
 s_add_u32 m0,s54,32768
 ds_read_b128 v[72:75],v2 offset:14336
 v_mfma_f32_16x16x32_bf16 v[116:119],a[4:7],v[32:35],0
 ds_read_b128 v[76:79],v2 offset:15360
 ds_read_b128 v[16:19],v2 offset:16384
 v_mfma_f32_16x16x32_bf16 v[120:123],a[0:3],v[36:39],0
 buffer_load_dwordx4 v0,s[12:15],s50 offen sc1 lds
 v_mfma_f32_16x16x32_bf16 v[124:127],a[4:7],v[36:39],0
 s_waitcnt lgkmcnt(9)
 ds_read_b128 v[20:23],v2 offset:17408
 ds_read_b128 v[24:27],v2 offset:18432
 v_mfma_f32_16x16x32_bf16 v[128:131],a[0:3],v[40:43],0
 buffer_load_dwordx4 v0,s[12:15],s50 offen offset:1024 sc1 lds
 v_mfma_f32_16x16x32_bf16 v[132:135],a[4:7],v[40:43],0
 ds_read_b128 v[28:31],v2 offset:19456
 ds_read_b128 v[32:35],v2 offset:20480
 v_mfma_f32_16x16x32_bf16 v[136:139],v[44:47],a[0:3],0
 ds_read_b128 v[36:39],v2 offset:21504
 ds_read_b128 v[40:43],v2 offset:22528
 v_mfma_f32_16x16x32_bf16 v[140:143],v[44:47],a[4:7],0
 s_waitcnt lgkmcnt(13)
 buffer_load_dwordx4 v0,s[12:15],s50 offen offset:2048 sc1 lds
 v_mfma_f32_16x16x32_bf16 v[144:147],v[48:51],a[0:3],0
 s_add_u32 s50,s50,24576
 s_add_u32 m0,s54,57344
 ds_read_b128 v[44:47],v2 offset:23552
 v_mfma_f32_16x16x32_bf16 v[148:151],v[48:51],a[4:7],0
 ds_read_b128 v[48:51],v2 offset:24576
 v_lshrrev_b32 v251,4,v12
 v_mfma_f32_16x16x32_bf16 v[152:155],v[52:55],a[0:3],0
 buffer_load_dwordx4 v0,s[12:15],s50 offen sc1 lds
 v_mfma_f32_16x16x32_bf16 v[156:159],v[52:55],a[4:7],0
 s_waitcnt lgkmcnt(13)
 ds_read_b128 v[52:55],v2 offset:25600
 v_lshl_add_u32 v251,v251,4,s3
 v_mfma_f32_16x16x32_bf16 v[160:163],v[56:59],a[0:3],0
 buffer_load_dwordx4 v0,s[12:15],s50 offen offset:1024 sc1 lds
 v_mfma_f32_16x16x32_bf16 v[164:167],v[56:59],a[4:7],0
 ds_read_b128 v[56:59],v2 offset:26624
 v_and_b32 v250,15,v12
 v_mfma_f32_16x16x32_bf16 v[168:171],v[60:63],a[0:3],0
 v_lshl_add_u32 v250,v250,2,s3
 v_lshrrev_b32 v232,5,v12
 v_mfma_f32_16x16x32_bf16 v[172:175],v[60:63],a[4:7],0
 s_waitcnt lgkmcnt(13)
 buffer_load_dwordx4 v0,s[12:15],s50 offen offset:2048 sc1 lds
 v_mfma_f32_16x16x32_bf16 v[176:179],v[64:67],a[0:3],0
 s_lshl_b32 s3,s47,5
 s_waitcnt vmcnt(10)
 buffer_atomic_add v6,v3,s[12:15],0 offen offset:24 sc1
 v_mfma_f32_16x16x32_bf16 v[180:183],v[64:67],a[4:7],0
 buffer_load_dwordx4 v0,s[12:15],s50 offen offset:3072 sc1 lds
 v_mfma_f32_16x16x32_bf16 v[184:187],v[68:71],a[0:3],0
 s_add_u32 s50,s50,4096
 s_add_u32 m0,s54,61440
 ds_read_b128 v[60:63],v2 offset:27648
 v_mfma_f32_16x16x32_bf16 v[188:191],v[68:71],a[4:7],0
 s_waitcnt lgkmcnt(12)
 v_lshl_add_u32 v250,v232,6,v250
 v_and_b32 v233,3,v12
 v_mfma_f32_16x16x32_bf16 v[80:83],a[8:11],v[72:75],v[80:83]
 buffer_load_dwordx4 v0,s[12:15],s50 offen sc1 lds
 v_mfma_f32_16x16x32_bf16 v[84:87],a[12:15],v[72:75],v[84:87]
 v_cmp_eq_u32 vcc,0,v233
 v_lshlrev_b32 v233,2,v12
 v_mfma_f32_16x16x32_bf16 v[88:91],a[8:11],v[76:79],v[88:91]
 buffer_load_dwordx4 v0,s[12:15],s50 offen offset:1024 sc1 lds
 v_mfma_f32_16x16x32_bf16 v[92:95],a[12:15],v[76:79],v[92:95]
 s_waitcnt lgkmcnt(10)
 v_cndmask_b32 v252,2.0,v233,vcc
 v_and_b32 v253,0x1f0,v0
 v_mfma_f32_16x16x32_bf16 v[96:99],a[8:11],v[16:19],v[96:99]
 v_lshl_add_u32 v253,v232,10,v253
 v_add_lshl_u32 v254,v13,s3,1
 v_mfma_f32_16x16x32_bf16 v[100:103],a[12:15],v[16:19],v[100:103]
 s_lshl_b32 s3,s45,18
 buffer_load_dwordx4 v0,s[12:15],s50 offen offset:2048 sc1 lds
 v_mfma_f32_16x16x32_bf16 v[104:107],a[8:11],v[20:23],v[104:107]
 s_add_u32 s50,s50,24576
 s_add_u32 m0,s54,86016
 s_add_u32 s3,s3,s55
 v_mfma_f32_16x16x32_bf16 v[108:111],a[12:15],v[20:23],v[108:111]
 s_add_u32 s3,s3,62914560
 v_add_u32 v14,s3,v0
 s_waitcnt lgkmcnt(8)
 v_mfma_f32_16x16x32_bf16 v[112:115],a[8:11],v[24:27],v[112:115]
 buffer_load_dwordx4 v0,s[12:15],s50 offen sc1 lds
 v_mfma_f32_16x16x32_bf16 v[116:119],a[12:15],v[24:27],v[116:119]
 v_mfma_f32_16x16x32_bf16 v[120:123],a[8:11],v[28:31],v[120:123]
 buffer_load_dwordx4 v0,s[12:15],s50 offen offset:1024 sc1 lds
 v_mfma_f32_16x16x32_bf16 v[124:127],a[12:15],v[28:31],v[124:127]
 s_waitcnt lgkmcnt(6)
 v_mfma_f32_16x16x32_bf16 v[128:131],a[8:11],v[32:35],v[128:131]
 v_mfma_f32_16x16x32_bf16 v[132:135],a[12:15],v[32:35],v[132:135]
 buffer_load_dwordx4 v0,s[12:15],s50 offen offset:2048 sc1 lds
 v_mfma_f32_16x16x32_bf16 v[136:139],v[36:39],a[8:11],v[136:139]
 v_mfma_f32_16x16x32_bf16 v[140:143],v[36:39],a[12:15],v[140:143]
 s_waitcnt lgkmcnt(4)
 buffer_load_dwordx4 v0,s[12:15],s50 offen offset:3072 sc1 lds
 v_mfma_f32_16x16x32_bf16 v[144:147],v[40:43],a[8:11],v[144:147]
 s_add_u32 s50,s50,4096
 s_add_u32 m0,s54,90112
 v_mfma_f32_16x16x32_bf16 v[148:151],v[40:43],a[12:15],v[148:151]
 v_mfma_f32_16x16x32_bf16 v[152:155],v[44:47],a[8:11],v[152:155]
 buffer_load_dwordx4 v0,s[12:15],s50 offen sc1 lds
 v_mfma_f32_16x16x32_bf16 v[156:159],v[44:47],a[12:15],v[156:159]
 s_waitcnt lgkmcnt(2)
 v_mfma_f32_16x16x32_bf16 v[160:163],v[48:51],a[8:11],v[160:163]
 buffer_load_dwordx4 v0,s[12:15],s50 offen offset:1024 sc1 lds
 v_mfma_f32_16x16x32_bf16 v[164:167],v[48:51],a[12:15],v[164:167]
 v_mfma_f32_16x16x32_bf16 v[168:171],v[52:55],a[8:11],v[168:171]
 v_mfma_f32_16x16x32_bf16 v[172:175],v[52:55],a[12:15],v[172:175]
 s_waitcnt lgkmcnt(0)
 buffer_load_dwordx4 v0,s[12:15],s50 offen offset:2048 sc1 lds
 v_mfma_f32_16x16x32_bf16 v[176:179],v[56:59],a[8:11],v[176:179]
 s_add_u32 s50,s50,24576
 v_mfma_f32_16x16x32_bf16 v[180:183],v[56:59],a[12:15],v[180:183]
 v_mfma_f32_16x16x32_bf16 v[184:187],v[60:63],a[8:11],v[184:187]
 v_mfma_f32_16x16x32_bf16 v[188:191],v[60:63],a[12:15],v[188:191]
 s_barrier
 ds_read_b128 v[64:67],v0
 ds_read_b128 v[68:71],v0 offset:1024
 ds_read_b128 v[72:75],v0 offset:2048
 ds_read_b128 v[76:79],v0 offset:3072
 ds_read_b128 v[16:19],v0 offset:4096
 ds_read_b128 v[20:23],v0 offset:5120
 ds_read_b128 v[24:27],v0 offset:6144
 ds_read_b128 v[28:31],v0 offset:7168
 ds_read_b128 v[32:35],v0 offset:8192
 ds_read_b128 v[36:39],v0 offset:9216
 ds_read_b128 v[40:43],v0 offset:10240
 ds_read_b128 v[44:47],v0 offset:11264
 ds_read_b128 v[48:51],v0 offset:12288
 ds_read_b128 v[52:55],v0 offset:13312
 ds_read_b128 v[56:59],v0 offset:14336
 ds_read_b128 v[60:63],v0 offset:15360
 s_add_u32 m0,s54,131072
 v_mov_b32 v7,0
 buffer_atomic_add v7,v3,s[12:15],0 offen offset:24 sc0 sc1
 buffer_load_dwordx4 v0,s[12:15],s50 offen sc1 lds
 buffer_load_dwordx4 v0,s[12:15],s50 offen offset:1024 sc1 lds
 buffer_load_dwordx4 v0,s[12:15],s50 offen offset:2048 sc1 lds
 buffer_load_dwordx4 v0,s[12:15],s50 offen offset:3072 sc1 lds
 s_add_u32 s50,s50,4096
 s_add_u32 m0,s54,135168
 s_nop 0
 buffer_load_dwordx4 v0,s[12:15],s50 offen sc1 lds
 buffer_load_dwordx4 v0,s[12:15],s50 offen offset:1024 sc1 lds
 buffer_load_dwordx4 v0,s[12:15],s50 offen offset:2048 sc1 lds
 s_add_u32 s50,s50,24576
 s_cmp_eq_u32 s46,0
 s_cbranch_scc1 .Lvs3_0
 s_cmp_eq_u32 s46,1
 s_cbranch_scc1 .Lvs3_1
 s_cmp_eq_u32 s46,2
 s_cbranch_scc1 .Lvs3_2
 s_branch .Lvs3_3
.Lvb3:
 s_waitcnt vmcnt(7)
 v_readfirstlane_b32 s59,v7
 s_nop 0
 s_cmp_ge_u32 s59,16
 s_cbranch_scc0 .Lseq_slow_18
.Lseq_back_19:
 s_cmp_eq_u32 s45,1
 s_cselect_b32 s53,0,4096
 s_add_u32 s53,s53,s68
 buffer_load_dwordx4 a[16:19],v0,s[12:15],s53 offen sc1
 buffer_load_dwordx4 a[20:23],v0,s[12:15],s53 offen offset:1024 sc1
 buffer_load_dwordx4 a[24:27],v0,s[12:15],s53 offen offset:2048 sc1
 buffer_load_dwordx4 a[28:31],v0,s[12:15],s53 offen offset:3072 sc1
 s_cmp_eq_u32 s45,2
 s_cselect_b32 s53,0,8192
 s_add_u32 s53,s53,s68
 buffer_load_dwordx4 a[32:35],v0,s[12:15],s53 offen sc1
 buffer_load_dwordx4 a[36:39],v0,s[12:15],s53 offen offset:1024 sc1
 buffer_load_dwordx4 a[40:43],v0,s[12:15],s53 offen offset:2048 sc1
 buffer_load_dwordx4 a[44:47],v0,s[12:15],s53 offen offset:3072 sc1
 s_cmp_eq_u32 s45,3
 s_cselect_b32 s53,0,12288
 s_add_u32 s53,s53,s68
 buffer_load_dwordx4 a[48:51],v0,s[12:15],s53 offen sc1
 buffer_load_dwordx4 a[52:55],v0,s[12:15],s53 offen offset:1024 sc1
 buffer_load_dwordx4 a[56:59],v0,s[12:15],s53 offen offset:2048 sc1
 buffer_load_dwordx4 a[60:63],v0,s[12:15],s53 offen offset:3072 sc1
 s_cmp_eq_u32 s45,4
 s_cselect_b32 s53,0,16384
 s_add_u32 s53,s53,s68
 buffer_load_dwordx4 a[64:67],v0,s[12:15],s53 offen sc1
 buffer_load_dwordx4 a[68:71],v0,s[12:15],s53 offen offset:1024 sc1
 buffer_load_dwordx4 a[72:75],v0,s[12:15],s53 offen offset:2048 sc1
 buffer_load_dwordx4 a[76:79],v0,s[12:15],s53 offen offset:3072 sc1
 s_waitcnt vmcnt(14) lgkmcnt(14)
 v_mfma_f32_16x16x32_bf16 v[80:83],a[16:19],v[64:67],v[80:83]
 s_cmp_eq_u32 s45,5
 s_cselect_b32 s53,0,20480
 s_add_u32 s53,s53,s68
 v_mfma_f32_16x16x32_bf16 v[84:87],a[20:23],v[64:67],v[84:87]
 s_add_u32 m0,s54,0
 buffer_load_dwordx4 a[80:83],v0,s[12:15],s53 offen sc1
 v_mfma_f32_16x16x32_bf16 v[88:91],a[16:19],v[68:71],v[88:91]
 s_mov_b32 s49,0
 ds_read_b128 v[64:67],v0 offset:16384
 s_lshl_b32 s64,s47,4
 v_mfma_f32_16x16x32_bf16 v[92:95],a[20:23],v[68:71],v[92:95]
 s_waitcnt lgkmcnt(13)
 ds_read_b128 v[68:71],v0 offset:17408
 s_add_u32 s64,s64,0
 v_mfma_f32_16x16x32_bf16 v[96:99],a[16:19],v[72:75],v[96:99]
 s_lshl_b32 s64,s64,13
 buffer_load_dwordx4 a[84:87],v0,s[12:15],s53 offen offset:1024 sc1
 v_mfma_f32_16x16x32_bf16 v[100:103],a[20:23],v[72:75],v[100:103]
 s_add_u32 s64,s64,33554432
 ds_read_b128 v[72:75],v0 offset:18432
 v_mfma_f32_16x16x32_bf16 v[104:107],a[16:19],v[76:79],v[104:107]
 v_mfma_f32_16x16x32_bf16 v[108:111],a[20:23],v[76:79],v[108:111]
 s_waitcnt vmcnt(14) lgkmcnt(13)
 ds_read_b128 v[76:79],v0 offset:19456
 v_mfma_f32_16x16x32_bf16 v[80:83],a[24:27],v[16:19],v[80:83]
 buffer_load_dwordx4 a[88:91],v0,s[12:15],s53 offen offset:2048 sc1
 v_mfma_f32_16x16x32_bf16 v[84:87],a[28:31],v[16:19],v[84:87]
 ds_read_b128 v[16:19],v0 offset:20480
 v_mfma_f32_16x16x32_bf16 v[88:91],a[24:27],v[20:23],v[88:91]
 v_mfma_f32_16x16x32_bf16 v[92:95],a[28:31],v[20:23],v[92:95]
 s_waitcnt lgkmcnt(13)
 ds_read_b128 v[20:23],v0 offset:21504
 v_mfma_f32_16x16x32_bf16 v[96:99],a[24:27],v[24:27],v[96:99]
 buffer_load_dwordx4 a[92:95],v0,s[12:15],s53 offen offset:3072 sc1
 v_mfma_f32_16x16x32_bf16 v[100:103],a[28:31],v[24:27],v[100:103]
 s_cmp_eq_u32 s45,6
 s_cselect_b32 s53,0,24576
 s_add_u32 s53,s53,s68
 v_mfma_f32_16x16x32_bf16 v[104:107],a[24:27],v[28:31],v[104:107]
 ds_read_b128 v[24:27],v0 offset:22528
 v_mfma_f32_16x16x32_bf16 v[108:111],a[28:31],v[28:31],v[108:111]
 s_waitcnt vmcnt(14) lgkmcnt(13)
 ds_read_b128 v[28:31],v0 offset:23552
 v_mfma_f32_16x16x32_bf16 v[80:83],a[32:35],v[32:35],v[80:83]
 buffer_load_dwordx4 a[96:99],v0,s[12:15],s53 offen sc1
 v_mfma_f32_16x16x32_bf16 v[84:87],a[36:39],v[32:35],v[84:87]
 ds_read_b128 v[32:35],v0 offset:24576
 v_mfma_f32_16x16x32_bf16 v[88:91],a[32:35],v[36:39],v[88:91]
 v_mfma_f32_16x16x32_bf16 v[92:95],a[36:39],v[36:39],v[92:95]
 s_waitcnt lgkmcnt(13)
 ds_read_b128 v[36:39],v0 offset:25600
 v_mfma_f32_16x16x32_bf16 v[96:99],a[32:35],v[40:43],v[96:99]
 s_branch .Lsk10
.Lvs2_1:
 s_branch .Lst14
.Lsk10:
 buffer_load_dwordx4 a[100:103],v0,s[12:15],s53 offen offset:1024 sc1
 v_mfma_f32_16x16x32_bf16 v[100:103],a[36:39],v[40:43],v[100:103]
 ds_read_b128 v[40:43],v0 offset:26624
 v_mfma_f32_16x16x32_bf16 v[104:107],a[32:35],v[44:47],v[104:107]
 v_mfma_f32_16x16x32_bf16 v[108:111],a[36:39],v[44:47],v[108:111]
 s_waitcnt vmcnt(14) lgkmcnt(13)
 ds_read_b128 v[44:47],v0 offset:27648
 v_mfma_f32_16x16x32_bf16 v[80:83],a[40:43],v[48:51],v[80:83]
 buffer_load_dwordx4 a[104:107],v0,s[12:15],s53 offen offset:2048 sc1
 v_mfma_f32_16x16x32_bf16 v[84:87],a[44:47],v[48:51],v[84:87]
 v_mfma_f32_16x16x32_bf16 v[88:91],a[40:43],v[52:55],v[88:91]
 v_mfma_f32_16x16x32_bf16 v[92:95],a[44:47],v[52:55],v[92:95]
 s_waitcnt lgkmcnt(12)
 v_mfma_f32_16x16x32_bf16 v[96:99],a[40:43],v[56:59],v[96:99]
 buffer_load_dwordx4 a[108:111],v0,s[12:15],s53 offen offset:3072 sc1
 v_mfma_f32_16x16x32_bf16 v[100:103],a[44:47],v[56:59],v[100:103]
 s_cmp_eq_u32 s45,7
 s_cselect_b32 s53,0,28672
 s_add_u32 s53,s53,s68
 v_mfma_f32_16x16x32_bf16 v[104:107],a[40:43],v[60:63],v[104:107]
 v_mfma_f32_16x16x32_bf16 v[108:111],a[44:47],v[60:63],v[108:111]
 s_waitcnt lgkmcnt(0) vmcnt(14)
 s_barrier
 ds_read_b128 v[48:51],v0 offset:28672
 v_mfma_f32_16x16x32_bf16 v[80:83],a[48:51],v[64:67],v[80:83]
 buffer_load_dwordx4 a[112:115],v0,s[12:15],s53 offen sc1
 v_mfma_f32_16x16x32_bf16 v[84:87],a[52:55],v[64:67],v[84:87]
 ds_read_b128 v[52:55],v0 offset:29696
 ds_read_b128 v[56:59],v0 offset:30720
 v_mfma_f32_16x16x32_bf16 v[88:91],a[48:51],v[68:71],v[88:91]
 ds_read_b128 v[60:63],v0 offset:31744
 ds_read_b128 v[64:67],v0 offset:32768
 v_mfma_f32_16x16x32_bf16 v[92:95],a[52:55],v[68:71],v[92:95]
 ds_read_b128 v[68:71],v0 offset:33792
 v_mfma_f32_16x16x32_bf16 v[96:99],a[48:51],v[72:75],v[96:99]
 buffer_load_dwordx4 a[116:119],v0,s[12:15],s53 offen offset:1024 sc1
 v_mfma_f32_16x16x32_bf16 v[100:103],a[52:55],v[72:75],v[100:103]
 ds_read_b128 v[72:75],v0 offset:34816
 v_mfma_f32_16x16x32_bf16 v[104:107],a[48:51],v[76:79],v[104:107]
 v_mfma_f32_16x16x32_bf16 v[108:111],a[52:55],v[76:79],v[108:111]
 s_waitcnt vmcnt(14)
 ds_read_b128 v[76:79],v0 offset:35840
 v_mfma_f32_16x16x32_bf16 v[80:83],a[56:59],v[16:19],v[80:83]
 buffer_load_dwordx4 a[120:123],v0,s[12:15],s53 offen offset:2048 sc1
 v_mfma_f32_16x16x32_bf16 v[84:87],a[60:63],v[16:19],v[84:87]
 ds_read_b128 v[16:19],v0 offset:36864
 v_mfma_f32_16x16x32_bf16 v[88:91],a[56:59],v[20:23],v[88:91]
 v_mfma_f32_16x16x32_bf16 v[92:95],a[60:63],v[20:23],v[92:95]
 ds_read_b128 v[20:23],v0 offset:37888
 v_mfma_f32_16x16x32_bf16 v[96:99],a[56:59],v[24:27],v[96:99]
 buffer_load_dwordx4 a[124:127],v0,s[12:15],s53 offen offset:3072 sc1
 v_mfma_f32_16x16x32_bf16 v[100:103],a[60:63],v[24:27],v[100:103]
 s_cmp_eq_u32 s45,8
 s_cselect_b32 s53,0,32768
 s_add_u32 s53,s53,s68
 v_mfma_f32_16x16x32_bf16 v[104:107],a[56:59],v[28:31],v[104:107]
 ds_read_b128 v[24:27],v0 offset:38912
 v_mfma_f32_16x16x32_bf16 v[108:111],a[60:63],v[28:31],v[108:111]
 s_waitcnt vmcnt(14)
 ds_read_b128 v[28:31],v0 offset:39936
 v_mfma_f32_16x16x32_bf16 v[80:83],a[64:67],v[32:35],v[80:83]
 buffer_load_dwordx4 a[128:131],v0,s[12:15],s53 offen sc1
 v_mfma_f32_16x16x32_bf16 v[84:87],a[68:71],v[32:35],v[84:87]
 ds_read_b128 v[32:35],v0 offset:40960
 v_mfma_f32_16x16x32_bf16 v[88:91],a[64:67],v[36:39],v[88:91]
 v_mfma_f32_16x16x32_bf16 v[92:95],a[68:71],v[36:39],v[92:95]
 ds_read_b128 v[36:39],v0 offset:41984
 v_mfma_f32_16x16x32_bf16 v[96:99],a[64:67],v[40:43],v[96:99]
 buffer_load_dwordx4 a[132:135],v0,s[12:15],s53 offen offset:1024 sc1
 v_mfma_f32_16x16x32_bf16 v[100:103],a[68:71],v[40:43],v[100:103]
 ds_read_b128 v[40:43],v0 offset:43008
 v_mfma_f32_16x16x32_bf16 v[104:107],a[64:67],v[44:47],v[104:107]
 v_mfma_f32_16x16x32_bf16 v[108:111],a[68:71],v[44:47],v[108:111]
 s_waitcnt vmcnt(14) lgkmcnt(13)
 ds_read_b128 v[44:47],v0 offset:44032
 v_mfma_f32_16x16x32_bf16 v[80:83],a[72:75],v[48:51],v[80:83]
 buffer_load_dwordx4 a[136:139],v0,s[12:15],s53 offen offset:2048 sc1
 v_mfma_f32_16x16x32_bf16 v[84:87],a[76:79],v[48:51],v[84:87]
 ds_read_b128 v[48:51],v0 offset:45056
 v_mfma_f32_16x16x32_bf16 v[88:91],a[72:75],v[52:55],v[88:91]
 v_mfma_f32_16x16x32_bf16 v[92:95],a[76:79],v[52:55],v[92:95]
 s_waitcnt lgkmcnt(13)
 ds_read_b128 v[52:55],v0 offset:46080
 v_mfma_f32_16x16x32_bf16 v[96:99],a[72:75],v[56:59],v[96:99]
 buffer_load_dwordx4 a[140:143],v0,s[12:15],s53 offen offset:3072 sc1
 v_mfma_f32_16x16x32_bf16 v[100:103],a[76:79],v[56:59],v[100:103]
 s_cmp_eq_u32 s45,9
 s_cselect_b32 s53,0,36864
 s_add_u32 s53,s53,s68
 v_mfma_f32_16x16x32_bf16 v[104:107],a[72:75],v[60:63],v[104:107]
 ds_read_b128 v[56:59],v0 offset:47104
 v_mfma_f32_16x16x32_bf16 v[108:111],a[76:79],v[60:63],v[108:111]
 s_waitcnt vmcnt(14) lgkmcnt(13)
 ds_read_b128 v[60:63],v0 offset:48128
 v_mfma_f32_16x16x32_bf16 v[80:83],a[80:83],v[64:67],v[80:83]
 buffer_load_dwordx4 a[144:147],v0,s[12:15],s53 offen sc1
 v_mfma_f32_16x16x32_bf16 v[84:87],a[84:87],v[64:67],v[84:87]
 ds_read_b128 v[64:67],v0 offset:49152
 v_mfma_f32_16x16x32_bf16 v[88:91],a[80:83],v[68:71],v[88:91]
 v_mfma_f32_16x16x32_bf16 v[92:95],a[84:87],v[68:71],v[92:95]
 s_waitcnt lgkmcnt(13)
 ds_read_b128 v[68:71],v0 offset:50176
 v_mfma_f32_16x16x32_bf16 v[96:99],a[80:83],v[72:75],v[96:99]
 buffer_load_dwordx4 a[148:151],v0,s[12:15],s53 offen offset:1024 sc1
 v_mfma_f32_16x16x32_bf16 v[100:103],a[84:87],v[72:75],v[100:103]
 ds_read_b128 v[72:75],v0 offset:51200
 v_mfma_f32_16x16x32_bf16 v[104:107],a[80:83],v[76:79],v[104:107]
 v_mfma_f32_16x16x32_bf16 v[108:111],a[84:87],v[76:79],v[108:111]
 s_waitcnt vmcnt(14) lgkmcnt(13)
 ds_read_b128 v[76:79],v0 offset:52224
 v_mfma_f32_16x16x32_bf16 v[80:83],a[88:91],v[16:19],v[80:83]
 buffer_load_dwordx4 a[152:155],v0,s[12:15],s53 offen offset:2048 sc1
 v_mfma_f32_16x16x32_bf16 v[84:87],a[92:95],v[16:19],v[84:87]
 ds_read_b128 v[16:19],v0 offset:53248
 v_mfma_f32_16x16x32_bf16 v[88:91],a[88:91],v[20:23],v[88:91]
 v_mfma_f32_16x16x32_bf16 v[92:95],a[92:95],v[20:23],v[92:95]
 s_waitcnt lgkmcnt(13)
 ds_read_b128 v[20:23],v0 offset:54272
 v_mfma_f32_16x16x32_bf16 v[96:99],a[88:91],v[24:27],v[96:99]
 buffer_load_dwordx4 a[156:159],v0,s[12:15],s53 offen offset:3072 sc1
 v_mfma_f32_16x16x32_bf16 v[100:103],a[92:95],v[24:27],v[100:103]
 s_cmp_eq_u32 s45,10
 s_cselect_b32 s53,0,40960
 s_add_u32 s53,s53,s68
 v_mfma_f32_16x16x32_bf16 v[104:107],a[88:91],v[28:31],v[104:107]
 ds_read_b128 v[24:27],v0 offset:55296
 v_mfma_f32_16x16x32_bf16 v[108:111],a[92:95],v[28:31],v[108:111]
 s_waitcnt vmcnt(14) lgkmcnt(13)
 ds_read_b128 v[28:31],v0 offset:56320
 v_mfma_f32_16x16x32_bf16 v[80:83],a[96:99],v[32:35],v[80:83]
 buffer_load_dwordx4 a[160:163],v0,s[12:15],s53 offen sc1
 v_mfma_f32_16x16x32_bf16 v[84:87],a[100:103],v[32:35],v[84:87]
 v_mfma_f32_16x16x32_bf16 v[88:91],a[96:99],v[36:39],v[88:91]
 v_mfma_f32_16x16x32_bf16 v[92:95],a[100:103],v[36:39],v[92:95]
 s_waitcnt lgkmcnt(12)
 v_mfma_f32_16x16x32_bf16 v[96:99],a[96:99],v[40:43],v[96:99]
 buffer_load_dwordx4 a[164:167],v0,s[12:15],s53 offen offset:1024 sc1
 v_mfma_f32_16x16x32_bf16 v[100:103],a[100:103],v[40:43],v[100:103]
 v_mfma_f32_16x16x32_bf16 v[104:107],a[96:99],v[44:47],v[104:107]
 v_mfma_f32_16x16x32_bf16 v[108:111],a[100:103],v[44:47],v[108:111]
 s_waitcnt lgkmcnt(0) vmcnt(14)
 s_barrier
 ds_read_b128 v[32:35],v0 offset:57344
 v_mfma_f32_16x16x32_bf16 v[80:83],a[104:107],v[48:51],v[80:83]
 buffer_load_dwordx4 a[168:171],v0,s[12:15],s53 offen offset:2048 sc1
 v_mfma_f32_16x16x32_bf16 v[84:87],a[108:111],v[48:51],v[84:87]
 ds_read_b128 v[36:39],v0 offset:58368
 ds_read_b128 v[40:43],v0 offset:59392
 v_mfma_f32_16x16x32_bf16 v[88:91],a[104:107],v[52:55],v[88:91]
 ds_read_b128 v[44:47],v0 offset:60416
 ds_read_b128 v[48:51],v0 offset:61440
 v_mfma_f32_16x16x32_bf16 v[92:95],a[108:111],v[52:55],v[92:95]
 ds_read_b128 v[52:55],v0 offset:62464
 v_mfma_f32_16x16x32_bf16 v[96:99],a[104:107],v[56:59],v[96:99]
 buffer_load_dwordx4 a[172:175],v0,s[12:15],s53 offen offset:3072 sc1
 v_mfma_f32_16x16x32_bf16 v[100:103],a[108:111],v[56:59],v[100:103]
 s_cmp_eq_u32 s45,11
 s_cselect_b32 s53,0,45056
 s_add_u32 s53,s53,s68
 v_mfma_f32_16x16x32_bf16 v[104:107],a[104:107],v[60:63],v[104:107]
 ds_read_b128 v[56:59],v0 offset:63488
 v_mfma_f32_16x16x32_bf16 v[108:111],a[108:111],v[60:63],v[108:111]
 s_waitcnt vmcnt(14)
 ds_read_b128 v[60:63],v0 offset:64512
 v_mfma_f32_16x16x32_bf16 v[80:83],a[112:115],v[64:67],v[80:83]
 buffer_load_dwordx4 a[176:179],v0,s[12:15],s53 offen sc1
 v_mfma_f32_16x16x32_bf16 v[84:87],a[116:119],v[64:67],v[84:87]
 buffer_load_dwordx4 v[216:219],v0,s[12:15],s57 offen sc1
 v_mfma_f32_16x16x32_bf16 v[88:91],a[112:115],v[68:71],v[88:91]
 ds_read_b128 v[64:67],v1
 v_mfma_f32_16x16x32_bf16 v[92:95],a[116:119],v[68:71],v[92:95]
 ds_read_b128 v[68:71],v1 offset:1024
 v_mfma_f32_16x16x32_bf16 v[96:99],a[112:115],v[72:75],v[96:99]
 buffer_load_dwordx4 a[180:183],v0,s[12:15],s53 offen offset:1024 sc1
 v_mfma_f32_16x16x32_bf16 v[100:103],a[116:119],v[72:75],v[100:103]
 buffer_load_dwordx4 v[220:223],v0,s[12:15],s57 offen offset:1024 sc1
 v_mfma_f32_16x16x32_bf16 v[104:107],a[112:115],v[76:79],v[104:107]
 ds_read_b128 v[72:75],v1 offset:2048
 v_mfma_f32_16x16x32_bf16 v[108:111],a[116:119],v[76:79],v[108:111]
 s_waitcnt vmcnt(16)
 ds_read_b128 v[76:79],v1 offset:3072
 v_mfma_f32_16x16x32_bf16 v[80:83],a[120:123],v[16:19],v[80:83]
 buffer_load_dwordx4 a[184:187],v0,s[12:15],s53 offen offset:2048 sc1
 v_mfma_f32_16x16x32_bf16 v[84:87],a[124:127],v[16:19],v[84:87]
 buffer_load_dwordx4 v[224:227],v0,s[12:15],s57 offen offset:2048 sc1
 v_mfma_f32_16x16x32_bf16 v[88:91],a[120:123],v[20:23],v[88:91]
 ds_read_b128 v[16:19],v1 offset:4096
 v_mfma_f32_16x16x32_bf16 v[92:95],a[124:127],v[20:23],v[92:95]
 ds_read_b128 v[20:23],v1 offset:5120
 v_mfma_f32_16x16x32_bf16 v[96:99],a[120:123],v[24:27],v[96:99]
 buffer_load_dwordx4 a[188:191],v0,s[12:15],s53 offen offset:3072 sc1
 v_mfma_f32_16x16x32_bf16 v[100:103],a[124:127],v[24:27],v[100:103]
 buffer_load_dwordx4 v[228:231],v0,s[12:15],s57 offen offset:3072 sc1
 v_mfma_f32_16x16x32_bf16 v[104:107],a[120:123],v[28:31],v[104:107]
 s_cmp_eq_u32 s45,12
 s_cselect_b32 s53,0,49152
 s_add_u32 s53,s53,s68
 v_mfma_f32_16x16x32_bf16 v[108:111],a[124:127],v[28:31],v[108:111]
 s_waitcnt vmcnt(18) lgkmcnt(12)
 ds_read_b128 v[24:27],v1 offset:6144
 ds_read_b128 v[28:31],v1 offset:7168
 v_mfma_f32_16x16x32_bf16 v[80:83],a[128:131],v[32:35],v[80:83]
 buffer_load_dwordx4 a[192:195],v0,s[12:15],s53 offen sc1
 v_mfma_f32_16x16x32_bf16 v[84:87],a[132:135],v[32:35],v[84:87]
 ds_read_b128 v[32:35],v1 offset:8192
 v_mfma_f32_16x16x32_bf16 v[88:91],a[128:131],v[36:39],v[88:91]
 v_mfma_f32_16x16x32_bf16 v[92:95],a[132:135],v[36:39],v[92:95]
 s_waitcnt lgkmcnt(13)
 ds_read_b128 v[36:39],v1 offset:9216
 v_mfma_f32_16x16x32_bf16 v[96:99],a[128:131],v[40:43],v[96:99]
 buffer_load_dwordx4 a[196:199],v0,s[12:15],s53 offen offset:1024 sc1
 v_mfma_f32_16x16x32_bf16 v[100:103],a[132:135],v[40:43],v[100:103]
 ds_read_b128 v[40:43],v1 offset:10240
 v_mfma_f32_16x16x32_bf16 v[104:107],a[128:131],v[44:47],v[104:107]
 v_mfma_f32_16x16x32_bf16 v[108:111],a[132:135],v[44:47],v[108:111]
 s_waitcnt vmcnt(18) lgkmcnt(13)
 ds_read_b128 v[44:47],v1 offset:11264
 v_mfma_f32_16x16x32_bf16 v[80:83],a[136:139],v[48:51],v[80:83]
 buffer_load_dwordx4 a[200:203],v0,s[12:15],s53 offen offset:2048 sc1
 v_mfma_f32_16x16x32_bf16 v[84:87],a[140:143],v[48:51],v[84:87]
 ds_read_b128 v[48:51],v1 offset:12288
 v_mfma_f32_16x16x32_bf16 v[88:91],a[136:139],v[52:55],v[88:91]
 v_mfma_f32_16x16x32_bf16 v[92:95],a[140:143],v[52:55],v[92:95]
 s_waitcnt lgkmcnt(13)
 ds_read_b128 v[52:55],v1 offset:13312
 v_mfma_f32_16x16x32_bf16 v[96:99],a[136:139],v[56:59],v[96:99]
 buffer_load_dwordx4 a[204:207],v0,s[12:15],s53 offen offset:3072 sc1
 v_mfma_f32_16x16x32_bf16 v[100:103],a[140:143],v[56:59],v[100:103]
 s_cmp_eq_u32 s45,13
 s_cselect_b32 s53,0,53248
 s_add_u32 s53,s53,s68
 v_mfma_f32_16x16x32_bf16 v[104:107],a[136:139],v[60:63],v[104:107]
 ds_read_b128 v[56:59],v1 offset:14336
 v_mfma_f32_16x16x32_bf16 v[108:111],a[140:143],v[60:63],v[108:111]
 s_waitcnt vmcnt(18) lgkmcnt(13)
 ds_read_b128 v[60:63],v1 offset:15360
 v_mfma_f32_16x16x32_bf16 v[80:83],a[144:147],v[64:67],v[80:83]
 buffer_load_dwordx4 a[208:211],v0,s[12:15],s53 offen sc1
 v_mfma_f32_16x16x32_bf16 v[84:87],a[148:151],v[64:67],v[84:87]
 ds_read_b128 v[64:67],v1 offset:16384
 v_mfma_f32_16x16x32_bf16 v[88:91],a[144:147],v[68:71],v[88:91]
 v_mfma_f32_16x16x32_bf16 v[92:95],a[148:151],v[68:71],v[92:95]
 s_waitcnt lgkmcnt(13)
 ds_read_b128 v[68:71],v1 offset:17408
 v_mfma_f32_16x16x32_bf16 v[96:99],a[144:147],v[72:75],v[96:99]
 buffer_load_dwordx4 a[212:215],v0,s[12:15],s53 offen offset:1024 sc1
 v_mfma_f32_16x16x32_bf16 v[100:103],a[148:151],v[72:75],v[100:103]
 ds_read_b128 v[72:75],v1 offset:18432
 v_mfma_f32_16x16x32_bf16 v[104:107],a[144:147],v[76:79],v[104:107]
 v_mfma_f32_16x16x32_bf16 v[108:111],a[148:151],v[76:79],v[108:111]
 s_waitcnt vmcnt(18) lgkmcnt(13)
 ds_read_b128 v[76:79],v1 offset:19456
 v_mfma_f32_16x16x32_bf16 v[80:83],a[152:155],v[16:19],v[80:83]
 buffer_load_dwordx4 a[216:219],v0,s[12:15],s53 offen offset:2048 sc1
 v_mfma_f32_16x16x32_bf16 v[84:87],a[156:159],v[16:19],v[84:87]
 v_mfma_f32_16x16x32_bf16 v[88:91],a[152:155],v[20:23],v[88:91]
 v_mfma_f32_16x16x32_bf16 v[92:95],a[156:159],v[20:23],v[92:95]
 s_waitcnt lgkmcnt(12)
 v_mfma_f32_16x16x32_bf16 v[96:99],a[152:155],v[24:27],v[96:99]
 buffer_load_dwordx4 a[220:223],v0,s[12:15],s53 offen offset:3072 sc1
 v_mfma_f32_16x16x32_bf16 v[100:103],a[156:159],v[24:27],v[100:103]
 s_cmp_eq_u32 s45,14
 s_cselect_b32 s53,0,57344
 s_add_u32 s53,s53,s68
 v_mfma_f32_16x16x32_bf16 v[104:107],a[152:155],v[28:31],v[104:107]
 v_mfma_f32_16x16x32_bf16 v[108:111],a[156:159],v[28:31],v[108:111]
 s_waitcnt lgkmcnt(0) vmcnt(18)
 s_barrier
 ds_read_b128 v[16:19],v1 offset:20480
 v_mfma_f32_16x16x32_bf16 v[80:83],a[160:163],v[32:35],v[80:83]
 buffer_load_dwordx4 a[224:227],v0,s[12:15],s53 offen sc1
 v_mfma_f32_16x16x32_bf16 v[84:87],a[164:167],v[32:35],v[84:87]
 ds_read_b128 v[20:23],v1 offset:21504
 ds_read_b128 v[24:27],v1 offset:22528
 v_mfma_f32_16x16x32_bf16 v[88:91],a[160:163],v[36:39],v[88:91]
 ds_read_b128 v[28:31],v1 offset:23552
 ds_read_b128 v[32:35],v1 offset:24576
 v_mfma_f32_16x16x32_bf16 v[92:95],a[164:167],v[36:39],v[92:95]
 ds_read_b128 v[36:39],v1 offset:25600
 v_mfma_f32_16x16x32_bf16 v[96:99],a[160:163],v[40:43],v[96:99]
 buffer_load_dwordx4 a[228:231],v0,s[12:15],s53 offen offset:1024 sc1
 v_mfma_f32_16x16x32_bf16 v[100:103],a[164:167],v[40:43],v[100:103]
 ds_read_b128 v[40:43],v1 offset:26624
 v_mfma_f32_16x16x32_bf16 v[104:107],a[160:163],v[44:47],v[104:107]
 v_mfma_f32_16x16x32_bf16 v[108:111],a[164:167],v[44:47],v[108:111]
 s_waitcnt vmcnt(18)
 ds_read_b128 v[44:47],v1 offset:27648
 v_mfma_f32_16x16x32_bf16 v[80:83],a[168:171],v[48:51],v[80:83]
 buffer_load_dwordx4 a[232:235],v0,s[12:15],s53 offen offset:2048 sc1
 v_mfma_f32_16x16x32_bf16 v[84:87],a[172:175],v[48:51],v[84:87]
 ds_read_b128 v[48:51],v1 offset:28672
 v_mfma_f32_16x16x32_bf16 v[88:91],a[168:171],v[52:55],v[88:91]
 v_mfma_f32_16x16x32_bf16 v[92:95],a[172:175],v[52:55],v[92:95]
 ds_read_b128 v[52:55],v1 offset:29696
 v_mfma_f32_16x16x32_bf16 v[96:99],a[168:171],v[56:59],v[96:99]
 buffer_load_dwordx4 a[236:239],v0,s[12:15],s53 offen offset:3072 sc1
 v_mfma_f32_16x16x32_bf16 v[100:103],a[172:175],v[56:59],v[100:103]
 s_cmp_eq_u32 s45,15
 s_cselect_b32 s53,0,61440
 s_waitcnt vmcnt(16)
 v_add_f32 v216,v216,v220
 v_mfma_f32_16x16x32_bf16 v[104:107],a[168:171],v[60:63],v[104:107]
 s_add_u32 s53,s53,s68
 v_add_f32 v217,v217,v221
 v_add_f32 v218,v218,v222
 v_mfma_f32_16x16x32_bf16 v[108:111],a[172:175],v[60:63],v[108:111]
 v_add_f32 v219,v219,v223
 ds_read_b128 v[56:59],v1 offset:30720
 v_mfma_f32_16x16x32_bf16 v[80:83],a[176:179],v[64:67],v[80:83]
 buffer_load_dwordx4 a[240:243],v0,s[12:15],s53 offen sc1
 v_mfma_f32_16x16x32_bf16 v[84:87],a[180:183],v[64:67],v[84:87]
 s_waitcnt vmcnt(13)
 v_add_f32 v224,v224,v228
 v_add_f32 v225,v225,v229
 v_mfma_f32_16x16x32_bf16 v[88:91],a[176:179],v[68:71],v[88:91]
 ds_read_b128 v[60:63],v1 offset:31744
 ds_read_b128 v[64:67],v1 offset:32768
 v_mfma_f32_16x16x32_bf16 v[92:95],a[180:183],v[68:71],v[92:95]
 v_add_f32 v226,v226,v230
 ds_read_b128 v[68:71],v1 offset:33792
 v_mfma_f32_16x16x32_bf16 v[96:99],a[176:179],v[72:75],v[96:99]
 buffer_load_dwordx4 a[244:247],v0,s[12:15],s53 offen offset:1024 sc1
 v_mfma_f32_16x16x32_bf16 v[100:103],a[180:183],v[72:75],v[100:103]
 v_add_f32 v227,v227,v231
 v_add_f32 v216,v216,v224
 v_mfma_f32_16x16x32_bf16 v[104:107],a[176:179],v[76:79],v[104:107]
 v_add_f32 v217,v217,v225
 ds_read_b128 v[72:75],v1 offset:34816
 v_mfma_f32_16x16x32_bf16 v[108:111],a[180:183],v[76:79],v[108:111]
 s_waitcnt lgkmcnt(13)
 v_add_f32 v218,v218,v226
 ds_read_b128 v[76:79],v1 offset:35840
 v_mfma_f32_16x16x32_bf16 v[80:83],a[184:187],v[16:19],v[80:83]
 buffer_load_dwordx4 a[248:251],v0,s[12:15],s53 offen offset:2048 sc1
 v_mfma_f32_16x16x32_bf16 v[84:87],a[188:191],v[16:19],v[84:87]
 v_add_f32 v219,v219,v227
 ds_read_b128 v[16:19],v1 offset:36864
 v_mfma_f32_16x16x32_bf16 v[88:91],a[184:187],v[20:23],v[88:91]
 v_permlane16_swap_b32 v216,v217
 v_mfma_f32_16x16x32_bf16 v[92:95],a[188:191],v[20:23],v[92:95]
 s_waitcnt lgkmcnt(13)
 v_permlane16_swap_b32 v218,v219
 ds_read_b128 v[20:23],v1 offset:37888
 v_mfma_f32_16x16x32_bf16 v[96:99],a[184:187],v[24:27],v[96:99]
 buffer_load_dwordx4 a[252:255],v0,s[12:15],s53 offen offset:3072 sc1
 v_mfma_f32_16x16x32_bf16 v[100:103],a[188:191],v[24:27],v[100:103]
 s_lshl_b32 s53,s44,13
 v_add_f32 v216,v216,v217
 v_add_f32 v218,v218,v219
 v_mfma_f32_16x16x32_bf16 v[104:107],a[184:187],v[28:31],v[104:107]
 s_add_u32 s53,s53,s64
 v_permlane32_swap_b32 v216,v218
 ds_read_b128 v[24:27],v1 offset:38912
 v_mfma_f32_16x16x32_bf16 v[108:111],a[188:191],v[28:31],v[108:111]
 s_waitcnt vmcnt(14) lgkmcnt(13)
 ds_read_b128 v[28:31],v1 offset:39936
 v_mfma_f32_16x16x32_bf16 v[80:83],a[192:195],v[32:35],v[80:83]
 v_add_f32 v216,v216,v218
 v_mfma_f32_16x16x32_bf16 v[84:87],a[196:199],v[32:35],v[84:87]
 v_mul_f32 v218,0x3a800000,v216
 ds_read_b128 v[32:35],v1 offset:40960
 v_mfma_f32_16x16x32_bf16 v[88:91],a[192:195],v[36:39],v[88:91]
 v_mul_f32 v216,0x3a800000,v216
 v_mfma_f32_16x16x32_bf16 v[92:95],a[196:199],v[36:39],v[92:95]
 s_waitcnt lgkmcnt(13)
 v_permlane16_swap_b32 v216,v218
 ds_read_b128 v[36:39],v1 offset:41984
 v_mfma_f32_16x16x32_bf16 v[96:99],a[192:195],v[40:43],v[96:99]
 buffer_load_dwordx4 v0,s[12:15],s50 offen sc1 lds
 v_mfma_f32_16x16x32_bf16 v[100:103],a[196:199],v[40:43],v[100:103]
 v_fma_f32 v218,-v216,v216,v218
 ds_read_b128 v[40:43],v1 offset:43008
 v_mfma_f32_16x16x32_bf16 v[104:107],a[192:195],v[44:47],v[104:107]
 v_max_f32 v218,0,v218
 v_mfma_f32_16x16x32_bf16 v[108:111],a[196:199],v[44:47],v[108:111]
 s_waitcnt vmcnt(13) lgkmcnt(13)
 v_add_f32 v218,0x3727c5ac,v218
 ds_read_b128 v[44:47],v1 offset:44032
 v_mfma_f32_16x16x32_bf16 v[80:83],a[200:203],v[48:51],v[80:83]
 v_rsq_f32 v217,v218
 v_mfma_f32_16x16x32_bf16 v[84:87],a[204:207],v[48:51],v[84:87]
 buffer_load_dwordx4 v0,s[12:15],s50 offen offset:1024 sc1 lds
 v_mfma_f32_16x16x32_bf16 v[88:91],a[200:203],v[52:55],v[88:91]
 v_mul_f32 v244,0xc0135761,v217
 v_mul_f32 v248,v218,v217
 v_mfma_f32_16x16x32_bf16 v[92:95],a[204:207],v[52:55],v[92:95]
 s_waitcnt lgkmcnt(12)
 ds_read_b128 v[48:51],v1 offset:45056
 ds_read_b128 v[52:55],v1 offset:46080
 v_mfma_f32_16x16x32_bf16 v[96:99],a[200:203],v[56:59],v[96:99]
 v_mul_f32 v246,v217,v217
 v_mfma_f32_16x16x32_bf16 v[100:103],a[204:207],v[56:59],v[100:103]
 v_mul_f32 v246,0x3d372713,v246
 ds_read_b128 v[56:59],v1 offset:47104
 v_mfma_f32_16x16x32_bf16 v[104:107],a[200:203],v[60:63],v[104:107]
 v_mul_f32 v246,v246,v244
 v_mfma_f32_16x16x32_bf16 v[108:111],a[204:207],v[60:63],v[108:111]
 s_waitcnt vmcnt(12) lgkmcnt(13)
 buffer_load_dwordx4 v0,s[12:15],s50 offen offset:2048 sc1 lds
 v_mfma_f32_16x16x32_bf16 v[80:83],a[208:211],v[64:67],v[80:83]
 v_cvt_pk_bf16_f32 v236,-v216,-v216
 ds_read_b128 v[60:63],v1 offset:48128
 v_mfma_f32_16x16x32_bf16 v[84:87],a[212:215],v[64:67],v[84:87]
 ds_write_b32 v250,v244
 v_mfma_f32_16x16x32_bf16 v[88:91],a[208:211],v[68:71],v[88:91]
 ds_write_b32 v250,v246 offset:128
 v_mfma_f32_16x16x32_bf16 v[92:95],a[212:215],v[68:71],v[92:95]
 s_waitcnt lgkmcnt(14)
 ds_write_b32 v250,v248 offset:256
 v_mfma_f32_16x16x32_bf16 v[96:99],a[208:211],v[72:75],v[96:99]
 ds_read_b128 v[192:195],v251
 v_mfma_f32_16x16x32_bf16 v[100:103],a[212:215],v[72:75],v[100:103]
 buffer_load_dwordx4 v0,s[12:15],s50 offen offset:3072 sc1 lds
 v_mfma_f32_16x16x32_bf16 v[104:107],a[208:211],v[76:79],v[104:107]
 s_add_u32 s50,s50,4096
 ds_read_b128 v[196:199],v251 offset:64
 ds_read_b128 v[200:203],v251 offset:128
 v_mfma_f32_16x16x32_bf16 v[108:111],a[212:215],v[76:79],v[108:111]
 s_waitcnt vmcnt(12) lgkmcnt(14)
 ds_read_b128 v[204:207],v251 offset:192
 s_add_u32 m0,s54,4096
 v_mfma_f32_16x16x32_bf16 v[80:83],a[216:219],v[16:19],v[80:83]
 s_waitcnt lgkmcnt(7)
 s_barrier
 ds_read_b128 v[64:67],v2
 ds_read_b128 v[68:71],v2 offset:1024
 v_mfma_f32_16x16x32_bf16 v[84:87],a[220:223],v[16:19],v[84:87]
 ds_read_b128 v[208:211],v251 offset:256
 ds_read_b128 v[72:75],v2 offset:2048
 v_mfma_f32_16x16x32_bf16 v[88:91],a[216:219],v[20:23],v[88:91]
 buffer_load_dwordx4 v0,s[12:15],s50 offen sc1 lds
 v_mfma_f32_16x16x32_bf16 v[92:95],a[220:223],v[20:23],v[92:95]
 ds_read_b128 v[212:215],v251 offset:320
 v_mov_b32 v240,v236
 v_mfma_f32_16x16x32_bf16 v[96:99],a[216:219],v[24:27],v[96:99]
 s_nop 0
 v_permlane32_swap_b32 v236,v240
 ds_read_b128 v[76:79],v2 offset:3072
 v_mfma_f32_16x16x32_bf16 v[100:103],a[220:223],v[24:27],v[100:103]
 v_mov_b32 v245,v244
 ds_read_b128 v[16:19],v2 offset:4096
 v_mfma_f32_16x16x32_bf16 v[104:107],a[216:219],v[28:31],v[104:107]
 v_permlane32_swap_b32 v244,v245
 ds_read_b128 v[20:23],v2 offset:5120
 v_mfma_f32_16x16x32_bf16 v[108:111],a[220:223],v[28:31],v[108:111]
 s_waitcnt vmcnt(11)
 ds_read_b128 v[24:27],v2 offset:6144
 ds_read_b128 v[28:31],v2 offset:7168
 v_mfma_f32_16x16x32_bf16 v[80:83],a[224:227],v[32:35],v[80:83]
 buffer_load_dwordx4 v0,s[12:15],s50 offen offset:1024 sc1 lds
 v_mfma_f32_16x16x32_bf16 v[84:87],a[228:231],v[32:35],v[84:87]
 v_mov_b32 v247,v246
 ds_read_b128 v[32:35],v2 offset:8192
 v_mfma_f32_16x16x32_bf16 v[88:91],a[224:227],v[36:39],v[88:91]
 v_permlane32_swap_b32 v246,v247
 v_mov_b32 v249,v248
 v_mfma_f32_16x16x32_bf16 v[92:95],a[228:231],v[36:39],v[92:95]
 s_nop 0
 v_permlane32_swap_b32 v248,v249
 ds_read_b128 v[36:39],v2 offset:9216
 v_mfma_f32_16x16x32_bf16 v[96:99],a[224:227],v[40:43],v[96:99]
 v_mov_b32 v237,v236
 v_mfma_f32_16x16x32_bf16 v[100:103],a[228:231],v[40:43],v[100:103]
 ds_read_b128 v[40:43],v2 offset:10240
 v_mfma_f32_16x16x32_bf16 v[104:107],a[224:227],v[44:47],v[104:107]
 buffer_load_dwordx4 v0,s[12:15],s50 offen offset:2048 sc1 lds
 v_mfma_f32_16x16x32_bf16 v[108:111],a[228:231],v[44:47],v[108:111]
 s_waitcnt vmcnt(11)
 v_mov_b32 v238,v236
 v_mov_b32 v239,v236
 v_mfma_f32_16x16x32_bf16 v[80:83],a[232:235],v[48:51],v[80:83]
 s_add_u32 s50,s50,24576
 v_mov_b32 v241,v240
 s_add_u32 m0,s54,28672
 v_mfma_f32_16x16x32_bf16 v[84:87],a[236:239],v[48:51],v[84:87]
 v_mov_b32 v242,v240
 ds_read_b128 v[44:47],v2 offset:11264
 v_mfma_f32_16x16x32_bf16 v[88:91],a[232:235],v[52:55],v[88:91]
 v_mov_b32 v243,v240
 ds_read_b128 v[48:51],v2 offset:12288
 v_mfma_f32_16x16x32_bf16 v[92:95],a[236:239],v[52:55],v[92:95]
 ds_read_b128 v[52:55],v2 offset:13312
 v_mfma_f32_16x16x32_bf16 v[96:99],a[232:235],v[56:59],v[96:99]
 buffer_load_dwordx4 v0,s[12:15],s50 offen sc1 lds
 v_mfma_f32_16x16x32_bf16 v[100:103],a[236:239],v[56:59],v[100:103]
 ds_read_b128 v[56:59],v2 offset:14336
 v_mfma_f32_16x16x32_bf16 v[104:107],a[232:235],v[60:63],v[104:107]
 v_mfma_f32_16x16x32_bf16 v[108:111],a[236:239],v[60:63],v[108:111]
 s_waitcnt vmcnt(10) lgkmcnt(14)
 ds_read_b128 v[60:63],v2 offset:15360
 v_mfma_f32_16x16x32_bf16 v[80:83],a[240:243],v[64:67],v[80:83]
 v_mfma_f32_16x16x32_bf16 v[84:87],a[244:247],v[64:67],v[84:87]
 buffer_load_dwordx4 v0,s[12:15],s50 offen offset:1024 sc1 lds
 v_mfma_f32_16x16x32_bf16 v[88:91],a[240:243],v[68:71],v[88:91]
 ds_read_b128 v[64:67],v2 offset:16384
 v_mfma_f32_16x16x32_bf16 v[92:95],a[244:247],v[68:71],v[92:95]
 s_waitcnt lgkmcnt(13)
 ds_read_b128 v[68:71],v2 offset:17408
 v_mfma_f32_16x16x32_bf16 v[96:99],a[240:243],v[72:75],v[96:99]
 v_mfma_f32_16x16x32_bf16 v[100:103],a[244:247],v[72:75],v[100:103]
 ds_read_b128 v[72:75],v2 offset:18432
 v_mfma_f32_16x16x32_bf16 v[104:107],a[240:243],v[76:79],v[104:107]
 v_mfma_f32_16x16x32_bf16 v[108:111],a[244:247],v[76:79],v[108:111]
 s_waitcnt vmcnt(9) lgkmcnt(13)
 buffer_load_dwordx4 v0,s[12:15],s50 offen offset:2048 sc1 lds
 v_mfma_f32_16x16x32_bf16 v[80:83],a[248:251],v[16:19],v[80:83]
 ds_read_b128 v[76:79],v2 offset:19456
 v_mfma_f32_16x16x32_bf16 v[84:87],a[252:255],v[16:19],v[84:87]
 ds_read_b128 v[16:19],v2 offset:20480
 v_mfma_f32_16x16x32_bf16 v[88:91],a[248:251],v[20:23],v[88:91]
 v_mfma_f32_16x16x32_bf16 v[92:95],a[252:255],v[20:23],v[92:95]
 s_waitcnt lgkmcnt(13)
 ds_read_b128 v[20:23],v2 offset:21504
 v_mfma_f32_16x16x32_bf16 v[96:99],a[248:251],v[24:27],v[96:99]
 v_mfma_f32_16x16x32_bf16 v[100:103],a[252:255],v[24:27],v[100:103]
 buffer_load_dwordx4 v0,s[12:15],s50 offen offset:3072 sc1 lds
 v_mfma_f32_16x16x32_bf16 v[104:107],a[248:251],v[28:31],v[104:107]
 s_add_u32 s50,s50,4096
 s_add_u32 m0,s54,32768
 ds_read_b128 v[24:27],v2 offset:22528
 v_mfma_f32_16x16x32_bf16 v[108:111],a[252:255],v[28:31],v[108:111]
 s_waitcnt lgkmcnt(13)
 ds_read_b128 v[28:31],v2 offset:23552
 v_mfma_f32_16x16x32_bf16 v[80:83],v[236:239],v[32:35],v[80:83]
 v_mfma_f32_16x16x32_bf16 v[84:87],v[240:243],v[32:35],v[84:87]
 ds_read_b128 v[32:35],v2 offset:24576
 v_mfma_f32_16x16x32_bf16 v[88:91],v[236:239],v[36:39],v[88:91]
 buffer_load_dwordx4 v0,s[12:15],s50 offen sc1 lds
 v_mfma_f32_16x16x32_bf16 v[92:95],v[240:243],v[36:39],v[92:95]
 s_waitcnt lgkmcnt(13)
 ds_read_b128 v[36:39],v2 offset:25600
 v_mfma_f32_16x16x32_bf16 v[96:99],v[236:239],v[40:43],v[96:99]
 v_mul_f32 v232,v80,v80
 v_mul_f32 v233,v81,v81
 v_mfma_f32_16x16x32_bf16 v[100:103],v[240:243],v[40:43],v[100:103]
 v_fma_f32 v232,v232,v200,v192
 v_fma_f32 v233,v233,v201,v193
 v_mfma_f32_16x16x32_bf16 v[104:107],v[236:239],v[44:47],v[104:107]
 v_mul_f32 v232,v232,v80
 v_mul_f32 v233,v233,v81
 v_mfma_f32_16x16x32_bf16 v[108:111],v[240:243],v[44:47],v[108:111]
 s_waitcnt lgkmcnt(12)
 v_exp_f32 v232,v232
 v_mfma_f32_16x16x32_bf16 v[112:115],a[16:19],v[48:51],v[112:115]
 buffer_load_dwordx4 v0,s[12:15],s50 offen offset:1024 sc1 lds
 v_mfma_f32_16x16x32_bf16 v[116:119],a[20:23],v[48:51],v[116:119]
 v_exp_f32 v233,v233
 v_mfma_f32_16x16x32_bf16 v[120:123],a[16:19],v[52:55],v[120:123]
 v_fma_f32 v232,v232,v208,v208
 v_fma_f32 v233,v233,v209,v209
 v_mfma_f32_16x16x32_bf16 v[124:127],a[20:23],v[52:55],v[124:127]
 s_waitcnt lgkmcnt(10)
 v_rcp_f32 v232,v232
 v_mfma_f32_16x16x32_bf16 v[128:131],a[16:19],v[56:59],v[128:131]
 v_rcp_f32 v233,v233
 v_mfma_f32_16x16x32_bf16 v[132:135],a[20:23],v[56:59],v[132:135]
 ds_read_b128 v[40:43],v2 offset:26624
 ds_read_b128 v[44:47],v2 offset:27648
 v_mfma_f32_16x16x32_bf16 v[112:115],a[24:27],v[60:63],v[112:115]
 buffer_load_dwordx4 v0,s[12:15],s50 offen offset:2048 sc1 lds
 v_mfma_f32_16x16x32_bf16 v[116:119],a[28:31],v[60:63],v[116:119]
 s_add_u32 s50,s50,24576
 s_add_u32 m0,s54,57344
 s_waitcnt lgkmcnt(10)
 v_mfma_f32_16x16x32_bf16 v[120:123],a[24:27],v[64:67],v[120:123]
 v_mul_f32 v80,v80,v232
 v_mul_f32 v81,v81,v233
 v_mfma_f32_16x16x32_bf16 v[124:127],a[28:31],v[64:67],v[124:127]
 v_mul_f32 v217,v80,v80
 v_mul_f32 v221,v81,v81
 v_mfma_f32_16x16x32_bf16 v[128:131],a[24:27],v[68:71],v[128:131]
 v_mul_f32 v234,v82,v82
 v_mul_f32 v235,v83,v83
 v_mfma_f32_16x16x32_bf16 v[132:135],a[28:31],v[68:71],v[132:135]
 s_branch .Lsk11
.Lvs2_2:
 s_branch .Lvb2
.Lsk11:
 s_waitcnt lgkmcnt(8)
 v_fma_f32 v234,v234,v202,v194
 v_fma_f32 v235,v235,v203,v195
 v_mfma_f32_16x16x32_bf16 v[112:115],a[32:35],v[72:75],v[112:115]
 buffer_load_dwordx4 v0,s[12:15],s50 offen sc1 lds
 v_mfma_f32_16x16x32_bf16 v[116:119],a[36:39],v[72:75],v[116:119]
 s_waitcnt vmcnt(8) lgkmcnt(0)
 s_barrier
 v_mul_f32 v234,v234,v82
 v_mul_f32 v235,v235,v83
 v_mfma_f32_16x16x32_bf16 v[120:123],a[32:35],v[76:79],v[120:123]
 v_exp_f32 v234,v234
 v_mfma_f32_16x16x32_bf16 v[124:127],a[36:39],v[76:79],v[124:127]
 ds_read_b128 v[48:51],v0
 ds_read_b128 v[52:55],v0 offset:1024
 v_mfma_f32_16x16x32_bf16 v[128:131],a[32:35],v[16:19],v[128:131]
 v_exp_f32 v235,v235
 v_mfma_f32_16x16x32_bf16 v[132:135],a[36:39],v[16:19],v[132:135]
 buffer_load_dwordx4 v0,s[12:15],s50 offen offset:1024 sc1 lds
 v_mfma_f32_16x16x32_bf16 v[112:115],a[40:43],v[20:23],v[112:115]
 v_fma_f32 v234,v234,v210,v210
 v_fma_f32 v235,v235,v211,v211
 v_mfma_f32_16x16x32_bf16 v[116:119],a[44:47],v[20:23],v[116:119]
 v_rcp_f32 v234,v234
 v_mfma_f32_16x16x32_bf16 v[120:123],a[40:43],v[24:27],v[120:123]
 v_rcp_f32 v235,v235
 v_mfma_f32_16x16x32_bf16 v[124:127],a[44:47],v[24:27],v[124:127]
 ds_read_b128 v[56:59],v0 offset:2048
 ds_read_b128 v[60:63],v0 offset:3072
 v_mfma_f32_16x16x32_bf16 v[128:131],a[40:43],v[28:31],v[128:131]
 v_mul_f32 v82,v82,v234
 v_mul_f32 v83,v83,v235
 v_mfma_f32_16x16x32_bf16 v[132:135],a[44:47],v[28:31],v[132:135]
 buffer_load_dwordx4 v0,s[12:15],s50 offen offset:2048 sc1 lds
 v_mfma_f32_16x16x32_bf16 v[112:115],a[48:51],v[32:35],v[112:115]
 v_mul_f32 v225,v82,v82
 v_mul_f32 v229,v83,v83
 v_mfma_f32_16x16x32_bf16 v[116:119],a[52:55],v[32:35],v[116:119]
 v_mul_f32 v232,v84,v84
 ds_read_b128 v[64:67],v0 offset:4096
 v_mfma_f32_16x16x32_bf16 v[120:123],a[48:51],v[36:39],v[120:123]
 ds_read_b128 v[68:71],v0 offset:5120
 v_mul_f32 v233,v85,v85
 v_mfma_f32_16x16x32_bf16 v[124:127],a[52:55],v[36:39],v[124:127]
 v_fma_f32 v232,v232,v204,v196
 v_fma_f32 v233,v233,v205,v197
 v_mfma_f32_16x16x32_bf16 v[128:131],a[48:51],v[40:43],v[128:131]
 v_mul_f32 v232,v232,v84
 v_mul_f32 v233,v233,v85
 v_mfma_f32_16x16x32_bf16 v[132:135],a[52:55],v[40:43],v[132:135]
 buffer_load_dwordx4 v0,s[12:15],s50 offen offset:3072 sc1 lds
 v_mfma_f32_16x16x32_bf16 v[112:115],a[56:59],v[44:47],v[112:115]
 s_add_u32 s50,s50,4096
 ds_read_b128 v[72:75],v0 offset:6144
 ds_read_b128 v[76:79],v0 offset:7168
 v_mfma_f32_16x16x32_bf16 v[116:119],a[60:63],v[44:47],v[116:119]
 s_add_u32 m0,s54,61440
 ds_read_b128 v[16:19],v0 offset:8192
 s_waitcnt lgkmcnt(7)
 v_mfma_f32_16x16x32_bf16 v[120:123],a[56:59],v[48:51],v[120:123]
 v_exp_f32 v232,v232
 v_mfma_f32_16x16x32_bf16 v[124:127],a[60:63],v[48:51],v[124:127]
 v_exp_f32 v233,v233
 v_mfma_f32_16x16x32_bf16 v[128:131],a[56:59],v[52:55],v[128:131]
 buffer_load_dwordx4 v0,s[12:15],s50 offen sc1 lds
 v_mfma_f32_16x16x32_bf16 v[132:135],a[60:63],v[52:55],v[132:135]
 s_waitcnt lgkmcnt(5)
 v_fma_f32 v232,v232,v212,v212
 v_fma_f32 v233,v233,v213,v213
 v_mfma_f32_16x16x32_bf16 v[112:115],a[64:67],v[56:59],v[112:115]
 v_rcp_f32 v232,v232
 v_mfma_f32_16x16x32_bf16 v[116:119],a[68:71],v[56:59],v[116:119]
 ds_read_b128 v[20:23],v0 offset:9216
 v_mul_f32 v84,v84,v232
 v_mfma_f32_16x16x32_bf16 v[120:123],a[64:67],v[60:63],v[120:123]
 v_rcp_f32 v233,v233
 v_mfma_f32_16x16x32_bf16 v[124:127],a[68:71],v[60:63],v[124:127]
 s_waitcnt lgkmcnt(4)
 v_mul_f32 v85,v85,v233
 v_mul_f32 v219,v84,v84
 v_mfma_f32_16x16x32_bf16 v[128:131],a[64:67],v[64:67],v[128:131]
 buffer_load_dwordx4 v0,s[12:15],s50 offen offset:1024 sc1 lds
 v_mfma_f32_16x16x32_bf16 v[132:135],a[68:71],v[64:67],v[132:135]
 v_mul_f32 v223,v85,v85
 ds_read_b128 v[24:27],v0 offset:10240
 v_mfma_f32_16x16x32_bf16 v[112:115],a[72:75],v[68:71],v[112:115]
 ds_read_b128 v[28:31],v0 offset:11264
 v_mul_f32 v234,v86,v86
 v_mfma_f32_16x16x32_bf16 v[116:119],a[76:79],v[68:71],v[116:119]
 s_waitcnt lgkmcnt(4)
 v_mul_f32 v235,v87,v87
 v_fma_f32 v234,v234,v206,v198
 v_mfma_f32_16x16x32_bf16 v[120:123],a[72:75],v[72:75],v[120:123]
 v_fma_f32 v235,v235,v207,v199
 v_mul_f32 v234,v234,v86
 v_mfma_f32_16x16x32_bf16 v[124:127],a[76:79],v[72:75],v[124:127]
 ds_read_b128 v[32:35],v0 offset:12288
 ds_read_b128 v[36:39],v0 offset:13312
 v_mfma_f32_16x16x32_bf16 v[128:131],a[72:75],v[76:79],v[128:131]
 buffer_load_dwordx4 v0,s[12:15],s50 offen offset:2048 sc1 lds
 v_mfma_f32_16x16x32_bf16 v[132:135],a[76:79],v[76:79],v[132:135]
 s_waitcnt lgkmcnt(4)
 v_mul_f32 v235,v235,v87
 ds_read_b128 v[40:43],v0 offset:14336
 v_mfma_f32_16x16x32_bf16 v[112:115],a[80:83],v[16:19],v[112:115]
 s_add_u32 s50,s50,24576
 v_exp_f32 v234,v234
 v_mfma_f32_16x16x32_bf16 v[116:119],a[84:87],v[16:19],v[116:119]
 s_add_u32 m0,s54,86016
 v_exp_f32 v235,v235
 v_mfma_f32_16x16x32_bf16 v[120:123],a[80:83],v[20:23],v[120:123]
 v_fma_f32 v234,v234,v214,v214
 v_fma_f32 v235,v235,v215,v215
 v_mfma_f32_16x16x32_bf16 v[124:127],a[84:87],v[20:23],v[124:127]
 s_waitcnt lgkmcnt(3)
 v_rcp_f32 v234,v234
 ds_read_b128 v[44:47],v0 offset:15360
 v_mfma_f32_16x16x32_bf16 v[128:131],a[80:83],v[24:27],v[128:131]
 v_rcp_f32 v235,v235
 v_mfma_f32_16x16x32_bf16 v[132:135],a[84:87],v[24:27],v[132:135]
 v_mul_f32 v86,v86,v234
 v_mul_f32 v87,v87,v235
 v_mfma_f32_16x16x32_bf16 v[112:115],a[88:91],v[28:31],v[112:115]
 buffer_load_dwordx4 v0,s[12:15],s50 offen sc1 lds
 v_mfma_f32_16x16x32_bf16 v[116:119],a[92:95],v[28:31],v[116:119]
 s_waitcnt lgkmcnt(2)
 v_mul_f32 v227,v86,v86
 v_mul_f32 v231,v87,v87
 ds_read_b128 v[48:51],v0 offset:16384
 ds_read_b128 v[52:55],v0 offset:17408
 v_mfma_f32_16x16x32_bf16 v[120:123],a[88:91],v[32:35],v[120:123]
 v_mul_f32 v232,v88,v88
 v_mul_f32 v233,v89,v89
 v_mfma_f32_16x16x32_bf16 v[124:127],a[92:95],v[32:35],v[124:127]
 v_fma_f32 v232,v232,v200,v192
 v_fma_f32 v233,v233,v201,v193
 v_mfma_f32_16x16x32_bf16 v[128:131],a[88:91],v[36:39],v[128:131]
 buffer_load_dwordx4 v0,s[12:15],s50 offen offset:1024 sc1 lds
 v_mfma_f32_16x16x32_bf16 v[132:135],a[92:95],v[36:39],v[132:135]
 s_waitcnt lgkmcnt(2)
 v_mul_f32 v232,v232,v88
 ds_read_b128 v[56:59],v0 offset:18432
 ds_read_b128 v[60:63],v0 offset:19456
 v_mfma_f32_16x16x32_bf16 v[112:115],a[96:99],v[40:43],v[112:115]
 v_mul_f32 v233,v233,v89
 ds_read_b128 v[64:67],v0 offset:20480
 v_mfma_f32_16x16x32_bf16 v[116:119],a[100:103],v[40:43],v[116:119]
 v_exp_f32 v232,v232
 v_mfma_f32_16x16x32_bf16 v[120:123],a[96:99],v[44:47],v[120:123]
 buffer_load_ushort v255,v254,s[32:35],0 offen offset:8
 v_exp_f32 v233,v233
 v_fma_f32 v232,v232,v208,v208
 v_mfma_f32_16x16x32_bf16 v[124:127],a[100:103],v[44:47],v[124:127]
 s_waitcnt lgkmcnt(3)
 buffer_load_dwordx4 v0,s[12:15],s50 offen offset:2048 sc1 lds
 v_fma_f32 v233,v233,v209,v209
 ds_read_b128 v[68:71],v0 offset:21504
 v_mfma_f32_16x16x32_bf16 v[128:131],a[96:99],v[48:51],v[128:131]
 v_rcp_f32 v232,v232
 v_mfma_f32_16x16x32_bf16 v[132:135],a[100:103],v[48:51],v[132:135]
 v_rcp_f32 v233,v233
 v_mul_f32 v88,v88,v232
 v_mfma_f32_16x16x32_bf16 v[112:115],a[104:107],v[52:55],v[112:115]
 buffer_load_ushort v254,v254,s[32:35],0 offen
 v_mul_f32 v89,v89,v233
 v_mfma_f32_16x16x32_bf16 v[116:119],a[108:111],v[52:55],v[116:119]
 s_waitcnt lgkmcnt(2)
 v_add_f32 v216,v88,v80
 ds_read_b128 v[72:75],v0 offset:22528
 ds_read_b128 v[76:79],v0 offset:23552
 v_mfma_f32_16x16x32_bf16 v[120:123],a[104:107],v[56:59],v[120:123]
 v_add_f32 v220,v89,v81
 v_fma_f32 v217,v88,v88,v217
 v_mfma_f32_16x16x32_bf16 v[124:127],a[108:111],v[56:59],v[124:127]
 buffer_load_dwordx4 v0,s[12:15],s50 offen offset:3072 sc1 lds
 s_add_u32 s50,s50,4096
 s_add_u32 m0,s54,90112
 v_fma_f32 v221,v89,v89,v221
 v_mfma_f32_16x16x32_bf16 v[128:131],a[104:107],v[60:63],v[128:131]
 v_mul_f32 v234,v90,v90
 v_mul_f32 v235,v91,v91
 v_mfma_f32_16x16x32_bf16 v[132:135],a[108:111],v[60:63],v[132:135]
 s_waitcnt lgkmcnt(2)
 ds_read_b128 v[16:19],v0 offset:24576
 ds_read_b128 v[20:23],v0 offset:25600
 ds_read_b128 v[24:27],v0 offset:26624
 ds_read_b128 v[28:31],v0 offset:27648
 v_mfma_f32_16x16x32_bf16 v[112:115],a[112:115],v[64:67],v[112:115]
 v_fma_f32 v234,v234,v202,v194
 v_fma_f32 v235,v235,v203,v195
 v_mfma_f32_16x16x32_bf16 v[116:119],a[116:119],v[64:67],v[116:119]
 v_mul_f32 v234,v234,v90
 v_mul_f32 v235,v235,v91
 v_mfma_f32_16x16x32_bf16 v[120:123],a[112:115],v[68:71],v[120:123]
 buffer_load_dwordx4 v0,s[12:15],s50 offen sc1 lds
 v_mfma_f32_16x16x32_bf16 v[124:127],a[116:119],v[68:71],v[124:127]
 s_waitcnt lgkmcnt(4)
 v_exp_f32 v234,v234
 v_mfma_f32_16x16x32_bf16 v[128:131],a[112:115],v[72:75],v[128:131]
 v_exp_f32 v235,v235
 v_fma_f32 v234,v234,v210,v210
 v_mfma_f32_16x16x32_bf16 v[132:135],a[116:119],v[72:75],v[132:135]
 v_fma_f32 v235,v235,v211,v211
 v_mul_f32 v232,v92,v92
 v_mfma_f32_16x16x32_bf16 v[112:115],a[120:123],v[76:79],v[112:115]
 v_rcp_f32 v234,v234
 v_mfma_f32_16x16x32_bf16 v[116:119],a[124:127],v[76:79],v[116:119]
 s_waitcnt vmcnt(14) lgkmcnt(0)
 v_rcp_f32 v235,v235
 v_mul_f32 v90,v90,v234
 s_barrier
 ds_read_b128 v[32:35],v0 offset:28672
 ds_read_b128 v[36:39],v0 offset:29696
 v_mfma_f32_16x16x32_bf16 v[120:123],a[120:123],v[16:19],v[120:123]
 buffer_load_dwordx4 v0,s[12:15],s50 offen offset:1024 sc1 lds
 v_mul_f32 v91,v91,v235
 v_mfma_f32_16x16x32_bf16 v[124:127],a[124:127],v[16:19],v[124:127]
 v_add_f32 v224,v90,v82
 v_add_f32 v228,v91,v83
 v_mfma_f32_16x16x32_bf16 v[128:131],a[120:123],v[20:23],v[128:131]
 v_fma_f32 v225,v90,v90,v225
 v_fma_f32 v229,v91,v91,v229
 v_mfma_f32_16x16x32_bf16 v[132:135],a[124:127],v[20:23],v[132:135]
 ds_read_b128 v[40:43],v0 offset:30720
 ds_read_b128 v[44:47],v0 offset:31744
 v_mfma_f32_16x16x32_bf16 v[112:115],a[128:131],v[24:27],v[112:115]
 v_mul_f32 v233,v93,v93
 v_fma_f32 v232,v232,v204,v196
 v_mfma_f32_16x16x32_bf16 v[116:119],a[132:135],v[24:27],v[116:119]
 v_fma_f32 v233,v233,v205,v197
 v_mul_f32 v232,v232,v92
 v_mfma_f32_16x16x32_bf16 v[120:123],a[128:131],v[28:31],v[120:123]
 buffer_load_dwordx4 v0,s[12:15],s50 offen offset:2048 sc1 lds
 s_add_u32 s50,s50,24576
 s_add_u32 m0,s54,131072
 v_mfma_f32_16x16x32_bf16 v[124:127],a[132:135],v[28:31],v[124:127]
 s_waitcnt lgkmcnt(2)
 ds_read_b128 v[48:51],v0 offset:32768
 ds_read_b128 v[52:55],v0 offset:33792
 v_mfma_f32_16x16x32_bf16 v[128:131],a[128:131],v[32:35],v[128:131]
 v_mul_f32 v233,v233,v93
 ds_read_b128 v[56:59],v0 offset:34816
 v_mfma_f32_16x16x32_bf16 v[132:135],a[132:135],v[32:35],v[132:135]
 v_exp_f32 v232,v232
 v_mfma_f32_16x16x32_bf16 v[112:115],a[136:139],v[36:39],v[112:115]
 v_exp_f32 v233,v233
 v_fma_f32 v232,v232,v212,v212
 v_mfma_f32_16x16x32_bf16 v[116:119],a[140:143],v[36:39],v[116:119]
 s_waitcnt lgkmcnt(3)
 v_fma_f32 v233,v233,v213,v213
 ds_read_b128 v[60:63],v0 offset:35840
 v_mfma_f32_16x16x32_bf16 v[120:123],a[136:139],v[40:43],v[120:123]
 buffer_load_dwordx4 v0,s[12:15],s50 offen sc1 lds
 v_rcp_f32 v232,v232
 v_mfma_f32_16x16x32_bf16 v[124:127],a[140:143],v[40:43],v[124:127]
 v_rcp_f32 v233,v233
 v_mul_f32 v92,v92,v232
 v_mfma_f32_16x16x32_bf16 v[128:131],a[136:139],v[44:47],v[128:131]
 v_mul_f32 v93,v93,v233
 v_add_f32 v218,v92,v84
 v_mfma_f32_16x16x32_bf16 v[132:135],a[140:143],v[44:47],v[132:135]
 s_waitcnt lgkmcnt(2)
 ds_read_b128 v[64:67],v0 offset:36864
 ds_read_b128 v[68:71],v0 offset:37888
 v_mfma_f32_16x16x32_bf16 v[112:115],a[144:147],v[48:51],v[112:115]
 v_add_f32 v222,v93,v85
 v_fma_f32 v219,v92,v92,v219
 v_mfma_f32_16x16x32_bf16 v[116:119],a[148:151],v[48:51],v[116:119]
 buffer_load_dwordx4 v0,s[12:15],s50 offen offset:1024 sc1 lds
 v_fma_f32 v223,v93,v93,v223
 v_mfma_f32_16x16x32_bf16 v[120:123],a[144:147],v[52:55],v[120:123]
 v_mul_f32 v234,v94,v94
 v_mul_f32 v235,v95,v95
 v_mfma_f32_16x16x32_bf16 v[124:127],a[148:151],v[52:55],v[124:127]
 s_waitcnt lgkmcnt(2)
 ds_read_b128 v[72:75],v0 offset:38912
 ds_read_b128 v[76:79],v0 offset:39936
 v_mfma_f32_16x16x32_bf16 v[128:131],a[144:147],v[56:59],v[128:131]
 v_fma_f32 v234,v234,v206,v198
 v_fma_f32 v235,v235,v207,v199
 v_mfma_f32_16x16x32_bf16 v[132:135],a[148:151],v[56:59],v[132:135]
 v_mul_f32 v234,v234,v94
 v_mul_f32 v235,v235,v95
 v_mfma_f32_16x16x32_bf16 v[112:115],a[152:155],v[60:63],v[112:115]
 v_exp_f32 v234,v234
 v_mfma_f32_16x16x32_bf16 v[116:119],a[156:159],v[60:63],v[116:119]
 s_waitcnt lgkmcnt(2)
 buffer_load_dwordx4 v0,s[12:15],s50 offen offset:2048 sc1 lds
 ds_read_b128 v[16:19],v0 offset:40960
 ds_read_b128 v[20:23],v0 offset:41984
 v_mfma_f32_16x16x32_bf16 v[120:123],a[152:155],v[64:67],v[120:123]
 v_exp_f32 v235,v235
 v_fma_f32 v234,v234,v214,v214
 v_mfma_f32_16x16x32_bf16 v[124:127],a[156:159],v[64:67],v[124:127]
 v_fma_f32 v235,v235,v215,v215
 ds_read_b128 v[24:27],v0 offset:43008
 v_mfma_f32_16x16x32_bf16 v[128:131],a[152:155],v[68:71],v[128:131]
 v_rcp_f32 v234,v234
 v_mfma_f32_16x16x32_bf16 v[132:135],a[156:159],v[68:71],v[132:135]
 s_waitcnt lgkmcnt(3)
 v_rcp_f32 v235,v235
 v_mul_f32 v94,v94,v234
 ds_read_b128 v[28:31],v0 offset:44032
 v_mfma_f32_16x16x32_bf16 v[112:115],a[160:163],v[72:75],v[112:115]
 v_mul_f32 v95,v95,v235
 v_add_f32 v226,v94,v86
 v_mfma_f32_16x16x32_bf16 v[116:119],a[164:167],v[72:75],v[116:119]
 buffer_load_dwordx4 v0,s[12:15],s50 offen offset:3072 sc1 lds
 s_add_u32 s50,s50,4096
 s_add_u32 m0,s54,135168
 v_mfma_f32_16x16x32_bf16 v[120:123],a[160:163],v[76:79],v[120:123]
 v_add_f32 v230,v95,v87
 v_fma_f32 v227,v94,v94,v227
 v_mfma_f32_16x16x32_bf16 v[124:127],a[164:167],v[76:79],v[124:127]
 s_waitcnt lgkmcnt(2)
 v_fma_f32 v231,v95,v95,v231
 ds_read_b128 v[32:35],v0 offset:45056
 ds_read_b128 v[36:39],v0 offset:46080
 v_mfma_f32_16x16x32_bf16 v[128:131],a[160:163],v[16:19],v[128:131]
 v_mul_f32 v232,v96,v96
 v_mul_f32 v233,v97,v97
 v_mfma_f32_16x16x32_bf16 v[132:135],a[164:167],v[16:19],v[132:135]
 v_fma_f32 v232,v232,v200,v192
 v_fma_f32 v233,v233,v201,v193
 v_mfma_f32_16x16x32_bf16 v[112:115],a[168:171],v[20:23],v[112:115]
 buffer_load_dwordx4 v0,s[12:15],s50 offen sc1 lds
 v_mfma_f32_16x16x32_bf16 v[116:119],a[172:175],v[20:23],v[116:119]
 s_waitcnt lgkmcnt(2)
 v_mul_f32 v232,v232,v96
 ds_read_b128 v[40:43],v0 offset:47104
 ds_read_b128 v[44:47],v0 offset:48128
 v_mfma_f32_16x16x32_bf16 v[120:123],a[168:171],v[24:27],v[120:123]
 v_mul_f32 v233,v233,v97
 ds_read_b128 v[48:51],v0 offset:49152
 v_mfma_f32_16x16x32_bf16 v[124:127],a[172:175],v[24:27],v[124:127]
 v_exp_f32 v232,v232
 v_mfma_f32_16x16x32_bf16 v[128:131],a[168:171],v[28:31],v[128:131]
 v_exp_f32 v233,v233
 v_fma_f32 v232,v232,v208,v208
 v_mfma_f32_16x16x32_bf16 v[132:135],a[172:175],v[28:31],v[132:135]
 s_waitcnt lgkmcnt(3)
 v_fma_f32 v233,v233,v209,v209
 ds_read_b128 v[52:55],v0 offset:50176
 v_mfma_f32_16x16x32_bf16 v[112:115],a[176:179],v[32:35],v[112:115]
 buffer_load_dwordx4 v0,s[12:15],s50 offen offset:1024 sc1 lds
 v_rcp_f32 v232,v232
 v_mfma_f32_16x16x32_bf16 v[116:119],a[180:183],v[32:35],v[116:119]
 v_rcp_f32 v233,v233
 v_mfma_f32_16x16x32_bf16 v[120:123],a[176:179],v[36:39],v[120:123]
 v_mul_f32 v96,v96,v232
 v_mul_f32 v97,v97,v233
 v_mfma_f32_16x16x32_bf16 v[124:127],a[180:183],v[36:39],v[124:127]
 s_waitcnt lgkmcnt(2)
 v_add_f32 v216,v216,v96
 ds_read_b128 v[56:59],v0 offset:51200
 ds_read_b128 v[60:63],v0 offset:52224
 v_mfma_f32_16x16x32_bf16 v[128:131],a[176:179],v[40:43],v[128:131]
 buffer_load_dwordx4 a[0:3],v0,s[12:15],s53 offen sc1
 v_add_f32 v220,v220,v97
 v_mfma_f32_16x16x32_bf16 v[132:135],a[180:183],v[40:43],v[132:135]
 v_fma_f32 v217,v96,v96,v217
 v_fma_f32 v221,v97,v97,v221
 v_mfma_f32_16x16x32_bf16 v[112:115],a[184:187],v[44:47],v[112:115]
 buffer_load_dwordx4 v0,s[12:15],s50 offen offset:2048 sc1 lds
 s_add_u32 m0,s55,114688
 s_nop 0
 buffer_load_dwordx4 v14,s[12:15],s49 offen sc1 lds
 s_mov_b32 s49,4096
 s_add_u32 m0,s55,118784
 s_nop 0
 buffer_load_dwordx4 v14,s[12:15],s49 offen sc1 lds
 s_mov_b32 s49,8192
 s_add_u32 m0,s55,122880
 s_nop 0
 buffer_load_dwordx4 v14,s[12:15],s49 offen sc1 lds
 s_mov_b32 s49,12288
 s_add_u32 m0,s55,126976
 s_nop 0
 buffer_load_dwordx4 v14,s[12:15],s49 offen sc1 lds
 v_mul_f32 v234,v98,v98
 v_mfma_f32_16x16x32_bf16 v[116:119],a[188:191],v[44:47],v[116:119]
 s_waitcnt lgkmcnt(2)
 v_mul_f32 v235,v99,v99
 ds_read_b128 v[64:67],v0 offset:53248
 ds_read_b128 v[68:71],v0 offset:54272
 ds_read_b128 v[72:75],v0 offset:55296
 ds_read_b128 v[76:79],v0 offset:56320
 v_mfma_f32_16x16x32_bf16 v[120:123],a[184:187],v[48:51],v[120:123]
 s_add_u32 s50,s50,24576
 v_fma_f32 v234,v234,v202,v194
 v_fma_f32 v235,v235,v203,v195
 v_mfma_f32_16x16x32_bf16 v[124:127],a[188:191],v[48:51],v[124:127]
 s_add_u32 m0,s54,0
 v_mul_f32 v234,v234,v98
 v_mul_f32 v235,v235,v99
 v_mfma_f32_16x16x32_bf16 v[128:131],a[184:187],v[52:55],v[128:131]
 v_exp_f32 v234,v234
 v_mfma_f32_16x16x32_bf16 v[132:135],a[188:191],v[52:55],v[132:135]
 s_waitcnt lgkmcnt(4)
 v_exp_f32 v235,v235
 v_mfma_f32_16x16x32_bf16 v[112:115],a[192:195],v[56:59],v[112:115]
 v_fma_f32 v234,v234,v210,v210
 v_fma_f32 v235,v235,v211,v211
 v_mfma_f32_16x16x32_bf16 v[116:119],a[196:199],v[56:59],v[116:119]
 v_rcp_f32 v234,v234
 v_mfma_f32_16x16x32_bf16 v[120:123],a[192:195],v[60:63],v[120:123]
 buffer_load_dwordx4 v0,s[12:15],s50 offen sc1 lds
 v_mfma_f32_16x16x32_bf16 v[124:127],a[196:199],v[60:63],v[124:127]
 s_waitcnt vmcnt(22) lgkmcnt(0)
 v_rcp_f32 v235,v235
 s_barrier
 ds_read_b128 v[16:19],v0 offset:57344
 ds_read_b128 v[20:23],v0 offset:58368
 v_mfma_f32_16x16x32_bf16 v[128:131],a[192:195],v[64:67],v[128:131]
 v_mul_f32 v98,v98,v234
 v_mul_f32 v99,v99,v235
 v_mfma_f32_16x16x32_bf16 v[132:135],a[196:199],v[64:67],v[132:135]
 v_add_f32 v224,v224,v98
 v_add_f32 v228,v228,v99
 v_mfma_f32_16x16x32_bf16 v[112:115],a[200:203],v[68:71],v[112:115]
 buffer_load_dwordx4 a[4:7],v0,s[12:15],s53 offen offset:1024 sc1
 v_mfma_f32_16x16x32_bf16 v[116:119],a[204:207],v[68:71],v[116:119]
 v_fma_f32 v225,v98,v98,v225
 v_fma_f32 v229,v99,v99,v229
 buffer_load_dwordx4 v0,s[12:15],s50 offen offset:1024 sc1 lds
 ds_read_b128 v[24:27],v0 offset:59392
 ds_read_b128 v[28:31],v0 offset:60416
 v_mfma_f32_16x16x32_bf16 v[120:123],a[200:203],v[72:75],v[120:123]
 v_mul_f32 v232,v100,v100
 v_mul_f32 v233,v101,v101
 v_mfma_f32_16x16x32_bf16 v[124:127],a[204:207],v[72:75],v[124:127]
 v_fma_f32 v232,v232,v204,v196
 v_fma_f32 v233,v233,v205,v197
 v_mfma_f32_16x16x32_bf16 v[128:131],a[200:203],v[76:79],v[128:131]
 v_mul_f32 v232,v232,v100
 ds_read_b128 v[32:35],v0 offset:61440
 v_mfma_f32_16x16x32_bf16 v[132:135],a[204:207],v[76:79],v[132:135]
 s_waitcnt lgkmcnt(3)
 ds_read_b128 v[36:39],v0 offset:62464
 v_mul_f32 v233,v233,v101
 v_mfma_f32_16x16x32_bf16 v[112:115],a[208:211],v[16:19],v[112:115]
 v_exp_f32 v232,v232
 v_mfma_f32_16x16x32_bf16 v[116:119],a[212:215],v[16:19],v[116:119]
 buffer_load_dwordx4 v0,s[12:15],s50 offen offset:2048 sc1 lds
 v_mfma_f32_16x16x32_bf16 v[120:123],a[208:211],v[20:23],v[120:123]
 v_exp_f32 v233,v233
 v_fma_f32 v232,v232,v212,v212
 v_mfma_f32_16x16x32_bf16 v[124:127],a[212:215],v[20:23],v[124:127]
 s_waitcnt lgkmcnt(2)
 v_fma_f32 v233,v233,v213,v213
 ds_read_b128 v[40:43],v0 offset:63488
 ds_read_b128 v[44:47],v0 offset:64512
 v_mfma_f32_16x16x32_bf16 v[128:131],a[208:211],v[24:27],v[128:131]
 v_rcp_f32 v232,v232
 v_mfma_f32_16x16x32_bf16 v[132:135],a[212:215],v[24:27],v[132:135]
 v_rcp_f32 v233,v233
 v_mfma_f32_16x16x32_bf16 v[112:115],a[216:219],v[28:31],v[112:115]
 v_mul_f32 v100,v100,v232
 v_mul_f32 v101,v101,v233
 v_mfma_f32_16x16x32_bf16 v[116:119],a[220:223],v[28:31],v[116:119]
 s_waitcnt lgkmcnt(2)
 v_add_f32 v218,v218,v100
 buffer_load_dwordx4 v0,s[12:15],s50 offen offset:3072 sc1 lds
 ds_read_b128 v[48:51],v1
 ds_read_b128 v[52:55],v1 offset:1024
 v_mfma_f32_16x16x32_bf16 v[120:123],a[216:219],v[32:35],v[120:123]
 s_add_u32 s50,s50,4096
 v_add_f32 v222,v222,v101
 v_fma_f32 v219,v100,v100,v219
 v_mfma_f32_16x16x32_bf16 v[124:127],a[220:223],v[32:35],v[124:127]
 s_add_u32 m0,s54,4096
 v_fma_f32 v223,v101,v101,v223
 v_mul_f32 v234,v102,v102
 v_mfma_f32_16x16x32_bf16 v[128:131],a[216:219],v[36:39],v[128:131]
 s_add_u32 s58,s58,262144
 buffer_load_dwordx4 a[8:11],v0,s[12:15],s53 offen offset:2048 sc1
 v_mfma_f32_16x16x32_bf16 v[132:135],a[220:223],v[36:39],v[132:135]
 s_waitcnt lgkmcnt(2)
 v_mul_f32 v235,v103,v103
 ds_read_b128 v[56:59],v1 offset:2048
 ds_read_b128 v[60:63],v1 offset:3072
 v_mfma_f32_16x16x32_bf16 v[112:115],a[224:227],v[40:43],v[112:115]
 v_fma_f32 v234,v234,v206,v198
 buffer_load_dwordx4 v0,s[12:15],s50 offen sc1 lds
 v_mfma_f32_16x16x32_bf16 v[116:119],a[228:231],v[40:43],v[116:119]
 s_add_u32 s57,s57,262144
 v_fma_f32 v235,v235,v207,v199
 v_mul_f32 v234,v234,v102
 v_mfma_f32_16x16x32_bf16 v[120:123],a[224:227],v[44:47],v[120:123]
 v_mul_f32 v235,v235,v103
 ds_read_b128 v[64:67],v1 offset:4096
 v_mfma_f32_16x16x32_bf16 v[124:127],a[228:231],v[44:47],v[124:127]
 s_waitcnt lgkmcnt(3)
 v_exp_f32 v234,v234
 ds_read_b128 v[68:71],v1 offset:5120
 v_mfma_f32_16x16x32_bf16 v[128:131],a[224:227],v[48:51],v[128:131]
 v_exp_f32 v235,v235
 v_fma_f32 v234,v234,v214,v214
 v_mfma_f32_16x16x32_bf16 v[132:135],a[228:231],v[48:51],v[132:135]
 v_fma_f32 v235,v235,v215,v215
 ds_read_b128 v[72:75],v1 offset:6144
 v_mfma_f32_16x16x32_bf16 v[112:115],a[232:235],v[52:55],v[112:115]
 v_rcp_f32 v234,v234
 buffer_load_dwordx4 v0,s[12:15],s50 offen offset:1024 sc1 lds
 v_mfma_f32_16x16x32_bf16 v[116:119],a[236:239],v[52:55],v[116:119]
 s_waitcnt lgkmcnt(3)
 v_rcp_f32 v235,v235
 ds_read_b128 v[76:79],v1 offset:7168
 v_mfma_f32_16x16x32_bf16 v[120:123],a[232:235],v[56:59],v[120:123]
 v_mul_f32 v102,v102,v234
 v_mul_f32 v103,v103,v235
 v_mfma_f32_16x16x32_bf16 v[124:127],a[236:239],v[56:59],v[124:127]
 v_add_f32 v226,v226,v102
 v_add_f32 v230,v230,v103
 v_mfma_f32_16x16x32_bf16 v[128:131],a[232:235],v[60:63],v[128:131]
 v_fma_f32 v227,v102,v102,v227
 v_fma_f32 v231,v103,v103,v231
 v_mfma_f32_16x16x32_bf16 v[132:135],a[236:239],v[60:63],v[132:135]
 s_waitcnt lgkmcnt(2)
 ds_read_b128 v[16:19],v1 offset:8192
 ds_read_b128 v[20:23],v1 offset:9216
 v_mfma_f32_16x16x32_bf16 v[112:115],a[240:243],v[64:67],v[112:115]
 v_mul_f32 v232,v104,v104
 buffer_load_dwordx4 v0,s[12:15],s50 offen offset:2048 sc1 lds
 v_mfma_f32_16x16x32_bf16 v[116:119],a[244:247],v[64:67],v[116:119]
 buffer_load_dwordx4 a[12:15],v0,s[12:15],s53 offen offset:3072 sc1
 v_mul_f32 v233,v105,v105
 v_mfma_f32_16x16x32_bf16 v[120:123],a[240:243],v[68:71],v[120:123]
 s_add_u32 s50,s50,24576
 v_fma_f32 v232,v232,v200,v192
 v_fma_f32 v233,v233,v201,v193
 v_mfma_f32_16x16x32_bf16 v[124:127],a[244:247],v[68:71],v[124:127]
 s_waitcnt lgkmcnt(2)
 v_mul_f32 v232,v232,v104
 ds_read_b128 v[24:27],v1 offset:10240
 ds_read_b128 v[28:31],v1 offset:11264
 v_mfma_f32_16x16x32_bf16 v[128:131],a[240:243],v[72:75],v[128:131]
 s_add_u32 m0,s54,28672
 v_mul_f32 v233,v233,v105
 ds_read_b128 v[32:35],v1 offset:12288
 v_mfma_f32_16x16x32_bf16 v[132:135],a[244:247],v[72:75],v[132:135]
 s_add_u32 s53,s53,4096
 v_exp_f32 v232,v232
 v_mfma_f32_16x16x32_bf16 v[112:115],a[248:251],v[76:79],v[112:115]
 v_exp_f32 v233,v233
 v_fma_f32 v232,v232,v208,v208
 buffer_load_dwordx4 v0,s[12:15],s50 offen sc1 lds
 v_mfma_f32_16x16x32_bf16 v[116:119],a[252:255],v[76:79],v[116:119]
 s_waitcnt lgkmcnt(3)
 v_fma_f32 v233,v233,v209,v209
 ds_read_b128 v[36:39],v1 offset:13312
 v_mfma_f32_16x16x32_bf16 v[120:123],a[248:251],v[16:19],v[120:123]
 v_rcp_f32 v232,v232
 v_mfma_f32_16x16x32_bf16 v[124:127],a[252:255],v[16:19],v[124:127]
 v_rcp_f32 v233,v233
 v_mfma_f32_16x16x32_bf16 v[128:131],a[248:251],v[20:23],v[128:131]
 v_mul_f32 v104,v104,v232
 v_mul_f32 v105,v105,v233
 v_mfma_f32_16x16x32_bf16 v[132:135],a[252:255],v[20:23],v[132:135]
 s_waitcnt lgkmcnt(2)
 v_add_f32 v216,v216,v104
 buffer_load_dwordx4 v0,s[12:15],s50 offen offset:1024 sc1 lds
 ds_read_b128 v[40:43],v1 offset:14336
 ds_read_b128 v[44:47],v1 offset:15360
 v_mfma_f32_16x16x32_bf16 v[112:115],v[236:239],v[24:27],v[112:115]
 v_add_f32 v220,v220,v105
 v_fma_f32 v217,v104,v104,v217
 v_mfma_f32_16x16x32_bf16 v[116:119],v[240:243],v[24:27],v[116:119]
 v_fma_f32 v221,v105,v105,v221
 v_mul_f32 v234,v106,v106
 v_mfma_f32_16x16x32_bf16 v[120:123],v[236:239],v[28:31],v[120:123]
 v_mul_f32 v235,v107,v107
 ds_read_b128 v[48:51],v1 offset:16384
 v_mfma_f32_16x16x32_bf16 v[124:127],v[240:243],v[28:31],v[124:127]
 s_waitcnt lgkmcnt(3)
 ds_read_b128 v[52:55],v1 offset:17408
 ds_read_b128 v[56:59],v1 offset:18432
 ds_read_b128 v[60:63],v1 offset:19456
 v_mfma_f32_16x16x32_bf16 v[128:131],v[236:239],v[32:35],v[128:131]
 v_fma_f32 v234,v234,v202,v194
 v_fma_f32 v235,v235,v203,v195
 v_mfma_f32_16x16x32_bf16 v[132:135],v[240:243],v[32:35],v[132:135]
 v_mul_f32 v234,v234,v106
 buffer_load_dwordx4 v0,s[12:15],s50 offen offset:2048 sc1 lds
 v_mfma_f32_16x16x32_bf16 v[136:139],v[36:39],a[16:19],v[136:139]
 v_mul_f32 v235,v235,v107
 v_mul_f32 v232,v108,v108
 v_mfma_f32_16x16x32_bf16 v[140:143],v[36:39],a[20:23],v[140:143]
 s_waitcnt lgkmcnt(4)
 v_exp_f32 v234,v234
 v_mfma_f32_16x16x32_bf16 v[144:147],v[40:43],a[16:19],v[144:147]
 v_exp_f32 v235,v235
 v_fma_f32 v234,v234,v210,v210
 v_mfma_f32_16x16x32_bf16 v[148:151],v[40:43],a[20:23],v[148:151]
 v_fma_f32 v235,v235,v211,v211
 v_mul_f32 v233,v109,v109
 v_mfma_f32_16x16x32_bf16 v[152:155],v[44:47],a[16:19],v[152:155]
 v_rcp_f32 v234,v234
 v_mfma_f32_16x16x32_bf16 v[156:159],v[44:47],a[20:23],v[156:159]
 s_waitcnt vmcnt(25) lgkmcnt(0)
 v_rcp_f32 v235,v235
 buffer_load_dwordx4 v0,s[12:15],s50 offen offset:3072 sc1 lds
 s_barrier
 ds_read_b128 v[64:67],v1 offset:20480
 ds_read_b128 v[68:71],v1 offset:21504
 v_mfma_f32_16x16x32_bf16 v[160:163],v[48:51],a[16:19],v[160:163]
 s_add_u32 s50,s50,4096
 v_mul_f32 v106,v106,v234
 v_mul_f32 v107,v107,v235
 v_mfma_f32_16x16x32_bf16 v[164:167],v[48:51],a[20:23],v[164:167]
 s_add_u32 m0,s54,32768
 v_add_f32 v224,v224,v106
 v_add_f32 v228,v228,v107
 v_mfma_f32_16x16x32_bf16 v[168:171],v[52:55],a[16:19],v[168:171]
 s_branch .Lsk12
.Lvs2_3:
 s_branch .Lvb2
.Lsk12:
 v_fma_f32 v225,v106,v106,v225
 v_fma_f32 v229,v107,v107,v229
 v_mfma_f32_16x16x32_bf16 v[172:175],v[52:55],a[20:23],v[172:175]
 ds_read_b128 v[72:75],v1 offset:22528
 ds_read_b128 v[76:79],v1 offset:23552
 v_mfma_f32_16x16x32_bf16 v[176:179],v[56:59],a[16:19],v[176:179]
 buffer_load_dwordx4 v0,s[12:15],s50 offen sc1 lds
 v_mfma_f32_16x16x32_bf16 v[180:183],v[56:59],a[20:23],v[180:183]
 v_fma_f32 v232,v232,v204,v196
 v_fma_f32 v233,v233,v205,v197
 v_mfma_f32_16x16x32_bf16 v[184:187],v[60:63],a[16:19],v[184:187]
 buffer_load_dwordx4 a[16:19],v0,s[12:15],s53 offen sc1
 v_mfma_f32_16x16x32_bf16 v[188:191],v[60:63],a[20:23],v[188:191]
 s_waitcnt lgkmcnt(2)
 v_mul_f32 v232,v232,v108
 ds_read_b128 v[16:19],v1 offset:24576
 ds_read_b128 v[20:23],v1 offset:25600
 v_mfma_f32_16x16x32_bf16 v[136:139],v[64:67],a[24:27],v[136:139]
 v_mul_f32 v233,v233,v109
 ds_read_b128 v[24:27],v1 offset:26624
 v_mfma_f32_16x16x32_bf16 v[140:143],v[64:67],a[28:31],v[140:143]
 v_exp_f32 v232,v232
 v_mfma_f32_16x16x32_bf16 v[144:147],v[68:71],a[24:27],v[144:147]
 v_exp_f32 v233,v233
 v_fma_f32 v232,v232,v212,v212
 buffer_load_dwordx4 v0,s[12:15],s50 offen offset:1024 sc1 lds
 v_mfma_f32_16x16x32_bf16 v[148:151],v[68:71],a[28:31],v[148:151]
 s_waitcnt lgkmcnt(3)
 v_fma_f32 v233,v233,v213,v213
 ds_read_b128 v[28:31],v1 offset:27648
 v_mfma_f32_16x16x32_bf16 v[152:155],v[72:75],a[24:27],v[152:155]
 v_rcp_f32 v232,v232
 buffer_load_dwordx4 a[20:23],v0,s[12:15],s53 offen offset:1024 sc1
 v_mfma_f32_16x16x32_bf16 v[156:159],v[72:75],a[28:31],v[156:159]
 v_rcp_f32 v233,v233
 v_mfma_f32_16x16x32_bf16 v[160:163],v[76:79],a[24:27],v[160:163]
 v_mul_f32 v108,v108,v232
 v_mul_f32 v109,v109,v233
 v_mfma_f32_16x16x32_bf16 v[164:167],v[76:79],a[28:31],v[164:167]
 s_waitcnt lgkmcnt(2)
 v_add_f32 v218,v218,v108
 ds_read_b128 v[32:35],v1 offset:28672
 ds_read_b128 v[36:39],v1 offset:29696
 v_mfma_f32_16x16x32_bf16 v[168:171],v[16:19],a[24:27],v[168:171]
 v_add_f32 v222,v222,v109
 buffer_load_dwordx4 v0,s[12:15],s50 offen offset:2048 sc1 lds
 v_mfma_f32_16x16x32_bf16 v[172:175],v[16:19],a[28:31],v[172:175]
 s_add_u32 s50,s50,24576
 v_fma_f32 v219,v108,v108,v219
 v_fma_f32 v223,v109,v109,v223
 v_mfma_f32_16x16x32_bf16 v[176:179],v[20:23],a[24:27],v[176:179]
 s_add_u32 m0,s54,57344
 v_mul_f32 v234,v110,v110
 v_mul_f32 v235,v111,v111
 v_mfma_f32_16x16x32_bf16 v[180:183],v[20:23],a[28:31],v[180:183]
 s_waitcnt lgkmcnt(2)
 ds_read_b128 v[40:43],v1 offset:30720
 ds_read_b128 v[44:47],v1 offset:31744
 v_mfma_f32_16x16x32_bf16 v[184:187],v[24:27],a[24:27],v[184:187]
 v_fma_f32 v234,v234,v206,v198
 v_fma_f32 v235,v235,v207,v199
 v_mfma_f32_16x16x32_bf16 v[188:191],v[24:27],a[28:31],v[188:191]
 v_mul_f32 v234,v234,v110
 v_mul_f32 v235,v235,v111
 v_mfma_f32_16x16x32_bf16 v[136:139],v[28:31],a[32:35],v[136:139]
 buffer_load_dwordx4 v0,s[12:15],s50 offen sc1 lds
 v_mfma_f32_16x16x32_bf16 v[140:143],v[28:31],a[36:39],v[140:143]
 s_waitcnt lgkmcnt(2)
 v_exp_f32 v234,v234
 buffer_load_dwordx4 a[24:27],v0,s[12:15],s53 offen offset:2048 sc1
 ds_read_b128 v[48:51],v1 offset:32768
 ds_read_b128 v[52:55],v1 offset:33792
 v_mfma_f32_16x16x32_bf16 v[144:147],v[32:35],a[32:35],v[144:147]
 v_exp_f32 v235,v235
 v_fma_f32 v234,v234,v214,v214
 v_mfma_f32_16x16x32_bf16 v[148:151],v[32:35],a[36:39],v[148:151]
 v_fma_f32 v235,v235,v215,v215
 ds_read_b128 v[56:59],v1 offset:34816
 v_mfma_f32_16x16x32_bf16 v[152:155],v[36:39],a[32:35],v[152:155]
 v_rcp_f32 v234,v234
 v_mfma_f32_16x16x32_bf16 v[156:159],v[36:39],a[36:39],v[156:159]
 s_waitcnt lgkmcnt(3)
 v_rcp_f32 v235,v235
 buffer_load_dwordx4 v0,s[12:15],s50 offen offset:1024 sc1 lds
 ds_read_b128 v[60:63],v1 offset:35840
 v_mfma_f32_16x16x32_bf16 v[160:163],v[40:43],a[32:35],v[160:163]
 v_mul_f32 v110,v110,v234
 v_mul_f32 v111,v111,v235
 v_mfma_f32_16x16x32_bf16 v[164:167],v[40:43],a[36:39],v[164:167]
 v_add_f32 v226,v226,v110
 v_add_f32 v230,v230,v111
 v_mfma_f32_16x16x32_bf16 v[168:171],v[44:47],a[32:35],v[168:171]
 v_fma_f32 v227,v110,v110,v227
 ds_read_b128 v[64:67],v1 offset:36864
 v_mfma_f32_16x16x32_bf16 v[172:175],v[44:47],a[36:39],v[172:175]
 s_waitcnt lgkmcnt(3)
 ds_read_b128 v[68:71],v1 offset:37888
 v_fma_f32 v231,v111,v111,v231
 v_mfma_f32_16x16x32_bf16 v[176:179],v[48:51],a[32:35],v[176:179]
 v_mul_f32 v232,v112,v112
 v_mul_f32 v233,v113,v113
 v_fma_f32 v232,v232,v200,v192
 v_mfma_f32_16x16x32_bf16 v[180:183],v[48:51],a[36:39],v[180:183]
 v_fma_f32 v233,v233,v201,v193
 v_mul_f32 v232,v232,v112
 v_mul_f32 v233,v233,v113
 v_exp_f32 v232,v232
 v_exp_f32 v233,v233
 buffer_load_dwordx4 v0,s[12:15],s50 offen offset:2048 sc1 lds
 buffer_load_dwordx4 a[28:31],v0,s[12:15],s53 offen offset:3072 sc1
 v_mfma_f32_16x16x32_bf16 v[184:187],v[52:55],a[32:35],v[184:187]
 v_fma_f32 v232,v232,v208,v208
 v_fma_f32 v233,v233,v209,v209
 v_rcp_f32 v232,v232
 v_rcp_f32 v233,v233
 v_mfma_f32_16x16x32_bf16 v[188:191],v[52:55],a[36:39],v[188:191]
 s_waitcnt lgkmcnt(2)
 v_mul_f32 v112,v112,v232
 v_mul_f32 v113,v113,v233
 ds_read_b128 v[72:75],v1 offset:38912
 ds_read_b128 v[76:79],v1 offset:39936
 v_mfma_f32_16x16x32_bf16 v[136:139],v[56:59],a[40:43],v[136:139]
 v_add_f32 v216,v216,v112
 v_add_f32 v220,v220,v113
 v_fma_f32 v217,v112,v112,v217
 v_mfma_f32_16x16x32_bf16 v[140:143],v[56:59],a[44:47],v[140:143]
 v_fma_f32 v221,v113,v113,v221
 v_mul_f32 v234,v114,v114
 v_mul_f32 v235,v115,v115
 v_fma_f32 v234,v234,v202,v194
 v_mfma_f32_16x16x32_bf16 v[144:147],v[60:63],a[40:43],v[144:147]
 v_fma_f32 v235,v235,v203,v195
 v_mul_f32 v234,v234,v114
 v_mul_f32 v235,v235,v115
 v_exp_f32 v234,v234
 v_exp_f32 v235,v235
 v_mfma_f32_16x16x32_bf16 v[148:151],v[60:63],a[44:47],v[148:151]
 s_waitcnt lgkmcnt(2)
 v_fma_f32 v234,v234,v210,v210
 v_fma_f32 v235,v235,v211,v211
 v_rcp_f32 v234,v234
 v_rcp_f32 v235,v235
 buffer_load_dwordx4 v0,s[12:15],s50 offen offset:3072 sc1 lds
 ds_read_b128 v[16:19],v1 offset:40960
 ds_read_b128 v[20:23],v1 offset:41984
 v_mfma_f32_16x16x32_bf16 v[152:155],v[64:67],a[40:43],v[152:155]
 s_add_u32 s50,s50,4096
 v_mul_f32 v114,v114,v234
 v_mul_f32 v115,v115,v235
 v_mfma_f32_16x16x32_bf16 v[156:159],v[64:67],a[44:47],v[156:159]
 v_add_f32 v224,v224,v114
 v_add_f32 v228,v228,v115
 v_fma_f32 v225,v114,v114,v225
 v_mfma_f32_16x16x32_bf16 v[160:163],v[68:71],a[40:43],v[160:163]
 v_fma_f32 v229,v115,v115,v229
 v_mul_f32 v232,v116,v116
 v_mul_f32 v233,v117,v117
 v_fma_f32 v232,v232,v204,v196
 v_mfma_f32_16x16x32_bf16 v[164:167],v[68:71],a[44:47],v[164:167]
 s_waitcnt lgkmcnt(2)
 v_fma_f32 v233,v233,v205,v197
 v_mul_f32 v232,v232,v116
 v_mul_f32 v233,v233,v117
 v_exp_f32 v232,v232
 v_exp_f32 v233,v233
 ds_read_b128 v[24:27],v1 offset:43008
 ds_read_b128 v[28:31],v1 offset:44032
 v_mfma_f32_16x16x32_bf16 v[168:171],v[72:75],a[40:43],v[168:171]
 s_add_u32 m0,s54,61440
 v_fma_f32 v232,v232,v212,v212
 v_fma_f32 v233,v233,v213,v213
 v_rcp_f32 v232,v232
 v_rcp_f32 v233,v233
 buffer_load_dwordx4 v0,s[12:15],s50 offen sc1 lds
 s_cmp_eq_u32 s44,1
 s_cselect_b32 s53,0,8192
 s_add_u32 s53,s53,s64
 buffer_load_dwordx4 a[32:35],v0,s[12:15],s53 offen sc1
 v_mfma_f32_16x16x32_bf16 v[172:175],v[72:75],a[44:47],v[172:175]
 v_mul_f32 v116,v116,v232
 v_mul_f32 v117,v117,v233
 v_mfma_f32_16x16x32_bf16 v[176:179],v[76:79],a[40:43],v[176:179]
 v_add_f32 v218,v218,v116
 v_add_f32 v222,v222,v117
 v_fma_f32 v219,v116,v116,v219
 v_mfma_f32_16x16x32_bf16 v[180:183],v[76:79],a[44:47],v[180:183]
 s_waitcnt lgkmcnt(2)
 v_fma_f32 v223,v117,v117,v223
 v_mul_f32 v234,v118,v118
 v_mul_f32 v235,v119,v119
 v_fma_f32 v234,v234,v206,v198
 ds_read_b128 v[32:35],v1 offset:45056
 ds_read_b128 v[36:39],v1 offset:46080
 ds_read_b128 v[40:43],v1 offset:47104
 ds_read_b128 v[44:47],v1 offset:48128
 v_mfma_f32_16x16x32_bf16 v[184:187],v[16:19],a[40:43],v[184:187]
 v_fma_f32 v235,v235,v207,v199
 v_mul_f32 v234,v234,v118
 v_mul_f32 v235,v235,v119
 v_exp_f32 v234,v234
 v_exp_f32 v235,v235
 v_mfma_f32_16x16x32_bf16 v[188:191],v[16:19],a[44:47],v[188:191]
 v_fma_f32 v234,v234,v214,v214
 v_fma_f32 v235,v235,v215,v215
 v_rcp_f32 v234,v234
 v_rcp_f32 v235,v235
 v_mfma_f32_16x16x32_bf16 v[136:139],v[20:23],a[48:51],v[136:139]
 v_mul_f32 v118,v118,v234
 v_mul_f32 v119,v119,v235
 buffer_load_dwordx4 v0,s[12:15],s50 offen offset:1024 sc1 lds
 v_mfma_f32_16x16x32_bf16 v[140:143],v[20:23],a[52:55],v[140:143]
 s_waitcnt lgkmcnt(4)
 v_add_f32 v226,v226,v118
 v_add_f32 v230,v230,v119
 v_fma_f32 v227,v118,v118,v227
 v_mfma_f32_16x16x32_bf16 v[144:147],v[24:27],a[48:51],v[144:147]
 v_fma_f32 v231,v119,v119,v231
 v_mul_f32 v232,v120,v120
 v_mul_f32 v233,v121,v121
 v_fma_f32 v232,v232,v200,v192
 v_mfma_f32_16x16x32_bf16 v[148:151],v[24:27],a[52:55],v[148:151]
 v_fma_f32 v233,v233,v201,v193
 v_mul_f32 v232,v232,v120
 v_mul_f32 v233,v233,v121
 v_exp_f32 v232,v232
 v_exp_f32 v233,v233
 v_mfma_f32_16x16x32_bf16 v[152:155],v[28:31],a[48:51],v[152:155]
 v_fma_f32 v232,v232,v208,v208
 v_fma_f32 v233,v233,v209,v209
 v_rcp_f32 v232,v232
 v_rcp_f32 v233,v233
 buffer_load_dwordx4 a[36:39],v0,s[12:15],s53 offen offset:1024 sc1
 v_mfma_f32_16x16x32_bf16 v[156:159],v[28:31],a[52:55],v[156:159]
 s_waitcnt vmcnt(33) lgkmcnt(0)
 v_mul_f32 v120,v120,v232
 v_mul_f32 v121,v121,v233
 s_barrier
 ds_read_b128 v[48:51],v2
 ds_read_b128 v[52:55],v2 offset:1024
 v_mfma_f32_16x16x32_bf16 v[160:163],v[32:35],a[48:51],v[160:163]
 v_add_f32 v216,v216,v120
 v_add_f32 v220,v220,v121
 v_fma_f32 v217,v120,v120,v217
 buffer_load_dwordx4 v0,s[12:15],s50 offen offset:2048 sc1 lds
 v_mfma_f32_16x16x32_bf16 v[164:167],v[32:35],a[52:55],v[164:167]
 v_fma_f32 v221,v121,v121,v221
 v_mul_f32 v234,v122,v122
 v_mul_f32 v235,v123,v123
 v_fma_f32 v234,v234,v202,v194
 v_mfma_f32_16x16x32_bf16 v[168:171],v[36:39],a[48:51],v[168:171]
 v_fma_f32 v235,v235,v203,v195
 v_mul_f32 v234,v234,v122
 v_mul_f32 v235,v235,v123
 v_exp_f32 v234,v234
 v_exp_f32 v235,v235
 v_mfma_f32_16x16x32_bf16 v[172:175],v[36:39],a[52:55],v[172:175]
 v_fma_f32 v234,v234,v210,v210
 v_fma_f32 v235,v235,v211,v211
 v_rcp_f32 v234,v234
 v_rcp_f32 v235,v235
 ds_read_b128 v[56:59],v2 offset:2048
 ds_read_b128 v[60:63],v2 offset:3072
 v_mfma_f32_16x16x32_bf16 v[176:179],v[40:43],a[48:51],v[176:179]
 s_add_u32 s50,s50,24576
 v_mul_f32 v122,v122,v234
 v_mul_f32 v123,v123,v235
 v_mfma_f32_16x16x32_bf16 v[180:183],v[40:43],a[52:55],v[180:183]
 v_add_f32 v224,v224,v122
 v_add_f32 v228,v228,v123
 v_fma_f32 v225,v122,v122,v225
 v_mfma_f32_16x16x32_bf16 v[184:187],v[44:47],a[48:51],v[184:187]
 s_add_u32 m0,s54,86016
 v_fma_f32 v229,v123,v123,v229
 v_mul_f32 v232,v124,v124
 v_mul_f32 v233,v125,v125
 v_fma_f32 v232,v232,v204,v196
 buffer_load_dwordx4 v0,s[12:15],s50 offen sc1 lds
 v_mfma_f32_16x16x32_bf16 v[188:191],v[44:47],a[52:55],v[188:191]
 s_waitcnt lgkmcnt(2)
 v_fma_f32 v233,v233,v205,v197
 v_mul_f32 v232,v232,v124
 v_mul_f32 v233,v233,v125
 v_exp_f32 v232,v232
 v_exp_f32 v233,v233
 ds_read_b128 v[64:67],v2 offset:4096
 ds_read_b128 v[68:71],v2 offset:5120
 v_mfma_f32_16x16x32_bf16 v[136:139],v[48:51],a[56:59],v[136:139]
 v_fma_f32 v232,v232,v212,v212
 v_fma_f32 v233,v233,v213,v213
 v_rcp_f32 v232,v232
 v_rcp_f32 v233,v233
 v_mfma_f32_16x16x32_bf16 v[140:143],v[48:51],a[60:63],v[140:143]
 v_mul_f32 v124,v124,v232
 v_mul_f32 v125,v125,v233
 buffer_load_dwordx4 a[40:43],v0,s[12:15],s53 offen offset:2048 sc1
 v_mfma_f32_16x16x32_bf16 v[144:147],v[52:55],a[56:59],v[144:147]
 v_add_f32 v218,v218,v124
 v_add_f32 v222,v222,v125
 v_fma_f32 v219,v124,v124,v219
 v_mfma_f32_16x16x32_bf16 v[148:151],v[52:55],a[60:63],v[148:151]
 s_waitcnt lgkmcnt(2)
 v_fma_f32 v223,v125,v125,v223
 v_mul_f32 v234,v126,v126
 v_mul_f32 v235,v127,v127
 v_fma_f32 v234,v234,v206,v198
 buffer_load_dwordx4 v0,s[12:15],s50 offen offset:1024 sc1 lds
 ds_read_b128 v[72:75],v2 offset:6144
 ds_read_b128 v[76:79],v2 offset:7168
 v_mfma_f32_16x16x32_bf16 v[152:155],v[56:59],a[56:59],v[152:155]
 v_fma_f32 v235,v235,v207,v199
 v_mul_f32 v234,v234,v126
 v_mul_f32 v235,v235,v127
 v_exp_f32 v234,v234
 v_exp_f32 v235,v235
 v_mfma_f32_16x16x32_bf16 v[156:159],v[56:59],a[60:63],v[156:159]
 v_fma_f32 v234,v234,v214,v214
 v_fma_f32 v235,v235,v215,v215
 v_rcp_f32 v234,v234
 v_rcp_f32 v235,v235
 v_mfma_f32_16x16x32_bf16 v[160:163],v[60:63],a[56:59],v[160:163]
 v_mul_f32 v126,v126,v234
 v_mul_f32 v127,v127,v235
 v_mfma_f32_16x16x32_bf16 v[164:167],v[60:63],a[60:63],v[164:167]
 s_waitcnt lgkmcnt(2)
 v_add_f32 v226,v226,v126
 v_add_f32 v230,v230,v127
 v_fma_f32 v227,v126,v126,v227
 ds_read_b128 v[16:19],v2 offset:8192
 ds_read_b128 v[20:23],v2 offset:9216
 v_mfma_f32_16x16x32_bf16 v[168:171],v[64:67],a[56:59],v[168:171]
 v_fma_f32 v231,v127,v127,v231
 v_mul_f32 v232,v128,v128
 v_mul_f32 v233,v129,v129
 v_fma_f32 v232,v232,v200,v192
 v_mfma_f32_16x16x32_bf16 v[172:175],v[64:67],a[60:63],v[172:175]
 v_fma_f32 v233,v233,v201,v193
 v_mul_f32 v232,v232,v128
 v_mul_f32 v233,v233,v129
 v_exp_f32 v232,v232
 v_exp_f32 v233,v233
 buffer_load_dwordx4 v0,s[12:15],s50 offen offset:2048 sc1 lds
 v_mfma_f32_16x16x32_bf16 v[176:179],v[68:71],a[56:59],v[176:179]
 v_fma_f32 v232,v232,v208,v208
 v_fma_f32 v233,v233,v209,v209
 v_rcp_f32 v232,v232
 v_rcp_f32 v233,v233
 v_mfma_f32_16x16x32_bf16 v[180:183],v[68:71],a[60:63],v[180:183]
 s_waitcnt lgkmcnt(2)
 v_mul_f32 v128,v128,v232
 v_mul_f32 v129,v129,v233
 buffer_load_dwordx4 a[44:47],v0,s[12:15],s53 offen offset:3072 sc1
 ds_read_b128 v[24:27],v2 offset:10240
 ds_read_b128 v[28:31],v2 offset:11264
 v_mfma_f32_16x16x32_bf16 v[184:187],v[72:75],a[56:59],v[184:187]
 v_add_f32 v216,v216,v128
 v_add_f32 v220,v220,v129
 v_fma_f32 v217,v128,v128,v217
 v_mfma_f32_16x16x32_bf16 v[188:191],v[72:75],a[60:63],v[188:191]
 v_fma_f32 v221,v129,v129,v221
 v_mul_f32 v234,v130,v130
 v_mul_f32 v235,v131,v131
 v_fma_f32 v234,v234,v202,v194
 v_mfma_f32_16x16x32_bf16 v[136:139],v[76:79],a[64:67],v[136:139]
 v_fma_f32 v235,v235,v203,v195
 v_mul_f32 v234,v234,v130
 v_mul_f32 v235,v235,v131
 v_exp_f32 v234,v234
 v_exp_f32 v235,v235
 v_mfma_f32_16x16x32_bf16 v[140:143],v[76:79],a[68:71],v[140:143]
 s_waitcnt lgkmcnt(2)
 v_fma_f32 v234,v234,v210,v210
 v_fma_f32 v235,v235,v211,v211
 v_rcp_f32 v234,v234
 v_rcp_f32 v235,v235
 buffer_load_dwordx4 v0,s[12:15],s50 offen offset:3072 sc1 lds
 ds_read_b128 v[32:35],v2 offset:12288
 ds_read_b128 v[36:39],v2 offset:13312
 v_mfma_f32_16x16x32_bf16 v[144:147],v[16:19],a[64:67],v[144:147]
 s_add_u32 s50,s50,4096
 v_mul_f32 v130,v130,v234
 v_mul_f32 v131,v131,v235
 v_mfma_f32_16x16x32_bf16 v[148:151],v[16:19],a[68:71],v[148:151]
 v_add_f32 v224,v224,v130
 v_add_f32 v228,v228,v131
 v_fma_f32 v225,v130,v130,v225
 v_mfma_f32_16x16x32_bf16 v[152:155],v[20:23],a[64:67],v[152:155]
 v_fma_f32 v229,v131,v131,v229
 v_mul_f32 v232,v132,v132
 v_mul_f32 v233,v133,v133
 v_fma_f32 v232,v232,v204,v196
 v_mfma_f32_16x16x32_bf16 v[156:159],v[20:23],a[68:71],v[156:159]
 s_waitcnt lgkmcnt(2)
 v_fma_f32 v233,v233,v205,v197
 v_mul_f32 v232,v232,v132
 v_mul_f32 v233,v233,v133
 v_exp_f32 v232,v232
 v_exp_f32 v233,v233
 ds_read_b128 v[40:43],v2 offset:14336
 ds_read_b128 v[44:47],v2 offset:15360
 v_mfma_f32_16x16x32_bf16 v[160:163],v[24:27],a[64:67],v[160:163]
 s_add_u32 m0,s54,90112
 v_fma_f32 v232,v232,v212,v212
 v_fma_f32 v233,v233,v213,v213
 v_rcp_f32 v232,v232
 v_rcp_f32 v233,v233
 buffer_load_dwordx4 v0,s[12:15],s50 offen sc1 lds
 v_mfma_f32_16x16x32_bf16 v[164:167],v[24:27],a[68:71],v[164:167]
 s_add_u32 s53,s53,4096
 v_mul_f32 v132,v132,v232
 v_mul_f32 v133,v133,v233
 v_mfma_f32_16x16x32_bf16 v[168:171],v[28:31],a[64:67],v[168:171]
 v_add_f32 v218,v218,v132
 v_add_f32 v222,v222,v133
 v_fma_f32 v219,v132,v132,v219
 buffer_load_dwordx4 a[48:51],v0,s[12:15],s53 offen sc1
 v_mfma_f32_16x16x32_bf16 v[172:175],v[28:31],a[68:71],v[172:175]
 s_waitcnt lgkmcnt(2)
 v_fma_f32 v223,v133,v133,v223
 v_mul_f32 v234,v134,v134
 v_mul_f32 v235,v135,v135
 v_fma_f32 v234,v234,v206,v198
 ds_read_b128 v[48:51],v2 offset:16384
 ds_read_b128 v[52:55],v2 offset:17408
 v_mfma_f32_16x16x32_bf16 v[176:179],v[32:35],a[64:67],v[176:179]
 v_fma_f32 v235,v235,v207,v199
 v_mul_f32 v234,v234,v134
 v_mul_f32 v235,v235,v135
 v_exp_f32 v234,v234
 v_exp_f32 v235,v235
 v_mfma_f32_16x16x32_bf16 v[180:183],v[32:35],a[68:71],v[180:183]
 v_fma_f32 v234,v234,v214,v214
 v_fma_f32 v235,v235,v215,v215
 v_rcp_f32 v234,v234
 v_rcp_f32 v235,v235
 v_mfma_f32_16x16x32_bf16 v[184:187],v[36:39],a[64:67],v[184:187]
 v_mul_f32 v134,v134,v234
 v_mul_f32 v135,v135,v235
 buffer_load_dwordx4 v0,s[12:15],s50 offen offset:1024 sc1 lds
 v_mfma_f32_16x16x32_bf16 v[188:191],v[36:39],a[68:71],v[188:191]
 s_waitcnt lgkmcnt(2)
 v_add_f32 v226,v226,v134
 v_add_f32 v230,v230,v135
 v_fma_f32 v227,v134,v134,v227
 ds_read_b128 v[56:59],v2 offset:18432
 ds_read_b128 v[60:63],v2 offset:19456
 v_mfma_f32_16x16x32_bf16 v[136:139],v[40:43],a[72:75],v[136:139]
 v_fma_f32 v231,v135,v135,v231
 v_add_f32_dpp v216,v216,v216 row_ror:8 row_mask:0xf bank_mask:0x3
 v_add_f32_dpp v217,v217,v217 row_ror:8 row_mask:0xf bank_mask:0x3
 v_add_f32_dpp v218,v218,v218 row_ror:8 row_mask:0xf bank_mask:0x3
 v_add_f32_dpp v219,v219,v219 row_ror:8 row_mask:0xf bank_mask:0x3
 v_mfma_f32_16x16x32_bf16 v[140:143],v[40:43],a[76:79],v[140:143]
 v_add_f32_dpp v216,v224,v224 row_ror:8 row_mask:0xf bank_mask:0xc
 v_add_f32_dpp v217,v225,v225 row_ror:8 row_mask:0xf bank_mask:0xc
 v_add_f32_dpp v218,v226,v226 row_ror:8 row_mask:0xf bank_mask:0xc
 v_add_f32_dpp v219,v227,v227 row_ror:8 row_mask:0xf bank_mask:0xc
 v_mfma_f32_16x16x32_bf16 v[144:147],v[44:47],a[72:75],v[144:147]
 v_add_f32_dpp v220,v220,v220 row_ror:8 row_mask:0xf bank_mask:0x3
 v_add_f32_dpp v221,v221,v221 row_ror:8 row_mask:0xf bank_mask:0x3
 v_add_f32_dpp v222,v222,v222 row_ror:8 row_mask:0xf bank_mask:0x3
 v_add_f32_dpp v223,v223,v223 row_ror:8 row_mask:0xf bank_mask:0x3
 ds_read_b128 v[64:67],v2 offset:20480
 ds_read_b128 v[68:71],v2 offset:21504
 ds_read_b128 v[72:75],v2 offset:22528
 ds_read_b128 v[76:79],v2 offset:23552
 ds_read_b128 v[16:19],v2 offset:24576
 ds_read_b128 v[20:23],v2 offset:25600
 ds_read_b128 v[24:27],v2 offset:26624
 ds_read_b128 v[28:31],v2 offset:27648
 v_mfma_f32_16x16x32_bf16 v[148:151],v[44:47],a[76:79],v[148:151]
 s_waitcnt lgkmcnt(10)
 v_add_f32_dpp v220,v228,v228 row_ror:8 row_mask:0xf bank_mask:0xc
 v_add_f32_dpp v221,v229,v229 row_ror:8 row_mask:0xf bank_mask:0xc
 v_add_f32_dpp v222,v230,v230 row_ror:8 row_mask:0xf bank_mask:0xc
 v_add_f32_dpp v223,v231,v231 row_ror:8 row_mask:0xf bank_mask:0xc
 v_mfma_f32_16x16x32_bf16 v[152:155],v[48:51],a[72:75],v[152:155]
 v_add_f32_dpp v216,v216,v216 row_shl:4 row_mask:0xf bank_mask:0x5
 v_add_f32_dpp v217,v217,v217 row_shl:4 row_mask:0xf bank_mask:0x5
 v_add_f32_dpp v218,v218,v218 row_shl:4 row_mask:0xf bank_mask:0x5
 v_add_f32_dpp v219,v219,v219 row_shl:4 row_mask:0xf bank_mask:0x5
 buffer_load_dwordx4 a[52:55],v0,s[12:15],s53 offen offset:1024 sc1
 buffer_load_dwordx4 v0,s[12:15],s50 offen offset:2048 sc1 lds
 v_mfma_f32_16x16x32_bf16 v[156:159],v[48:51],a[76:79],v[156:159]
 v_add_f32_dpp v216,v220,v220 row_shr:4 row_mask:0xf bank_mask:0xa
 v_add_f32_dpp v217,v221,v221 row_shr:4 row_mask:0xf bank_mask:0xa
 v_add_f32_dpp v218,v222,v222 row_shr:4 row_mask:0xf bank_mask:0xa
 v_add_f32_dpp v219,v223,v223 row_shr:4 row_mask:0xf bank_mask:0xa
 v_mfma_f32_16x16x32_bf16 v[160:163],v[52:55],a[72:75],v[160:163]
 v_add_f32_dpp v216,v216,v216 quad_perm:[1,0,3,2] row_mask:0xf bank_mask:0xf
 v_add_f32_dpp v217,v217,v217 quad_perm:[1,0,3,2] row_mask:0xf bank_mask:0xf
 v_add_f32_dpp v218,v218,v218 quad_perm:[1,0,3,2] row_mask:0xf bank_mask:0xf
 v_add_f32_dpp v219,v219,v219 quad_perm:[1,0,3,2] row_mask:0xf bank_mask:0xf
 v_mfma_f32_16x16x32_bf16 v[164:167],v[52:55],a[76:79],v[164:167]
 s_waitcnt lgkmcnt(8)
 v_add_f32_dpp v216,v216,v216 quad_perm:[2,3,0,1] row_mask:0xf bank_mask:0xf
 v_add_f32_dpp v217,v217,v217 quad_perm:[2,3,0,1] row_mask:0xf bank_mask:0xf
 v_add_f32_dpp v218,v218,v218 quad_perm:[2,3,0,1] row_mask:0xf bank_mask:0xf
 v_add_f32_dpp v219,v219,v219 quad_perm:[2,3,0,1] row_mask:0xf bank_mask:0xf
 v_mfma_f32_16x16x32_bf16 v[168:171],v[56:59],a[72:75],v[168:171]
 s_add_u32 s50,s50,24576
 buffer_store_dwordx4 v[216:219],v252,s[12:15],s58 offen sc1
 v_mfma_f32_16x16x32_bf16 v[172:175],v[56:59],a[76:79],v[172:175]
 s_add_u32 m0,s54,131072
 v_mfma_f32_16x16x32_bf16 v[176:179],v[60:63],a[72:75],v[176:179]
 s_waitcnt vmcnt(33) lgkmcnt(0)
 s_barrier
 buffer_load_dwordx4 v0,s[12:15],s50 offen sc1 lds
 v_mfma_f32_16x16x32_bf16 v[180:183],v[60:63],a[76:79],v[180:183]
 ds_read_b128 v[32:35],v0
 ds_read_b128 v[36:39],v0 offset:1024
 v_mfma_f32_16x16x32_bf16 v[184:187],v[64:67],a[72:75],v[184:187]
 ds_read_b128 v[40:43],v0 offset:2048
 ds_read_b128 v[44:47],v0 offset:3072
 v_mfma_f32_16x16x32_bf16 v[188:191],v[64:67],a[76:79],v[188:191]
 buffer_load_dwordx4 a[56:59],v0,s[12:15],s53 offen offset:2048 sc1
 v_mfma_f32_16x16x32_bf16 v[136:139],v[68:71],a[80:83],v[136:139]
 buffer_load_dwordx4 v0,s[12:15],s50 offen offset:1024 sc1 lds
 v_mfma_f32_16x16x32_bf16 v[140:143],v[68:71],a[84:87],v[140:143]
 ds_read_b128 v[48:51],v0 offset:4096
 ds_read_b128 v[52:55],v0 offset:5120
 v_mfma_f32_16x16x32_bf16 v[144:147],v[72:75],a[80:83],v[144:147]
 ds_read_b128 v[56:59],v0 offset:6144
 ds_read_b128 v[60:63],v0 offset:7168
 v_mfma_f32_16x16x32_bf16 v[148:151],v[72:75],a[84:87],v[148:151]
 ds_read_b128 v[64:67],v0 offset:8192
 ds_read_b128 v[68:71],v0 offset:9216
 v_mfma_f32_16x16x32_bf16 v[152:155],v[76:79],a[80:83],v[152:155]
 ds_read_b128 v[72:75],v0 offset:10240
 v_mfma_f32_16x16x32_bf16 v[156:159],v[76:79],a[84:87],v[156:159]
 buffer_load_dwordx4 a[60:63],v0,s[12:15],s53 offen offset:3072 sc1
 v_mfma_f32_16x16x32_bf16 v[160:163],v[16:19],a[80:83],v[160:163]
 buffer_load_dwordx4 v0,s[12:15],s50 offen offset:2048 sc1 lds
 v_mfma_f32_16x16x32_bf16 v[164:167],v[16:19],a[84:87],v[164:167]
 s_cmp_eq_u32 s44,2
 s_cselect_b32 s53,0,16384
 s_add_u32 s53,s53,s64
 v_mfma_f32_16x16x32_bf16 v[168:171],v[20:23],a[80:83],v[168:171]
 ds_read_b128 v[76:79],v0 offset:11264
 ds_read_b128 v[16:19],v0 offset:12288
 v_mfma_f32_16x16x32_bf16 v[172:175],v[20:23],a[84:87],v[172:175]
 ds_read_b128 v[20:23],v0 offset:13312
 v_mfma_f32_16x16x32_bf16 v[176:179],v[24:27],a[80:83],v[176:179]
 v_mfma_f32_16x16x32_bf16 v[180:183],v[24:27],a[84:87],v[180:183]
 buffer_load_dwordx4 a[64:67],v0,s[12:15],s53 offen sc1
 v_mfma_f32_16x16x32_bf16 v[184:187],v[28:31],a[80:83],v[184:187]
 buffer_load_dwordx4 v0,s[12:15],s50 offen offset:3072 sc1 lds
 v_mfma_f32_16x16x32_bf16 v[188:191],v[28:31],a[84:87],v[188:191]
 s_add_u32 s50,s50,4096
 s_add_u32 m0,s54,135168
 s_waitcnt lgkmcnt(12)
 v_mfma_f32_16x16x32_bf16 v[136:139],v[32:35],a[88:91],v[136:139]
 ds_read_b128 v[24:27],v0 offset:14336
 ds_read_b128 v[28:31],v0 offset:15360
 v_mfma_f32_16x16x32_bf16 v[140:143],v[32:35],a[92:95],v[140:143]
 ds_read_b128 v[32:35],v0 offset:16384
 v_mfma_f32_16x16x32_bf16 v[144:147],v[36:39],a[88:91],v[144:147]
 buffer_load_dwordx4 v0,s[12:15],s50 offen sc1 lds
 v_mfma_f32_16x16x32_bf16 v[148:151],v[36:39],a[92:95],v[148:151]
 s_waitcnt lgkmcnt(13)
 ds_read_b128 v[36:39],v0 offset:17408
 v_mfma_f32_16x16x32_bf16 v[152:155],v[40:43],a[88:91],v[152:155]
 buffer_load_dwordx4 a[68:71],v0,s[12:15],s53 offen offset:1024 sc1
 v_mfma_f32_16x16x32_bf16 v[156:159],v[40:43],a[92:95],v[156:159]
 ds_read_b128 v[40:43],v0 offset:18432
 v_mfma_f32_16x16x32_bf16 v[160:163],v[44:47],a[88:91],v[160:163]
 v_mfma_f32_16x16x32_bf16 v[164:167],v[44:47],a[92:95],v[164:167]
 s_waitcnt lgkmcnt(13)
 ds_read_b128 v[44:47],v0 offset:19456
 v_mfma_f32_16x16x32_bf16 v[168:171],v[48:51],a[88:91],v[168:171]
 buffer_load_dwordx4 v0,s[12:15],s50 offen offset:1024 sc1 lds
 v_mfma_f32_16x16x32_bf16 v[172:175],v[48:51],a[92:95],v[172:175]
 ds_read_b128 v[48:51],v0 offset:20480
 v_mfma_f32_16x16x32_bf16 v[176:179],v[52:55],a[88:91],v[176:179]
 buffer_load_dwordx4 a[72:75],v0,s[12:15],s53 offen offset:2048 sc1
 v_mfma_f32_16x16x32_bf16 v[180:183],v[52:55],a[92:95],v[180:183]
 s_waitcnt lgkmcnt(13)
 ds_read_b128 v[52:55],v0 offset:21504
 v_mfma_f32_16x16x32_bf16 v[184:187],v[56:59],a[88:91],v[184:187]
 v_mfma_f32_16x16x32_bf16 v[188:191],v[56:59],a[92:95],v[188:191]
 ds_read_b128 v[56:59],v0 offset:22528
 v_mfma_f32_16x16x32_bf16 v[136:139],v[60:63],a[96:99],v[136:139]
 buffer_load_dwordx4 v0,s[12:15],s50 offen offset:2048 sc1 lds
 v_mfma_f32_16x16x32_bf16 v[140:143],v[60:63],a[100:103],v[140:143]
 s_waitcnt lgkmcnt(13)
 ds_read_b128 v[60:63],v0 offset:23552
 s_add_u32 s50,s50,24576
 v_mfma_f32_16x16x32_bf16 v[144:147],v[64:67],a[96:99],v[144:147]
 s_add_u32 m0,s62,0
 s_sub_u32 s50,s50,s54
 s_add_u32 s50,s50,s62
 v_mfma_f32_16x16x32_bf16 v[148:151],v[64:67],a[100:103],v[148:151]
 buffer_load_dwordx4 a[76:79],v0,s[12:15],s53 offen offset:3072 sc1
 v_mfma_f32_16x16x32_bf16 v[152:155],v[68:71],a[96:99],v[152:155]
 s_add_u32 s53,s53,4096
 ds_read_b128 v[64:67],v0 offset:24576
 v_mfma_f32_16x16x32_bf16 v[156:159],v[68:71],a[100:103],v[156:159]
 s_waitcnt lgkmcnt(13)
 ds_read_b128 v[68:71],v0 offset:25600
 v_mfma_f32_16x16x32_bf16 v[160:163],v[72:75],a[96:99],v[160:163]
 v_mfma_f32_16x16x32_bf16 v[164:167],v[72:75],a[100:103],v[164:167]
 ds_read_b128 v[72:75],v0 offset:26624
 v_mfma_f32_16x16x32_bf16 v[168:171],v[76:79],a[96:99],v[168:171]
 v_mfma_f32_16x16x32_bf16 v[172:175],v[76:79],a[100:103],v[172:175]
 s_waitcnt lgkmcnt(13)
 buffer_load_dwordx4 a[80:83],v0,s[12:15],s53 offen sc1
 v_mfma_f32_16x16x32_bf16 v[176:179],v[16:19],a[96:99],v[176:179]
 ds_read_b128 v[76:79],v0 offset:27648
 v_mfma_f32_16x16x32_bf16 v[180:183],v[16:19],a[100:103],v[180:183]
 v_mfma_f32_16x16x32_bf16 v[184:187],v[20:23],a[96:99],v[184:187]
 v_mfma_f32_16x16x32_bf16 v[188:191],v[20:23],a[100:103],v[188:191]
 s_waitcnt lgkmcnt(12)
 v_mfma_f32_16x16x32_bf16 v[136:139],v[24:27],a[104:107],v[136:139]
 v_mfma_f32_16x16x32_bf16 v[140:143],v[24:27],a[108:111],v[140:143]
 v_mfma_f32_16x16x32_bf16 v[144:147],v[28:31],a[104:107],v[144:147]
 s_branch .Lsk13
.Lst13:
 s_branch .Lvb2
.Lsk13:
 buffer_load_dwordx4 a[84:87],v0,s[12:15],s53 offen offset:1024 sc1
 v_mfma_f32_16x16x32_bf16 v[148:151],v[28:31],a[108:111],v[148:151]
 s_waitcnt lgkmcnt(10)
 v_mfma_f32_16x16x32_bf16 v[152:155],v[32:35],a[104:107],v[152:155]
 s_waitcnt vmcnt(38) lgkmcnt(0)
 s_barrier
 buffer_load_dwordx4 v0,s[12:15],s50 offen sc1 lds
 v_mfma_f32_16x16x32_bf16 v[156:159],v[32:35],a[108:111],v[156:159]
 ds_read_b128 v[16:19],v0 offset:28672
 ds_read_b128 v[20:23],v0 offset:29696
 v_mfma_f32_16x16x32_bf16 v[160:163],v[36:39],a[104:107],v[160:163]
 ds_read_b128 v[24:27],v0 offset:30720
 ds_read_b128 v[28:31],v0 offset:31744
 v_mfma_f32_16x16x32_bf16 v[164:167],v[36:39],a[108:111],v[164:167]
 ds_read_b128 v[32:35],v0 offset:32768
 ds_read_b128 v[36:39],v0 offset:33792
 v_mfma_f32_16x16x32_bf16 v[168:171],v[40:43],a[104:107],v[168:171]
 buffer_load_dwordx4 a[88:91],v0,s[12:15],s53 offen offset:2048 sc1
 v_mfma_f32_16x16x32_bf16 v[172:175],v[40:43],a[108:111],v[172:175]
 ds_read_b128 v[40:43],v0 offset:34816
 v_mfma_f32_16x16x32_bf16 v[176:179],v[44:47],a[104:107],v[176:179]
 v_mfma_f32_16x16x32_bf16 v[180:183],v[44:47],a[108:111],v[180:183]
 ds_read_b128 v[44:47],v0 offset:35840
 v_mfma_f32_16x16x32_bf16 v[184:187],v[48:51],a[104:107],v[184:187]
 v_mfma_f32_16x16x32_bf16 v[188:191],v[48:51],a[108:111],v[188:191]
 ds_read_b128 v[48:51],v0 offset:36864
 v_mfma_f32_16x16x32_bf16 v[136:139],v[52:55],a[112:115],v[136:139]
 v_mfma_f32_16x16x32_bf16 v[140:143],v[52:55],a[116:119],v[140:143]
 buffer_load_dwordx4 a[92:95],v0,s[12:15],s53 offen offset:3072 sc1
 v_mfma_f32_16x16x32_bf16 v[144:147],v[56:59],a[112:115],v[144:147]
 s_cmp_eq_u32 s44,3
 s_cselect_b32 s53,0,24576
 s_add_u32 s53,s53,s64
 v_mfma_f32_16x16x32_bf16 v[148:151],v[56:59],a[116:119],v[148:151]
 buffer_load_dwordx4 v0,s[12:15],s50 offen offset:1024 sc1 lds
 v_mfma_f32_16x16x32_bf16 v[152:155],v[60:63],a[112:115],v[152:155]
 ds_read_b128 v[52:55],v0 offset:37888
 ds_read_b128 v[56:59],v0 offset:38912
 v_mfma_f32_16x16x32_bf16 v[156:159],v[60:63],a[116:119],v[156:159]
 ds_read_b128 v[60:63],v0 offset:39936
 v_mfma_f32_16x16x32_bf16 v[160:163],v[64:67],a[112:115],v[160:163]
 v_mfma_f32_16x16x32_bf16 v[164:167],v[64:67],a[116:119],v[164:167]
 buffer_load_dwordx4 a[96:99],v0,s[12:15],s53 offen sc1
 v_mfma_f32_16x16x32_bf16 v[168:171],v[68:71],a[112:115],v[168:171]
 s_waitcnt vmcnt(20)
 buffer_atomic_add v6,v3,s[12:15],0 offen offset:28 sc1
 v_mfma_f32_16x16x32_bf16 v[172:175],v[68:71],a[116:119],v[172:175]
 ds_read_b128 v[64:67],v0 offset:40960
 ds_read_b128 v[68:71],v0 offset:41984
 v_mfma_f32_16x16x32_bf16 v[176:179],v[72:75],a[112:115],v[176:179]
 v_mfma_f32_16x16x32_bf16 v[180:183],v[72:75],a[116:119],v[180:183]
 ds_read_b128 v[72:75],v0 offset:43008
 v_mfma_f32_16x16x32_bf16 v[184:187],v[76:79],a[112:115],v[184:187]
 v_mfma_f32_16x16x32_bf16 v[188:191],v[76:79],a[116:119],v[188:191]
 s_waitcnt lgkmcnt(13)
 ds_read_b128 v[76:79],v0 offset:44032
 v_mfma_f32_16x16x32_bf16 v[136:139],v[16:19],a[120:123],v[136:139]
 buffer_load_dwordx4 a[100:103],v0,s[12:15],s53 offen offset:1024 sc1
 v_mfma_f32_16x16x32_bf16 v[140:143],v[16:19],a[124:127],v[140:143]
 ds_read_b128 v[16:19],v0 offset:45056
 v_mfma_f32_16x16x32_bf16 v[144:147],v[20:23],a[120:123],v[144:147]
 buffer_load_dwordx4 v0,s[12:15],s50 offen offset:2048 sc1 lds
 v_mfma_f32_16x16x32_bf16 v[148:151],v[20:23],a[124:127],v[148:151]
 s_waitcnt lgkmcnt(13)
 ds_read_b128 v[20:23],v0 offset:46080
 v_mfma_f32_16x16x32_bf16 v[152:155],v[24:27],a[120:123],v[152:155]
 v_mfma_f32_16x16x32_bf16 v[156:159],v[24:27],a[124:127],v[156:159]
 ds_read_b128 v[24:27],v0 offset:47104
 v_mfma_f32_16x16x32_bf16 v[160:163],v[28:31],a[120:123],v[160:163]
 buffer_load_dwordx4 a[104:107],v0,s[12:15],s53 offen offset:2048 sc1
 v_mfma_f32_16x16x32_bf16 v[164:167],v[28:31],a[124:127],v[164:167]
 s_waitcnt lgkmcnt(13)
 ds_read_b128 v[28:31],v0 offset:48128
 v_mfma_f32_16x16x32_bf16 v[168:171],v[32:35],a[120:123],v[168:171]
 v_mfma_f32_16x16x32_bf16 v[172:175],v[32:35],a[124:127],v[172:175]
 ds_read_b128 v[32:35],v0 offset:49152
 v_mfma_f32_16x16x32_bf16 v[176:179],v[36:39],a[120:123],v[176:179]
 v_mfma_f32_16x16x32_bf16 v[180:183],v[36:39],a[124:127],v[180:183]
 s_waitcnt lgkmcnt(13)
 ds_read_b128 v[36:39],v0 offset:50176
 v_mfma_f32_16x16x32_bf16 v[184:187],v[40:43],a[120:123],v[184:187]
 buffer_load_dwordx4 a[108:111],v0,s[12:15],s53 offen offset:3072 sc1
 v_mfma_f32_16x16x32_bf16 v[188:191],v[40:43],a[124:127],v[188:191]
 s_add_u32 s53,s53,4096
 ds_read_b128 v[40:43],v0 offset:51200
 v_mfma_f32_16x16x32_bf16 v[136:139],v[44:47],a[128:131],v[136:139]
 v_mfma_f32_16x16x32_bf16 v[140:143],v[44:47],a[132:135],v[140:143]
 s_waitcnt lgkmcnt(13)
 buffer_load_dwordx4 v0,s[12:15],s50 offen offset:3072 sc1 lds
 v_mfma_f32_16x16x32_bf16 v[144:147],v[48:51],a[128:131],v[144:147]
 ds_read_b128 v[44:47],v0 offset:52224
 v_mfma_f32_16x16x32_bf16 v[148:151],v[48:51],a[132:135],v[148:151]
 ds_read_b128 v[48:51],v0 offset:53248
 v_mfma_f32_16x16x32_bf16 v[152:155],v[52:55],a[128:131],v[152:155]
 v_mfma_f32_16x16x32_bf16 v[156:159],v[52:55],a[132:135],v[156:159]
 s_waitcnt lgkmcnt(13)
 buffer_load_dwordx4 a[112:115],v0,s[12:15],s53 offen sc1
 v_mfma_f32_16x16x32_bf16 v[160:163],v[56:59],a[128:131],v[160:163]
 ds_read_b128 v[52:55],v0 offset:54272
 v_mfma_f32_16x16x32_bf16 v[164:167],v[56:59],a[132:135],v[164:167]
 ds_read_b128 v[56:59],v0 offset:55296
 v_mfma_f32_16x16x32_bf16 v[168:171],v[60:63],a[128:131],v[168:171]
 v_mfma_f32_16x16x32_bf16 v[172:175],v[60:63],a[132:135],v[172:175]
 s_waitcnt lgkmcnt(13)
 ds_read_b128 v[60:63],v0 offset:56320
 v_mfma_f32_16x16x32_bf16 v[176:179],v[64:67],a[128:131],v[176:179]
 v_mov_b32 v7,0
 buffer_atomic_add v7,v3,s[12:15],0 offen offset:28 sc0 sc1
 v_mfma_f32_16x16x32_bf16 v[180:183],v[64:67],a[132:135],v[180:183]
 buffer_load_dwordx4 a[116:119],v0,s[12:15],s53 offen offset:1024 sc1
 v_mfma_f32_16x16x32_bf16 v[184:187],v[68:71],a[128:131],v[184:187]
 v_mfma_f32_16x16x32_bf16 v[188:191],v[68:71],a[132:135],v[188:191]
 s_waitcnt lgkmcnt(12)
 v_mfma_f32_16x16x32_bf16 v[136:139],v[72:75],a[136:139],v[136:139]
 v_mfma_f32_16x16x32_bf16 v[140:143],v[72:75],a[140:143],v[140:143]
 v_mfma_f32_16x16x32_bf16 v[144:147],v[76:79],a[136:139],v[144:147]
 v_mfma_f32_16x16x32_bf16 v[148:151],v[76:79],a[140:143],v[148:151]
 s_waitcnt lgkmcnt(0)
 s_barrier
 ds_read_b128 v[64:67],v0 offset:57344
 v_mfma_f32_16x16x32_bf16 v[152:155],v[16:19],a[136:139],v[152:155]
 buffer_load_dwordx4 a[120:123],v0,s[12:15],s53 offen offset:2048 sc1
 v_mfma_f32_16x16x32_bf16 v[156:159],v[16:19],a[140:143],v[156:159]
 ds_read_b128 v[68:71],v0 offset:58368
 ds_read_b128 v[72:75],v0 offset:59392
 v_mfma_f32_16x16x32_bf16 v[160:163],v[20:23],a[136:139],v[160:163]
 ds_read_b128 v[76:79],v0 offset:60416
 ds_read_b128 v[16:19],v0 offset:61440
 v_mfma_f32_16x16x32_bf16 v[164:167],v[20:23],a[140:143],v[164:167]
 ds_read_b128 v[20:23],v0 offset:62464
 v_mfma_f32_16x16x32_bf16 v[168:171],v[24:27],a[136:139],v[168:171]
 v_mfma_f32_16x16x32_bf16 v[172:175],v[24:27],a[140:143],v[172:175]
 ds_read_b128 v[24:27],v0 offset:63488
 v_mfma_f32_16x16x32_bf16 v[176:179],v[28:31],a[136:139],v[176:179]
 buffer_load_dwordx4 a[124:127],v0,s[12:15],s53 offen offset:3072 sc1
 v_mfma_f32_16x16x32_bf16 v[180:183],v[28:31],a[140:143],v[180:183]
 s_cmp_eq_u32 s44,4
 s_cselect_b32 s53,0,32768
 v_mfma_f32_16x16x32_bf16 v[184:187],v[32:35],a[136:139],v[184:187]
 s_add_u32 s53,s53,s64
 ds_read_b128 v[28:31],v0 offset:64512
 v_mfma_f32_16x16x32_bf16 v[188:191],v[32:35],a[140:143],v[188:191]
 ds_read_b128 v[32:35],v1
 v_mfma_f32_16x16x32_bf16 v[136:139],v[36:39],a[144:147],v[136:139]
 v_mfma_f32_16x16x32_bf16 v[140:143],v[36:39],a[148:151],v[140:143]
 ds_read_b128 v[36:39],v1 offset:1024
 v_mfma_f32_16x16x32_bf16 v[144:147],v[40:43],a[144:147],v[144:147]
 v_mfma_f32_16x16x32_bf16 v[148:151],v[40:43],a[148:151],v[148:151]
 buffer_load_dwordx4 a[128:131],v0,s[12:15],s53 offen sc1
 v_mfma_f32_16x16x32_bf16 v[152:155],v[44:47],a[144:147],v[152:155]
 ds_read_b128 v[40:43],v1 offset:2048
 v_mfma_f32_16x16x32_bf16 v[156:159],v[44:47],a[148:151],v[156:159]
 ds_read_b128 v[44:47],v1 offset:3072
 v_mfma_f32_16x16x32_bf16 v[160:163],v[48:51],a[144:147],v[160:163]
 v_mfma_f32_16x16x32_bf16 v[164:167],v[48:51],a[148:151],v[164:167]
 ds_read_b128 v[48:51],v1 offset:4096
 v_mfma_f32_16x16x32_bf16 v[168:171],v[52:55],a[144:147],v[168:171]
 v_mfma_f32_16x16x32_bf16 v[172:175],v[52:55],a[148:151],v[172:175]
 buffer_load_dwordx4 a[132:135],v0,s[12:15],s53 offen offset:1024 sc1
 v_mfma_f32_16x16x32_bf16 v[176:179],v[56:59],a[144:147],v[176:179]
 ds_read_b128 v[52:55],v1 offset:5120
 v_mfma_f32_16x16x32_bf16 v[180:183],v[56:59],a[148:151],v[180:183]
 ds_read_b128 v[56:59],v1 offset:6144
 v_mfma_f32_16x16x32_bf16 v[184:187],v[60:63],a[144:147],v[184:187]
 v_mfma_f32_16x16x32_bf16 v[188:191],v[60:63],a[148:151],v[188:191]
 s_waitcnt lgkmcnt(13)
 ds_read_b128 v[60:63],v1 offset:7168
 v_mfma_f32_16x16x32_bf16 v[136:139],v[64:67],a[152:155],v[136:139]
 v_mfma_f32_16x16x32_bf16 v[140:143],v[64:67],a[156:159],v[140:143]
 ds_read_b128 v[64:67],v1 offset:8192
 v_mfma_f32_16x16x32_bf16 v[144:147],v[68:71],a[152:155],v[144:147]
 buffer_load_dwordx4 a[136:139],v0,s[12:15],s53 offen offset:2048 sc1
 v_mfma_f32_16x16x32_bf16 v[148:151],v[68:71],a[156:159],v[148:151]
 s_waitcnt lgkmcnt(13)
 ds_read_b128 v[68:71],v1 offset:9216
 v_mfma_f32_16x16x32_bf16 v[152:155],v[72:75],a[152:155],v[152:155]
 v_mfma_f32_16x16x32_bf16 v[156:159],v[72:75],a[156:159],v[156:159]
 ds_read_b128 v[72:75],v1 offset:10240
 v_mfma_f32_16x16x32_bf16 v[160:163],v[76:79],a[152:155],v[160:163]
 v_mfma_f32_16x16x32_bf16 v[164:167],v[76:79],a[156:159],v[164:167]
 s_waitcnt lgkmcnt(13)
 ds_read_b128 v[76:79],v1 offset:11264
 v_mfma_f32_16x16x32_bf16 v[168:171],v[16:19],a[152:155],v[168:171]
 buffer_load_dwordx4 a[140:143],v0,s[12:15],s53 offen offset:3072 sc1
 v_mfma_f32_16x16x32_bf16 v[172:175],v[16:19],a[156:159],v[172:175]
 s_add_u32 s53,s53,4096
 ds_read_b128 v[16:19],v1 offset:12288
 v_mfma_f32_16x16x32_bf16 v[176:179],v[20:23],a[152:155],v[176:179]
 v_mfma_f32_16x16x32_bf16 v[180:183],v[20:23],a[156:159],v[180:183]
 s_waitcnt lgkmcnt(13)
 ds_read_b128 v[20:23],v1 offset:13312
 v_mfma_f32_16x16x32_bf16 v[184:187],v[24:27],a[152:155],v[184:187]
 v_mfma_f32_16x16x32_bf16 v[188:191],v[24:27],a[156:159],v[188:191]
 ds_read_b128 v[24:27],v1 offset:14336
 v_mfma_f32_16x16x32_bf16 v[136:139],v[28:31],a[160:163],v[136:139]
 v_mfma_f32_16x16x32_bf16 v[140:143],v[28:31],a[164:167],v[140:143]
 s_waitcnt lgkmcnt(13)
 buffer_load_dwordx4 a[144:147],v0,s[12:15],s53 offen sc1
 v_mfma_f32_16x16x32_bf16 v[144:147],v[32:35],a[160:163],v[144:147]
 ds_read_b128 v[28:31],v1 offset:15360
 v_mfma_f32_16x16x32_bf16 v[148:151],v[32:35],a[164:167],v[148:151]
 ds_read_b128 v[32:35],v1 offset:16384
 v_mfma_f32_16x16x32_bf16 v[152:155],v[36:39],a[160:163],v[152:155]
 v_mfma_f32_16x16x32_bf16 v[156:159],v[36:39],a[164:167],v[156:159]
 s_waitcnt lgkmcnt(13)
 ds_read_b128 v[36:39],v1 offset:17408
 v_mfma_f32_16x16x32_bf16 v[160:163],v[40:43],a[160:163],v[160:163]
 v_mfma_f32_16x16x32_bf16 v[164:167],v[40:43],a[164:167],v[164:167]
 buffer_load_dwordx4 a[148:151],v0,s[12:15],s53 offen offset:1024 sc1
 v_mfma_f32_16x16x32_bf16 v[168:171],v[44:47],a[160:163],v[168:171]
 ds_read_b128 v[40:43],v1 offset:18432
 v_mfma_f32_16x16x32_bf16 v[172:175],v[44:47],a[164:167],v[172:175]
 s_waitcnt lgkmcnt(13)
 ds_read_b128 v[44:47],v1 offset:19456
 v_mfma_f32_16x16x32_bf16 v[176:179],v[48:51],a[160:163],v[176:179]
 s_waitcnt vmcnt(9)
 v_readfirstlane_b32 s59,v7
 s_nop 0
 s_cmp_ge_u32 s59,16
 s_cbranch_scc0 .Lseq_slow_20
.Lseq_back_21:
 buffer_load_dwordx4 v[216:219],v0,s[12:15],s57 offen sc1
 buffer_load_dwordx4 v[220:223],v0,s[12:15],s57 offen offset:1024 sc1
 v_mfma_f32_16x16x32_bf16 v[180:183],v[48:51],a[164:167],v[180:183]
 buffer_load_dwordx4 v[224:227],v0,s[12:15],s57 offen offset:2048 sc1
 buffer_load_dwordx4 v[228:231],v0,s[12:15],s57 offen offset:3072 sc1
 v_mfma_f32_16x16x32_bf16 v[184:187],v[52:55],a[160:163],v[184:187]
 s_add_u32 s66,s63,16777216
 s_mul_i32 s60,s44,28672
 s_add_u32 s60,s60,s66
 v_mfma_f32_16x16x32_bf16 v[188:191],v[52:55],a[164:167],v[188:191]
 s_add_u32 s61,s60,4096
 s_add_u32 s67,s66,4096
 s_waitcnt lgkmcnt(12)
 v_mfma_f32_16x16x32_bf16 v[136:139],v[56:59],a[168:171],v[136:139]
 buffer_load_dwordx4 a[152:155],v0,s[12:15],s53 offen offset:2048 sc1
 v_mfma_f32_16x16x32_bf16 v[140:143],v[56:59],a[172:175],v[140:143]
 v_add_u32 v232,s54,v0
 v_mfma_f32_16x16x32_bf16 v[144:147],v[60:63],a[168:171],v[144:147]
 v_mfma_f32_16x16x32_bf16 v[148:151],v[60:63],a[172:175],v[148:151]
 s_waitcnt lgkmcnt(0)
 s_barrier
 ds_read_b128 v[48:51],v1 offset:20480
 v_mfma_f32_16x16x32_bf16 v[152:155],v[64:67],a[168:171],v[152:155]
 ds_read_b128 v[52:55],v1 offset:21504
 ds_read_b128 v[56:59],v1 offset:22528
 v_mfma_f32_16x16x32_bf16 v[156:159],v[64:67],a[172:175],v[156:159]
 ds_read_b128 v[60:63],v1 offset:23552
 ds_read_b128 v[64:67],v1 offset:24576
 v_mfma_f32_16x16x32_bf16 v[160:163],v[68:71],a[168:171],v[160:163]
 v_mfma_f32_16x16x32_bf16 v[164:167],v[68:71],a[172:175],v[164:167]
 buffer_load_dwordx4 a[156:159],v0,s[12:15],s53 offen offset:3072 sc1
 v_mfma_f32_16x16x32_bf16 v[168:171],v[72:75],a[168:171],v[168:171]
 s_cmp_eq_u32 s44,5
 s_cselect_b32 s53,0,40960
 s_add_u32 s53,s53,s64
 v_mfma_f32_16x16x32_bf16 v[172:175],v[72:75],a[172:175],v[172:175]
 ds_read_b128 v[68:71],v1 offset:25600
 ds_read_b128 v[72:75],v1 offset:26624
 v_mfma_f32_16x16x32_bf16 v[176:179],v[76:79],a[168:171],v[176:179]
 v_mfma_f32_16x16x32_bf16 v[180:183],v[76:79],a[172:175],v[180:183]
 ds_read_b128 v[76:79],v1 offset:27648
 v_mfma_f32_16x16x32_bf16 v[184:187],v[16:19],a[168:171],v[184:187]
 v_mfma_f32_16x16x32_bf16 v[188:191],v[16:19],a[172:175],v[188:191]
 ds_read_b128 v[16:19],v1 offset:28672
 v_mfma_f32_16x16x32_bf16 v[136:139],v[20:23],a[176:179],v[136:139]
 buffer_load_dwordx4 a[160:163],v0,s[12:15],s53 offen sc1
 v_mfma_f32_16x16x32_bf16 v[140:143],v[20:23],a[180:183],v[140:143]
 ds_read_b128 v[20:23],v1 offset:29696
 v_mfma_f32_16x16x32_bf16 v[144:147],v[24:27],a[176:179],v[144:147]
 v_mfma_f32_16x16x32_bf16 v[148:151],v[24:27],a[180:183],v[148:151]
 ds_read_b128 v[24:27],v1 offset:30720
 v_mfma_f32_16x16x32_bf16 v[152:155],v[28:31],a[176:179],v[152:155]
 v_mfma_f32_16x16x32_bf16 v[156:159],v[28:31],a[180:183],v[156:159]
 ds_read_b128 v[28:31],v1 offset:31744
 v_mfma_f32_16x16x32_bf16 v[160:163],v[32:35],a[176:179],v[160:163]
 v_mfma_f32_16x16x32_bf16 v[164:167],v[32:35],a[180:183],v[164:167]
 ds_read_b128 v[32:35],v1 offset:32768
 v_mfma_f32_16x16x32_bf16 v[168:171],v[36:39],a[176:179],v[168:171]
 buffer_load_dwordx4 a[164:167],v0,s[12:15],s53 offen offset:1024 sc1
 v_mfma_f32_16x16x32_bf16 v[172:175],v[36:39],a[180:183],v[172:175]
 ds_read_b128 v[36:39],v1 offset:33792
 v_mfma_f32_16x16x32_bf16 v[176:179],v[40:43],a[176:179],v[176:179]
 v_mfma_f32_16x16x32_bf16 v[180:183],v[40:43],a[180:183],v[180:183]
 ds_read_b128 v[40:43],v1 offset:34816
 v_mfma_f32_16x16x32_bf16 v[184:187],v[44:47],a[176:179],v[184:187]
 v_mfma_f32_16x16x32_bf16 v[188:191],v[44:47],a[180:183],v[188:191]
 s_waitcnt lgkmcnt(13)
 ds_read_b128 v[44:47],v1 offset:35840
 v_mfma_f32_16x16x32_bf16 v[136:139],v[48:51],a[184:187],v[136:139]
 v_mfma_f32_16x16x32_bf16 v[140:143],v[48:51],a[188:191],v[140:143]
 buffer_load_dwordx4 a[168:171],v0,s[12:15],s53 offen offset:2048 sc1
 v_mfma_f32_16x16x32_bf16 v[144:147],v[52:55],a[184:187],v[144:147]
 ds_read_b128 v[48:51],v1 offset:36864
 v_mfma_f32_16x16x32_bf16 v[148:151],v[52:55],a[188:191],v[148:151]
 s_waitcnt lgkmcnt(13)
 ds_read_b128 v[52:55],v1 offset:37888
 v_mfma_f32_16x16x32_bf16 v[152:155],v[56:59],a[184:187],v[152:155]
 v_mfma_f32_16x16x32_bf16 v[156:159],v[56:59],a[188:191],v[156:159]
 ds_read_b128 v[56:59],v1 offset:38912
 v_mfma_f32_16x16x32_bf16 v[160:163],v[60:63],a[184:187],v[160:163]
 v_mfma_f32_16x16x32_bf16 v[164:167],v[60:63],a[188:191],v[164:167]
 s_waitcnt lgkmcnt(13)
 ds_read_b128 v[60:63],v1 offset:39936
 v_mfma_f32_16x16x32_bf16 v[168:171],v[64:67],a[184:187],v[168:171]
 v_mfma_f32_16x16x32_bf16 v[172:175],v[64:67],a[188:191],v[172:175]
 buffer_load_dwordx4 a[172:175],v0,s[12:15],s53 offen offset:3072 sc1
 v_mfma_f32_16x16x32_bf16 v[176:179],v[68:71],a[184:187],v[176:179]
 s_add_u32 s53,s53,4096
 ds_read_b128 v[64:67],v1 offset:40960
 v_mfma_f32_16x16x32_bf16 v[180:183],v[68:71],a[188:191],v[180:183]
 s_waitcnt lgkmcnt(13)
 ds_read_b128 v[68:71],v1 offset:41984
 v_mfma_f32_16x16x32_bf16 v[184:187],v[72:75],a[184:187],v[184:187]
 v_mfma_f32_16x16x32_bf16 v[188:191],v[72:75],a[188:191],v[188:191]
 ds_read_b128 v[72:75],v1 offset:43008
 v_mfma_f32_16x16x32_bf16 v[136:139],v[76:79],a[192:195],v[136:139]
 v_mfma_f32_16x16x32_bf16 v[140:143],v[76:79],a[196:199],v[140:143]
 s_waitcnt lgkmcnt(13)
 ds_read_b128 v[76:79],v1 offset:44032
 v_mfma_f32_16x16x32_bf16 v[144:147],v[16:19],a[192:195],v[144:147]
 buffer_load_dwordx4 a[176:179],v0,s[12:15],s53 offen sc1
 v_mfma_f32_16x16x32_bf16 v[148:151],v[16:19],a[196:199],v[148:151]
 ds_read_b128 v[16:19],v1 offset:45056
 v_mfma_f32_16x16x32_bf16 v[152:155],v[20:23],a[192:195],v[152:155]
 s_waitcnt vmcnt(9)
 v_add_f32 v216,v216,v220
 v_add_f32 v217,v217,v221
 v_mfma_f32_16x16x32_bf16 v[156:159],v[20:23],a[196:199],v[156:159]
 s_waitcnt vmcnt(7) lgkmcnt(13)
 v_add_f32 v218,v218,v222
 v_add_f32 v219,v219,v223
 v_add_f32 v224,v224,v228
 v_mfma_f32_16x16x32_bf16 v[160:163],v[24:27],a[192:195],v[160:163]
 v_add_f32 v225,v225,v229
 v_add_f32 v226,v226,v230
 v_mfma_f32_16x16x32_bf16 v[164:167],v[24:27],a[196:199],v[164:167]
 v_add_f32 v227,v227,v231
 v_add_f32 v216,v216,v224
 v_add_f32 v217,v217,v225
 v_mfma_f32_16x16x32_bf16 v[168:171],v[28:31],a[192:195],v[168:171]
 v_add_f32 v218,v218,v226
 v_add_f32 v219,v219,v227
 v_permlane16_swap_b32 v216,v217
 v_mfma_f32_16x16x32_bf16 v[172:175],v[28:31],a[196:199],v[172:175]
 s_waitcnt lgkmcnt(11)
 v_permlane16_swap_b32 v218,v219
 v_add_f32 v216,v216,v217
 v_mfma_f32_16x16x32_bf16 v[176:179],v[32:35],a[192:195],v[176:179]
 v_add_f32 v218,v218,v219
 s_nop 1
 v_permlane32_swap_b32 v216,v218
 v_add_f32 v216,v216,v218
 v_mfma_f32_16x16x32_bf16 v[180:183],v[32:35],a[196:199],v[180:183]
 v_mul_f32 v218,0x3a124925,v216
 v_mul_f32 v216,0x3a124925,v216
 s_nop 1
 v_permlane16_swap_b32 v216,v218
 v_mfma_f32_16x16x32_bf16 v[184:187],v[36:39],a[192:195],v[184:187]
 v_fma_f32 v218,-v216,v216,v218
 v_max_f32 v218,0,v218
 buffer_load_dwordx4 a[180:183],v0,s[12:15],s53 offen offset:1024 sc1
 v_mfma_f32_16x16x32_bf16 v[188:191],v[36:39],a[196:199],v[188:191]
 s_waitcnt lgkmcnt(9)
 v_add_f32 v218,0x3727c5ac,v218
 v_rsq_f32 v217,v218
 s_nop 0
 v_mul_f32 v216,-v216,v217
 v_mfma_f32_16x16x32_bf16 v[136:139],v[40:43],a[200:203],v[136:139]
 ds_write_b32 v250,v216
 ds_write_b32 v250,v217 offset:128
 ds_read_b128 v[192:195],v251
 v_mfma_f32_16x16x32_bf16 v[140:143],v[40:43],a[204:207],v[140:143]
 ds_read_b128 v[200:203],v251 offset:128
 ds_read_b128 v[196:199],v251 offset:64
 v_mfma_f32_16x16x32_bf16 v[144:147],v[44:47],a[200:203],v[144:147]
 ds_read_b128 v[204:207],v251 offset:192
 ds_read_b128 v[20:23],v1 offset:46080
 v_mfma_f32_16x16x32_bf16 v[148:151],v[44:47],a[204:207],v[148:151]
 s_waitcnt lgkmcnt(14)
 buffer_load_dwordx4 a[184:187],v0,s[12:15],s53 offen offset:2048 sc1
 v_mfma_f32_16x16x32_bf16 v[152:155],v[48:51],a[200:203],v[152:155]
 ds_read_b128 v[24:27],v1 offset:47104
 ds_read_b128 v[28:31],v1 offset:48128
 v_mfma_f32_16x16x32_bf16 v[156:159],v[48:51],a[204:207],v[156:159]
 v_mfma_f32_16x16x32_bf16 v[160:163],v[52:55],a[200:203],v[160:163]
 v_mfma_f32_16x16x32_bf16 v[164:167],v[52:55],a[204:207],v[164:167]
 s_waitcnt lgkmcnt(14)
 v_mfma_f32_16x16x32_bf16 v[168:171],v[56:59],a[200:203],v[168:171]
 v_mfma_f32_16x16x32_bf16 v[172:175],v[56:59],a[204:207],v[172:175]
 s_waitcnt lgkmcnt(5)
 v_fma_f32 v80,v80,v200,v192
 v_fma_f32 v81,v81,v201,v193
 v_mfma_f32_16x16x32_bf16 v[176:179],v[60:63],a[200:203],v[176:179]
 v_fma_f32 v82,v82,v202,v194
 v_fma_f32 v83,v83,v203,v195
 v_mfma_f32_16x16x32_bf16 v[180:183],v[60:63],a[204:207],v[180:183]
 s_waitcnt lgkmcnt(3)
 v_fma_f32 v84,v84,v204,v196
 v_fma_f32 v85,v85,v205,v197
 v_mfma_f32_16x16x32_bf16 v[184:187],v[64:67],a[200:203],v[184:187]
 v_fma_f32 v86,v86,v206,v198
 v_fma_f32 v87,v87,v207,v199
 v_cvt_pk_bf16_f32 v80,v80,v81
 v_mfma_f32_16x16x32_bf16 v[188:191],v[64:67],a[204:207],v[188:191]
 v_cvt_pk_bf16_f32 v81,v82,v83
 v_cvt_pk_bf16_f32 v82,v84,v85
 v_cvt_pk_bf16_f32 v83,v86,v87
 buffer_load_dwordx4 a[188:191],v0,s[12:15],s53 offen offset:3072 sc1
 v_mfma_f32_16x16x32_bf16 v[136:139],v[68:71],a[208:211],v[136:139]
 buffer_store_dwordx4 v[80:83],v0,s[12:15],s60 offen sc1
 v_fma_f32 v88,v88,v200,v192
 v_fma_f32 v89,v89,v201,v193
 v_mfma_f32_16x16x32_bf16 v[140:143],v[68:71],a[212:215],v[140:143]
 v_fma_f32 v90,v90,v202,v194
 v_fma_f32 v91,v91,v203,v195
 v_fma_f32 v92,v92,v204,v196
 v_mfma_f32_16x16x32_bf16 v[144:147],v[72:75],a[208:211],v[144:147]
 v_fma_f32 v93,v93,v205,v197
 v_fma_f32 v94,v94,v206,v198
 v_fma_f32 v95,v95,v207,v199
 v_mfma_f32_16x16x32_bf16 v[148:151],v[72:75],a[212:215],v[148:151]
 v_cvt_pk_bf16_f32 v88,v88,v89
 v_cvt_pk_bf16_f32 v89,v90,v91
 v_cvt_pk_bf16_f32 v90,v92,v93
 v_mfma_f32_16x16x32_bf16 v[152:155],v[76:79],a[208:211],v[152:155]
 v_cvt_pk_bf16_f32 v91,v94,v95
 buffer_store_dwordx4 v[88:91],v0,s[12:15],s60 offen offset:1024 sc1
 v_fma_f32 v96,v96,v200,v192
 v_mfma_f32_16x16x32_bf16 v[156:159],v[76:79],a[212:215],v[156:159]
 s_waitcnt lgkmcnt(0)
 v_fma_f32 v97,v97,v201,v193
 v_fma_f32 v98,v98,v202,v194
 v_fma_f32 v99,v99,v203,v195
 s_barrier
 ds_read_b128 v[32:35],v2
 ds_read_b128 v[36:39],v2 offset:1024
 v_mfma_f32_16x16x32_bf16 v[160:163],v[16:19],a[208:211],v[160:163]
 s_cmp_eq_u32 s44,6
 s_cselect_b32 s53,0,49152
 v_fma_f32 v100,v100,v204,v196
 v_fma_f32 v101,v101,v205,v197
 v_fma_f32 v102,v102,v206,v198
 s_add_u32 s53,s53,s64
 buffer_load_dwordx4 a[192:195],v0,s[12:15],s53 offen sc1
 v_mfma_f32_16x16x32_bf16 v[164:167],v[16:19],a[212:215],v[164:167]
 v_fma_f32 v103,v103,v207,v199
 v_cvt_pk_bf16_f32 v96,v96,v97
 v_cvt_pk_bf16_f32 v97,v98,v99
 v_mfma_f32_16x16x32_bf16 v[168:171],v[20:23],a[208:211],v[168:171]
 v_cvt_pk_bf16_f32 v98,v100,v101
 v_cvt_pk_bf16_f32 v99,v102,v103
 buffer_store_dwordx4 v[96:99],v0,s[12:15],s60 offen offset:2048 sc1
 v_mfma_f32_16x16x32_bf16 v[172:175],v[20:23],a[212:215],v[172:175]
 v_fma_f32 v104,v104,v200,v192
 v_fma_f32 v105,v105,v201,v193
 v_fma_f32 v106,v106,v202,v194
 ds_read_b128 v[40:43],v2 offset:2048
 ds_read_b128 v[44:47],v2 offset:3072
 v_mfma_f32_16x16x32_bf16 v[176:179],v[24:27],a[208:211],v[176:179]
 v_fma_f32 v107,v107,v203,v195
 v_fma_f32 v108,v108,v204,v196
 v_fma_f32 v109,v109,v205,v197
 v_mfma_f32_16x16x32_bf16 v[180:183],v[24:27],a[212:215],v[180:183]
 v_fma_f32 v110,v110,v206,v198
 v_fma_f32 v111,v111,v207,v199
 v_cvt_pk_bf16_f32 v104,v104,v105
 v_mfma_f32_16x16x32_bf16 v[184:187],v[28:31],a[208:211],v[184:187]
 v_cvt_pk_bf16_f32 v105,v106,v107
 v_cvt_pk_bf16_f32 v106,v108,v109
 v_cvt_pk_bf16_f32 v107,v110,v111
 v_mfma_f32_16x16x32_bf16 v[188:191],v[28:31],a[212:215],v[188:191]
 s_waitcnt lgkmcnt(2)
 buffer_store_dwordx4 v[104:107],v0,s[12:15],s60 offen offset:3072 sc1
 v_fma_f32 v112,v112,v200,v192
 v_fma_f32 v113,v113,v201,v193
 ds_read_b128 v[48:51],v2 offset:4096
 ds_read_b128 v[52:55],v2 offset:5120
 v_mfma_f32_16x16x32_bf16 v[136:139],v[32:35],a[216:219],v[136:139]
 v_fma_f32 v114,v114,v202,v194
 v_fma_f32 v115,v115,v203,v195
 v_fma_f32 v116,v116,v204,v196
 buffer_load_dwordx4 a[196:199],v0,s[12:15],s53 offen offset:1024 sc1
 v_mfma_f32_16x16x32_bf16 v[140:143],v[32:35],a[220:223],v[140:143]
 v_fma_f32 v117,v117,v205,v197
 v_fma_f32 v118,v118,v206,v198
 v_fma_f32 v119,v119,v207,v199
 v_mfma_f32_16x16x32_bf16 v[144:147],v[36:39],a[216:219],v[144:147]
 v_cvt_pk_bf16_f32 v112,v112,v113
 v_cvt_pk_bf16_f32 v113,v114,v115
 v_cvt_pk_bf16_f32 v114,v116,v117
 v_mfma_f32_16x16x32_bf16 v[148:151],v[36:39],a[220:223],v[148:151]
 s_waitcnt lgkmcnt(2)
 v_cvt_pk_bf16_f32 v115,v118,v119
 buffer_store_dwordx4 v[112:115],v0,s[12:15],s61 offen sc1
 v_fma_f32 v120,v120,v200,v192
 ds_read_b128 v[56:59],v2 offset:6144
 ds_read_b128 v[60:63],v2 offset:7168
 v_mfma_f32_16x16x32_bf16 v[152:155],v[40:43],a[216:219],v[152:155]
 v_fma_f32 v121,v121,v201,v193
 v_fma_f32 v122,v122,v202,v194
 v_fma_f32 v123,v123,v203,v195
 v_mfma_f32_16x16x32_bf16 v[156:159],v[40:43],a[220:223],v[156:159]
 v_fma_f32 v124,v124,v204,v196
 v_fma_f32 v125,v125,v205,v197
 v_fma_f32 v126,v126,v206,v198
 v_mfma_f32_16x16x32_bf16 v[160:163],v[44:47],a[216:219],v[160:163]
 v_fma_f32 v127,v127,v207,v199
 v_cvt_pk_bf16_f32 v120,v120,v121
 v_cvt_pk_bf16_f32 v121,v122,v123
 v_mfma_f32_16x16x32_bf16 v[164:167],v[44:47],a[220:223],v[164:167]
 s_waitcnt lgkmcnt(2)
 v_cvt_pk_bf16_f32 v122,v124,v125
 v_cvt_pk_bf16_f32 v123,v126,v127
 buffer_store_dwordx4 v[120:123],v0,s[12:15],s61 offen offset:1024 sc1
 buffer_load_dwordx4 a[200:203],v0,s[12:15],s53 offen offset:2048 sc1
 ds_read_b128 v[64:67],v2 offset:8192
 ds_read_b128 v[68:71],v2 offset:9216
 v_mfma_f32_16x16x32_bf16 v[168:171],v[48:51],a[216:219],v[168:171]
 v_fma_f32 v128,v128,v200,v192
 v_fma_f32 v129,v129,v201,v193
 v_fma_f32 v130,v130,v202,v194
 v_mfma_f32_16x16x32_bf16 v[172:175],v[48:51],a[220:223],v[172:175]
 v_fma_f32 v131,v131,v203,v195
 v_fma_f32 v132,v132,v204,v196
 v_fma_f32 v133,v133,v205,v197
 v_mfma_f32_16x16x32_bf16 v[176:179],v[52:55],a[216:219],v[176:179]
 v_fma_f32 v134,v134,v206,v198
 v_fma_f32 v135,v135,v207,v199
 v_cvt_pk_bf16_f32 v128,v128,v129
 v_mfma_f32_16x16x32_bf16 v[180:183],v[52:55],a[220:223],v[180:183]
 s_waitcnt lgkmcnt(2)
 v_cvt_pk_bf16_f32 v129,v130,v131
 v_cvt_pk_bf16_f32 v130,v132,v133
 v_cvt_pk_bf16_f32 v131,v134,v135
 ds_read_b128 v[72:75],v2 offset:10240
 ds_read_b128 v[76:79],v2 offset:11264
 v_mfma_f32_16x16x32_bf16 v[184:187],v[56:59],a[216:219],v[184:187]
 buffer_store_dwordx4 v[128:131],v0,s[12:15],s61 offen offset:2048 sc1
 v_mfma_f32_16x16x32_bf16 v[188:191],v[56:59],a[220:223],v[188:191]
 buffer_load_dwordx4 a[204:207],v0,s[12:15],s53 offen offset:3072 sc1
 v_mfma_f32_16x16x32_bf16 v[136:139],v[60:63],a[224:227],v[136:139]
 s_add_u32 s53,s53,4096
 ds_read_b128 v[16:19],v2 offset:12288
 ds_read_b128 v[20:23],v2 offset:13312
 v_mfma_f32_16x16x32_bf16 v[140:143],v[60:63],a[228:231],v[140:143]
 s_waitcnt lgkmcnt(4)
 ds_read_b128 v[24:27],v2 offset:14336
 ds_read_b128 v[28:31],v2 offset:15360
 v_mfma_f32_16x16x32_bf16 v[144:147],v[64:67],a[224:227],v[144:147]
 ds_read_b128 v[32:35],v2 offset:16384
 ds_read_b128 v[36:39],v2 offset:17408
 v_mfma_f32_16x16x32_bf16 v[148:151],v[64:67],a[228:231],v[148:151]
 ds_read_b128 v[40:43],v2 offset:18432
 ds_read_b128 v[44:47],v2 offset:19456
 v_mfma_f32_16x16x32_bf16 v[152:155],v[68:71],a[224:227],v[152:155]
 s_branch .Lsk14
.Lst14:
 s_branch .Lvb2
.Lsk14:
 ds_read_b128 v[48:51],v2 offset:20480
 ds_read_b128 v[52:55],v2 offset:21504
 v_mfma_f32_16x16x32_bf16 v[156:159],v[68:71],a[228:231],v[156:159]
 s_waitcnt lgkmcnt(10)
 ds_read_b128 v[56:59],v2 offset:22528
 ds_read_b128 v[60:63],v2 offset:23552
 v_mfma_f32_16x16x32_bf16 v[160:163],v[72:75],a[224:227],v[160:163]
 buffer_load_dwordx4 a[208:211],v0,s[12:15],s53 offen sc1
 v_mfma_f32_16x16x32_bf16 v[164:167],v[72:75],a[228:231],v[164:167]
 ds_read_b128 v[64:67],v2 offset:24576
 ds_read_b128 v[68:71],v2 offset:25600
 v_mfma_f32_16x16x32_bf16 v[168:171],v[76:79],a[224:227],v[168:171]
 ds_read_b128 v[72:75],v2 offset:26624
 v_mfma_f32_16x16x32_bf16 v[172:175],v[76:79],a[228:231],v[172:175]
 s_waitcnt lgkmcnt(13)
 ds_read_b128 v[76:79],v2 offset:27648
 v_mfma_f32_16x16x32_bf16 v[176:179],v[16:19],a[224:227],v[176:179]
 v_mfma_f32_16x16x32_bf16 v[180:183],v[16:19],a[228:231],v[180:183]
 v_mfma_f32_16x16x32_bf16 v[184:187],v[20:23],a[224:227],v[184:187]
 v_mfma_f32_16x16x32_bf16 v[188:191],v[20:23],a[228:231],v[188:191]
 s_waitcnt lgkmcnt(12)
 buffer_load_dwordx4 a[212:215],v0,s[12:15],s53 offen offset:1024 sc1
 v_mfma_f32_16x16x32_bf16 v[136:139],v[24:27],a[232:235],v[136:139]
 v_mfma_f32_16x16x32_bf16 v[140:143],v[24:27],a[236:239],v[140:143]
 v_mfma_f32_16x16x32_bf16 v[144:147],v[28:31],a[232:235],v[144:147]
 v_mfma_f32_16x16x32_bf16 v[148:151],v[28:31],a[236:239],v[148:151]
 s_waitcnt lgkmcnt(0)
 s_barrier
 ds_read_b128 v[16:19],v0
 v_mfma_f32_16x16x32_bf16 v[152:155],v[32:35],a[232:235],v[152:155]
 ds_read_b128 v[20:23],v0 offset:1024
 ds_read_b128 v[24:27],v0 offset:2048
 v_mfma_f32_16x16x32_bf16 v[156:159],v[32:35],a[236:239],v[156:159]
 ds_read_b128 v[28:31],v0 offset:3072
 ds_read_b128 v[32:35],v0 offset:4096
 v_mfma_f32_16x16x32_bf16 v[160:163],v[36:39],a[232:235],v[160:163]
 v_mfma_f32_16x16x32_bf16 v[164:167],v[36:39],a[236:239],v[164:167]
 buffer_load_dwordx4 a[216:219],v0,s[12:15],s53 offen offset:2048 sc1
 v_mfma_f32_16x16x32_bf16 v[168:171],v[40:43],a[232:235],v[168:171]
 ds_read_b128 v[36:39],v0 offset:5120
 v_mfma_f32_16x16x32_bf16 v[172:175],v[40:43],a[236:239],v[172:175]
 ds_read_b128 v[40:43],v0 offset:6144
 v_mfma_f32_16x16x32_bf16 v[176:179],v[44:47],a[232:235],v[176:179]
 v_mfma_f32_16x16x32_bf16 v[180:183],v[44:47],a[236:239],v[180:183]
 ds_read_b128 v[44:47],v0 offset:7168
 v_mfma_f32_16x16x32_bf16 v[184:187],v[48:51],a[232:235],v[184:187]
 v_mfma_f32_16x16x32_bf16 v[188:191],v[48:51],a[236:239],v[188:191]
 ds_read_b128 v[48:51],v0 offset:8192
 v_mfma_f32_16x16x32_bf16 v[136:139],v[52:55],a[240:243],v[136:139]
 buffer_load_dwordx4 a[220:223],v0,s[12:15],s53 offen offset:3072 sc1
 v_mfma_f32_16x16x32_bf16 v[140:143],v[52:55],a[244:247],v[140:143]
 s_cmp_eq_u32 s44,7
 s_cselect_b32 s53,0,57344
 v_mfma_f32_16x16x32_bf16 v[144:147],v[56:59],a[240:243],v[144:147]
 s_add_u32 s53,s53,s64
 ds_read_b128 v[52:55],v0 offset:9216
 v_mfma_f32_16x16x32_bf16 v[148:151],v[56:59],a[244:247],v[148:151]
 ds_read_b128 v[56:59],v0 offset:10240
 v_mfma_f32_16x16x32_bf16 v[152:155],v[60:63],a[240:243],v[152:155]
 v_mfma_f32_16x16x32_bf16 v[156:159],v[60:63],a[244:247],v[156:159]
 ds_read_b128 v[60:63],v0 offset:11264
 v_mfma_f32_16x16x32_bf16 v[160:163],v[64:67],a[240:243],v[160:163]
 v_mfma_f32_16x16x32_bf16 v[164:167],v[64:67],a[244:247],v[164:167]
 ds_read_b128 v[64:67],v0 offset:12288
 v_mfma_f32_16x16x32_bf16 v[168:171],v[68:71],a[240:243],v[168:171]
 buffer_load_dwordx4 a[224:227],v0,s[12:15],s53 offen sc1
 v_mfma_f32_16x16x32_bf16 v[172:175],v[68:71],a[244:247],v[172:175]
 ds_read_b128 v[68:71],v0 offset:13312
 v_mfma_f32_16x16x32_bf16 v[176:179],v[72:75],a[240:243],v[176:179]
 v_mfma_f32_16x16x32_bf16 v[180:183],v[72:75],a[244:247],v[180:183]
 v_mfma_f32_16x16x32_bf16 v[184:187],v[76:79],a[240:243],v[184:187]
 v_mfma_f32_16x16x32_bf16 v[188:191],v[76:79],a[244:247],v[188:191]
 s_waitcnt lgkmcnt(12)
 v_mfma_f32_16x16x32_bf16 v[136:139],v[16:19],a[248:251],v[136:139]
 v_mfma_f32_16x16x32_bf16 v[140:143],v[16:19],a[252:255],v[140:143]
 buffer_load_dwordx4 a[228:231],v0,s[12:15],s53 offen offset:1024 sc1
 v_mfma_f32_16x16x32_bf16 v[144:147],v[20:23],a[248:251],v[144:147]
 v_mfma_f32_16x16x32_bf16 v[148:151],v[20:23],a[252:255],v[148:151]
 s_waitcnt lgkmcnt(10)
 v_mfma_f32_16x16x32_bf16 v[152:155],v[24:27],a[248:251],v[152:155]
 v_mfma_f32_16x16x32_bf16 v[156:159],v[24:27],a[252:255],v[156:159]
 v_mfma_f32_16x16x32_bf16 v[160:163],v[28:31],a[248:251],v[160:163]
 v_mfma_f32_16x16x32_bf16 v[164:167],v[28:31],a[252:255],v[164:167]
 s_waitcnt lgkmcnt(8)
 v_mfma_f32_16x16x32_bf16 v[168:171],v[32:35],a[248:251],v[168:171]
 v_mfma_f32_16x16x32_bf16 v[172:175],v[32:35],a[252:255],v[172:175]
 buffer_load_dwordx4 a[232:235],v0,s[12:15],s53 offen offset:2048 sc1
 v_mfma_f32_16x16x32_bf16 v[176:179],v[36:39],a[248:251],v[176:179]
 v_mfma_f32_16x16x32_bf16 v[180:183],v[36:39],a[252:255],v[180:183]
 s_waitcnt lgkmcnt(6)
 v_mfma_f32_16x16x32_bf16 v[184:187],v[40:43],a[248:251],v[184:187]
 v_mfma_f32_16x16x32_bf16 v[188:191],v[40:43],a[252:255],v[188:191]
 v_mfma_f32_16x16x32_bf16 v[136:139],v[44:47],v[236:239],v[136:139]
 v_mfma_f32_16x16x32_bf16 v[140:143],v[44:47],v[240:243],v[140:143]
 s_waitcnt lgkmcnt(4)
 v_mfma_f32_16x16x32_bf16 v[144:147],v[48:51],v[236:239],v[144:147]
 buffer_load_dwordx4 a[236:239],v0,s[12:15],s53 offen offset:3072 sc1
 v_mfma_f32_16x16x32_bf16 v[148:151],v[48:51],v[240:243],v[148:151]
 v_mfma_f32_16x16x32_bf16 v[152:155],v[52:55],v[236:239],v[152:155]
 v_mfma_f32_16x16x32_bf16 v[156:159],v[52:55],v[240:243],v[156:159]
 s_waitcnt lgkmcnt(2)
 v_mfma_f32_16x16x32_bf16 v[160:163],v[56:59],v[236:239],v[160:163]
 v_mfma_f32_16x16x32_bf16 v[164:167],v[56:59],v[240:243],v[164:167]
 v_mfma_f32_16x16x32_bf16 v[168:171],v[60:63],v[236:239],v[168:171]
 v_mfma_f32_16x16x32_bf16 v[172:175],v[60:63],v[240:243],v[172:175]
 s_waitcnt lgkmcnt(0)
 v_mfma_f32_16x16x32_bf16 v[176:179],v[64:67],v[236:239],v[176:179]
 v_mfma_f32_16x16x32_bf16 v[180:183],v[64:67],v[240:243],v[180:183]
 v_mfma_f32_16x16x32_bf16 v[184:187],v[68:71],v[236:239],v[184:187]
 s_waitcnt vmcnt(9)
 s_barrier
 buffer_atomic_add v6,v4,s[12:15],0 offen offset:32 sc1
 v_mfma_f32_16x16x32_bf16 v[188:191],v[68:71],v[240:243],v[188:191]
.Lwz:
 ds_write_b128 v232,v[80:83] offset:28672
 ds_write_b128 v232,v[88:91] offset:29696
 ds_write_b128 v232,v[96:99] offset:30720
 ds_write_b128 v232,v[104:107] offset:31744
 ds_write_b128 v232,v[112:115] offset:32768
 ds_write_b128 v232,v[120:123] offset:33792
 ds_write_b128 v232,v[128:131] offset:34816
 v_lshlrev_b32 v236,16,v254
 v_lshlrev_b32 v240,16,v255
 v_mov_b32 v237,v236
 v_mov_b32 v238,v236
 v_mov_b32 v239,v236
 v_mov_b32 v241,v240
 v_mov_b32 v242,v240
 v_mov_b32 v243,v240
 s_add_u32 s53,s53,4096
 s_waitcnt lgkmcnt(0)
 s_barrier
 ds_read_b128 v[72:75],v0 offset:28672
 ds_read_b128 v[76:79],v0 offset:29696
 ds_read_b128 v[16:19],v0 offset:30720
 ds_read_b128 v[20:23],v0 offset:31744
 ds_read_b128 v[24:27],v0 offset:32768
 ds_read_b128 v[28:31],v0 offset:33792
 s_waitcnt lgkmcnt(4)
 v_mfma_f32_16x16x32_bf16 v[80:83],v[72:75],a[0:3],v[236:239]
 s_mov_b32 s49,16384
 buffer_load_dwordx4 a[240:243],v0,s[12:15],s53 offen sc1
 v_mfma_f32_16x16x32_bf16 v[84:87],v[72:75],a[4:7],v[240:243]
 s_add_u32 m0,s55,131072
 v_mul_f32 v232,v136,v136
 v_mul_f32 v233,v137,v137
 v_mfma_f32_16x16x32_bf16 v[88:91],v[76:79],a[0:3],v[236:239]
 v_fma_f32 v232,v232,v246,v244
 ds_read_b128 v[32:35],v0 offset:34816
 v_mfma_f32_16x16x32_bf16 v[92:95],v[76:79],a[4:7],v[240:243]
 s_waitcnt lgkmcnt(3)
 ds_read_b128 v[36:39],v0 offset:35840
 v_fma_f32 v233,v233,v246,v244
 v_mfma_f32_16x16x32_bf16 v[96:99],v[16:19],a[0:3],v[236:239]
 buffer_load_dwordx4 a[244:247],v0,s[12:15],s53 offen offset:1024 sc1
 v_mfma_f32_16x16x32_bf16 v[100:103],v[16:19],a[4:7],v[240:243]
 v_mul_f32 v232,v232,v136
 v_mul_f32 v233,v233,v137
 v_mfma_f32_16x16x32_bf16 v[104:107],v[20:23],a[0:3],v[236:239]
 v_exp_f32 v232,v232
 v_exp_f32 v233,v233
 v_mfma_f32_16x16x32_bf16 v[108:111],v[20:23],a[4:7],v[240:243]
 s_waitcnt lgkmcnt(2)
 v_fma_f32 v232,v232,v248,v248
 ds_read_b128 v[40:43],v0 offset:36864
 ds_read_b128 v[44:47],v0 offset:37888
 v_mfma_f32_16x16x32_bf16 v[112:115],v[24:27],a[0:3],v[236:239]
 buffer_load_dwordx4 a[248:251],v0,s[12:15],s53 offen offset:2048 sc1
 v_fma_f32 v233,v233,v248,v248
 v_rcp_f32 v232,v232
 v_mfma_f32_16x16x32_bf16 v[116:119],v[24:27],a[4:7],v[240:243]
 v_rcp_f32 v233,v233
 v_mfma_f32_16x16x32_bf16 v[120:123],v[28:31],a[0:3],v[236:239]
 v_mul_f32 v136,v136,v232
 v_mul_f32 v137,v137,v233
 v_mfma_f32_16x16x32_bf16 v[124:127],v[28:31],a[4:7],v[240:243]
 s_waitcnt lgkmcnt(2)
 v_mul_f32 v234,v138,v138
 v_mul_f32 v235,v139,v139
 ds_read_b128 v[48:51],v0 offset:38912
 ds_read_b128 v[52:55],v0 offset:39936
 v_mfma_f32_16x16x32_bf16 v[128:131],v[32:35],a[0:3],v[236:239]
 buffer_load_dwordx4 a[252:255],v0,s[12:15],s53 offen offset:3072 sc1
 v_fma_f32 v234,v234,v246,v244
 v_mfma_f32_16x16x32_bf16 v[132:135],v[32:35],a[4:7],v[240:243]
 v_fma_f32 v235,v235,v246,v244
 v_mul_f32 v234,v234,v138
 v_mfma_f32_16x16x32_bf16 v[80:83],v[36:39],a[8:11],v[80:83]
 v_mul_f32 v235,v235,v139
 ds_read_b128 v[56:59],v0 offset:40960
 v_mfma_f32_16x16x32_bf16 v[84:87],v[36:39],a[12:15],v[84:87]
 s_waitcnt lgkmcnt(3)
 v_exp_f32 v234,v234
 v_exp_f32 v235,v235
 ds_read_b128 v[60:63],v0 offset:41984
 v_mfma_f32_16x16x32_bf16 v[88:91],v[40:43],a[8:11],v[88:91]
 buffer_load_dwordx4 v[216:219],v0,s[12:15],s56 offen sc1
 v_fma_f32 v234,v234,v248,v248
 v_fma_f32 v235,v235,v248,v248
 v_mfma_f32_16x16x32_bf16 v[92:95],v[40:43],a[12:15],v[92:95]
 v_rcp_f32 v234,v234
 v_mfma_f32_16x16x32_bf16 v[96:99],v[44:47],a[8:11],v[96:99]
 v_rcp_f32 v235,v235
 v_mul_f32 v138,v138,v234
 v_mfma_f32_16x16x32_bf16 v[100:103],v[44:47],a[12:15],v[100:103]
 s_waitcnt lgkmcnt(2)
 v_mul_f32 v139,v139,v235
 v_mul_f32 v232,v140,v140
 ds_read_b128 v[64:67],v0 offset:43008
 ds_read_b128 v[68:71],v0 offset:44032
 v_mfma_f32_16x16x32_bf16 v[104:107],v[48:51],a[8:11],v[104:107]
 buffer_load_dwordx4 v[220:223],v0,s[12:15],s56 offen offset:1024 sc1
 v_mul_f32 v233,v141,v141
 v_mfma_f32_16x16x32_bf16 v[108:111],v[48:51],a[12:15],v[108:111]
 v_fma_f32 v232,v232,v247,v245
 v_fma_f32 v233,v233,v247,v245
 v_mfma_f32_16x16x32_bf16 v[112:115],v[52:55],a[8:11],v[112:115]
 v_mul_f32 v232,v232,v140
 v_mul_f32 v233,v233,v141
 v_mfma_f32_16x16x32_bf16 v[116:119],v[52:55],a[12:15],v[116:119]
 s_waitcnt lgkmcnt(2)
 v_exp_f32 v232,v232
 ds_read_b128 v[72:75],v0 offset:45056
 ds_read_b128 v[76:79],v0 offset:46080
 v_mfma_f32_16x16x32_bf16 v[120:123],v[56:59],a[8:11],v[120:123]
 buffer_load_dwordx4 v[224:227],v0,s[12:15],s56 offen offset:2048 sc1
 v_exp_f32 v233,v233
 v_fma_f32 v232,v232,v249,v249
 v_mfma_f32_16x16x32_bf16 v[124:127],v[56:59],a[12:15],v[124:127]
 v_fma_f32 v233,v233,v249,v249
 ds_read_b128 v[16:19],v0 offset:47104
 v_mfma_f32_16x16x32_bf16 v[128:131],v[60:63],a[8:11],v[128:131]
 v_rcp_f32 v232,v232
 v_rcp_f32 v233,v233
 v_mfma_f32_16x16x32_bf16 v[132:135],v[60:63],a[12:15],v[132:135]
 s_waitcnt lgkmcnt(3)
 v_mul_f32 v140,v140,v232
 ds_read_b128 v[20:23],v0 offset:48128
 v_mfma_f32_16x16x32_bf16 v[80:83],v[64:67],a[16:19],v[80:83]
 buffer_load_dwordx4 v[228:231],v0,s[12:15],s56 offen offset:3072 sc1
 v_mul_f32 v141,v141,v233
 v_mul_f32 v234,v142,v142
 v_mfma_f32_16x16x32_bf16 v[84:87],v[64:67],a[20:23],v[84:87]
 v_mul_f32 v235,v143,v143
 v_fma_f32 v234,v234,v247,v245
 v_mfma_f32_16x16x32_bf16 v[88:91],v[68:71],a[16:19],v[88:91]
 v_fma_f32 v235,v235,v247,v245
 v_mul_f32 v234,v234,v142
 v_mfma_f32_16x16x32_bf16 v[92:95],v[68:71],a[20:23],v[92:95]
 s_waitcnt lgkmcnt(2)
 v_mov_b32 v7,0
 buffer_atomic_add v7,v5,s[12:15],0 offen offset:32 sc0 sc1
 v_mul_f32 v235,v235,v143
 ds_read_b128 v[24:27],v0 offset:49152
 ds_read_b128 v[28:31],v0 offset:50176
 v_mfma_f32_16x16x32_bf16 v[96:99],v[72:75],a[16:19],v[96:99]
 v_exp_f32 v234,v234
 v_exp_f32 v235,v235
 v_mfma_f32_16x16x32_bf16 v[100:103],v[72:75],a[20:23],v[100:103]
 v_fma_f32 v234,v234,v249,v249
 v_fma_f32 v235,v235,v249,v249
 v_mfma_f32_16x16x32_bf16 v[104:107],v[76:79],a[16:19],v[104:107]
 v_rcp_f32 v234,v234
 v_mfma_f32_16x16x32_bf16 v[108:111],v[76:79],a[20:23],v[108:111]
 s_waitcnt lgkmcnt(2)
 buffer_load_dwordx4 v14,s[12:15],s49 offen sc1 lds
 v_rcp_f32 v235,v235
 ds_read_b128 v[32:35],v0 offset:51200
 ds_read_b128 v[36:39],v0 offset:52224
 v_mfma_f32_16x16x32_bf16 v[112:115],v[16:19],a[16:19],v[112:115]
 s_mov_b32 s49,20480
 v_mul_f32 v142,v142,v234
 v_mul_f32 v143,v143,v235
 v_mfma_f32_16x16x32_bf16 v[116:119],v[16:19],a[20:23],v[116:119]
 s_add_u32 m0,s55,135168
 v_mul_f32 v232,v144,v144
 v_mul_f32 v233,v145,v145
 v_mfma_f32_16x16x32_bf16 v[120:123],v[20:23],a[16:19],v[120:123]
 v_fma_f32 v232,v232,v246,v244
 v_fma_f32 v233,v233,v246,v244
 v_mfma_f32_16x16x32_bf16 v[124:127],v[20:23],a[20:23],v[124:127]
 s_waitcnt lgkmcnt(2)
 buffer_load_dwordx4 v14,s[12:15],s49 offen sc1 lds
 v_mul_f32 v232,v232,v144
 ds_read_b128 v[40:43],v0 offset:53248
 ds_read_b128 v[44:47],v0 offset:54272
 v_mfma_f32_16x16x32_bf16 v[128:131],v[24:27],a[16:19],v[128:131]
 s_mov_b32 s49,24576
 v_mul_f32 v233,v233,v145
 s_add_u32 m0,s55,139264
 v_mfma_f32_16x16x32_bf16 v[132:135],v[24:27],a[20:23],v[132:135]
 v_exp_f32 v232,v232
 v_exp_f32 v233,v233
 v_mfma_f32_16x16x32_bf16 v[80:83],v[28:31],a[24:27],v[80:83]
 v_fma_f32 v232,v232,v248,v248
 v_fma_f32 v233,v233,v248,v248
 v_mfma_f32_16x16x32_bf16 v[84:87],v[28:31],a[28:31],v[84:87]
 s_waitcnt lgkmcnt(2)
 buffer_load_dwordx4 v14,s[12:15],s49 offen sc1 lds
 v_rcp_f32 v232,v232
 ds_read_b128 v[48:51],v0 offset:55296
 ds_read_b128 v[52:55],v0 offset:56320
 v_mfma_f32_16x16x32_bf16 v[88:91],v[32:35],a[24:27],v[88:91]
 v_rcp_f32 v233,v233
 v_mul_f32 v144,v144,v232
 v_mfma_f32_16x16x32_bf16 v[92:95],v[32:35],a[28:31],v[92:95]
 s_mov_b32 s49,28672
 v_mul_f32 v145,v145,v233
 v_mul_f32 v234,v146,v146
 v_mfma_f32_16x16x32_bf16 v[96:99],v[36:39],a[24:27],v[96:99]
 s_add_u32 m0,s55,143360
 v_mul_f32 v235,v147,v147
 v_fma_f32 v234,v234,v246,v244
 v_mfma_f32_16x16x32_bf16 v[100:103],v[36:39],a[28:31],v[100:103]
 s_waitcnt lgkmcnt(2)
 buffer_load_dwordx4 v14,s[12:15],s49 offen sc1 lds
 v_fma_f32 v235,v235,v246,v244
 v_mfma_f32_16x16x32_bf16 v[104:107],v[40:43],a[24:27],v[104:107]
 s_mov_b32 s49,32768
 v_mul_f32 v234,v234,v146
 v_mul_f32 v235,v235,v147
 v_mfma_f32_16x16x32_bf16 v[108:111],v[40:43],a[28:31],v[108:111]
 s_add_u32 m0,s55,147456
 v_exp_f32 v234,v234
 v_mfma_f32_16x16x32_bf16 v[112:115],v[44:47],a[24:27],v[112:115]
 v_exp_f32 v235,v235
 v_fma_f32 v234,v234,v248,v248
 v_mfma_f32_16x16x32_bf16 v[116:119],v[44:47],a[28:31],v[116:119]
 s_waitcnt lgkmcnt(0)
 buffer_load_dwordx4 v14,s[12:15],s49 offen sc1 lds
 v_fma_f32 v235,v235,v248,v248
 v_mfma_f32_16x16x32_bf16 v[120:123],v[48:51],a[24:27],v[120:123]
 v_rcp_f32 v234,v234
 v_rcp_f32 v235,v235
 v_mfma_f32_16x16x32_bf16 v[124:127],v[48:51],a[28:31],v[124:127]
 v_mul_f32 v146,v146,v234
 v_mul_f32 v147,v147,v235
 v_mfma_f32_16x16x32_bf16 v[128:131],v[52:55],a[24:27],v[128:131]
 v_mfma_f32_16x16x32_bf16 v[132:135],v[52:55],a[28:31],v[132:135]
 s_barrier
 s_mov_b32 s49,36864
 v_pk_mul_f32 v[232:233],v[148:149],v[148:149]
 v_pk_mul_f32 v[234:235],v[150:151],v[150:151]
 v_pk_fma_f32 v[232:233],v[232:233],v[246:247],v[244:245] op_sel:[0,1,1] op_sel_hi:[1,1,1]
 s_add_u32 m0,s55,151552
 v_pk_fma_f32 v[234:235],v[234:235],v[246:247],v[244:245] op_sel:[0,1,1] op_sel_hi:[1,1,1]
 v_pk_mul_f32 v[232:233],v[232:233],v[148:149]
 v_pk_mul_f32 v[234:235],v[234:235],v[150:151]
 buffer_load_dwordx4 v14,s[12:15],s49 offen sc1 lds
 v_exp_f32 v232,v232
 v_exp_f32 v233,v233
 v_exp_f32 v234,v234
 s_mov_b32 s49,40960
 v_exp_f32 v235,v235
 v_pk_fma_f32 v[232:233],v[232:233],v[248:249],v[248:249] op_sel:[0,1,1] op_sel_hi:[1,1,1]
 v_pk_fma_f32 v[234:235],v[234:235],v[248:249],v[248:249] op_sel:[0,1,1] op_sel_hi:[1,1,1]
 s_add_u32 m0,s55,155648
 v_rcp_f32 v232,v232
 v_rcp_f32 v233,v233
 v_rcp_f32 v234,v234
 buffer_load_dwordx4 v14,s[12:15],s49 offen sc1 lds
 v_rcp_f32 v235,v235
 v_pk_mul_f32 v[148:149],v[148:149],v[232:233]
 v_pk_mul_f32 v[150:151],v[150:151],v[234:235]
 s_mov_b32 s51,225280
 v_pk_mul_f32 v[232:233],v[152:153],v[152:153]
 v_pk_mul_f32 v[234:235],v[154:155],v[154:155]
 v_pk_fma_f32 v[232:233],v[232:233],v[246:247],v[244:245] op_sel:[0,0,0] op_sel_hi:[1,0,0]
 buffer_load_dwordx4 v[192:195],v14,s[12:15],s51 offen sc1
 v_pk_fma_f32 v[234:235],v[234:235],v[246:247],v[244:245] op_sel:[0,0,0] op_sel_hi:[1,0,0]
 v_pk_mul_f32 v[232:233],v[232:233],v[152:153]
 v_pk_mul_f32 v[234:235],v[234:235],v[154:155]
 s_mov_b32 s51,221184
 v_exp_f32 v232,v232
 v_exp_f32 v233,v233
 v_exp_f32 v234,v234
 buffer_load_dwordx4 v[196:199],v14,s[12:15],s51 offen sc1
 v_exp_f32 v235,v235
 v_pk_fma_f32 v[232:233],v[232:233],v[248:249],v[248:249] op_sel:[0,0,0] op_sel_hi:[1,0,0]
 v_pk_fma_f32 v[234:235],v[234:235],v[248:249],v[248:249] op_sel:[0,0,0] op_sel_hi:[1,0,0]
 s_mov_b32 s51,217088
 v_rcp_f32 v232,v232
 v_rcp_f32 v233,v233
 v_rcp_f32 v234,v234
 buffer_load_dwordx4 v[200:203],v14,s[12:15],s51 offen sc1
 v_rcp_f32 v235,v235
 v_pk_mul_f32 v[152:153],v[152:153],v[232:233]
 v_pk_mul_f32 v[154:155],v[154:155],v[234:235]
 s_mov_b32 s51,212992
 v_pk_mul_f32 v[232:233],v[156:157],v[156:157]
 v_pk_mul_f32 v[234:235],v[158:159],v[158:159]
 v_pk_fma_f32 v[232:233],v[232:233],v[246:247],v[244:245] op_sel:[0,1,1] op_sel_hi:[1,1,1]
 buffer_load_dwordx4 v[204:207],v14,s[12:15],s51 offen sc1
 v_pk_fma_f32 v[234:235],v[234:235],v[246:247],v[244:245] op_sel:[0,1,1] op_sel_hi:[1,1,1]
 v_pk_mul_f32 v[232:233],v[232:233],v[156:157]
 v_pk_mul_f32 v[234:235],v[234:235],v[158:159]
 s_mov_b32 s51,208896
 v_exp_f32 v232,v232
 v_exp_f32 v233,v233
 v_exp_f32 v234,v234
 buffer_load_dwordx4 v[208:211],v14,s[12:15],s51 offen sc1
 v_exp_f32 v235,v235
 v_pk_fma_f32 v[232:233],v[232:233],v[248:249],v[248:249] op_sel:[0,1,1] op_sel_hi:[1,1,1]
 v_pk_fma_f32 v[234:235],v[234:235],v[248:249],v[248:249] op_sel:[0,1,1] op_sel_hi:[1,1,1]
 s_cmp_eq_u32 s44,8
 s_cselect_b32 s53,0,65536
 v_rcp_f32 v232,v232
 v_rcp_f32 v233,v233
 v_rcp_f32 v234,v234
 s_add_u32 s53,s53,s64
 v_rcp_f32 v235,v235
 v_pk_mul_f32 v[156:157],v[156:157],v[232:233]
 v_pk_mul_f32 v[158:159],v[158:159],v[234:235]
 buffer_load_dwordx4 a[0:3],v0,s[12:15],s53 offen sc1
 v_pk_mul_f32 v[232:233],v[160:161],v[160:161]
 v_pk_mul_f32 v[234:235],v[162:163],v[162:163]
 v_pk_fma_f32 v[232:233],v[232:233],v[246:247],v[244:245] op_sel:[0,0,0] op_sel_hi:[1,0,0]
 buffer_load_dwordx4 a[4:7],v0,s[12:15],s53 offen offset:1024 sc1
 v_pk_fma_f32 v[234:235],v[234:235],v[246:247],v[244:245] op_sel:[0,0,0] op_sel_hi:[1,0,0]
 v_pk_mul_f32 v[232:233],v[232:233],v[160:161]
 v_pk_mul_f32 v[234:235],v[234:235],v[162:163]
 buffer_load_dwordx4 a[8:11],v0,s[12:15],s53 offen offset:2048 sc1
 v_exp_f32 v232,v232
 v_exp_f32 v233,v233
 v_exp_f32 v234,v234
 buffer_load_dwordx4 a[12:15],v0,s[12:15],s53 offen offset:3072 sc1
 v_exp_f32 v235,v235
 v_pk_fma_f32 v[232:233],v[232:233],v[248:249],v[248:249] op_sel:[0,0,0] op_sel_hi:[1,0,0]
 v_pk_fma_f32 v[234:235],v[234:235],v[248:249],v[248:249] op_sel:[0,0,0] op_sel_hi:[1,0,0]
 v_rcp_f32 v232,v232
 v_rcp_f32 v233,v233
 v_rcp_f32 v234,v234
 v_rcp_f32 v235,v235
 v_pk_mul_f32 v[160:161],v[160:161],v[232:233]
 v_pk_mul_f32 v[162:163],v[162:163],v[234:235]
 s_cmp_eq_u32 s46,0
 s_cbranch_scc1 .Lvs4_0
 s_cmp_eq_u32 s46,1
 s_cbranch_scc1 .Lvs4_1
 s_cmp_eq_u32 s46,2
 s_cbranch_scc1 .Lvs4_2
 s_branch .Lvs4_3
.Lvs4_2:
.Lvs4_3:
.Lvb4:
 s_waitcnt vmcnt(16)
 v_readfirstlane_b32 s59,v7
 s_nop 0
 s_cmp_ge_u32 s59,16
 s_cbranch_scc0 .Lseq_slow_22
.Lseq_back_23:
 s_cmp_eq_u32 s44,1
 s_cselect_b32 s50,0,28672
 s_add_u32 s50,s50,s66
 s_add_u32 m0,s54,57344
 s_nop 0
 buffer_load_dwordx4 v0,s[12:15],s50 offen sc1 lds
 buffer_load_dwordx4 v0,s[12:15],s50 offen offset:1024 sc1 lds
 buffer_load_dwordx4 v0,s[12:15],s50 offen offset:2048 sc1 lds
 buffer_load_dwordx4 v0,s[12:15],s50 offen offset:3072 sc1 lds
 s_add_u32 s50,s50,4096
 s_add_u32 m0,s54,61440
 s_nop 0
 buffer_load_dwordx4 v0,s[12:15],s50 offen sc1 lds
 buffer_load_dwordx4 v0,s[12:15],s50 offen offset:1024 sc1 lds
 buffer_load_dwordx4 v0,s[12:15],s50 offen offset:2048 sc1 lds
 s_cmp_eq_u32 s44,2
 s_cselect_b32 s50,0,57344
 v_pk_mul_f32 v[232:233],v[164:165],v[164:165]
 v_pk_mul_f32 v[234:235],v[166:167],v[166:167]
 v_pk_fma_f32 v[232:233],v[232:233],v[246:247],v[244:245] op_sel:[0,1,1] op_sel_hi:[1,1,1]
 v_pk_fma_f32 v[234:235],v[234:235],v[246:247],v[244:245] op_sel:[0,1,1] op_sel_hi:[1,1,1]
 v_pk_mul_f32 v[232:233],v[232:233],v[164:165]
 v_pk_mul_f32 v[234:235],v[234:235],v[166:167]
 v_exp_f32 v232,v232
 v_exp_f32 v233,v233
 v_exp_f32 v234,v234
 v_exp_f32 v235,v235
 s_add_u32 s50,s50,s66
 v_pk_fma_f32 v[232:233],v[232:233],v[248:249],v[248:249] op_sel:[0,1,1] op_sel_hi:[1,1,1]
 v_pk_fma_f32 v[234:235],v[234:235],v[248:249],v[248:249] op_sel:[0,1,1] op_sel_hi:[1,1,1]
 v_rcp_f32 v232,v232
 v_rcp_f32 v233,v233
 v_rcp_f32 v234,v234
 v_rcp_f32 v235,v235
 v_pk_mul_f32 v[164:165],v[164:165],v[232:233]
 v_pk_mul_f32 v[166:167],v[166:167],v[234:235]
 v_pk_mul_f32 v[232:233],v[168:169],v[168:169]
 v_pk_mul_f32 v[234:235],v[170:171],v[170:171]
 s_add_u32 m0,s54,86016
 v_pk_fma_f32 v[232:233],v[232:233],v[246:247],v[244:245] op_sel:[0,0,0] op_sel_hi:[1,0,0]
 v_pk_fma_f32 v[234:235],v[234:235],v[246:247],v[244:245] op_sel:[0,0,0] op_sel_hi:[1,0,0]
 v_pk_mul_f32 v[232:233],v[232:233],v[168:169]
 v_pk_mul_f32 v[234:235],v[234:235],v[170:171]
 v_exp_f32 v232,v232
 v_exp_f32 v233,v233
 v_exp_f32 v234,v234
 v_exp_f32 v235,v235
 v_pk_fma_f32 v[232:233],v[232:233],v[248:249],v[248:249] op_sel:[0,0,0] op_sel_hi:[1,0,0]
 v_pk_fma_f32 v[234:235],v[234:235],v[248:249],v[248:249] op_sel:[0,0,0] op_sel_hi:[1,0,0]
 buffer_load_dwordx4 v0,s[12:15],s50 offen sc1 lds
 v_rcp_f32 v232,v232
 v_rcp_f32 v233,v233
 v_rcp_f32 v234,v234
 v_rcp_f32 v235,v235
 v_pk_mul_f32 v[168:169],v[168:169],v[232:233]
 v_pk_mul_f32 v[170:171],v[170:171],v[234:235]
 v_pk_mul_f32 v[232:233],v[172:173],v[172:173]
 v_pk_mul_f32 v[234:235],v[174:175],v[174:175]
 v_pk_fma_f32 v[232:233],v[232:233],v[246:247],v[244:245] op_sel:[0,1,1] op_sel_hi:[1,1,1]
 v_pk_fma_f32 v[234:235],v[234:235],v[246:247],v[244:245] op_sel:[0,1,1] op_sel_hi:[1,1,1]
 buffer_load_dwordx4 v0,s[12:15],s50 offen offset:1024 sc1 lds
 v_pk_mul_f32 v[232:233],v[232:233],v[172:173]
 v_pk_mul_f32 v[234:235],v[234:235],v[174:175]
 v_exp_f32 v232,v232
 v_exp_f32 v233,v233
 v_exp_f32 v234,v234
 v_exp_f32 v235,v235
 v_pk_fma_f32 v[232:233],v[232:233],v[248:249],v[248:249] op_sel:[0,1,1] op_sel_hi:[1,1,1]
 v_pk_fma_f32 v[234:235],v[234:235],v[248:249],v[248:249] op_sel:[0,1,1] op_sel_hi:[1,1,1]
 v_rcp_f32 v232,v232
 v_rcp_f32 v233,v233
 buffer_load_dwordx4 v0,s[12:15],s50 offen offset:2048 sc1 lds
 v_rcp_f32 v234,v234
 v_rcp_f32 v235,v235
 v_pk_mul_f32 v[172:173],v[172:173],v[232:233]
 v_pk_mul_f32 v[174:175],v[174:175],v[234:235]
 v_pk_mul_f32 v[232:233],v[176:177],v[176:177]
 v_pk_mul_f32 v[234:235],v[178:179],v[178:179]
 v_pk_fma_f32 v[232:233],v[232:233],v[246:247],v[244:245] op_sel:[0,0,0] op_sel_hi:[1,0,0]
 v_pk_fma_f32 v[234:235],v[234:235],v[246:247],v[244:245] op_sel:[0,0,0] op_sel_hi:[1,0,0]
 v_pk_mul_f32 v[232:233],v[232:233],v[176:177]
 v_pk_mul_f32 v[234:235],v[234:235],v[178:179]
 buffer_load_dwordx4 v0,s[12:15],s50 offen offset:3072 sc1 lds
 v_exp_f32 v232,v232
 v_exp_f32 v233,v233
 v_exp_f32 v234,v234
 v_exp_f32 v235,v235
 v_pk_fma_f32 v[232:233],v[232:233],v[248:249],v[248:249] op_sel:[0,0,0] op_sel_hi:[1,0,0]
 v_pk_fma_f32 v[234:235],v[234:235],v[248:249],v[248:249] op_sel:[0,0,0] op_sel_hi:[1,0,0]
 v_rcp_f32 v232,v232
 v_rcp_f32 v233,v233
 v_rcp_f32 v234,v234
 v_rcp_f32 v235,v235
 s_add_u32 s50,s50,4096
 v_pk_mul_f32 v[176:177],v[176:177],v[232:233]
 v_pk_mul_f32 v[178:179],v[178:179],v[234:235]
 v_pk_mul_f32 v[232:233],v[180:181],v[180:181]
 v_pk_mul_f32 v[234:235],v[182:183],v[182:183]
 v_pk_fma_f32 v[232:233],v[232:233],v[246:247],v[244:245] op_sel:[0,1,1] op_sel_hi:[1,1,1]
 v_pk_fma_f32 v[234:235],v[234:235],v[246:247],v[244:245] op_sel:[0,1,1] op_sel_hi:[1,1,1]
 v_pk_mul_f32 v[232:233],v[232:233],v[180:181]
 v_pk_mul_f32 v[234:235],v[234:235],v[182:183]
 v_exp_f32 v232,v232
 v_exp_f32 v233,v233
 s_add_u32 m0,s54,90112
 v_exp_f32 v234,v234
 v_exp_f32 v235,v235
 v_pk_fma_f32 v[232:233],v[232:233],v[248:249],v[248:249] op_sel:[0,1,1] op_sel_hi:[1,1,1]
 v_pk_fma_f32 v[234:235],v[234:235],v[248:249],v[248:249] op_sel:[0,1,1] op_sel_hi:[1,1,1]
 v_rcp_f32 v232,v232
 v_rcp_f32 v233,v233
 v_rcp_f32 v234,v234
 v_rcp_f32 v235,v235
 v_pk_mul_f32 v[180:181],v[180:181],v[232:233]
 v_pk_mul_f32 v[182:183],v[182:183],v[234:235]
 buffer_load_dwordx4 v0,s[12:15],s50 offen sc1 lds
 v_pk_mul_f32 v[232:233],v[184:185],v[184:185]
 v_pk_mul_f32 v[234:235],v[186:187],v[186:187]
 v_pk_fma_f32 v[232:233],v[232:233],v[246:247],v[244:245] op_sel:[0,0,0] op_sel_hi:[1,0,0]
 v_pk_fma_f32 v[234:235],v[234:235],v[246:247],v[244:245] op_sel:[0,0,0] op_sel_hi:[1,0,0]
 v_pk_mul_f32 v[232:233],v[232:233],v[184:185]
 v_pk_mul_f32 v[234:235],v[234:235],v[186:187]
 v_exp_f32 v232,v232
 v_exp_f32 v233,v233
 v_exp_f32 v234,v234
 v_exp_f32 v235,v235
 buffer_load_dwordx4 v0,s[12:15],s50 offen offset:1024 sc1 lds
 v_pk_fma_f32 v[232:233],v[232:233],v[248:249],v[248:249] op_sel:[0,0,0] op_sel_hi:[1,0,0]
 v_pk_fma_f32 v[234:235],v[234:235],v[248:249],v[248:249] op_sel:[0,0,0] op_sel_hi:[1,0,0]
 v_rcp_f32 v232,v232
 v_rcp_f32 v233,v233
 v_rcp_f32 v234,v234
 v_rcp_f32 v235,v235
 v_pk_mul_f32 v[184:185],v[184:185],v[232:233]
 v_pk_mul_f32 v[186:187],v[186:187],v[234:235]
 v_pk_mul_f32 v[232:233],v[188:189],v[188:189]
 v_pk_mul_f32 v[234:235],v[190:191],v[190:191]
 buffer_load_dwordx4 v0,s[12:15],s50 offen offset:2048 sc1 lds
 v_pk_fma_f32 v[232:233],v[232:233],v[246:247],v[244:245] op_sel:[0,1,1] op_sel_hi:[1,1,1]
 v_pk_fma_f32 v[234:235],v[234:235],v[246:247],v[244:245] op_sel:[0,1,1] op_sel_hi:[1,1,1]
 v_pk_mul_f32 v[232:233],v[232:233],v[188:189]
 v_pk_mul_f32 v[234:235],v[234:235],v[190:191]
 v_exp_f32 v232,v232
 v_exp_f32 v233,v233
 v_exp_f32 v234,v234
 v_exp_f32 v235,v235
 v_pk_fma_f32 v[232:233],v[232:233],v[248:249],v[248:249] op_sel:[0,1,1] op_sel_hi:[1,1,1]
 v_pk_fma_f32 v[234:235],v[234:235],v[248:249],v[248:249] op_sel:[0,1,1] op_sel_hi:[1,1,1]
 v_rcp_f32 v232,v232
 v_rcp_f32 v233,v233
 v_rcp_f32 v234,v234
 v_rcp_f32 v235,v235
 v_pk_mul_f32 v[188:189],v[188:189],v[232:233]
 v_pk_mul_f32 v[190:191],v[190:191],v[234:235]
 s_waitcnt vmcnt(7)
 s_barrier
 ds_read_b128 v[56:59],v0 offset:57344
 ds_read_b128 v[60:63],v0 offset:58368
 ds_read_b128 v[64:67],v0 offset:59392
 ds_read_b128 v[68:71],v0 offset:60416
 ds_read_b128 v[72:75],v0 offset:61440
 ds_read_b128 v[76:79],v0 offset:62464
 s_waitcnt lgkmcnt(4)
 v_mfma_f32_16x16x32_bf16 v[80:83],v[56:59],a[32:35],v[80:83]
 s_cmp_eq_u32 s44,3
 s_cselect_b32 s50,0,86016
 s_add_u32 s50,s50,s66
 v_mfma_f32_16x16x32_bf16 v[84:87],v[56:59],a[36:39],v[84:87]
 s_add_u32 m0,s54,0
 s_nop 0
 buffer_load_dwordx4 v0,s[12:15],s50 offen sc1 lds
 v_mfma_f32_16x16x32_bf16 v[88:91],v[60:63],a[32:35],v[88:91]
 s_branch .Lsk15
.Lvs3_0:
 s_branch .Lvb3
.Lsk15:
 s_add_u32 s53,s53,4096
 ds_read_b128 v[16:19],v0 offset:63488
 ds_read_b128 v[20:23],v0 offset:64512
 v_mfma_f32_16x16x32_bf16 v[92:95],v[60:63],a[36:39],v[92:95]
 s_waitcnt lgkmcnt(4)
 ds_read_b128 v[24:27],v1
 ds_read_b128 v[28:31],v1 offset:1024
 v_mfma_f32_16x16x32_bf16 v[96:99],v[64:67],a[32:35],v[96:99]
 s_mov_b32 s51,192512
 buffer_load_dwordx4 v0,s[12:15],s50 offen offset:1024 sc1 lds
 v_mfma_f32_16x16x32_bf16 v[100:103],v[64:67],a[36:39],v[100:103]
 s_mov_b32 s49,45056
 ds_read_b128 v[32:35],v1 offset:2048
 ds_read_b128 v[36:39],v1 offset:3072
 v_mfma_f32_16x16x32_bf16 v[104:107],v[68:71],a[32:35],v[104:107]
 ds_read_b128 v[40:43],v1 offset:4096
 ds_read_b128 v[44:47],v1 offset:5120
 v_mfma_f32_16x16x32_bf16 v[108:111],v[68:71],a[36:39],v[108:111]
 s_waitcnt lgkmcnt(8)
 ds_read_b128 v[48:51],v1 offset:6144
 ds_read_b128 v[52:55],v1 offset:7168
 v_mfma_f32_16x16x32_bf16 v[112:115],v[72:75],a[32:35],v[112:115]
 buffer_load_dwordx4 v0,s[12:15],s50 offen offset:2048 sc1 lds
 v_mfma_f32_16x16x32_bf16 v[116:119],v[72:75],a[36:39],v[116:119]
 ds_read_b128 v[56:59],v1 offset:8192
 ds_read_b128 v[60:63],v1 offset:9216
 v_mfma_f32_16x16x32_bf16 v[120:123],v[76:79],a[32:35],v[120:123]
 ds_read_b128 v[64:67],v1 offset:10240
 ds_read_b128 v[68:71],v1 offset:11264
 v_mfma_f32_16x16x32_bf16 v[124:127],v[76:79],a[36:39],v[124:127]
 s_waitcnt lgkmcnt(12)
 ds_read_b128 v[72:75],v1 offset:12288
 ds_read_b128 v[76:79],v1 offset:13312
 v_mfma_f32_16x16x32_bf16 v[128:131],v[16:19],a[32:35],v[128:131]
 buffer_load_dwordx4 v0,s[12:15],s50 offen offset:3072 sc1 lds
 v_mfma_f32_16x16x32_bf16 v[132:135],v[16:19],a[36:39],v[132:135]
 s_add_u32 s50,s50,4096
 s_add_u32 m0,s54,4096
 ds_read_b128 v[16:19],v1 offset:14336
 v_mfma_f32_16x16x32_bf16 v[80:83],v[20:23],a[40:43],v[80:83]
 v_mfma_f32_16x16x32_bf16 v[84:87],v[20:23],a[44:47],v[84:87]
 s_waitcnt lgkmcnt(13)
 ds_read_b128 v[20:23],v1 offset:15360
 v_mfma_f32_16x16x32_bf16 v[88:91],v[24:27],a[40:43],v[88:91]
 buffer_load_dwordx4 v0,s[12:15],s50 offen sc1 lds
 v_mfma_f32_16x16x32_bf16 v[92:95],v[24:27],a[44:47],v[92:95]
 ds_read_b128 v[24:27],v1 offset:16384
 v_mfma_f32_16x16x32_bf16 v[96:99],v[28:31],a[40:43],v[96:99]
 v_mfma_f32_16x16x32_bf16 v[100:103],v[28:31],a[44:47],v[100:103]
 s_waitcnt lgkmcnt(13)
 ds_read_b128 v[28:31],v1 offset:17408
 v_mfma_f32_16x16x32_bf16 v[104:107],v[32:35],a[40:43],v[104:107]
 buffer_load_dwordx4 v0,s[12:15],s50 offen offset:1024 sc1 lds
 v_mfma_f32_16x16x32_bf16 v[108:111],v[32:35],a[44:47],v[108:111]
 ds_read_b128 v[32:35],v1 offset:18432
 v_mfma_f32_16x16x32_bf16 v[112:115],v[36:39],a[40:43],v[112:115]
 v_mfma_f32_16x16x32_bf16 v[116:119],v[36:39],a[44:47],v[116:119]
 s_waitcnt lgkmcnt(13)
 ds_read_b128 v[36:39],v1 offset:19456
 v_mfma_f32_16x16x32_bf16 v[120:123],v[40:43],a[40:43],v[120:123]
 buffer_load_dwordx4 v0,s[12:15],s50 offen offset:2048 sc1 lds
 v_mfma_f32_16x16x32_bf16 v[124:127],v[40:43],a[44:47],v[124:127]
 s_cmp_eq_u32 s44,4
 s_cselect_b32 s50,0,114688
 s_add_u32 s50,s50,s66
 v_mfma_f32_16x16x32_bf16 v[128:131],v[44:47],a[40:43],v[128:131]
 s_add_u32 m0,s54,28672
 v_mfma_f32_16x16x32_bf16 v[132:135],v[44:47],a[44:47],v[132:135]
 s_waitcnt lgkmcnt(12)
 v_mfma_f32_16x16x32_bf16 v[80:83],v[48:51],a[48:51],v[80:83]
 buffer_load_dwordx4 v0,s[12:15],s50 offen sc1 lds
 v_mfma_f32_16x16x32_bf16 v[84:87],v[48:51],a[52:55],v[84:87]
 v_mfma_f32_16x16x32_bf16 v[88:91],v[52:55],a[48:51],v[88:91]
 v_mfma_f32_16x16x32_bf16 v[92:95],v[52:55],a[52:55],v[92:95]
 s_waitcnt vmcnt(8) lgkmcnt(0)
 s_barrier
 ds_read_b128 v[40:43],v1 offset:20480
 v_mfma_f32_16x16x32_bf16 v[96:99],v[56:59],a[48:51],v[96:99]
 buffer_load_dwordx4 v0,s[12:15],s50 offen offset:1024 sc1 lds
 v_mfma_f32_16x16x32_bf16 v[100:103],v[56:59],a[52:55],v[100:103]
 ds_read_b128 v[44:47],v1 offset:21504
 ds_read_b128 v[48:51],v1 offset:22528
 v_mfma_f32_16x16x32_bf16 v[104:107],v[60:63],a[48:51],v[104:107]
 ds_read_b128 v[52:55],v1 offset:23552
 ds_read_b128 v[56:59],v1 offset:24576
 v_mfma_f32_16x16x32_bf16 v[108:111],v[60:63],a[52:55],v[108:111]
 ds_read_b128 v[60:63],v1 offset:25600
 v_mfma_f32_16x16x32_bf16 v[112:115],v[64:67],a[48:51],v[112:115]
 buffer_load_dwordx4 v0,s[12:15],s50 offen offset:2048 sc1 lds
 v_mfma_f32_16x16x32_bf16 v[116:119],v[64:67],a[52:55],v[116:119]
 ds_read_b128 v[64:67],v1 offset:26624
 v_mfma_f32_16x16x32_bf16 v[120:123],v[68:71],a[48:51],v[120:123]
 v_mfma_f32_16x16x32_bf16 v[124:127],v[68:71],a[52:55],v[124:127]
 ds_read_b128 v[68:71],v1 offset:27648
 v_mfma_f32_16x16x32_bf16 v[128:131],v[72:75],a[48:51],v[128:131]
 buffer_load_dwordx4 v0,s[12:15],s50 offen offset:3072 sc1 lds
 v_mfma_f32_16x16x32_bf16 v[132:135],v[72:75],a[52:55],v[132:135]
 s_add_u32 s50,s50,4096
 s_add_u32 m0,s54,32768
 ds_read_b128 v[72:75],v1 offset:28672
 v_mfma_f32_16x16x32_bf16 v[80:83],v[76:79],a[56:59],v[80:83]
 v_mfma_f32_16x16x32_bf16 v[84:87],v[76:79],a[60:63],v[84:87]
 ds_read_b128 v[76:79],v1 offset:29696
 v_mfma_f32_16x16x32_bf16 v[88:91],v[16:19],a[56:59],v[88:91]
 v_mfma_f32_16x16x32_bf16 v[92:95],v[16:19],a[60:63],v[92:95]
 buffer_load_dwordx4 v0,s[12:15],s50 offen sc1 lds
 v_mfma_f32_16x16x32_bf16 v[96:99],v[20:23],a[56:59],v[96:99]
 ds_read_b128 v[16:19],v1 offset:30720
 v_mfma_f32_16x16x32_bf16 v[100:103],v[20:23],a[60:63],v[100:103]
 ds_read_b128 v[20:23],v1 offset:31744
 v_mfma_f32_16x16x32_bf16 v[104:107],v[24:27],a[56:59],v[104:107]
 v_mfma_f32_16x16x32_bf16 v[108:111],v[24:27],a[60:63],v[108:111]
 buffer_load_dwordx4 v0,s[12:15],s50 offen offset:1024 sc1 lds
 v_mfma_f32_16x16x32_bf16 v[112:115],v[28:31],a[56:59],v[112:115]
 ds_read_b128 v[24:27],v1 offset:32768
 v_mfma_f32_16x16x32_bf16 v[116:119],v[28:31],a[60:63],v[116:119]
 ds_read_b128 v[28:31],v1 offset:33792
 v_mfma_f32_16x16x32_bf16 v[120:123],v[32:35],a[56:59],v[120:123]
 v_mfma_f32_16x16x32_bf16 v[124:127],v[32:35],a[60:63],v[124:127]
 buffer_load_dwordx4 v0,s[12:15],s50 offen offset:2048 sc1 lds
 v_mfma_f32_16x16x32_bf16 v[128:131],v[36:39],a[56:59],v[128:131]
 s_cmp_eq_u32 s44,5
 s_cselect_b32 s50,0,143360
 s_add_u32 s50,s50,s66
 v_mfma_f32_16x16x32_bf16 v[132:135],v[36:39],a[60:63],v[132:135]
 s_add_u32 m0,s54,57344
 ds_read_b128 v[32:35],v1 offset:34816
 s_waitcnt lgkmcnt(13)
 v_mfma_f32_16x16x32_bf16 v[80:83],v[40:43],a[64:67],v[80:83]
 ds_read_b128 v[36:39],v1 offset:35840
 v_mfma_f32_16x16x32_bf16 v[84:87],v[40:43],a[68:71],v[84:87]
 buffer_load_dwordx4 v0,s[12:15],s50 offen sc1 lds
 v_mfma_f32_16x16x32_bf16 v[88:91],v[44:47],a[64:67],v[88:91]
 ds_read_b128 v[40:43],v1 offset:36864
 v_mfma_f32_16x16x32_bf16 v[92:95],v[44:47],a[68:71],v[92:95]
 s_waitcnt lgkmcnt(13)
 ds_read_b128 v[44:47],v1 offset:37888
 v_mfma_f32_16x16x32_bf16 v[96:99],v[48:51],a[64:67],v[96:99]
 v_mfma_f32_16x16x32_bf16 v[100:103],v[48:51],a[68:71],v[100:103]
 buffer_load_dwordx4 v0,s[12:15],s50 offen offset:1024 sc1 lds
 v_mfma_f32_16x16x32_bf16 v[104:107],v[52:55],a[64:67],v[104:107]
 ds_read_b128 v[48:51],v1 offset:38912
 v_mfma_f32_16x16x32_bf16 v[108:111],v[52:55],a[68:71],v[108:111]
 s_waitcnt lgkmcnt(13)
 ds_read_b128 v[52:55],v1 offset:39936
 v_mfma_f32_16x16x32_bf16 v[112:115],v[56:59],a[64:67],v[112:115]
 v_mfma_f32_16x16x32_bf16 v[116:119],v[56:59],a[68:71],v[116:119]
 buffer_load_dwordx4 v0,s[12:15],s50 offen offset:2048 sc1 lds
 v_mfma_f32_16x16x32_bf16 v[120:123],v[60:63],a[64:67],v[120:123]
 ds_read_b128 v[56:59],v1 offset:40960
 v_mfma_f32_16x16x32_bf16 v[124:127],v[60:63],a[68:71],v[124:127]
 s_waitcnt lgkmcnt(13)
 ds_read_b128 v[60:63],v1 offset:41984
 v_mfma_f32_16x16x32_bf16 v[128:131],v[64:67],a[64:67],v[128:131]
 v_mfma_f32_16x16x32_bf16 v[132:135],v[64:67],a[68:71],v[132:135]
 buffer_load_dwordx4 v0,s[12:15],s50 offen offset:3072 sc1 lds
 v_mfma_f32_16x16x32_bf16 v[80:83],v[68:71],a[72:75],v[80:83]
 s_add_u32 s50,s50,4096
 s_add_u32 m0,s54,61440
 ds_read_b128 v[64:67],v1 offset:43008
 v_mfma_f32_16x16x32_bf16 v[84:87],v[68:71],a[76:79],v[84:87]
 s_waitcnt lgkmcnt(13)
 ds_read_b128 v[68:71],v1 offset:44032
 v_mfma_f32_16x16x32_bf16 v[88:91],v[72:75],a[72:75],v[88:91]
 v_mfma_f32_16x16x32_bf16 v[92:95],v[72:75],a[76:79],v[92:95]
 buffer_load_dwordx4 v0,s[12:15],s50 offen sc1 lds
 v_mfma_f32_16x16x32_bf16 v[96:99],v[76:79],a[72:75],v[96:99]
 ds_read_b128 v[72:75],v1 offset:45056
 v_mfma_f32_16x16x32_bf16 v[100:103],v[76:79],a[76:79],v[100:103]
 s_waitcnt lgkmcnt(13)
 ds_read_b128 v[76:79],v1 offset:46080
 v_mfma_f32_16x16x32_bf16 v[104:107],v[16:19],a[72:75],v[104:107]
 v_mfma_f32_16x16x32_bf16 v[108:111],v[16:19],a[76:79],v[108:111]
 buffer_load_dwordx4 v0,s[12:15],s50 offen offset:1024 sc1 lds
 v_mfma_f32_16x16x32_bf16 v[112:115],v[20:23],a[72:75],v[112:115]
 ds_read_b128 v[16:19],v1 offset:47104
 v_mfma_f32_16x16x32_bf16 v[116:119],v[20:23],a[76:79],v[116:119]
 s_waitcnt lgkmcnt(13)
 ds_read_b128 v[20:23],v1 offset:48128
 v_mfma_f32_16x16x32_bf16 v[120:123],v[24:27],a[72:75],v[120:123]
 v_mfma_f32_16x16x32_bf16 v[124:127],v[24:27],a[76:79],v[124:127]
 buffer_load_dwordx4 v0,s[12:15],s50 offen offset:2048 sc1 lds
 v_mfma_f32_16x16x32_bf16 v[128:131],v[28:31],a[72:75],v[128:131]
 s_cmp_eq_u32 s44,6
 s_cselect_b32 s50,0,172032
 s_add_u32 s50,s50,s66
 v_mfma_f32_16x16x32_bf16 v[132:135],v[28:31],a[76:79],v[132:135]
 s_add_u32 m0,s54,86016
 s_waitcnt lgkmcnt(12)
 v_mfma_f32_16x16x32_bf16 v[80:83],v[32:35],a[80:83],v[80:83]
 v_mfma_f32_16x16x32_bf16 v[84:87],v[32:35],a[84:87],v[84:87]
 v_mfma_f32_16x16x32_bf16 v[88:91],v[36:39],a[80:83],v[88:91]
 buffer_load_dwordx4 a[16:19],v0,s[12:15],s53 offen sc1
 v_mfma_f32_16x16x32_bf16 v[92:95],v[36:39],a[84:87],v[92:95]
 s_waitcnt vmcnt(15) lgkmcnt(0)
 s_barrier
 ds_read_b128 v[24:27],v0
 v_mfma_f32_16x16x32_bf16 v[96:99],v[40:43],a[80:83],v[96:99]
 ds_read_b128 v[28:31],v0 offset:1024
 ds_read_b128 v[32:35],v0 offset:2048
 v_mfma_f32_16x16x32_bf16 v[100:103],v[40:43],a[84:87],v[100:103]
 ds_read_b128 v[36:39],v0 offset:3072
 ds_read_b128 v[40:43],v0 offset:4096
 v_mfma_f32_16x16x32_bf16 v[104:107],v[44:47],a[80:83],v[104:107]
 buffer_load_dwordx4 v0,s[12:15],s50 offen sc1 lds
 v_mfma_f32_16x16x32_bf16 v[108:111],v[44:47],a[84:87],v[108:111]
 ds_read_b128 v[44:47],v0 offset:5120
 v_mfma_f32_16x16x32_bf16 v[112:115],v[48:51],a[80:83],v[112:115]
 v_mfma_f32_16x16x32_bf16 v[116:119],v[48:51],a[84:87],v[116:119]
 ds_read_b128 v[48:51],v0 offset:6144
 v_mfma_f32_16x16x32_bf16 v[120:123],v[52:55],a[80:83],v[120:123]
 buffer_load_dwordx4 v0,s[12:15],s50 offen offset:1024 sc1 lds
 v_mfma_f32_16x16x32_bf16 v[124:127],v[52:55],a[84:87],v[124:127]
 ds_read_b128 v[52:55],v0 offset:7168
 v_mfma_f32_16x16x32_bf16 v[128:131],v[56:59],a[80:83],v[128:131]
 v_mfma_f32_16x16x32_bf16 v[132:135],v[56:59],a[84:87],v[132:135]
 ds_read_b128 v[56:59],v0 offset:8192
 v_mfma_f32_16x16x32_bf16 v[80:83],v[60:63],a[88:91],v[80:83]
 buffer_load_dwordx4 v0,s[12:15],s50 offen offset:2048 sc1 lds
 v_mfma_f32_16x16x32_bf16 v[84:87],v[60:63],a[92:95],v[84:87]
 ds_read_b128 v[60:63],v0 offset:9216
 v_mfma_f32_16x16x32_bf16 v[88:91],v[64:67],a[88:91],v[88:91]
 v_mfma_f32_16x16x32_bf16 v[92:95],v[64:67],a[92:95],v[92:95]
 ds_read_b128 v[64:67],v0 offset:10240
 v_mfma_f32_16x16x32_bf16 v[96:99],v[68:71],a[88:91],v[96:99]
 buffer_load_dwordx4 v0,s[12:15],s50 offen offset:3072 sc1 lds
 v_mfma_f32_16x16x32_bf16 v[100:103],v[68:71],a[92:95],v[100:103]
 s_add_u32 s50,s50,4096
 s_add_u32 m0,s54,90112
 v_mfma_f32_16x16x32_bf16 v[104:107],v[72:75],a[88:91],v[104:107]
 ds_read_b128 v[68:71],v0 offset:11264
 v_mfma_f32_16x16x32_bf16 v[108:111],v[72:75],a[92:95],v[108:111]
 ds_read_b128 v[72:75],v0 offset:12288
 v_mfma_f32_16x16x32_bf16 v[112:115],v[76:79],a[88:91],v[112:115]
 buffer_load_dwordx4 v0,s[12:15],s50 offen sc1 lds
 v_mfma_f32_16x16x32_bf16 v[116:119],v[76:79],a[92:95],v[116:119]
 ds_read_b128 v[76:79],v0 offset:13312
 v_mfma_f32_16x16x32_bf16 v[120:123],v[16:19],a[88:91],v[120:123]
 v_mfma_f32_16x16x32_bf16 v[124:127],v[16:19],a[92:95],v[124:127]
 ds_read_b128 v[16:19],v0 offset:14336
 v_mfma_f32_16x16x32_bf16 v[128:131],v[20:23],a[88:91],v[128:131]
 buffer_load_dwordx4 v0,s[12:15],s50 offen offset:1024 sc1 lds
 v_mfma_f32_16x16x32_bf16 v[132:135],v[20:23],a[92:95],v[132:135]
 s_waitcnt lgkmcnt(13)
 ds_read_b128 v[20:23],v0 offset:15360
 v_mfma_f32_16x16x32_bf16 v[80:83],v[24:27],a[96:99],v[80:83]
 v_mfma_f32_16x16x32_bf16 v[84:87],v[24:27],a[100:103],v[84:87]
 ds_read_b128 v[24:27],v0 offset:16384
 v_mfma_f32_16x16x32_bf16 v[88:91],v[28:31],a[96:99],v[88:91]
 buffer_load_dwordx4 v0,s[12:15],s50 offen offset:2048 sc1 lds
 v_mfma_f32_16x16x32_bf16 v[92:95],v[28:31],a[100:103],v[92:95]
 s_waitcnt lgkmcnt(13)
 ds_read_b128 v[28:31],v0 offset:17408
 s_add_u32 m0,s54,0
 v_mfma_f32_16x16x32_bf16 v[96:99],v[32:35],a[96:99],v[96:99]
 s_cmp_eq_u32 s44,7
 s_cselect_b32 s50,0,200704
 s_add_u32 s50,s50,s66
 v_mfma_f32_16x16x32_bf16 v[100:103],v[32:35],a[100:103],v[100:103]
 ds_read_b128 v[32:35],v0 offset:18432
 v_mfma_f32_16x16x32_bf16 v[104:107],v[36:39],a[96:99],v[104:107]
 buffer_load_dwordx4 a[20:23],v0,s[12:15],s53 offen offset:1024 sc1
 v_mfma_f32_16x16x32_bf16 v[108:111],v[36:39],a[100:103],v[108:111]
 s_waitcnt lgkmcnt(13)
 ds_read_b128 v[36:39],v0 offset:19456
 v_mfma_f32_16x16x32_bf16 v[112:115],v[40:43],a[96:99],v[112:115]
 v_mfma_f32_16x16x32_bf16 v[116:119],v[40:43],a[100:103],v[116:119]
 ds_read_b128 v[40:43],v0 offset:20480
 v_mfma_f32_16x16x32_bf16 v[120:123],v[44:47],a[96:99],v[120:123]
 buffer_load_dwordx4 a[24:27],v0,s[12:15],s53 offen offset:2048 sc1
 v_mfma_f32_16x16x32_bf16 v[124:127],v[44:47],a[100:103],v[124:127]
 s_waitcnt lgkmcnt(13)
 ds_read_b128 v[44:47],v0 offset:21504
 v_mfma_f32_16x16x32_bf16 v[128:131],v[48:51],a[96:99],v[128:131]
 v_mfma_f32_16x16x32_bf16 v[132:135],v[48:51],a[100:103],v[132:135]
 ds_read_b128 v[48:51],v0 offset:22528
 v_mfma_f32_16x16x32_bf16 v[80:83],v[52:55],a[104:107],v[80:83]
 v_mfma_f32_16x16x32_bf16 v[84:87],v[52:55],a[108:111],v[84:87]
 s_waitcnt lgkmcnt(13)
 buffer_load_dwordx4 a[28:31],v0,s[12:15],s53 offen offset:3072 sc1
 v_mfma_f32_16x16x32_bf16 v[88:91],v[56:59],a[104:107],v[88:91]
 s_cmp_eq_u32 s44,9
 s_cselect_b32 s53,0,73728
 s_add_u32 s53,s53,s64
 v_mfma_f32_16x16x32_bf16 v[92:95],v[56:59],a[108:111],v[92:95]
 ds_read_b128 v[52:55],v0 offset:23552
 ds_read_b128 v[56:59],v0 offset:24576
 v_mfma_f32_16x16x32_bf16 v[96:99],v[60:63],a[104:107],v[96:99]
 v_mfma_f32_16x16x32_bf16 v[100:103],v[60:63],a[108:111],v[100:103]
 s_waitcnt lgkmcnt(13)
 buffer_load_dwordx4 a[32:35],v0,s[12:15],s53 offen sc1
 v_mfma_f32_16x16x32_bf16 v[104:107],v[64:67],a[104:107],v[104:107]
 ds_read_b128 v[60:63],v0 offset:25600
 v_mfma_f32_16x16x32_bf16 v[108:111],v[64:67],a[108:111],v[108:111]
 ds_read_b128 v[64:67],v0 offset:26624
 v_mfma_f32_16x16x32_bf16 v[112:115],v[68:71],a[104:107],v[112:115]
 v_mfma_f32_16x16x32_bf16 v[116:119],v[68:71],a[108:111],v[116:119]
 s_waitcnt lgkmcnt(13)
 buffer_load_dwordx4 a[36:39],v0,s[12:15],s53 offen offset:1024 sc1
 v_mfma_f32_16x16x32_bf16 v[120:123],v[72:75],a[104:107],v[120:123]
 ds_read_b128 v[68:71],v0 offset:27648
 v_mfma_f32_16x16x32_bf16 v[124:127],v[72:75],a[108:111],v[124:127]
 v_mfma_f32_16x16x32_bf16 v[128:131],v[76:79],a[104:107],v[128:131]
 v_mfma_f32_16x16x32_bf16 v[132:135],v[76:79],a[108:111],v[132:135]
 s_waitcnt lgkmcnt(12)
 buffer_load_dwordx4 a[40:43],v0,s[12:15],s53 offen offset:2048 sc1
 v_mfma_f32_16x16x32_bf16 v[80:83],v[16:19],a[112:115],v[80:83]
 v_mfma_f32_16x16x32_bf16 v[84:87],v[16:19],a[116:119],v[84:87]
 v_mfma_f32_16x16x32_bf16 v[88:91],v[20:23],a[112:115],v[88:91]
 v_mfma_f32_16x16x32_bf16 v[92:95],v[20:23],a[116:119],v[92:95]
 s_waitcnt lgkmcnt(10)
 buffer_load_dwordx4 a[44:47],v0,s[12:15],s53 offen offset:3072 sc1
 v_mfma_f32_16x16x32_bf16 v[96:99],v[24:27],a[112:115],v[96:99]
 s_waitcnt vmcnt(22) lgkmcnt(0)
 s_barrier
 ds_read_b128 v[72:75],v0 offset:28672
 ds_read_b128 v[76:79],v0 offset:29696
 v_mfma_f32_16x16x32_bf16 v[100:103],v[24:27],a[116:119],v[100:103]
 s_add_u32 s53,s53,4096
 ds_read_b128 v[16:19],v0 offset:30720
 ds_read_b128 v[20:23],v0 offset:31744
 v_mfma_f32_16x16x32_bf16 v[104:107],v[28:31],a[112:115],v[104:107]
 ds_read_b128 v[24:27],v0 offset:32768
 v_mfma_f32_16x16x32_bf16 v[108:111],v[28:31],a[116:119],v[108:111]
 buffer_load_dwordx4 v0,s[12:15],s50 offen sc1 lds
 v_mfma_f32_16x16x32_bf16 v[112:115],v[32:35],a[112:115],v[112:115]
 ds_read_b128 v[28:31],v0 offset:33792
 v_mfma_f32_16x16x32_bf16 v[116:119],v[32:35],a[116:119],v[116:119]
 ds_read_b128 v[32:35],v0 offset:34816
 v_mfma_f32_16x16x32_bf16 v[120:123],v[36:39],a[112:115],v[120:123]
 v_mfma_f32_16x16x32_bf16 v[124:127],v[36:39],a[116:119],v[124:127]
 buffer_load_dwordx4 v0,s[12:15],s50 offen offset:1024 sc1 lds
 v_mfma_f32_16x16x32_bf16 v[128:131],v[40:43],a[112:115],v[128:131]
 ds_read_b128 v[36:39],v0 offset:35840
 v_mfma_f32_16x16x32_bf16 v[132:135],v[40:43],a[116:119],v[132:135]
 ds_read_b128 v[40:43],v0 offset:36864
 v_mfma_f32_16x16x32_bf16 v[80:83],v[44:47],a[120:123],v[80:83]
 v_mfma_f32_16x16x32_bf16 v[84:87],v[44:47],a[124:127],v[84:87]
 buffer_load_dwordx4 v0,s[12:15],s50 offen offset:2048 sc1 lds
 v_mfma_f32_16x16x32_bf16 v[88:91],v[48:51],a[120:123],v[88:91]
 ds_read_b128 v[44:47],v0 offset:37888
 v_mfma_f32_16x16x32_bf16 v[92:95],v[48:51],a[124:127],v[92:95]
 ds_read_b128 v[48:51],v0 offset:38912
 v_mfma_f32_16x16x32_bf16 v[96:99],v[52:55],a[120:123],v[96:99]
 v_mfma_f32_16x16x32_bf16 v[100:103],v[52:55],a[124:127],v[100:103]
 buffer_load_dwordx4 v0,s[12:15],s50 offen offset:3072 sc1 lds
 v_mfma_f32_16x16x32_bf16 v[104:107],v[56:59],a[120:123],v[104:107]
 s_add_u32 s50,s50,4096
 s_add_u32 m0,s54,4096
 ds_read_b128 v[52:55],v0 offset:39936
 v_mfma_f32_16x16x32_bf16 v[108:111],v[56:59],a[124:127],v[108:111]
 ds_read_b128 v[56:59],v0 offset:40960
 v_mfma_f32_16x16x32_bf16 v[112:115],v[60:63],a[120:123],v[112:115]
 v_mfma_f32_16x16x32_bf16 v[116:119],v[60:63],a[124:127],v[116:119]
 buffer_load_dwordx4 v0,s[12:15],s50 offen sc1 lds
 v_mfma_f32_16x16x32_bf16 v[120:123],v[64:67],a[120:123],v[120:123]
 ds_read_b128 v[60:63],v0 offset:41984
 v_mfma_f32_16x16x32_bf16 v[124:127],v[64:67],a[124:127],v[124:127]
 ds_read_b128 v[64:67],v0 offset:43008
 v_mfma_f32_16x16x32_bf16 v[128:131],v[68:71],a[120:123],v[128:131]
 v_mfma_f32_16x16x32_bf16 v[132:135],v[68:71],a[124:127],v[132:135]
 s_waitcnt lgkmcnt(13)
 ds_read_b128 v[68:71],v0 offset:44032
 v_mfma_f32_16x16x32_bf16 v[80:83],v[72:75],a[128:131],v[80:83]
 buffer_load_dwordx4 v0,s[12:15],s50 offen offset:1024 sc1 lds
 v_mfma_f32_16x16x32_bf16 v[84:87],v[72:75],a[132:135],v[84:87]
 ds_read_b128 v[72:75],v0 offset:45056
 v_mfma_f32_16x16x32_bf16 v[88:91],v[76:79],a[128:131],v[88:91]
 v_mfma_f32_16x16x32_bf16 v[92:95],v[76:79],a[132:135],v[92:95]
 s_waitcnt lgkmcnt(13)
 ds_read_b128 v[76:79],v0 offset:46080
 v_mfma_f32_16x16x32_bf16 v[96:99],v[16:19],a[128:131],v[96:99]
 buffer_load_dwordx4 v0,s[12:15],s50 offen offset:2048 sc1 lds
 v_mfma_f32_16x16x32_bf16 v[100:103],v[16:19],a[132:135],v[100:103]
 s_cmp_eq_u32 s44,8
 s_cselect_b32 s50,0,229376
 ds_read_b128 v[16:19],v0 offset:47104
 v_mfma_f32_16x16x32_bf16 v[104:107],v[20:23],a[128:131],v[104:107]
 s_add_u32 s50,s50,s67
 s_add_u32 m0,s54,28672
 v_mfma_f32_16x16x32_bf16 v[108:111],v[20:23],a[132:135],v[108:111]
 s_waitcnt lgkmcnt(13)
 ds_read_b128 v[20:23],v0 offset:48128
 v_mfma_f32_16x16x32_bf16 v[112:115],v[24:27],a[128:131],v[112:115]
 buffer_load_dwordx4 a[48:51],v0,s[12:15],s53 offen sc1
 v_mfma_f32_16x16x32_bf16 v[116:119],v[24:27],a[132:135],v[116:119]
 ds_read_b128 v[24:27],v0 offset:49152
 v_mfma_f32_16x16x32_bf16 v[120:123],v[28:31],a[128:131],v[120:123]
 v_mfma_f32_16x16x32_bf16 v[124:127],v[28:31],a[132:135],v[124:127]
 s_waitcnt lgkmcnt(13)
 ds_read_b128 v[28:31],v0 offset:50176
 v_mfma_f32_16x16x32_bf16 v[128:131],v[32:35],a[128:131],v[128:131]
 buffer_load_dwordx4 a[52:55],v0,s[12:15],s53 offen offset:1024 sc1
 v_mfma_f32_16x16x32_bf16 v[132:135],v[32:35],a[132:135],v[132:135]
 ds_read_b128 v[32:35],v0 offset:51200
 v_mfma_f32_16x16x32_bf16 v[80:83],v[36:39],a[136:139],v[80:83]
 v_mfma_f32_16x16x32_bf16 v[84:87],v[36:39],a[140:143],v[84:87]
 s_waitcnt lgkmcnt(13)
 ds_read_b128 v[36:39],v0 offset:52224
 v_mfma_f32_16x16x32_bf16 v[88:91],v[40:43],a[136:139],v[88:91]
 buffer_load_dwordx4 a[56:59],v0,s[12:15],s53 offen offset:2048 sc1
 v_mfma_f32_16x16x32_bf16 v[92:95],v[40:43],a[140:143],v[92:95]
 ds_read_b128 v[40:43],v0 offset:53248
 v_mfma_f32_16x16x32_bf16 v[96:99],v[44:47],a[136:139],v[96:99]
 v_mfma_f32_16x16x32_bf16 v[100:103],v[44:47],a[140:143],v[100:103]
 s_waitcnt lgkmcnt(13)
 ds_read_b128 v[44:47],v0 offset:54272
 v_mfma_f32_16x16x32_bf16 v[104:107],v[48:51],a[136:139],v[104:107]
 buffer_load_dwordx4 a[60:63],v0,s[12:15],s53 offen offset:3072 sc1
 v_mfma_f32_16x16x32_bf16 v[108:111],v[48:51],a[140:143],v[108:111]
 s_cmp_eq_u32 s44,10
 s_cselect_b32 s53,0,81920
 s_add_u32 s53,s53,s64
 v_mfma_f32_16x16x32_bf16 v[112:115],v[52:55],a[136:139],v[112:115]
 ds_read_b128 v[48:51],v0 offset:55296
 v_mfma_f32_16x16x32_bf16 v[116:119],v[52:55],a[140:143],v[116:119]
 s_waitcnt lgkmcnt(13)
 ds_read_b128 v[52:55],v0 offset:56320
 v_mfma_f32_16x16x32_bf16 v[120:123],v[56:59],a[136:139],v[120:123]
 buffer_load_dwordx4 a[64:67],v0,s[12:15],s53 offen sc1
 v_mfma_f32_16x16x32_bf16 v[124:127],v[56:59],a[140:143],v[124:127]
 v_mfma_f32_16x16x32_bf16 v[128:131],v[60:63],a[136:139],v[128:131]
 v_mfma_f32_16x16x32_bf16 v[132:135],v[60:63],a[140:143],v[132:135]
 s_waitcnt lgkmcnt(12)
 v_mfma_f32_16x16x32_bf16 v[80:83],v[64:67],a[144:147],v[80:83]
 buffer_load_dwordx4 a[68:71],v0,s[12:15],s53 offen offset:1024 sc1
 v_mfma_f32_16x16x32_bf16 v[84:87],v[64:67],a[148:151],v[84:87]
 v_mfma_f32_16x16x32_bf16 v[88:91],v[68:71],a[144:147],v[88:91]
 v_mfma_f32_16x16x32_bf16 v[92:95],v[68:71],a[148:151],v[92:95]
 s_waitcnt vmcnt(28) lgkmcnt(0)
 s_barrier
 ds_read_b128 v[56:59],v0 offset:57344
 v_mfma_f32_16x16x32_bf16 v[96:99],v[72:75],a[144:147],v[96:99]
 buffer_load_dwordx4 v0,s[12:15],s50 offen sc1 lds
 v_mfma_f32_16x16x32_bf16 v[100:103],v[72:75],a[148:151],v[100:103]
 ds_read_b128 v[60:63],v0 offset:58368
 ds_read_b128 v[64:67],v0 offset:59392
 v_mfma_f32_16x16x32_bf16 v[104:107],v[76:79],a[144:147],v[104:107]
 ds_read_b128 v[68:71],v0 offset:60416
 ds_read_b128 v[72:75],v0 offset:61440
 v_mfma_f32_16x16x32_bf16 v[108:111],v[76:79],a[148:151],v[108:111]
 ds_read_b128 v[76:79],v0 offset:62464
 v_mfma_f32_16x16x32_bf16 v[112:115],v[16:19],a[144:147],v[112:115]
 buffer_load_dwordx4 v0,s[12:15],s50 offen offset:1024 sc1 lds
 v_mfma_f32_16x16x32_bf16 v[116:119],v[16:19],a[148:151],v[116:119]
 ds_read_b128 v[16:19],v0 offset:63488
 v_mfma_f32_16x16x32_bf16 v[120:123],v[20:23],a[144:147],v[120:123]
 v_mfma_f32_16x16x32_bf16 v[124:127],v[20:23],a[148:151],v[124:127]
 ds_read_b128 v[20:23],v0 offset:64512
 v_mfma_f32_16x16x32_bf16 v[128:131],v[24:27],a[144:147],v[128:131]
 v_mfma_f32_16x16x32_bf16 v[132:135],v[24:27],a[148:151],v[132:135]
 buffer_load_dwordx4 v0,s[12:15],s50 offen offset:2048 sc1 lds
 v_mfma_f32_16x16x32_bf16 v[80:83],v[28:31],a[152:155],v[80:83]
 s_cmp_eq_u32 s44,9
 s_cselect_b32 s50,0,258048
 s_add_u32 s50,s50,s67
 v_mfma_f32_16x16x32_bf16 v[84:87],v[28:31],a[156:159],v[84:87]
 s_add_u32 m0,s54,31744
 ds_read_b128 v[24:27],v1
 v_mfma_f32_16x16x32_bf16 v[88:91],v[32:35],a[152:155],v[88:91]
 ds_read_b128 v[28:31],v1 offset:1024
 v_mfma_f32_16x16x32_bf16 v[92:95],v[32:35],a[156:159],v[92:95]
 buffer_load_dwordx4 v0,s[12:15],s50 offen sc1 lds
 v_mfma_f32_16x16x32_bf16 v[96:99],v[36:39],a[152:155],v[96:99]
 ds_read_b128 v[32:35],v1 offset:2048
 v_mfma_f32_16x16x32_bf16 v[100:103],v[36:39],a[156:159],v[100:103]
 ds_read_b128 v[36:39],v1 offset:3072
 v_mfma_f32_16x16x32_bf16 v[104:107],v[40:43],a[152:155],v[104:107]
 v_mfma_f32_16x16x32_bf16 v[108:111],v[40:43],a[156:159],v[108:111]
 buffer_load_dwordx4 v0,s[12:15],s50 offen offset:1024 sc1 lds
 v_mfma_f32_16x16x32_bf16 v[112:115],v[44:47],a[152:155],v[112:115]
 ds_read_b128 v[40:43],v1 offset:4096
 v_mfma_f32_16x16x32_bf16 v[116:119],v[44:47],a[156:159],v[116:119]
 ds_read_b128 v[44:47],v1 offset:5120
 v_mfma_f32_16x16x32_bf16 v[120:123],v[48:51],a[152:155],v[120:123]
 v_mfma_f32_16x16x32_bf16 v[124:127],v[48:51],a[156:159],v[124:127]
 buffer_load_dwordx4 v0,s[12:15],s50 offen offset:2048 sc1 lds
 v_mfma_f32_16x16x32_bf16 v[128:131],v[52:55],a[152:155],v[128:131]
 s_cmp_eq_u32 s44,10
 s_cselect_b32 s50,0,286720
 s_add_u32 s50,s50,s67
 v_mfma_f32_16x16x32_bf16 v[132:135],v[52:55],a[156:159],v[132:135]
 s_add_u32 m0,s54,34816
 ds_read_b128 v[48:51],v1 offset:6144
 s_waitcnt lgkmcnt(13)
 v_mfma_f32_16x16x32_bf16 v[80:83],v[56:59],a[160:163],v[80:83]
 ds_read_b128 v[52:55],v1 offset:7168
 v_mfma_f32_16x16x32_bf16 v[84:87],v[56:59],a[164:167],v[84:87]
 buffer_load_dwordx4 v0,s[12:15],s50 offen sc1 lds
 v_mfma_f32_16x16x32_bf16 v[88:91],v[60:63],a[160:163],v[88:91]
 s_cmp_eq_u32 s44,10
 s_cselect_b32 s50,0,286720
 ds_read_b128 v[56:59],v1 offset:8192
 v_mfma_f32_16x16x32_bf16 v[92:95],v[60:63],a[164:167],v[92:95]
 s_waitcnt lgkmcnt(13)
 ds_read_b128 v[60:63],v1 offset:9216
 s_add_u32 s50,s50,s67
 v_mfma_f32_16x16x32_bf16 v[96:99],v[64:67],a[160:163],v[96:99]
 s_add_u32 s50,s50,1024
 s_add_u32 m0,s54,57344
 v_mfma_f32_16x16x32_bf16 v[100:103],v[64:67],a[164:167],v[100:103]
 buffer_load_dwordx4 a[72:75],v0,s[12:15],s53 offen offset:2048 sc1
 v_mfma_f32_16x16x32_bf16 v[104:107],v[68:71],a[160:163],v[104:107]
 ds_read_b128 v[64:67],v1 offset:10240
 v_mfma_f32_16x16x32_bf16 v[108:111],v[68:71],a[164:167],v[108:111]
 s_waitcnt lgkmcnt(13)
 ds_read_b128 v[68:71],v1 offset:11264
 v_mfma_f32_16x16x32_bf16 v[112:115],v[72:75],a[160:163],v[112:115]
 v_mfma_f32_16x16x32_bf16 v[116:119],v[72:75],a[164:167],v[116:119]
 buffer_load_dwordx4 a[76:79],v0,s[12:15],s53 offen offset:3072 sc1
 v_mfma_f32_16x16x32_bf16 v[120:123],v[76:79],a[160:163],v[120:123]
 s_add_u32 s53,s53,4096
 ds_read_b128 v[72:75],v1 offset:12288
 v_mfma_f32_16x16x32_bf16 v[124:127],v[76:79],a[164:167],v[124:127]
 s_waitcnt lgkmcnt(13)
 ds_read_b128 v[76:79],v1 offset:13312
 v_mfma_f32_16x16x32_bf16 v[128:131],v[16:19],a[160:163],v[128:131]
 v_mfma_f32_16x16x32_bf16 v[132:135],v[16:19],a[164:167],v[132:135]
 buffer_load_dwordx4 a[80:83],v0,s[12:15],s53 offen sc1
 v_mfma_f32_16x16x32_bf16 v[80:83],v[20:23],a[168:171],v[80:83]
 ds_read_b128 v[16:19],v1 offset:14336
 v_mfma_f32_16x16x32_bf16 v[84:87],v[20:23],a[172:175],v[84:87]
 s_waitcnt lgkmcnt(13)
 ds_read_b128 v[20:23],v1 offset:15360
 v_mfma_f32_16x16x32_bf16 v[88:91],v[24:27],a[168:171],v[88:91]
 v_mfma_f32_16x16x32_bf16 v[92:95],v[24:27],a[172:175],v[92:95]
 buffer_load_dwordx4 a[84:87],v0,s[12:15],s53 offen offset:1024 sc1
 v_mfma_f32_16x16x32_bf16 v[96:99],v[28:31],a[168:171],v[96:99]
 ds_read_b128 v[24:27],v1 offset:16384
 v_mfma_f32_16x16x32_bf16 v[100:103],v[28:31],a[172:175],v[100:103]
 s_waitcnt lgkmcnt(13)
 ds_read_b128 v[28:31],v1 offset:17408
 v_mfma_f32_16x16x32_bf16 v[104:107],v[32:35],a[168:171],v[104:107]
 v_mfma_f32_16x16x32_bf16 v[108:111],v[32:35],a[172:175],v[108:111]
 ds_read_b128 v[32:35],v1 offset:18432
 v_mfma_f32_16x16x32_bf16 v[112:115],v[36:39],a[168:171],v[112:115]
 buffer_load_dwordx4 a[88:91],v0,s[12:15],s53 offen offset:2048 sc1
 v_mfma_f32_16x16x32_bf16 v[116:119],v[36:39],a[172:175],v[116:119]
 s_waitcnt lgkmcnt(13)
 ds_read_b128 v[36:39],v1 offset:19456
 v_mfma_f32_16x16x32_bf16 v[120:123],v[40:43],a[168:171],v[120:123]
 v_mfma_f32_16x16x32_bf16 v[124:127],v[40:43],a[172:175],v[124:127]
 v_mfma_f32_16x16x32_bf16 v[128:131],v[44:47],a[168:171],v[128:131]
 buffer_load_dwordx4 a[92:95],v0,s[12:15],s53 offen offset:3072 sc1
 v_mfma_f32_16x16x32_bf16 v[132:135],v[44:47],a[172:175],v[132:135]
 s_branch .Lsk16
.Lvs3_1:
 s_branch .Lvb3
.Lsk16:
 s_cmp_eq_u32 s44,11
 s_cselect_b32 s53,0,90112
 s_waitcnt lgkmcnt(12)
 v_mfma_f32_16x16x32_bf16 v[80:83],v[48:51],a[176:179],v[80:83]
 s_add_u32 s53,s53,s64
 v_mfma_f32_16x16x32_bf16 v[84:87],v[48:51],a[180:183],v[84:87]
 v_mfma_f32_16x16x32_bf16 v[88:91],v[52:55],a[176:179],v[88:91]
 buffer_load_dwordx4 a[96:99],v0,s[12:15],s53 offen sc1
 v_mfma_f32_16x16x32_bf16 v[92:95],v[52:55],a[180:183],v[92:95]
 s_waitcnt vmcnt(34) lgkmcnt(0)
 s_barrier
 ds_read_b128 v[40:43],v1 offset:20480
 v_mfma_f32_16x16x32_bf16 v[96:99],v[56:59],a[176:179],v[96:99]
 ds_read_b128 v[44:47],v1 offset:21504
 ds_read_b128 v[48:51],v1 offset:22528
 v_mfma_f32_16x16x32_bf16 v[100:103],v[56:59],a[180:183],v[100:103]
 ds_read_b128 v[52:55],v1 offset:23552
 ds_read_b128 v[56:59],v1 offset:24576
 v_mfma_f32_16x16x32_bf16 v[104:107],v[60:63],a[176:179],v[104:107]
 buffer_load_dwordx4 v0,s[12:15],s50 offen sc1 lds
 v_mfma_f32_16x16x32_bf16 v[108:111],v[60:63],a[180:183],v[108:111]
 ds_read_b128 v[60:63],v1 offset:25600
 v_mfma_f32_16x16x32_bf16 v[112:115],v[64:67],a[176:179],v[112:115]
 v_mfma_f32_16x16x32_bf16 v[116:119],v[64:67],a[180:183],v[116:119]
 ds_read_b128 v[64:67],v1 offset:26624
 v_mfma_f32_16x16x32_bf16 v[120:123],v[68:71],a[176:179],v[120:123]
 buffer_load_dwordx4 v0,s[12:15],s50 offen offset:1024 sc1 lds
 v_mfma_f32_16x16x32_bf16 v[124:127],v[68:71],a[180:183],v[124:127]
 s_cmp_eq_u32 s44,11
 s_cselect_b32 s50,0,315392
 v_mfma_f32_16x16x32_bf16 v[128:131],v[72:75],a[176:179],v[128:131]
 s_add_u32 s50,s50,s67
 s_add_u32 m0,s54,59392
 ds_read_b128 v[68:71],v1 offset:27648
 v_mfma_f32_16x16x32_bf16 v[132:135],v[72:75],a[180:183],v[132:135]
 ds_read_b128 v[72:75],v1 offset:28672
 v_mfma_f32_16x16x32_bf16 v[80:83],v[76:79],a[184:187],v[80:83]
 buffer_load_dwordx4 v0,s[12:15],s50 offen sc1 lds
 v_mfma_f32_16x16x32_bf16 v[84:87],v[76:79],a[188:191],v[84:87]
 ds_read_b128 v[76:79],v1 offset:29696
 v_mfma_f32_16x16x32_bf16 v[88:91],v[16:19],a[184:187],v[88:91]
 v_mfma_f32_16x16x32_bf16 v[92:95],v[16:19],a[188:191],v[92:95]
 ds_read_b128 v[16:19],v1 offset:30720
 v_mfma_f32_16x16x32_bf16 v[96:99],v[20:23],a[184:187],v[96:99]
 buffer_load_dwordx4 v0,s[12:15],s50 offen offset:1024 sc1 lds
 v_mfma_f32_16x16x32_bf16 v[100:103],v[20:23],a[188:191],v[100:103]
 ds_read_b128 v[20:23],v1 offset:31744
 v_mfma_f32_16x16x32_bf16 v[104:107],v[24:27],a[184:187],v[104:107]
 v_mfma_f32_16x16x32_bf16 v[108:111],v[24:27],a[188:191],v[108:111]
 ds_read_b128 v[24:27],v1 offset:32768
 v_mfma_f32_16x16x32_bf16 v[112:115],v[28:31],a[184:187],v[112:115]
 buffer_load_dwordx4 v0,s[12:15],s50 offen offset:2048 sc1 lds
 v_mfma_f32_16x16x32_bf16 v[116:119],v[28:31],a[188:191],v[116:119]
 s_cmp_eq_u32 s44,12
 s_cselect_b32 s50,0,344064
 v_mfma_f32_16x16x32_bf16 v[120:123],v[32:35],a[184:187],v[120:123]
 s_add_u32 s50,s50,s67
 s_add_u32 m0,s54,62464
 ds_read_b128 v[28:31],v1 offset:33792
 v_mfma_f32_16x16x32_bf16 v[124:127],v[32:35],a[188:191],v[124:127]
 ds_read_b128 v[32:35],v1 offset:34816
 v_mfma_f32_16x16x32_bf16 v[128:131],v[36:39],a[184:187],v[128:131]
 buffer_load_dwordx4 v0,s[12:15],s50 offen sc1 lds
 v_mfma_f32_16x16x32_bf16 v[132:135],v[36:39],a[188:191],v[132:135]
 s_waitcnt lgkmcnt(13)
 ds_read_b128 v[36:39],v1 offset:35840
 v_mfma_f32_16x16x32_bf16 v[80:83],v[40:43],a[192:195],v[80:83]
 v_mfma_f32_16x16x32_bf16 v[84:87],v[40:43],a[196:199],v[84:87]
 ds_read_b128 v[40:43],v1 offset:36864
 v_mfma_f32_16x16x32_bf16 v[88:91],v[44:47],a[192:195],v[88:91]
 buffer_load_dwordx4 v0,s[12:15],s50 offen offset:1024 sc1 lds
 v_mfma_f32_16x16x32_bf16 v[92:95],v[44:47],a[196:199],v[92:95]
 s_waitcnt lgkmcnt(13)
 ds_read_b128 v[44:47],v1 offset:37888
 s_add_u32 m0,s54,86016
 v_mfma_f32_16x16x32_bf16 v[96:99],v[48:51],a[192:195],v[96:99]
 s_cmp_eq_u32 s44,12
 s_cselect_b32 s50,0,344064
 s_add_u32 s50,s50,s67
 v_mfma_f32_16x16x32_bf16 v[100:103],v[48:51],a[196:199],v[100:103]
 s_add_u32 s50,s50,2048
 ds_read_b128 v[48:51],v1 offset:38912
 v_mfma_f32_16x16x32_bf16 v[104:107],v[52:55],a[192:195],v[104:107]
 v_mfma_f32_16x16x32_bf16 v[108:111],v[52:55],a[196:199],v[108:111]
 s_waitcnt lgkmcnt(13)
 buffer_load_dwordx4 a[100:103],v0,s[12:15],s53 offen offset:1024 sc1
 v_mfma_f32_16x16x32_bf16 v[112:115],v[56:59],a[192:195],v[112:115]
 ds_read_b128 v[52:55],v1 offset:39936
 v_mfma_f32_16x16x32_bf16 v[116:119],v[56:59],a[196:199],v[116:119]
 ds_read_b128 v[56:59],v1 offset:40960
 v_mfma_f32_16x16x32_bf16 v[120:123],v[60:63],a[192:195],v[120:123]
 v_mfma_f32_16x16x32_bf16 v[124:127],v[60:63],a[196:199],v[124:127]
 s_waitcnt lgkmcnt(13)
 buffer_load_dwordx4 a[104:107],v0,s[12:15],s53 offen offset:2048 sc1
 v_mfma_f32_16x16x32_bf16 v[128:131],v[64:67],a[192:195],v[128:131]
 ds_read_b128 v[60:63],v1 offset:41984
 v_mfma_f32_16x16x32_bf16 v[132:135],v[64:67],a[196:199],v[132:135]
 ds_read_b128 v[64:67],v1 offset:43008
 v_mfma_f32_16x16x32_bf16 v[80:83],v[68:71],a[200:203],v[80:83]
 v_mfma_f32_16x16x32_bf16 v[84:87],v[68:71],a[204:207],v[84:87]
 s_waitcnt lgkmcnt(13)
 buffer_load_dwordx4 a[108:111],v0,s[12:15],s53 offen offset:3072 sc1
 v_mfma_f32_16x16x32_bf16 v[88:91],v[72:75],a[200:203],v[88:91]
 s_add_u32 s53,s53,4096
 ds_read_b128 v[68:71],v1 offset:44032
 v_mfma_f32_16x16x32_bf16 v[92:95],v[72:75],a[204:207],v[92:95]
 ds_read_b128 v[72:75],v1 offset:45056
 v_mfma_f32_16x16x32_bf16 v[96:99],v[76:79],a[200:203],v[96:99]
 v_mfma_f32_16x16x32_bf16 v[100:103],v[76:79],a[204:207],v[100:103]
 s_waitcnt lgkmcnt(13)
 buffer_load_dwordx4 a[112:115],v0,s[12:15],s53 offen sc1
 v_mfma_f32_16x16x32_bf16 v[104:107],v[16:19],a[200:203],v[104:107]
 ds_read_b128 v[76:79],v1 offset:46080
 v_mfma_f32_16x16x32_bf16 v[108:111],v[16:19],a[204:207],v[108:111]
 ds_read_b128 v[16:19],v1 offset:47104
 v_mfma_f32_16x16x32_bf16 v[112:115],v[20:23],a[200:203],v[112:115]
 v_mfma_f32_16x16x32_bf16 v[116:119],v[20:23],a[204:207],v[116:119]
 s_waitcnt lgkmcnt(13)
 buffer_load_dwordx4 a[116:119],v0,s[12:15],s53 offen offset:1024 sc1
 v_mfma_f32_16x16x32_bf16 v[120:123],v[24:27],a[200:203],v[120:123]
 ds_read_b128 v[20:23],v1 offset:48128
 v_mfma_f32_16x16x32_bf16 v[124:127],v[24:27],a[204:207],v[124:127]
 v_mfma_f32_16x16x32_bf16 v[128:131],v[28:31],a[200:203],v[128:131]
 v_mfma_f32_16x16x32_bf16 v[132:135],v[28:31],a[204:207],v[132:135]
 s_waitcnt lgkmcnt(12)
 buffer_load_dwordx4 a[120:123],v0,s[12:15],s53 offen offset:2048 sc1
 v_mfma_f32_16x16x32_bf16 v[80:83],v[32:35],a[208:211],v[80:83]
 v_mfma_f32_16x16x32_bf16 v[84:87],v[32:35],a[212:215],v[84:87]
 v_mfma_f32_16x16x32_bf16 v[88:91],v[36:39],a[208:211],v[88:91]
 v_mfma_f32_16x16x32_bf16 v[92:95],v[36:39],a[212:215],v[92:95]
 s_waitcnt lgkmcnt(10)
 buffer_load_dwordx4 a[124:127],v0,s[12:15],s53 offen offset:3072 sc1
 v_mfma_f32_16x16x32_bf16 v[96:99],v[40:43],a[208:211],v[96:99]
 s_waitcnt vmcnt(34) lgkmcnt(0)
 s_barrier
 ds_read_b128 v[24:27],v0
 ds_read_b128 v[28:31],v0 offset:1024
 v_mfma_f32_16x16x32_bf16 v[100:103],v[40:43],a[212:215],v[100:103]
 ds_read_b128 v[32:35],v0 offset:2048
 ds_read_b128 v[36:39],v0 offset:3072
 v_mfma_f32_16x16x32_bf16 v[104:107],v[44:47],a[208:211],v[104:107]
 s_cmp_eq_u32 s44,12
 s_cselect_b32 s53,0,98304
 ds_read_b128 v[40:43],v0 offset:4096
 v_mfma_f32_16x16x32_bf16 v[108:111],v[44:47],a[212:215],v[108:111]
 buffer_load_dwordx4 v0,s[12:15],s50 offen sc1 lds
 v_mfma_f32_16x16x32_bf16 v[112:115],v[48:51],a[208:211],v[112:115]
 s_cmp_eq_u32 s44,13
 s_cselect_b32 s50,0,372736
 s_add_u32 s50,s50,s67
 v_mfma_f32_16x16x32_bf16 v[116:119],v[48:51],a[212:215],v[116:119]
 s_add_u32 m0,s54,87040
 ds_read_b128 v[44:47],v0 offset:5120
 ds_read_b128 v[48:51],v0 offset:6144
 v_mfma_f32_16x16x32_bf16 v[120:123],v[52:55],a[208:211],v[120:123]
 s_add_u32 s53,s53,s64
 v_mfma_f32_16x16x32_bf16 v[124:127],v[52:55],a[212:215],v[124:127]
 buffer_load_dwordx4 v0,s[12:15],s50 offen sc1 lds
 v_mfma_f32_16x16x32_bf16 v[128:131],v[56:59],a[208:211],v[128:131]
 ds_read_b128 v[52:55],v0 offset:7168
 v_mfma_f32_16x16x32_bf16 v[132:135],v[56:59],a[212:215],v[132:135]
 ds_read_b128 v[56:59],v0 offset:8192
 v_mfma_f32_16x16x32_bf16 v[80:83],v[60:63],a[216:219],v[80:83]
 v_mfma_f32_16x16x32_bf16 v[84:87],v[60:63],a[220:223],v[84:87]
 buffer_load_dwordx4 v0,s[12:15],s50 offen offset:1024 sc1 lds
 v_mfma_f32_16x16x32_bf16 v[88:91],v[64:67],a[216:219],v[88:91]
 ds_read_b128 v[60:63],v0 offset:9216
 v_mfma_f32_16x16x32_bf16 v[92:95],v[64:67],a[220:223],v[92:95]
 ds_read_b128 v[64:67],v0 offset:10240
 v_mfma_f32_16x16x32_bf16 v[96:99],v[68:71],a[216:219],v[96:99]
 v_mfma_f32_16x16x32_bf16 v[100:103],v[68:71],a[220:223],v[100:103]
 ds_read_b128 v[68:71],v0 offset:11264
 v_mfma_f32_16x16x32_bf16 v[104:107],v[72:75],a[216:219],v[104:107]
 buffer_load_dwordx4 v0,s[12:15],s50 offen offset:2048 sc1 lds
 v_mfma_f32_16x16x32_bf16 v[108:111],v[72:75],a[220:223],v[108:111]
 s_cmp_eq_u32 s44,14
 s_cselect_b32 s50,0,401408
 s_add_u32 s50,s50,s67
 v_mfma_f32_16x16x32_bf16 v[112:115],v[76:79],a[216:219],v[112:115]
 s_add_u32 m0,s54,90112
 ds_read_b128 v[72:75],v0 offset:12288
 v_mfma_f32_16x16x32_bf16 v[116:119],v[76:79],a[220:223],v[116:119]
 ds_read_b128 v[76:79],v0 offset:13312
 v_mfma_f32_16x16x32_bf16 v[120:123],v[16:19],a[216:219],v[120:123]
 buffer_load_dwordx4 v0,s[12:15],s50 offen sc1 lds
 v_mfma_f32_16x16x32_bf16 v[124:127],v[16:19],a[220:223],v[124:127]
 ds_read_b128 v[16:19],v0 offset:14336
 v_mfma_f32_16x16x32_bf16 v[128:131],v[20:23],a[216:219],v[128:131]
 v_mfma_f32_16x16x32_bf16 v[132:135],v[20:23],a[220:223],v[132:135]
 s_waitcnt lgkmcnt(13)
 ds_read_b128 v[20:23],v0 offset:15360
 v_mfma_f32_16x16x32_bf16 v[80:83],v[24:27],a[224:227],v[80:83]
 buffer_load_dwordx4 v0,s[12:15],s50 offen offset:1024 sc1 lds
 v_mfma_f32_16x16x32_bf16 v[84:87],v[24:27],a[228:231],v[84:87]
 ds_read_b128 v[24:27],v0 offset:16384
 v_mfma_f32_16x16x32_bf16 v[88:91],v[28:31],a[224:227],v[88:91]
 v_mfma_f32_16x16x32_bf16 v[92:95],v[28:31],a[228:231],v[92:95]
 s_waitcnt lgkmcnt(13)
 ds_read_b128 v[28:31],v0 offset:17408
 v_mfma_f32_16x16x32_bf16 v[96:99],v[32:35],a[224:227],v[96:99]
 buffer_load_dwordx4 v0,s[12:15],s50 offen offset:2048 sc1 lds
 v_mfma_f32_16x16x32_bf16 v[100:103],v[32:35],a[228:231],v[100:103]
 s_cmp_eq_u32 s44,15
 s_cselect_b32 s50,0,430080
 ds_read_b128 v[32:35],v0 offset:18432
 v_mfma_f32_16x16x32_bf16 v[104:107],v[36:39],a[224:227],v[104:107]
 s_add_u32 s50,s50,s67
 s_add_u32 m0,s54,0
 v_mfma_f32_16x16x32_bf16 v[108:111],v[36:39],a[228:231],v[108:111]
 s_waitcnt lgkmcnt(13)
 ds_read_b128 v[36:39],v0 offset:19456
 v_mfma_f32_16x16x32_bf16 v[112:115],v[40:43],a[224:227],v[112:115]
 buffer_load_dwordx4 a[128:131],v0,s[12:15],s53 offen sc1
 v_mfma_f32_16x16x32_bf16 v[116:119],v[40:43],a[228:231],v[116:119]
 ds_read_b128 v[40:43],v0 offset:20480
 v_mfma_f32_16x16x32_bf16 v[120:123],v[44:47],a[224:227],v[120:123]
 v_mfma_f32_16x16x32_bf16 v[124:127],v[44:47],a[228:231],v[124:127]
 s_waitcnt lgkmcnt(13)
 ds_read_b128 v[44:47],v0 offset:21504
 v_mfma_f32_16x16x32_bf16 v[128:131],v[48:51],a[224:227],v[128:131]
 buffer_load_dwordx4 a[132:135],v0,s[12:15],s53 offen offset:1024 sc1
 v_mfma_f32_16x16x32_bf16 v[132:135],v[48:51],a[228:231],v[132:135]
 ds_read_b128 v[48:51],v0 offset:22528
 v_mfma_f32_16x16x32_bf16 v[80:83],v[52:55],a[232:235],v[80:83]
 v_mfma_f32_16x16x32_bf16 v[84:87],v[52:55],a[236:239],v[84:87]
 s_waitcnt lgkmcnt(13)
 ds_read_b128 v[52:55],v0 offset:23552
 v_mfma_f32_16x16x32_bf16 v[88:91],v[56:59],a[232:235],v[88:91]
 buffer_load_dwordx4 a[136:139],v0,s[12:15],s53 offen offset:2048 sc1
 v_mfma_f32_16x16x32_bf16 v[92:95],v[56:59],a[236:239],v[92:95]
 ds_read_b128 v[56:59],v0 offset:24576
 v_mfma_f32_16x16x32_bf16 v[96:99],v[60:63],a[232:235],v[96:99]
 v_mfma_f32_16x16x32_bf16 v[100:103],v[60:63],a[236:239],v[100:103]
 s_waitcnt lgkmcnt(13)
 ds_read_b128 v[60:63],v0 offset:25600
 v_mfma_f32_16x16x32_bf16 v[104:107],v[64:67],a[232:235],v[104:107]
 buffer_load_dwordx4 a[140:143],v0,s[12:15],s53 offen offset:3072 sc1
 v_mfma_f32_16x16x32_bf16 v[108:111],v[64:67],a[236:239],v[108:111]
 s_add_u32 s53,s53,4096
 ds_read_b128 v[64:67],v0 offset:26624
 v_mfma_f32_16x16x32_bf16 v[112:115],v[68:71],a[232:235],v[112:115]
 v_mfma_f32_16x16x32_bf16 v[116:119],v[68:71],a[236:239],v[116:119]
 s_waitcnt lgkmcnt(13)
 ds_read_b128 v[68:71],v0 offset:27648
 v_mfma_f32_16x16x32_bf16 v[120:123],v[72:75],a[232:235],v[120:123]
 buffer_load_dwordx4 a[144:147],v0,s[12:15],s53 offen sc1
 v_mfma_f32_16x16x32_bf16 v[124:127],v[72:75],a[236:239],v[124:127]
 v_mfma_f32_16x16x32_bf16 v[128:131],v[76:79],a[232:235],v[128:131]
 v_mfma_f32_16x16x32_bf16 v[132:135],v[76:79],a[236:239],v[132:135]
 s_waitcnt lgkmcnt(12)
 v_mfma_f32_16x16x32_bf16 v[80:83],v[16:19],a[240:243],v[80:83]
 buffer_load_dwordx4 a[148:151],v0,s[12:15],s53 offen offset:1024 sc1
 v_mfma_f32_16x16x32_bf16 v[84:87],v[16:19],a[244:247],v[84:87]
 v_add_u32 v212,s55,v0
 v_mfma_f32_16x16x32_bf16 v[88:91],v[20:23],a[240:243],v[88:91]
 v_mfma_f32_16x16x32_bf16 v[92:95],v[20:23],a[244:247],v[92:95]
 s_waitcnt vmcnt(34) lgkmcnt(0)
 s_barrier
 ds_read_b128 v[72:75],v0 offset:28672
 v_mfma_f32_16x16x32_bf16 v[96:99],v[24:27],a[240:243],v[96:99]
 ds_read_b128 v[76:79],v0 offset:29696
 ds_read_b128 v[16:19],v0 offset:30720
 v_mfma_f32_16x16x32_bf16 v[100:103],v[24:27],a[244:247],v[100:103]
 buffer_load_dwordx4 a[152:155],v0,s[12:15],s53 offen offset:2048 sc1
 v_mfma_f32_16x16x32_bf16 v[104:107],v[28:31],a[240:243],v[104:107]
 v_add_u32 v213,114688,v212
 ds_read_b128 v[20:23],v0 offset:35840
 v_mfma_f32_16x16x32_bf16 v[108:111],v[28:31],a[244:247],v[108:111]
 ds_read_b128 v[24:27],v0 offset:36864
 ds_read_b128 v[28:31],v0 offset:37888
 v_mfma_f32_16x16x32_bf16 v[112:115],v[32:35],a[240:243],v[112:115]
 v_mfma_f32_16x16x32_bf16 v[116:119],v[32:35],a[244:247],v[116:119]
 buffer_load_dwordx4 a[156:159],v0,s[12:15],s53 offen offset:3072 sc1
 v_mfma_f32_16x16x32_bf16 v[120:123],v[36:39],a[240:243],v[120:123]
 s_cmp_eq_u32 s44,13
 s_cselect_b32 s53,0,106496
 s_add_u32 s53,s53,s64
 v_mfma_f32_16x16x32_bf16 v[124:127],v[36:39],a[244:247],v[124:127]
 ds_read_b128 v[32:35],v0 offset:43008
 ds_read_b128 v[36:39],v0 offset:44032
 v_mfma_f32_16x16x32_bf16 v[128:131],v[40:43],a[240:243],v[128:131]
 s_lshl_b32 s57,s47,17
 v_mfma_f32_16x16x32_bf16 v[132:135],v[40:43],a[244:247],v[132:135]
 buffer_load_dwordx4 a[160:163],v0,s[12:15],s53 offen sc1
 v_mfma_f32_16x16x32_bf16 v[80:83],v[44:47],a[248:251],v[80:83]
 ds_read_b128 v[40:43],v0 offset:45056
 v_mfma_f32_16x16x32_bf16 v[84:87],v[44:47],a[252:255],v[84:87]
 ds_read_b128 v[44:47],v0 offset:50176
 v_mfma_f32_16x16x32_bf16 v[88:91],v[48:51],a[248:251],v[88:91]
 v_mfma_f32_16x16x32_bf16 v[92:95],v[48:51],a[252:255],v[92:95]
 buffer_load_dwordx4 a[164:167],v0,s[12:15],s53 offen offset:1024 sc1
 v_mfma_f32_16x16x32_bf16 v[96:99],v[52:55],a[248:251],v[96:99]
 s_add_u32 s57,s57,50331648
 ds_read_b128 v[48:51],v0 offset:51200
 s_add_u32 s68,s57,0
 v_mfma_f32_16x16x32_bf16 v[100:103],v[52:55],a[252:255],v[100:103]
 ds_read_b128 v[52:55],v0 offset:52224
 s_mov_b32 s65,s68
 v_mfma_f32_16x16x32_bf16 v[104:107],v[56:59],a[248:251],v[104:107]
 s_add_u32 s65,s65,2048
 v_mfma_f32_16x16x32_bf16 v[108:111],v[56:59],a[252:255],v[108:111]
 buffer_load_dwordx4 a[168:171],v0,s[12:15],s53 offen offset:2048 sc1
 v_mfma_f32_16x16x32_bf16 v[112:115],v[60:63],a[248:251],v[112:115]
 ds_read_b128 v[56:59],v0 offset:31744
 v_mfma_f32_16x16x32_bf16 v[116:119],v[60:63],a[252:255],v[116:119]
 ds_read_b128 v[60:63],v0 offset:32768
 v_mfma_f32_16x16x32_bf16 v[120:123],v[64:67],a[248:251],v[120:123]
 s_lshl_b32 s60,s45,11
 v_mfma_f32_16x16x32_bf16 v[124:127],v[64:67],a[252:255],v[124:127]
 buffer_load_dwordx4 a[172:175],v0,s[12:15],s53 offen offset:3072 sc1
 v_mfma_f32_16x16x32_bf16 v[128:131],v[68:71],a[248:251],v[128:131]
 s_add_u32 s53,s53,4096
 ds_read_b128 v[64:67],v0 offset:33792
 v_mfma_f32_16x16x32_bf16 v[132:135],v[68:71],a[252:255],v[132:135]
 s_waitcnt lgkmcnt(13)
 ds_read_b128 v[68:71],v0 offset:38912
 v_mfma_f32_16x16x32_bf16 v[112:115],v[72:75],a[0:3],v[112:115]
 v_mfma_f32_16x16x32_bf16 v[116:119],v[72:75],a[4:7],v[116:119]
 buffer_load_dwordx4 a[176:179],v0,s[12:15],s53 offen sc1
 v_mfma_f32_16x16x32_bf16 v[120:123],v[76:79],a[0:3],v[120:123]
 ds_read_b128 v[72:75],v0 offset:39936
 v_mfma_f32_16x16x32_bf16 v[124:127],v[76:79],a[4:7],v[124:127]
 s_add_u32 s60,s60,s57
 ds_read_b128 v[76:79],v0 offset:40960
 s_waitcnt lgkmcnt(14)
 v_mfma_f32_16x16x32_bf16 v[128:131],v[16:19],a[0:3],v[128:131]
 v_mfma_f32_16x16x32_bf16 v[132:135],v[16:19],a[4:7],v[132:135]
 buffer_load_dwordx4 a[180:183],v0,s[12:15],s53 offen offset:1024 sc1
 v_mfma_f32_16x16x32_bf16 v[112:115],v[20:23],a[8:11],v[112:115]
 ds_read_b128 v[16:19],v0 offset:46080
 v_mfma_f32_16x16x32_bf16 v[116:119],v[20:23],a[12:15],v[116:119]
 s_waitcnt lgkmcnt(13)
 ds_read_b128 v[20:23],v0 offset:47104
 v_mfma_f32_16x16x32_bf16 v[120:123],v[24:27],a[8:11],v[120:123]
 v_mfma_f32_16x16x32_bf16 v[124:127],v[24:27],a[12:15],v[124:127]
 s_add_u32 s60,s60,49152
 buffer_load_dwordx4 a[184:187],v0,s[12:15],s53 offen offset:2048 sc1
 v_mfma_f32_16x16x32_bf16 v[128:131],v[28:31],a[8:11],v[128:131]
 ds_read_b128 v[24:27],v0 offset:48128
 v_mfma_f32_16x16x32_bf16 v[132:135],v[28:31],a[12:15],v[132:135]
 s_waitcnt lgkmcnt(13)
 ds_read_b128 v[28:31],v0 offset:53248
 v_mfma_f32_16x16x32_bf16 v[112:115],v[32:35],a[16:19],v[112:115]
 v_mfma_f32_16x16x32_bf16 v[116:119],v[32:35],a[20:23],v[116:119]
 buffer_load_dwordx4 a[188:191],v0,s[12:15],s53 offen offset:3072 sc1
 v_mfma_f32_16x16x32_bf16 v[120:123],v[36:39],a[16:19],v[120:123]
 s_cmp_eq_u32 s44,14
 s_cselect_b32 s53,0,114688
 s_add_u32 s53,s53,s64
 v_mfma_f32_16x16x32_bf16 v[124:127],v[36:39],a[20:23],v[124:127]
 s_add_u32 s62,s60,32768
 ds_read_b128 v[32:35],v0 offset:54272
 s_waitcnt lgkmcnt(13)
 v_mfma_f32_16x16x32_bf16 v[128:131],v[40:43],a[16:19],v[128:131]
 ds_read_b128 v[36:39],v0 offset:55296
 v_mfma_f32_16x16x32_bf16 v[132:135],v[40:43],a[20:23],v[132:135]
 ds_read_b128 v[40:43],v0 offset:34816
 v_mfma_f32_16x16x32_bf16 v[112:115],v[44:47],a[24:27],v[112:115]
 buffer_load_dwordx4 a[192:195],v0,s[12:15],s53 offen sc1
 v_mfma_f32_16x16x32_bf16 v[116:119],v[44:47],a[28:31],v[116:119]
 s_waitcnt lgkmcnt(13)
 ds_read_b128 v[44:47],v0 offset:41984
 v_mfma_f32_16x16x32_bf16 v[120:123],v[48:51],a[24:27],v[120:123]
 v_mfma_f32_16x16x32_bf16 v[124:127],v[48:51],a[28:31],v[124:127]
 s_lshr_b32 s58,s45,1
 ds_read_b128 v[48:51],v0 offset:49152
 v_mfma_f32_16x16x32_bf16 v[128:131],v[52:55],a[24:27],v[128:131]
 buffer_load_dwordx4 a[196:199],v0,s[12:15],s53 offen offset:1024 sc1
 v_mfma_f32_16x16x32_bf16 v[132:135],v[52:55],a[28:31],v[132:135]
 s_waitcnt lgkmcnt(13)
 ds_read_b128 v[52:55],v0 offset:56320
 v_mfma_f32_16x16x32_bf16 v[112:115],v[56:59],a[32:35],v[112:115]
 v_mfma_f32_16x16x32_bf16 v[116:119],v[56:59],a[36:39],v[116:119]
 v_mfma_f32_16x16x32_bf16 v[120:123],v[60:63],a[32:35],v[120:123]
 buffer_load_dwordx4 v0,s[12:15],s50 offen sc1 lds
 v_mfma_f32_16x16x32_bf16 v[124:127],v[60:63],a[36:39],v[124:127]
 s_mul_i32 s58,s58,6144
 s_waitcnt lgkmcnt(12)
 v_mfma_f32_16x16x32_bf16 v[128:131],v[64:67],a[32:35],v[128:131]
 v_mfma_f32_16x16x32_bf16 v[132:135],v[64:67],a[36:39],v[132:135]
 v_mfma_f32_16x16x32_bf16 v[112:115],v[68:71],a[40:43],v[112:115]
 buffer_load_dwordx4 v0,s[12:15],s50 offen offset:1024 sc1 lds
 v_mfma_f32_16x16x32_bf16 v[116:119],v[68:71],a[44:47],v[116:119]
 s_waitcnt vmcnt(34) lgkmcnt(0)
 s_barrier
 ds_read_b128 v[56:59],v0 offset:57344
 v_mfma_f32_16x16x32_bf16 v[120:123],v[72:75],a[40:43],v[120:123]
 ds_read_b128 v[60:63],v0 offset:58368
 ds_read_b128 v[64:67],v0 offset:64512
 v_mfma_f32_16x16x32_bf16 v[124:127],v[72:75],a[44:47],v[124:127]
 ds_read_b128 v[68:71],v1
 ds_read_b128 v[72:75],v1 offset:6144
 v_mfma_f32_16x16x32_bf16 v[128:131],v[76:79],a[40:43],v[128:131]
 s_add_u32 s58,s58,s57
 buffer_load_dwordx4 v0,s[12:15],s50 offen offset:2048 sc1 lds
 v_mfma_f32_16x16x32_bf16 v[132:135],v[76:79],a[44:47],v[132:135]
 s_cmp_eq_u32 s44,8
 s_cselect_b32 s50,0,229376
 v_mfma_f32_16x16x32_bf16 v[112:115],v[16:19],a[48:51],v[112:115]
 s_add_u32 s50,s50,s66
 s_add_u32 m0,s54,3072
 ds_read_b128 v[76:79],v1 offset:7168
 v_mfma_f32_16x16x32_bf16 v[116:119],v[16:19],a[52:55],v[116:119]
 ds_read_b128 v[16:19],v1 offset:13312
 v_mfma_f32_16x16x32_bf16 v[120:123],v[20:23],a[48:51],v[120:123]
 buffer_load_dwordx4 v0,s[12:15],s50 offen sc1 lds
 v_mfma_f32_16x16x32_bf16 v[124:127],v[20:23],a[52:55],v[124:127]
 ds_read_b128 v[20:23],v1 offset:14336
 v_mfma_f32_16x16x32_bf16 v[128:131],v[24:27],a[48:51],v[128:131]
 s_and_b32 s3,s45,1
 v_mfma_f32_16x16x32_bf16 v[132:135],v[24:27],a[52:55],v[132:135]
 ds_read_b128 v[24:27],v0 offset:59392
 v_mfma_f32_16x16x32_bf16 v[112:115],v[28:31],a[56:59],v[112:115]
 buffer_load_dwordx4 v0,s[12:15],s50 offen offset:1024 sc1 lds
 v_mfma_f32_16x16x32_bf16 v[116:119],v[28:31],a[60:63],v[116:119]
 ds_read_b128 v[28:31],v0 offset:60416
 v_mfma_f32_16x16x32_bf16 v[120:123],v[32:35],a[56:59],v[120:123]
 v_mfma_f32_16x16x32_bf16 v[124:127],v[32:35],a[60:63],v[124:127]
 ds_read_b128 v[32:35],v0 offset:61440
 v_mfma_f32_16x16x32_bf16 v[128:131],v[36:39],a[56:59],v[128:131]
 s_lshl_b32 s61,s3,12
 buffer_load_dwordx4 v0,s[12:15],s50 offen offset:2048 sc1 lds
 v_mfma_f32_16x16x32_bf16 v[132:135],v[36:39],a[60:63],v[132:135]
 ds_read_b128 v[36:39],v1 offset:1024
 v_mfma_f32_16x16x32_bf16 v[112:115],v[40:43],a[64:67],v[112:115]
 v_mfma_f32_16x16x32_bf16 v[116:119],v[40:43],a[68:71],v[116:119]
 ds_read_b128 v[40:43],v1 offset:2048
 v_mfma_f32_16x16x32_bf16 v[112:115],v[44:47],a[72:75],v[112:115]
 buffer_load_dwordx4 v0,s[12:15],s50 offen offset:3072 sc1 lds
 v_mfma_f32_16x16x32_bf16 v[116:119],v[44:47],a[76:79],v[116:119]
 ds_read_b128 v[44:47],v1 offset:3072
 s_add_u32 m0,s54,28672
 v_mfma_f32_16x16x32_bf16 v[112:115],v[48:51],a[80:83],v[112:115]
 s_add_u32 s61,s61,s58
 s_cmp_eq_u32 s44,9
 s_cselect_b32 s50,0,258048
 v_mfma_f32_16x16x32_bf16 v[116:119],v[48:51],a[84:87],v[116:119]
 s_add_u32 s50,s50,s66
 ds_read_b128 v[48:51],v1 offset:8192
 v_mfma_f32_16x16x32_bf16 v[112:115],v[52:55],a[88:91],v[112:115]
 buffer_load_dwordx4 a[200:203],v0,s[12:15],s53 offen offset:2048 sc1
 v_mfma_f32_16x16x32_bf16 v[116:119],v[52:55],a[92:95],v[116:119]
 s_waitcnt lgkmcnt(13)
 ds_read_b128 v[52:55],v1 offset:9216
 v_mfma_f32_16x16x32_bf16 v[120:123],v[56:59],a[64:67],v[120:123]
 v_mfma_f32_16x16x32_bf16 v[124:127],v[56:59],a[68:71],v[124:127]
 ds_read_b128 v[56:59],v1 offset:10240
 v_mfma_f32_16x16x32_bf16 v[128:131],v[60:63],a[64:67],v[128:131]
 s_lshl_b32 s3,s3,9
 v_mfma_f32_16x16x32_bf16 v[132:135],v[60:63],a[68:71],v[132:135]
 s_waitcnt lgkmcnt(13)
 buffer_load_dwordx4 a[204:207],v0,s[12:15],s53 offen offset:3072 sc1
 v_mfma_f32_16x16x32_bf16 v[120:123],v[64:67],a[72:75],v[120:123]
 s_add_u32 s53,s53,4096
 ds_read_b128 v[60:63],v1 offset:15360
 v_mfma_f32_16x16x32_bf16 v[124:127],v[64:67],a[76:79],v[124:127]
 ds_read_b128 v[64:67],v1 offset:16384
 v_mfma_f32_16x16x32_bf16 v[128:131],v[68:71],a[72:75],v[128:131]
 v_mfma_f32_16x16x32_bf16 v[132:135],v[68:71],a[76:79],v[132:135]
 s_waitcnt lgkmcnt(13)
 buffer_load_dwordx4 a[208:211],v0,s[12:15],s53 offen sc1
 v_mfma_f32_16x16x32_bf16 v[120:123],v[72:75],a[80:83],v[120:123]
 ds_read_b128 v[68:71],v1 offset:17408
 v_mfma_f32_16x16x32_bf16 v[124:127],v[72:75],a[84:87],v[124:127]
 s_add_u32 s58,s58,s3
 ds_read_b128 v[72:75],v0 offset:62464
 v_mfma_f32_16x16x32_bf16 v[128:131],v[76:79],a[80:83],v[128:131]
 v_mfma_f32_16x16x32_bf16 v[132:135],v[76:79],a[84:87],v[132:135]
 s_waitcnt lgkmcnt(13)
 buffer_load_dwordx4 a[212:215],v0,s[12:15],s53 offen offset:1024 sc1
 v_mfma_f32_16x16x32_bf16 v[120:123],v[16:19],a[88:91],v[120:123]
 ds_read_b128 v[76:79],v0 offset:63488
 v_mfma_f32_16x16x32_bf16 v[124:127],v[16:19],a[92:95],v[124:127]
 ds_read_b128 v[16:19],v1 offset:4096
 v_mfma_f32_16x16x32_bf16 v[128:131],v[20:23],a[88:91],v[128:131]
 v_mfma_f32_16x16x32_bf16 v[132:135],v[20:23],a[92:95],v[132:135]
 s_waitcnt vmcnt(42) lgkmcnt(13)
 buffer_load_dwordx4 a[216:219],v0,s[12:15],s53 offen offset:2048 sc1
 v_mfma_f32_16x16x32_bf16 v[112:115],v[24:27],a[96:99],v[112:115]
 s_add_u32 s58,s58,2048
 ds_read_b128 v[20:23],v1 offset:5120
 v_mfma_f32_16x16x32_bf16 v[116:119],v[24:27],a[100:103],v[116:119]
 ds_read_b128 v[24:27],v1 offset:11264
 v_mfma_f32_16x16x32_bf16 v[120:123],v[28:31],a[96:99],v[120:123]
 v_mfma_f32_16x16x32_bf16 v[124:127],v[28:31],a[100:103],v[124:127]
 s_waitcnt vmcnt(41) lgkmcnt(13)
 buffer_load_dwordx4 a[220:223],v0,s[12:15],s53 offen offset:3072 sc1
 v_mfma_f32_16x16x32_bf16 v[128:131],v[32:35],a[96:99],v[128:131]
 s_cmp_eq_u32 s44,15
 s_cselect_b32 s53,0,122880
 s_add_u32 s53,s53,s64
 v_mfma_f32_16x16x32_bf16 v[132:135],v[32:35],a[100:103],v[132:135]
 v_bfe_u32 v214,v12,4,1
 ds_read_b128 v[28:31],v1 offset:12288
 v_mfma_f32_16x16x32_bf16 v[112:115],v[36:39],a[104:107],v[112:115]
 ds_read_b128 v[32:35],v1 offset:18432
 v_mfma_f32_16x16x32_bf16 v[116:119],v[36:39],a[108:111],v[116:119]
 s_waitcnt lgkmcnt(13)
 buffer_load_dwordx4 a[224:227],v0,s[12:15],s53 offen sc1
 v_mfma_f32_16x16x32_bf16 v[120:123],v[40:43],a[104:107],v[120:123]
 ds_read_b128 v[36:39],v1 offset:19456
 v_mfma_f32_16x16x32_bf16 v[124:127],v[40:43],a[108:111],v[124:127]
 v_mfma_f32_16x16x32_bf16 v[128:131],v[44:47],a[104:107],v[128:131]
 v_mfma_f32_16x16x32_bf16 v[132:135],v[44:47],a[108:111],v[132:135]
 s_waitcnt vmcnt(41) lgkmcnt(12)
 buffer_load_dwordx4 a[228:231],v0,s[12:15],s53 offen offset:1024 sc1
 v_mfma_f32_16x16x32_bf16 v[112:115],v[48:51],a[112:115],v[112:115]
 v_lshlrev_b32 v214,5,v214
 v_mfma_f32_16x16x32_bf16 v[116:119],v[48:51],a[116:119],v[116:119]
 v_mfma_f32_16x16x32_bf16 v[120:123],v[52:55],a[112:115],v[120:123]
 v_mfma_f32_16x16x32_bf16 v[124:127],v[52:55],a[116:119],v[124:127]
 s_waitcnt vmcnt(40) lgkmcnt(10)
 buffer_load_dwordx4 a[232:235],v0,s[12:15],s53 offen offset:2048 sc1
 v_mfma_f32_16x16x32_bf16 v[128:131],v[56:59],a[112:115],v[128:131]
 s_waitcnt vmcnt(34) lgkmcnt(0)
 s_barrier
 ds_read_b128 v[40:43],v1 offset:20480
 ds_read_b128 v[44:47],v1 offset:27648
 v_mfma_f32_16x16x32_bf16 v[132:135],v[56:59],a[116:119],v[132:135]
 v_lshrrev_b32 v215,5,v12
 ds_read_b128 v[48:51],v1 offset:34816
 v_mfma_f32_16x16x32_bf16 v[112:115],v[60:63],a[120:123],v[112:115]
 ds_read_b128 v[52:55],v1 offset:41984
 ds_read_b128 v[56:59],v1 offset:21504
 v_mfma_f32_16x16x32_bf16 v[116:119],v[60:63],a[124:127],v[116:119]
 buffer_load_dwordx4 a[236:239],v0,s[12:15],s53 offen offset:3072 sc1
 v_mfma_f32_16x16x32_bf16 v[120:123],v[64:67],a[120:123],v[120:123]
 s_add_u32 s53,s53,4096
 ds_read_b128 v[60:63],v1 offset:22528
 v_mfma_f32_16x16x32_bf16 v[124:127],v[64:67],a[124:127],v[124:127]
 ds_read_b128 v[64:67],v1 offset:23552
 v_mfma_f32_16x16x32_bf16 v[128:131],v[68:71],a[120:123],v[128:131]
 v_mfma_f32_16x16x32_bf16 v[132:135],v[68:71],a[124:127],v[132:135]
 s_waitcnt vmcnt(33)
 buffer_load_dwordx4 a[240:243],v0,s[12:15],s53 offen sc1
 v_mfma_f32_16x16x32_bf16 v[112:115],v[72:75],a[128:131],v[112:115]
 v_lshl_add_u32 v214,v215,4,v214
 ds_read_b128 v[68:71],v1 offset:28672
 v_mfma_f32_16x16x32_bf16 v[116:119],v[72:75],a[132:135],v[116:119]
 ds_read_b128 v[72:75],v1 offset:29696
 v_mfma_f32_16x16x32_bf16 v[120:123],v[76:79],a[128:131],v[120:123]
 v_mfma_f32_16x16x32_bf16 v[124:127],v[76:79],a[132:135],v[124:127]
 s_waitcnt vmcnt(32)
 ds_read_b128 v[76:79],v1 offset:30720
 v_mfma_f32_16x16x32_bf16 v[112:115],v[16:19],a[136:139],v[112:115]
 buffer_load_dwordx4 a[244:247],v0,s[12:15],s53 offen offset:1024 sc1
 v_mfma_f32_16x16x32_bf16 v[116:119],v[16:19],a[140:143],v[116:119]
 ds_read_b128 v[16:19],v1 offset:35840
 v_mfma_f32_16x16x32_bf16 v[120:123],v[20:23],a[136:139],v[120:123]
 s_lshl_b32 s3,s47,5
 v_mfma_f32_16x16x32_bf16 v[124:127],v[20:23],a[140:143],v[124:127]
 s_waitcnt vmcnt(31)
 ds_read_b128 v[20:23],v1 offset:36864
 v_mfma_f32_16x16x32_bf16 v[112:115],v[24:27],a[144:147],v[112:115]
 buffer_load_dwordx4 a[248:251],v0,s[12:15],s53 offen offset:2048 sc1
 v_mfma_f32_16x16x32_bf16 v[116:119],v[24:27],a[148:151],v[116:119]
 s_branch .Lsk17
.Lvs3_2:
 s_branch .Lvb3
.Lsk17:
 ds_read_b128 v[24:27],v1 offset:37888
 v_mfma_f32_16x16x32_bf16 v[120:123],v[28:31],a[144:147],v[120:123]
 v_mfma_f32_16x16x32_bf16 v[124:127],v[28:31],a[148:151],v[124:127]
 s_waitcnt vmcnt(30)
 ds_read_b128 v[28:31],v1 offset:43008
 v_mfma_f32_16x16x32_bf16 v[112:115],v[32:35],a[152:155],v[112:115]
 buffer_load_dwordx4 a[252:255],v0,s[12:15],s53 offen offset:3072 sc1
 v_mfma_f32_16x16x32_bf16 v[116:119],v[32:35],a[156:159],v[116:119]
 s_mov_b32 s53,s57
 v_add_lshl_u32 v215,v13,s3,11
 ds_read_b128 v[32:35],v1 offset:44032
 v_mfma_f32_16x16x32_bf16 v[120:123],v[36:39],a[152:155],v[120:123]
 v_mfma_f32_16x16x32_bf16 v[124:127],v[36:39],a[156:159],v[124:127]
 s_waitcnt lgkmcnt(13)
 ds_read_b128 v[36:39],v1 offset:45056
 v_mfma_f32_16x16x32_bf16 v[128:131],v[40:43],a[128:131],v[128:131]
 buffer_load_dwordx4 v0,s[12:15],s50 offen sc1 lds
 v_mfma_f32_16x16x32_bf16 v[132:135],v[40:43],a[132:135],v[132:135]
 ds_read_b128 v[40:43],v1 offset:24576
 v_mfma_f32_16x16x32_bf16 v[128:131],v[44:47],a[136:139],v[128:131]
 s_lshl_b32 s3,s45,7
 v_mfma_f32_16x16x32_bf16 v[132:135],v[44:47],a[140:143],v[132:135]
 s_waitcnt lgkmcnt(13)
 ds_read_b128 v[44:47],v1 offset:25600
 v_mfma_f32_16x16x32_bf16 v[128:131],v[48:51],a[144:147],v[128:131]
 buffer_load_dwordx4 v0,s[12:15],s50 offen offset:1024 sc1 lds
 v_mfma_f32_16x16x32_bf16 v[132:135],v[48:51],a[148:151],v[132:135]
 ds_read_b128 v[48:51],v1 offset:26624
 v_mfma_f32_16x16x32_bf16 v[128:131],v[52:55],a[152:155],v[128:131]
 v_mfma_f32_16x16x32_bf16 v[132:135],v[52:55],a[156:159],v[132:135]
 s_waitcnt vmcnt(31) lgkmcnt(13)
 ds_read_b128 v[52:55],v1 offset:31744
 v_mfma_f32_16x16x32_bf16 v[112:115],v[56:59],a[160:163],v[112:115]
 buffer_load_dwordx4 v0,s[12:15],s50 offen offset:2048 sc1 lds
 v_mfma_f32_16x16x32_bf16 v[116:119],v[56:59],a[164:167],v[116:119]
 v_add3_u32 v214,v214,v215,s3
 ds_read_b128 v[56:59],v1 offset:32768
 v_mfma_f32_16x16x32_bf16 v[120:123],v[60:63],a[160:163],v[120:123]
 v_mfma_f32_16x16x32_bf16 v[124:127],v[60:63],a[164:167],v[124:127]
 s_waitcnt vmcnt(30) lgkmcnt(13)
 ds_read_b128 v[60:63],v1 offset:33792
 v_mfma_f32_16x16x32_bf16 v[128:131],v[64:67],a[160:163],v[128:131]
 buffer_load_dwordx4 v0,s[12:15],s50 offen offset:3072 sc1 lds
 v_mfma_f32_16x16x32_bf16 v[132:135],v[64:67],a[164:167],v[132:135]
 s_cmp_eq_u32 s44,10
 s_cselect_b32 s50,0,286720
 s_add_u32 s50,s50,s66
 v_mfma_f32_16x16x32_bf16 v[112:115],v[68:71],a[168:171],v[112:115]
 s_add_u32 m0,s54,32768
 ds_read_b128 v[64:67],v1 offset:38912
 v_mfma_f32_16x16x32_bf16 v[116:119],v[68:71],a[172:175],v[116:119]
 s_mul_i32 s69,s45,3
 ds_read_b128 v[68:71],v1 offset:39936
 s_waitcnt lgkmcnt(14)
 v_mfma_f32_16x16x32_bf16 v[120:123],v[72:75],a[168:171],v[120:123]
 buffer_load_dwordx4 v0,s[12:15],s50 offen sc1 lds
 v_mfma_f32_16x16x32_bf16 v[124:127],v[72:75],a[172:175],v[124:127]
 ds_read_b128 v[72:75],v1 offset:40960
 v_mfma_f32_16x16x32_bf16 v[128:131],v[76:79],a[168:171],v[128:131]
 v_mfma_f32_16x16x32_bf16 v[132:135],v[76:79],a[172:175],v[132:135]
 s_waitcnt vmcnt(30) lgkmcnt(13)
 ds_read_b128 v[76:79],v1 offset:46080
 v_mfma_f32_16x16x32_bf16 v[112:115],v[16:19],a[176:179],v[112:115]
 buffer_load_dwordx4 v0,s[12:15],s50 offen offset:1024 sc1 lds
 v_mfma_f32_16x16x32_bf16 v[116:119],v[16:19],a[180:183],v[116:119]
 s_add_u32 s69,s69,1
 ds_read_b128 v[16:19],v1 offset:47104
 v_mfma_f32_16x16x32_bf16 v[120:123],v[20:23],a[176:179],v[120:123]
 v_mfma_f32_16x16x32_bf16 v[124:127],v[20:23],a[180:183],v[124:127]
 s_waitcnt vmcnt(29) lgkmcnt(13)
 ds_read_b128 v[20:23],v1 offset:48128
 v_mfma_f32_16x16x32_bf16 v[128:131],v[24:27],a[176:179],v[128:131]
 buffer_load_dwordx4 v0,s[12:15],s50 offen offset:2048 sc1 lds
 v_mfma_f32_16x16x32_bf16 v[132:135],v[24:27],a[180:183],v[132:135]
 s_cmp_eq_u32 s44,10
 s_cselect_b32 s50,0,286720
 s_add_u32 s50,s50,s66
 v_mfma_f32_16x16x32_bf16 v[112:115],v[28:31],a[184:187],v[112:115]
 s_add_u32 s50,s50,3072
 s_add_u32 m0,s54,57344
 v_mfma_f32_16x16x32_bf16 v[116:119],v[28:31],a[188:191],v[116:119]
 s_lshr_b32 s69,s69,1
 s_waitcnt lgkmcnt(12)
 v_mfma_f32_16x16x32_bf16 v[120:123],v[32:35],a[184:187],v[120:123]
 s_cmp_eq_u32 s69,1
 s_cselect_b32 s53,s68,s65
 s_add_u32 s65,s65,2048
 v_mfma_f32_16x16x32_bf16 v[124:127],v[32:35],a[188:191],v[124:127]
 buffer_load_dwordx4 v[244:247],v14,s[12:15],s51 offen sc1
 v_mfma_f32_16x16x32_bf16 v[128:131],v[36:39],a[184:187],v[128:131]
 s_mov_b32 s51,196608
 v_mfma_f32_16x16x32_bf16 v[132:135],v[36:39],a[188:191],v[132:135]
 s_waitcnt vmcnt(22) lgkmcnt(0)
 s_barrier
 ds_read_b128 v[24:27],v0
 v_mfma_f32_16x16x32_bf16 v[112:115],v[40:43],a[192:195],v[112:115]
 ds_read_b128 v[28:31],v0 offset:1024
 ds_read_b128 v[32:35],v0 offset:2048
 v_mfma_f32_16x16x32_bf16 v[116:119],v[40:43],a[196:199],v[116:119]
 s_movk_i32 s52,8192
 buffer_load_dwordx4 v[240:243],v14,s[12:15],s51 offen sc1
 v_mfma_f32_16x16x32_bf16 v[120:123],v[44:47],a[192:195],v[120:123]
 s_mov_b32 s51,200704
 ds_read_b128 v[36:39],v0 offset:7168
 ds_read_b128 v[40:43],v0 offset:8192
 v_mfma_f32_16x16x32_bf16 v[124:127],v[44:47],a[196:199],v[124:127]
 s_waitcnt vmcnt(21)
 ds_read_b128 v[44:47],v0 offset:9216
 v_mfma_f32_16x16x32_bf16 v[128:131],v[48:51],a[192:195],v[128:131]
 v_mfma_f32_16x16x32_bf16 v[132:135],v[48:51],a[196:199],v[132:135]
 buffer_load_dwordx4 v[236:239],v14,s[12:15],s51 offen sc1
 v_mfma_f32_16x16x32_bf16 v[112:115],v[52:55],a[200:203],v[112:115]
 s_mov_b32 s51,204800
 ds_read_b128 v[48:51],v0 offset:14336
 v_mfma_f32_16x16x32_bf16 v[116:119],v[52:55],a[204:207],v[116:119]
 ds_read_b128 v[52:55],v0 offset:15360
 v_mfma_f32_16x16x32_bf16 v[120:123],v[56:59],a[200:203],v[120:123]
 v_mfma_f32_16x16x32_bf16 v[124:127],v[56:59],a[204:207],v[124:127]
 buffer_load_dwordx4 v[232:235],v14,s[12:15],s51 offen sc1
 v_mfma_f32_16x16x32_bf16 v[128:131],v[60:63],a[200:203],v[128:131]
 s_mov_b32 s51,167936
 ds_read_b128 v[56:59],v0 offset:16384
 v_mfma_f32_16x16x32_bf16 v[132:135],v[60:63],a[204:207],v[132:135]
 s_waitcnt vmcnt(21)
 ds_read_b128 v[60:63],v0 offset:21504
 v_mfma_f32_16x16x32_bf16 v[112:115],v[64:67],a[208:211],v[112:115]
 v_mfma_f32_16x16x32_bf16 v[116:119],v[64:67],a[212:215],v[116:119]
 buffer_load_dwordx4 v0,s[12:15],s50 offen sc1 lds
 v_mfma_f32_16x16x32_bf16 v[120:123],v[68:71],a[208:211],v[120:123]
 s_cmp_eq_u32 s44,11
 s_cselect_b32 s50,0,315392
 s_add_u32 s50,s50,s66
 v_mfma_f32_16x16x32_bf16 v[124:127],v[68:71],a[212:215],v[124:127]
 s_add_u32 m0,s54,58368
 ds_read_b128 v[64:67],v0 offset:22528
 s_waitcnt vmcnt(20)
 v_mfma_f32_16x16x32_bf16 v[128:131],v[72:75],a[208:211],v[128:131]
 ds_read_b128 v[68:71],v0 offset:23552
 v_mfma_f32_16x16x32_bf16 v[132:135],v[72:75],a[212:215],v[132:135]
 buffer_load_dwordx4 v0,s[12:15],s50 offen sc1 lds
 v_mfma_f32_16x16x32_bf16 v[112:115],v[76:79],a[216:219],v[112:115]
 ds_read_b128 v[72:75],v0 offset:3072
 v_mfma_f32_16x16x32_bf16 v[116:119],v[76:79],a[220:223],v[116:119]
 ds_read_b128 v[76:79],v0 offset:4096
 v_mfma_f32_16x16x32_bf16 v[120:123],v[16:19],a[216:219],v[120:123]
 v_mfma_f32_16x16x32_bf16 v[124:127],v[16:19],a[220:223],v[124:127]
 buffer_load_dwordx4 v0,s[12:15],s50 offen offset:1024 sc1 lds
 v_mfma_f32_16x16x32_bf16 v[128:131],v[20:23],a[216:219],v[128:131]
 ds_read_b128 v[16:19],v0 offset:5120
 v_mfma_f32_16x16x32_bf16 v[132:135],v[20:23],a[220:223],v[132:135]
 s_waitcnt vmcnt(20) lgkmcnt(13)
 ds_read_b128 v[20:23],v0 offset:6144
 v_mfma_f32_16x16x32_bf16 v[112:115],v[24:27],a[224:227],v[112:115]
 v_mfma_f32_16x16x32_bf16 v[116:119],v[24:27],a[228:231],v[116:119]
 buffer_load_dwordx4 v0,s[12:15],s50 offen offset:2048 sc1 lds
 v_mfma_f32_16x16x32_bf16 v[120:123],v[28:31],a[224:227],v[120:123]
 ds_read_b128 v[24:27],v0 offset:10240
 v_mfma_f32_16x16x32_bf16 v[124:127],v[28:31],a[228:231],v[124:127]
 s_waitcnt vmcnt(19) lgkmcnt(13)
 ds_read_b128 v[28:31],v0 offset:11264
 v_mfma_f32_16x16x32_bf16 v[128:131],v[32:35],a[224:227],v[128:131]
 v_mfma_f32_16x16x32_bf16 v[132:135],v[32:35],a[228:231],v[132:135]
 buffer_load_dwordx4 v0,s[12:15],s50 offen offset:3072 sc1 lds
 v_mfma_f32_16x16x32_bf16 v[112:115],v[36:39],a[232:235],v[112:115]
 s_cmp_eq_u32 s44,12
 s_cselect_b32 s50,0,344064
 s_add_u32 s50,s50,s66
 v_mfma_f32_16x16x32_bf16 v[116:119],v[36:39],a[236:239],v[116:119]
 s_add_u32 s50,s50,2048
 s_add_u32 m0,s54,62464
 s_waitcnt lgkmcnt(12)
 v_mfma_f32_16x16x32_bf16 v[120:123],v[40:43],a[232:235],v[120:123]
 ds_read_b128 v[32:35],v0 offset:12288
 ds_read_b128 v[36:39],v0 offset:13312
 v_mfma_f32_16x16x32_bf16 v[124:127],v[40:43],a[236:239],v[124:127]
 buffer_load_dwordx4 v0,s[12:15],s50 offen sc1 lds
 v_mfma_f32_16x16x32_bf16 v[128:131],v[44:47],a[232:235],v[128:131]
 ds_read_b128 v[40:43],v0 offset:17408
 v_mfma_f32_16x16x32_bf16 v[132:135],v[44:47],a[236:239],v[132:135]
 s_waitcnt vmcnt(19) lgkmcnt(13)
 ds_read_b128 v[44:47],v0 offset:18432
 v_mfma_f32_16x16x32_bf16 v[112:115],v[48:51],a[240:243],v[112:115]
 v_mfma_f32_16x16x32_bf16 v[116:119],v[48:51],a[244:247],v[116:119]
 ds_read_b128 v[48:51],v0 offset:19456
 v_mfma_f32_16x16x32_bf16 v[120:123],v[52:55],a[240:243],v[120:123]
 buffer_load_dwordx4 v0,s[12:15],s50 offen offset:1024 sc1 lds
 v_mfma_f32_16x16x32_bf16 v[124:127],v[52:55],a[244:247],v[124:127]
 s_cmp_eq_u32 s44,13
 s_cselect_b32 s50,0,372736
 s_waitcnt vmcnt(18) lgkmcnt(13)
 v_mfma_f32_16x16x32_bf16 v[128:131],v[56:59],a[240:243],v[128:131]
 s_add_u32 s50,s50,s66
 s_add_u32 s50,s50,2048
 s_add_u32 m0,s54,86016
 v_mfma_f32_16x16x32_bf16 v[132:135],v[56:59],a[244:247],v[132:135]
 ds_read_b128 v[52:55],v0 offset:20480
 ds_read_b128 v[56:59],v0 offset:24576
 v_mfma_f32_16x16x32_bf16 v[112:115],v[60:63],a[248:251],v[112:115]
 buffer_load_dwordx4 v0,s[12:15],s50 offen sc1 lds
 v_mfma_f32_16x16x32_bf16 v[116:119],v[60:63],a[252:255],v[116:119]
 s_waitcnt lgkmcnt(13)
 ds_read_b128 v[60:63],v0 offset:25600
 v_mfma_f32_16x16x32_bf16 v[120:123],v[64:67],a[248:251],v[120:123]
 v_mfma_f32_16x16x32_bf16 v[124:127],v[64:67],a[252:255],v[124:127]
 ds_read_b128 v[64:67],v0 offset:26624
 v_mfma_f32_16x16x32_bf16 v[128:131],v[68:71],a[248:251],v[128:131]
 buffer_load_dwordx4 v0,s[12:15],s50 offen offset:1024 sc1 lds
 v_mfma_f32_16x16x32_bf16 v[132:135],v[68:71],a[252:255],v[132:135]
 s_cmp_eq_u32 s44,14
 s_cselect_b32 s50,0,401408
 s_waitcnt lgkmcnt(13)
 v_mfma_f32_16x16x32_bf16 v[80:83],v[72:75],a[0:3],v[80:83]
 s_add_u32 s50,s50,s66
 s_add_u32 s50,s50,2048
 s_add_u32 m0,s54,88064
 v_mfma_f32_16x16x32_bf16 v[84:87],v[72:75],a[4:7],v[84:87]
 v_mul_f32 v168,v168,v112
 v_mul_f32 v169,v169,v113
 v_mfma_f32_16x16x32_bf16 v[88:91],v[76:79],a[0:3],v[88:91]
 buffer_load_dwordx4 v0,s[12:15],s50 offen sc1 lds
 v_mfma_f32_16x16x32_bf16 v[92:95],v[76:79],a[4:7],v[92:95]
 s_waitcnt lgkmcnt(11)
 v_mul_f32 v170,v170,v114
 v_mul_f32 v171,v171,v115
 v_mfma_f32_16x16x32_bf16 v[96:99],v[16:19],a[0:3],v[96:99]
 v_mul_f32 v176,v176,v120
 v_mul_f32 v177,v177,v121
 v_mfma_f32_16x16x32_bf16 v[100:103],v[16:19],a[4:7],v[100:103]
 v_mul_f32 v178,v178,v122
 v_mul_f32 v179,v179,v123
 v_mfma_f32_16x16x32_bf16 v[104:107],v[20:23],a[0:3],v[104:107]
 buffer_load_dwordx4 v0,s[12:15],s50 offen offset:1024 sc1 lds
 v_mfma_f32_16x16x32_bf16 v[108:111],v[20:23],a[4:7],v[108:111]
 s_waitcnt lgkmcnt(9)
 v_cvt_pk_bf16_f32 v112,v168,v169
 v_cvt_pk_bf16_f32 v113,v170,v171
 v_mfma_f32_16x16x32_bf16 v[80:83],v[24:27],a[8:11],v[80:83]
 s_add_u32 m0,s54,90112
 v_cvt_pk_bf16_f32 v114,v176,v177
 v_cvt_pk_bf16_f32 v115,v178,v179
 v_mfma_f32_16x16x32_bf16 v[84:87],v[24:27],a[12:15],v[84:87]
 buffer_store_dwordx4 v[112:115],v0,s[12:15],s61 offen sc1
 v_mfma_f32_16x16x32_bf16 v[88:91],v[28:31],a[8:11],v[88:91]
 v_mul_f32 v172,v172,v116
 v_mul_f32 v173,v173,v117
 v_mfma_f32_16x16x32_bf16 v[92:95],v[28:31],a[12:15],v[92:95]
 s_waitcnt lgkmcnt(7)
 v_mul_f32 v174,v174,v118
 v_mul_f32 v175,v175,v119
 v_mfma_f32_16x16x32_bf16 v[96:99],v[32:35],a[8:11],v[96:99]
 v_mul_f32 v180,v180,v124
 ds_read_b128 v[68:71],v0 offset:27648
 v_mfma_f32_16x16x32_bf16 v[100:103],v[32:35],a[12:15],v[100:103]
 v_mul_f32 v181,v181,v125
 v_mul_f32 v182,v182,v126
 v_mfma_f32_16x16x32_bf16 v[104:107],v[36:39],a[8:11],v[104:107]
 v_mul_f32 v183,v183,v127
 v_cvt_pk_bf16_f32 v116,v172,v173
 v_mfma_f32_16x16x32_bf16 v[108:111],v[36:39],a[12:15],v[108:111]
 s_waitcnt lgkmcnt(6)
 v_cvt_pk_bf16_f32 v117,v174,v175
 v_cvt_pk_bf16_f32 v118,v180,v181
 v_mfma_f32_16x16x32_bf16 v[80:83],v[40:43],a[16:19],v[80:83]
 v_cvt_pk_bf16_f32 v119,v182,v183
 v_mul_f32 v184,v184,v128
 v_mfma_f32_16x16x32_bf16 v[84:87],v[40:43],a[20:23],v[84:87]
 buffer_store_dwordx4 v[116:119],v0,s[12:15],s61 offen offset:1024 sc1
 v_mfma_f32_16x16x32_bf16 v[88:91],v[44:47],a[16:19],v[88:91]
 v_mul_f32 v185,v185,v129
 v_mul_f32 v186,v186,v130
 v_mfma_f32_16x16x32_bf16 v[92:95],v[44:47],a[20:23],v[92:95]
 s_waitcnt lgkmcnt(4)
 v_mul_f32 v187,v187,v131
 v_mul_f32 v188,v188,v132
 v_mfma_f32_16x16x32_bf16 v[96:99],v[48:51],a[16:19],v[96:99]
 s_waitcnt vmcnt(17) lgkmcnt(0)
 s_barrier
 ds_read_b128 v[72:75],v0 offset:28672
 ds_read_b128 v[76:79],v0 offset:29696
 v_mfma_f32_16x16x32_bf16 v[100:103],v[48:51],a[20:23],v[100:103]
 v_mul_f32 v189,v189,v133
 v_mul_f32 v190,v190,v134
 v_mfma_f32_16x16x32_bf16 v[104:107],v[52:55],a[16:19],v[104:107]
 s_cmp_eq_u32 s44,15
 s_cselect_b32 s50,0,430080
 s_add_u32 s50,s50,s66
 v_mfma_f32_16x16x32_bf16 v[108:111],v[52:55],a[20:23],v[108:111]
 s_add_u32 s50,s50,2048
 v_mul_f32 v191,v191,v135
 v_mfma_f32_16x16x32_bf16 v[80:83],v[56:59],a[24:27],v[80:83]
 buffer_load_dwordx4 v0,s[12:15],s50 offen sc1 lds
 v_mfma_f32_16x16x32_bf16 v[84:87],v[56:59],a[28:31],v[84:87]
 v_cvt_pk_bf16_f32 v128,v184,v185
 v_cvt_pk_bf16_f32 v129,v186,v187
 v_mfma_f32_16x16x32_bf16 v[88:91],v[60:63],a[24:27],v[88:91]
 v_cvt_pk_bf16_f32 v130,v188,v189
 ds_read_b128 v[16:19],v0 offset:30720
 v_mfma_f32_16x16x32_bf16 v[92:95],v[60:63],a[28:31],v[92:95]
 ds_read_b128 v[20:23],v0 offset:31744
 v_cvt_pk_bf16_f32 v131,v190,v191
 v_mfma_f32_16x16x32_bf16 v[96:99],v[64:67],a[24:27],v[96:99]
 v_permlane32_swap_b32 v128,v130
 v_permlane32_swap_b32 v129,v131
 v_mfma_f32_16x16x32_bf16 v[100:103],v[64:67],a[28:31],v[100:103]
 buffer_store_dwordx4 v[128:131],v253,s[12:15],s58 offen sc1
 v_mfma_f32_16x16x32_bf16 v[104:107],v[68:71],a[24:27],v[104:107]
 ds_read_b128 v[24:27],v0 offset:35840
 ds_read_b128 v[28:31],v0 offset:36864
 v_mfma_f32_16x16x32_bf16 v[108:111],v[68:71],a[28:31],v[108:111]
 s_waitcnt lgkmcnt(4)
 ds_read_b128 v[32:35],v0 offset:37888
 ds_read_b128 v[36:39],v0 offset:38912
 v_mfma_f32_16x16x32_bf16 v[80:83],v[72:75],a[32:35],v[80:83]
 ds_read_b128 v[40:43],v0 offset:43008
 ds_read_b128 v[44:47],v0 offset:44032
 v_mfma_f32_16x16x32_bf16 v[84:87],v[72:75],a[36:39],v[84:87]
 ds_read_b128 v[48:51],v0 offset:45056
 ds_read_b128 v[52:55],v0 offset:46080
 v_mfma_f32_16x16x32_bf16 v[88:91],v[76:79],a[32:35],v[88:91]
 buffer_load_dwordx4 v0,s[12:15],s50 offen offset:1024 sc1 lds
 v_mfma_f32_16x16x32_bf16 v[92:95],v[76:79],a[36:39],v[92:95]
 s_cmp_eq_u32 s44,12
 s_cselect_b32 s50,0,344064
 s_waitcnt lgkmcnt(8)
 v_mfma_f32_16x16x32_bf16 v[96:99],v[16:19],a[32:35],v[96:99]
 s_add_u32 s50,s50,s66
 s_add_u32 m0,s54,92160
 ds_read_b128 v[56:59],v0 offset:50176
 v_mfma_f32_16x16x32_bf16 v[100:103],v[16:19],a[36:39],v[100:103]
 ds_read_b128 v[60:63],v0 offset:51200
 ds_read_b128 v[64:67],v0 offset:52224
 v_mfma_f32_16x16x32_bf16 v[104:107],v[20:23],a[32:35],v[104:107]
 buffer_load_dwordx4 v0,s[12:15],s50 offen sc1 lds
 v_mfma_f32_16x16x32_bf16 v[108:111],v[20:23],a[36:39],v[108:111]
 s_cmp_eq_u32 s44,12
 s_cselect_b32 s50,0,344064
 s_waitcnt lgkmcnt(9)
 v_mfma_f32_16x16x32_bf16 v[80:83],v[24:27],a[40:43],v[80:83]
 s_add_u32 s50,s50,s66
 s_add_u32 s50,s50,1024
 s_add_u32 m0,s54,0
 v_mfma_f32_16x16x32_bf16 v[84:87],v[24:27],a[44:47],v[84:87]
 ds_read_b128 v[68:71],v0 offset:53248
 ds_read_b128 v[72:75],v0 offset:32768
 v_mfma_f32_16x16x32_bf16 v[88:91],v[28:31],a[40:43],v[88:91]
 buffer_load_dwordx4 v0,s[12:15],s50 offen sc1 lds
 v_mfma_f32_16x16x32_bf16 v[92:95],v[28:31],a[44:47],v[92:95]
 s_cmp_eq_u32 s44,13
 s_cselect_b32 s50,0,372736
 s_waitcnt lgkmcnt(9)
 v_mfma_f32_16x16x32_bf16 v[96:99],v[32:35],a[40:43],v[96:99]
 s_add_u32 s50,s50,s66
 s_add_u32 m0,s54,1024
 ds_read_b128 v[76:79],v0 offset:33792
 v_mfma_f32_16x16x32_bf16 v[100:103],v[32:35],a[44:47],v[100:103]
 ds_read_b128 v[16:19],v0 offset:34816
 ds_read_b128 v[20:23],v0 offset:39936
 v_mfma_f32_16x16x32_bf16 v[104:107],v[36:39],a[40:43],v[104:107]
 buffer_load_dwordx4 v0,s[12:15],s50 offen sc1 lds
 v_mfma_f32_16x16x32_bf16 v[108:111],v[36:39],a[44:47],v[108:111]
 s_waitcnt lgkmcnt(10)
 ds_read_b128 v[24:27],v0 offset:40960
 ds_read_b128 v[28:31],v0 offset:41984
 v_mfma_f32_16x16x32_bf16 v[80:83],v[40:43],a[48:51],v[80:83]
 ds_read_b128 v[32:35],v0 offset:47104
 ds_read_b128 v[36:39],v0 offset:48128
 v_mfma_f32_16x16x32_bf16 v[84:87],v[40:43],a[52:55],v[84:87]
 ds_read_b128 v[40:43],v0 offset:49152
 v_mfma_f32_16x16x32_bf16 v[88:91],v[44:47],a[48:51],v[88:91]
 buffer_load_dwordx4 v0,s[12:15],s50 offen offset:1024 sc1 lds
 v_mfma_f32_16x16x32_bf16 v[92:95],v[44:47],a[52:55],v[92:95]
 s_cmp_eq_u32 s44,14
 s_cselect_b32 s50,0,401408
 s_waitcnt lgkmcnt(13)
 v_mfma_f32_16x16x32_bf16 v[96:99],v[48:51],a[48:51],v[96:99]
 s_add_u32 s50,s50,s66
 s_add_u32 m0,s54,3072
 ds_read_b128 v[44:47],v0 offset:54272
 v_mfma_f32_16x16x32_bf16 v[100:103],v[48:51],a[52:55],v[100:103]
 ds_read_b128 v[48:51],v0 offset:55296
 v_mfma_f32_16x16x32_bf16 v[104:107],v[52:55],a[48:51],v[104:107]
 buffer_load_dwordx4 v0,s[12:15],s50 offen sc1 lds
 v_mfma_f32_16x16x32_bf16 v[108:111],v[52:55],a[52:55],v[108:111]
 s_waitcnt lgkmcnt(13)
 ds_read_b128 v[52:55],v0 offset:56320
 v_mfma_f32_16x16x32_bf16 v[80:83],v[56:59],a[56:59],v[80:83]
 v_mfma_f32_16x16x32_bf16 v[84:87],v[56:59],a[60:63],v[84:87]
 v_mfma_f32_16x16x32_bf16 v[88:91],v[60:63],a[56:59],v[88:91]
 buffer_load_dwordx4 v0,s[12:15],s50 offen offset:1024 sc1 lds
 v_mfma_f32_16x16x32_bf16 v[92:95],v[60:63],a[60:63],v[92:95]
 s_cmp_eq_u32 s44,15
 s_cselect_b32 s50,0,430080
 s_waitcnt lgkmcnt(12)
 v_mfma_f32_16x16x32_bf16 v[96:99],v[64:67],a[56:59],v[96:99]
 s_add_u32 s50,s50,s66
 s_add_u32 m0,s54,5120
 v_lshlrev_b32 v168,16,v220
 v_mfma_f32_16x16x32_bf16 v[100:103],v[64:67],a[60:63],v[100:103]
 v_mfma_f32_16x16x32_bf16 v[104:107],v[68:71],a[56:59],v[104:107]
 buffer_load_dwordx4 v0,s[12:15],s50 offen sc1 lds
 v_mfma_f32_16x16x32_bf16 v[108:111],v[68:71],a[60:63],v[108:111]
 s_waitcnt vmcnt(16) lgkmcnt(0)
 v_and_b32 v169,0xffff0000,v220
 s_barrier
 v_mfma_f32_16x16x32_bf16 v[80:83],v[72:75],a[64:67],v[80:83]
 v_lshlrev_b32 v170,16,v221
 ds_read_b128 v[56:59],v0 offset:57344
 v_mfma_f32_16x16x32_bf16 v[84:87],v[72:75],a[68:71],v[84:87]
 ds_read_b128 v[60:63],v0 offset:64512
 ds_read_b128 v[64:67],v1 offset:6144
 v_mfma_f32_16x16x32_bf16 v[88:91],v[76:79],a[64:67],v[88:91]
 buffer_load_dwordx4 v0,s[12:15],s50 offen offset:1024 sc1 lds
 v_mfma_f32_16x16x32_bf16 v[92:95],v[76:79],a[68:71],v[92:95]
 v_and_b32 v171,0xffff0000,v221
 s_add_u32 m0,s55,28672
 v_mfma_f32_16x16x32_bf16 v[96:99],v[16:19],a[64:67],v[96:99]
 ds_read_b128 v[68:71],v1 offset:13312
 ds_read_b128 v[72:75],v0 offset:58368
 v_mfma_f32_16x16x32_bf16 v[100:103],v[16:19],a[68:71],v[100:103]
 v_lshlrev_b32 v172,16,v222
 ds_read_b128 v[76:79],v0 offset:59392
 v_mfma_f32_16x16x32_bf16 v[80:83],v[20:23],a[72:75],v[80:83]
 ds_read_b128 v[16:19],v0 offset:60416
 v_mfma_f32_16x16x32_bf16 v[84:87],v[20:23],a[76:79],v[84:87]
 buffer_load_dwordx4 v14,s[12:15],s49 offen sc1 lds
 v_mfma_f32_16x16x32_bf16 v[88:91],v[24:27],a[72:75],v[88:91]
 s_mov_b32 s49,49152
 v_and_b32 v173,0xffff0000,v222
 s_add_u32 m0,s55,32768
 v_mfma_f32_16x16x32_bf16 v[92:95],v[24:27],a[76:79],v[92:95]
 ds_read_b128 v[20:23],v0 offset:61440
 ds_read_b128 v[24:27],v1
 v_mfma_f32_16x16x32_bf16 v[96:99],v[28:31],a[72:75],v[96:99]
 v_lshlrev_b32 v174,16,v223
 v_mfma_f32_16x16x32_bf16 v[100:103],v[28:31],a[76:79],v[100:103]
 buffer_load_dwordx4 v14,s[12:15],s49 offen sc1 lds
 v_mfma_f32_16x16x32_bf16 v[80:83],v[32:35],a[80:83],v[80:83]
 s_mov_b32 s49,53248
 s_add_u32 m0,s55,36864
 ds_read_b128 v[28:31],v1 offset:1024
 v_mfma_f32_16x16x32_bf16 v[84:87],v[32:35],a[84:87],v[84:87]
 v_and_b32 v175,0xffff0000,v223
 ds_read_b128 v[32:35],v1 offset:2048
 v_mfma_f32_16x16x32_bf16 v[88:91],v[36:39],a[80:83],v[88:91]
 v_mfma_f32_16x16x32_bf16 v[92:95],v[36:39],a[84:87],v[92:95]
 v_lshlrev_b32 v176,16,v224
 ds_read_b128 v[36:39],v1 offset:3072
 v_mfma_f32_16x16x32_bf16 v[96:99],v[40:43],a[80:83],v[96:99]
 s_waitcnt vmcnt(11)
 buffer_atomic_add v6,v3,s[12:15],0 offen offset:36 sc1
 v_mfma_f32_16x16x32_bf16 v[100:103],v[40:43],a[84:87],v[100:103]
 v_and_b32 v177,0xffff0000,v224
 ds_read_b128 v[40:43],v1 offset:7168
 v_mfma_f32_16x16x32_bf16 v[80:83],v[44:47],a[88:91],v[80:83]
 v_mfma_f32_16x16x32_bf16 v[84:87],v[44:47],a[92:95],v[84:87]
 ds_read_b128 v[44:47],v1 offset:8192
 v_mfma_f32_16x16x32_bf16 v[88:91],v[48:51],a[88:91],v[88:91]
 buffer_load_dwordx4 v14,s[12:15],s49 offen sc1 lds
 v_mfma_f32_16x16x32_bf16 v[92:95],v[48:51],a[92:95],v[92:95]
 s_mov_b32 s49,57344
 v_lshlrev_b32 v178,16,v225
 s_add_u32 m0,s55,40960
 v_mfma_f32_16x16x32_bf16 v[96:99],v[52:55],a[88:91],v[96:99]
 v_and_b32 v179,0xffff0000,v225
 ds_read_b128 v[48:51],v1 offset:9216
 v_mfma_f32_16x16x32_bf16 v[100:103],v[52:55],a[92:95],v[100:103]
 s_waitcnt lgkmcnt(13)
 ds_read_b128 v[52:55],v1 offset:10240
 v_mfma_f32_16x16x32_bf16 v[104:107],v[56:59],a[64:67],v[104:107]
 buffer_load_dwordx4 v14,s[12:15],s49 offen sc1 lds
 v_mfma_f32_16x16x32_bf16 v[108:111],v[56:59],a[68:71],v[108:111]
 s_mov_b32 s49,61440
 v_lshlrev_b32 v180,16,v226
 s_add_u32 m0,s55,45056
 v_mfma_f32_16x16x32_bf16 v[104:107],v[60:63],a[72:75],v[104:107]
 ds_read_b128 v[56:59],v1 offset:14336
 v_mfma_f32_16x16x32_bf16 v[108:111],v[60:63],a[76:79],v[108:111]
 s_waitcnt lgkmcnt(13)
 v_and_b32 v181,0xffff0000,v226
 ds_read_b128 v[60:63],v1 offset:15360
 v_mfma_f32_16x16x32_bf16 v[104:107],v[64:67],a[80:83],v[104:107]
 buffer_load_dwordx4 v14,s[12:15],s49 offen sc1 lds
 v_mfma_f32_16x16x32_bf16 v[108:111],v[64:67],a[84:87],v[108:111]
 s_mov_b32 s49,65536
 s_add_u32 m0,s55,49152
 ds_read_b128 v[64:67],v1 offset:16384
 v_mfma_f32_16x16x32_bf16 v[104:107],v[68:71],a[88:91],v[104:107]
 v_lshlrev_b32 v182,16,v227
 v_mfma_f32_16x16x32_bf16 v[108:111],v[68:71],a[92:95],v[108:111]
 s_waitcnt lgkmcnt(13)
 ds_read_b128 v[68:71],v1 offset:17408
 v_mfma_f32_16x16x32_bf16 v[80:83],v[72:75],a[96:99],v[80:83]
 buffer_load_dwordx4 v14,s[12:15],s49 offen sc1 lds
 v_mfma_f32_16x16x32_bf16 v[84:87],v[72:75],a[100:103],v[84:87]
 s_mov_b32 s49,69632
 v_and_b32 v183,0xffff0000,v227
 s_add_u32 m0,s55,53248
 v_mfma_f32_16x16x32_bf16 v[88:91],v[76:79],a[96:99],v[88:91]
 ds_read_b128 v[72:75],v0 offset:62464
 v_mfma_f32_16x16x32_bf16 v[92:95],v[76:79],a[100:103],v[92:95]
 s_waitcnt lgkmcnt(13)
 v_lshlrev_b32 v184,16,v228
 ds_read_b128 v[76:79],v0 offset:63488
 v_mfma_f32_16x16x32_bf16 v[96:99],v[16:19],a[96:99],v[96:99]
 buffer_load_dwordx4 v14,s[12:15],s49 offen sc1 lds
 v_mfma_f32_16x16x32_bf16 v[100:103],v[16:19],a[100:103],v[100:103]
 s_mov_b32 s49,73728
 v_and_b32 v185,0xffff0000,v228
 ds_read_b128 v[16:19],v1 offset:4096
 v_mfma_f32_16x16x32_bf16 v[104:107],v[20:23],a[96:99],v[104:107]
 s_add_u32 m0,s55,57344
 v_mfma_f32_16x16x32_bf16 v[108:111],v[20:23],a[100:103],v[108:111]
 s_waitcnt lgkmcnt(13)
 v_lshlrev_b32 v186,16,v229
 ds_read_b128 v[20:23],v1 offset:5120
 v_mfma_f32_16x16x32_bf16 v[80:83],v[24:27],a[104:107],v[80:83]
 buffer_load_dwordx4 a[0:3],v14,s[12:15],s51 offen sc1
 v_mfma_f32_16x16x32_bf16 v[84:87],v[24:27],a[108:111],v[84:87]
 s_mov_b32 s51,172032
 ds_read_b128 v[24:27],v1 offset:11264
 v_mfma_f32_16x16x32_bf16 v[88:91],v[28:31],a[104:107],v[88:91]
 v_and_b32 v187,0xffff0000,v229
 v_mfma_f32_16x16x32_bf16 v[92:95],v[28:31],a[108:111],v[92:95]
 s_waitcnt lgkmcnt(13)
 ds_read_b128 v[28:31],v1 offset:12288
 v_mfma_f32_16x16x32_bf16 v[96:99],v[32:35],a[104:107],v[96:99]
 buffer_load_dwordx4 a[4:7],v14,s[12:15],s51 offen sc1
 v_mfma_f32_16x16x32_bf16 v[100:103],v[32:35],a[108:111],v[100:103]
 s_mov_b32 s51,176128
 v_lshlrev_b32 v188,16,v230
 ds_read_b128 v[32:35],v1 offset:18432
 v_mfma_f32_16x16x32_bf16 v[104:107],v[36:39],a[104:107],v[104:107]
 v_mfma_f32_16x16x32_bf16 v[108:111],v[36:39],a[108:111],v[108:111]
 s_waitcnt lgkmcnt(13)
 ds_read_b128 v[36:39],v1 offset:19456
 v_and_b32 v189,0xffff0000,v230
 v_mfma_f32_16x16x32_bf16 v[80:83],v[40:43],a[112:115],v[80:83]
 buffer_load_dwordx4 a[8:11],v14,s[12:15],s51 offen sc1
 v_mfma_f32_16x16x32_bf16 v[84:87],v[40:43],a[116:119],v[84:87]
 s_mov_b32 s51,180224
 v_lshlrev_b32 v190,16,v231
 v_mfma_f32_16x16x32_bf16 v[88:91],v[44:47],a[112:115],v[88:91]
 v_mfma_f32_16x16x32_bf16 v[92:95],v[44:47],a[116:119],v[92:95]
 s_waitcnt lgkmcnt(12)
 v_mfma_f32_16x16x32_bf16 v[96:99],v[48:51],a[112:115],v[96:99]
 buffer_load_dwordx4 a[12:15],v14,s[12:15],s51 offen sc1
 v_mfma_f32_16x16x32_bf16 v[100:103],v[48:51],a[116:119],v[100:103]
 s_mov_b32 s51,184320
 v_and_b32 v191,0xffff0000,v231
 v_mfma_f32_16x16x32_bf16 v[104:107],v[52:55],a[112:115],v[104:107]
 v_lshrrev_b32 v121,2,v12
 v_mfma_f32_16x16x32_bf16 v[108:111],v[52:55],a[116:119],v[108:111]
 s_waitcnt vmcnt(19) lgkmcnt(0)
 s_barrier
 ds_read_b128 v[40:43],v1 offset:20480
 v_mfma_f32_16x16x32_bf16 v[80:83],v[56:59],a[120:123],v[80:83]
 v_lshlrev_b32 v120,7,v121
 ds_read_b128 v[44:47],v1 offset:21504
 v_mfma_f32_16x16x32_bf16 v[84:87],v[56:59],a[124:127],v[84:87]
 buffer_load_dwordx4 v14,s[12:15],s49 offen sc1 lds
 v_mfma_f32_16x16x32_bf16 v[88:91],v[60:63],a[120:123],v[88:91]
 s_mov_b32 s49,77824
 s_add_u32 m0,s55,61440
 ds_read_b128 v[48:51],v1 offset:27648
 v_mfma_f32_16x16x32_bf16 v[92:95],v[60:63],a[124:127],v[92:95]
 v_bfe_u32 v121,v12,3,2
 ds_read_b128 v[52:55],v1 offset:28672
 v_mfma_f32_16x16x32_bf16 v[96:99],v[64:67],a[120:123],v[96:99]
 ds_read_b128 v[56:59],v1 offset:34816
 ds_read_b128 v[60:63],v1 offset:35840
 v_mfma_f32_16x16x32_bf16 v[100:103],v[64:67],a[124:127],v[100:103]
 buffer_load_dwordx4 v14,s[12:15],s49 offen sc1 lds
 v_mfma_f32_16x16x32_bf16 v[104:107],v[68:71],a[120:123],v[104:107]
 s_branch .Lsk18
.Lvs3_3:
 s_branch .Lvb3
.Lsk18:
 s_mov_b32 s49,81920
 v_lshl_add_u32 v120,v121,5,v120
 s_add_u32 m0,s55,65536
 v_mfma_f32_16x16x32_bf16 v[108:111],v[68:71],a[124:127],v[108:111]
 ds_read_b128 v[64:67],v1 offset:41984
 ds_read_b128 v[68:71],v1 offset:43008
 v_mfma_f32_16x16x32_bf16 v[96:99],v[72:75],a[128:131],v[96:99]
 v_and_b32 v121,3,v12
 v_mfma_f32_16x16x32_bf16 v[100:103],v[72:75],a[132:135],v[100:103]
 buffer_load_dwordx4 v14,s[12:15],s49 offen sc1 lds
 v_mfma_f32_16x16x32_bf16 v[104:107],v[76:79],a[128:131],v[104:107]
 s_mov_b32 s49,86016
 v_lshl_add_u32 v120,v121,3,v120
 s_add_u32 m0,s55,69632
 v_mfma_f32_16x16x32_bf16 v[108:111],v[76:79],a[132:135],v[108:111]
 ds_read_b128 v[72:75],v1 offset:22528
 ds_read_b128 v[76:79],v1 offset:23552
 v_mfma_f32_16x16x32_bf16 v[96:99],v[16:19],a[136:139],v[96:99]
 v_mfma_f32_16x16x32_bf16 v[100:103],v[16:19],a[140:143],v[100:103]
 buffer_load_dwordx4 v14,s[12:15],s49 offen sc1 lds
 v_mfma_f32_16x16x32_bf16 v[104:107],v[20:23],a[136:139],v[104:107]
 s_mov_b32 s49,90112
 v_xor_b32 v121,32,v120
 s_add_u32 m0,s55,73728
 v_mfma_f32_16x16x32_bf16 v[108:111],v[20:23],a[140:143],v[108:111]
 v_xor_b32 v122,64,v120
 ds_read_b128 v[16:19],v1 offset:29696
 v_mfma_f32_16x16x32_bf16 v[96:99],v[24:27],a[144:147],v[96:99]
 ds_read_b128 v[20:23],v1 offset:30720
 v_mfma_f32_16x16x32_bf16 v[100:103],v[24:27],a[148:151],v[100:103]
 buffer_load_dwordx4 v14,s[12:15],s49 offen sc1 lds
 v_mfma_f32_16x16x32_bf16 v[104:107],v[28:31],a[144:147],v[104:107]
 s_mov_b32 s49,94208
 v_xor_b32 v123,96,v120
 s_add_u32 m0,s55,77824
 v_mfma_f32_16x16x32_bf16 v[108:111],v[28:31],a[148:151],v[108:111]
 ds_read_b128 v[24:27],v1 offset:36864
 ds_read_b128 v[28:31],v1 offset:37888
 v_mfma_f32_16x16x32_bf16 v[96:99],v[32:35],a[152:155],v[96:99]
 v_add_u32 v124,0x10000,v120
 v_mfma_f32_16x16x32_bf16 v[100:103],v[32:35],a[156:159],v[100:103]
 buffer_load_dwordx4 v14,s[12:15],s49 offen sc1 lds
 v_mfma_f32_16x16x32_bf16 v[104:107],v[36:39],a[152:155],v[104:107]
 s_mov_b32 s49,98304
 v_add_u32 v125,0x10000,v121
 s_add_u32 m0,s55,81920
 v_mfma_f32_16x16x32_bf16 v[108:111],v[36:39],a[156:159],v[108:111]
 s_waitcnt lgkmcnt(12)
 ds_read_b128 v[32:35],v1 offset:44032
 ds_read_b128 v[36:39],v1 offset:45056
 v_mfma_f32_16x16x32_bf16 v[96:99],v[40:43],a[160:163],v[96:99]
 v_mfma_f32_16x16x32_bf16 v[100:103],v[40:43],a[164:167],v[100:103]
 buffer_load_dwordx4 v14,s[12:15],s49 offen sc1 lds
 v_mfma_f32_16x16x32_bf16 v[104:107],v[44:47],a[160:163],v[104:107]
 s_mov_b32 s49,102400
 v_add_u32 v126,0x10000,v122
 ds_read_b128 v[40:43],v1 offset:24576
 v_mfma_f32_16x16x32_bf16 v[108:111],v[44:47],a[164:167],v[108:111]
 s_waitcnt lgkmcnt(13)
 v_add_u32 v127,0x10000,v123
 ds_read_b128 v[44:47],v1 offset:25600
 v_mfma_f32_16x16x32_bf16 v[96:99],v[48:51],a[168:171],v[96:99]
 s_add_u32 m0,s55,86016
 v_mfma_f32_16x16x32_bf16 v[100:103],v[48:51],a[172:175],v[100:103]
 buffer_load_dwordx4 a[16:19],v14,s[12:15],s51 offen sc1
 v_mfma_f32_16x16x32_bf16 v[104:107],v[52:55],a[168:171],v[104:107]
 s_mov_b32 s51,188416
 v_add_u32 v128,0x10000,v124
 ds_read_b128 v[48:51],v1 offset:31744
 v_mfma_f32_16x16x32_bf16 v[108:111],v[52:55],a[172:175],v[108:111]
 s_waitcnt lgkmcnt(13)
 ds_read_b128 v[52:55],v1 offset:32768
 v_mfma_f32_16x16x32_bf16 v[96:99],v[56:59],a[176:179],v[96:99]
 v_add_u32 v129,0x10000,v125
 v_mfma_f32_16x16x32_bf16 v[100:103],v[56:59],a[180:183],v[100:103]
 ds_read_b128 v[56:59],v1 offset:38912
 v_mfma_f32_16x16x32_bf16 v[104:107],v[60:63],a[176:179],v[104:107]
 v_mfma_f32_16x16x32_bf16 v[108:111],v[60:63],a[180:183],v[108:111]
 s_waitcnt lgkmcnt(13)
 v_add_u32 v130,0x10000,v126
 ds_read_b128 v[60:63],v1 offset:39936
 v_mfma_f32_16x16x32_bf16 v[96:99],v[64:67],a[184:187],v[96:99]
 v_mfma_f32_16x16x32_bf16 v[100:103],v[64:67],a[188:191],v[100:103]
 v_mov_b32 v7,0
 buffer_atomic_add v7,v3,s[12:15],0 offen offset:36 sc0 sc1
 v_mfma_f32_16x16x32_bf16 v[104:107],v[68:71],a[184:187],v[104:107]
 v_add_u32 v131,0x10000,v127
 ds_read_b128 v[64:67],v1 offset:46080
 v_mfma_f32_16x16x32_bf16 v[108:111],v[68:71],a[188:191],v[108:111]
 s_waitcnt lgkmcnt(13)
 buffer_load_dwordx4 a[20:23],v14,s[12:15],s51 offen sc1
 v_mfma_f32_16x16x32_bf16 v[96:99],v[72:75],a[192:195],v[96:99]
 ds_read_b128 v[68:71],v1 offset:47104
 v_mfma_f32_16x16x32_bf16 v[100:103],v[72:75],a[196:199],v[100:103]
 ds_read_b128 v[72:75],v1 offset:26624
 v_mfma_f32_16x16x32_bf16 v[104:107],v[76:79],a[192:195],v[104:107]
 v_mfma_f32_16x16x32_bf16 v[108:111],v[76:79],a[196:199],v[108:111]
 s_waitcnt lgkmcnt(13)
 ds_read_b128 v[76:79],v1 offset:33792
 v_mfma_f32_16x16x32_bf16 v[96:99],v[16:19],a[200:203],v[96:99]
 v_mfma_f32_16x16x32_bf16 v[100:103],v[16:19],a[204:207],v[100:103]
 ds_read_b128 v[16:19],v1 offset:40960
 v_mfma_f32_16x16x32_bf16 v[104:107],v[20:23],a[200:203],v[104:107]
 v_mfma_f32_16x16x32_bf16 v[108:111],v[20:23],a[204:207],v[108:111]
 s_waitcnt lgkmcnt(13)
 ds_read_b128 v[20:23],v1 offset:48128
 v_mfma_f32_16x16x32_bf16 v[96:99],v[24:27],a[208:211],v[96:99]
 v_mfma_f32_16x16x32_bf16 v[100:103],v[24:27],a[212:215],v[100:103]
 v_mfma_f32_16x16x32_bf16 v[104:107],v[28:31],a[208:211],v[104:107]
 v_mfma_f32_16x16x32_bf16 v[108:111],v[28:31],a[212:215],v[108:111]
 s_waitcnt lgkmcnt(12)
 v_mfma_f32_16x16x32_bf16 v[96:99],v[32:35],a[216:219],v[96:99]
 v_mfma_f32_16x16x32_bf16 v[100:103],v[32:35],a[220:223],v[100:103]
 v_mfma_f32_16x16x32_bf16 v[104:107],v[36:39],a[216:219],v[104:107]
 v_mfma_f32_16x16x32_bf16 v[108:111],v[36:39],a[220:223],v[108:111]
 s_waitcnt vmcnt(22) lgkmcnt(0)
 s_barrier
 ds_read_b128 v[24:27],v0
 v_mfma_f32_16x16x32_bf16 v[96:99],v[40:43],a[224:227],v[96:99]
 buffer_load_dwordx4 v14,s[12:15],s49 offen sc1 lds
 v_mfma_f32_16x16x32_bf16 v[100:103],v[40:43],a[228:231],v[100:103]
 s_mov_b32 s49,106496
 s_add_u32 m0,s55,90112
 ds_read_b128 v[28:31],v0 offset:7168
 v_mfma_f32_16x16x32_bf16 v[104:107],v[44:47],a[224:227],v[104:107]
 ds_read_b128 v[32:35],v0 offset:14336
 ds_read_b128 v[36:39],v0 offset:21504
 v_mfma_f32_16x16x32_bf16 v[108:111],v[44:47],a[228:231],v[108:111]
 ds_read_b128 v[40:43],v0 offset:1024
 ds_read_b128 v[44:47],v0 offset:2048
 v_mfma_f32_16x16x32_bf16 v[96:99],v[48:51],a[232:235],v[96:99]
 buffer_load_dwordx4 v14,s[12:15],s49 offen sc1 lds
 v_mfma_f32_16x16x32_bf16 v[100:103],v[48:51],a[236:239],v[100:103]
 s_mov_b32 s49,110592
 s_add_u32 m0,s55,94208
 ds_read_b128 v[48:51],v0 offset:8192
 v_mfma_f32_16x16x32_bf16 v[104:107],v[52:55],a[232:235],v[104:107]
 v_mfma_f32_16x16x32_bf16 v[108:111],v[52:55],a[236:239],v[108:111]
 ds_read_b128 v[52:55],v0 offset:9216
 v_mfma_f32_16x16x32_bf16 v[96:99],v[56:59],a[240:243],v[96:99]
 buffer_load_dwordx4 v14,s[12:15],s49 offen sc1 lds
 v_mfma_f32_16x16x32_bf16 v[100:103],v[56:59],a[244:247],v[100:103]
 s_mov_b32 s49,114688
 s_add_u32 m0,s55,98304
 ds_read_b128 v[56:59],v0 offset:15360
 v_mfma_f32_16x16x32_bf16 v[104:107],v[60:63],a[240:243],v[104:107]
 v_mfma_f32_16x16x32_bf16 v[108:111],v[60:63],a[244:247],v[108:111]
 ds_read_b128 v[60:63],v0 offset:16384
 v_mfma_f32_16x16x32_bf16 v[96:99],v[64:67],a[248:251],v[96:99]
 buffer_load_dwordx4 v14,s[12:15],s49 offen sc1 lds
 v_mfma_f32_16x16x32_bf16 v[100:103],v[64:67],a[252:255],v[100:103]
 s_mov_b32 s49,118784
 s_add_u32 m0,s55,102400
 ds_read_b128 v[64:67],v0 offset:22528
 v_mfma_f32_16x16x32_bf16 v[104:107],v[68:71],a[248:251],v[104:107]
 v_mfma_f32_16x16x32_bf16 v[108:111],v[68:71],a[252:255],v[108:111]
 ds_read_b128 v[68:71],v0 offset:23552
 v_mfma_f32_16x16x32_bf16 v[80:83],v[72:75],a[128:131],v[80:83]
 buffer_load_dwordx4 v14,s[12:15],s49 offen sc1 lds
 v_mfma_f32_16x16x32_bf16 v[84:87],v[72:75],a[132:135],v[84:87]
 s_mov_b32 s49,122880
 v_mul_f32 v152,v152,v96
 v_mul_f32 v153,v153,v97
 v_mfma_f32_16x16x32_bf16 v[80:83],v[76:79],a[136:139],v[80:83]
 s_add_u32 m0,s55,106496
 v_mul_f32 v154,v154,v98
 v_mul_f32 v155,v155,v99
 v_mfma_f32_16x16x32_bf16 v[84:87],v[76:79],a[140:143],v[84:87]
 v_mul_f32 v160,v160,v104
 v_mul_f32 v161,v161,v105
 v_mfma_f32_16x16x32_bf16 v[80:83],v[16:19],a[144:147],v[80:83]
 buffer_load_dwordx4 v14,s[12:15],s49 offen sc1 lds
 v_mfma_f32_16x16x32_bf16 v[84:87],v[16:19],a[148:151],v[84:87]
 s_mov_b32 s49,126976
 v_mul_f32 v162,v162,v106
 v_mul_f32 v163,v163,v107
 v_mfma_f32_16x16x32_bf16 v[80:83],v[20:23],a[152:155],v[80:83]
 s_add_u32 m0,s55,110592
 v_cvt_pk_bf16_f32 v96,v152,v153
 v_cvt_pk_bf16_f32 v97,v154,v155
 v_mfma_f32_16x16x32_bf16 v[84:87],v[20:23],a[156:159],v[84:87]
 s_waitcnt lgkmcnt(10)
 v_cvt_pk_bf16_f32 v98,v160,v161
 v_cvt_pk_bf16_f32 v99,v162,v163
 v_mfma_f32_16x16x32_bf16 v[88:91],v[24:27],a[128:131],v[88:91]
 buffer_load_dwordx4 v14,s[12:15],s49 offen sc1 lds
 v_mfma_f32_16x16x32_bf16 v[92:95],v[24:27],a[132:135],v[92:95]
 s_mov_b32 s49,131072
 buffer_store_dwordx4 v[96:99],v0,s[12:15],s60 offen sc1
 v_mfma_f32_16x16x32_bf16 v[88:91],v[28:31],a[136:139],v[88:91]
 s_waitcnt vmcnt(9)
 v_readfirstlane_b32 s59,v7
 s_nop 0
 s_cmp_ge_u32 s59,16
 s_cbranch_scc0 .Lseq_slow_24
.Lseq_back_25:
 v_mfma_f32_16x16x32_bf16 v[92:95],v[28:31],a[140:143],v[92:95]
 s_waitcnt lgkmcnt(8)
 v_mul_f32 v156,v156,v100
 v_mul_f32 v157,v157,v101
 v_mfma_f32_16x16x32_bf16 v[88:91],v[32:35],a[144:147],v[88:91]
 s_add_u32 m0,s55,0
 v_mul_f32 v158,v158,v102
 v_mul_f32 v159,v159,v103
 v_mfma_f32_16x16x32_bf16 v[92:95],v[32:35],a[148:151],v[92:95]
 v_mul_f32 v164,v164,v108
 v_mul_f32 v165,v165,v109
 v_mfma_f32_16x16x32_bf16 v[88:91],v[36:39],a[152:155],v[88:91]
 v_mul_f32 v166,v166,v110
 v_mul_f32 v167,v167,v111
 v_mfma_f32_16x16x32_bf16 v[92:95],v[36:39],a[156:159],v[92:95]
 s_waitcnt lgkmcnt(6)
 v_cvt_pk_bf16_f32 v100,v156,v157
 v_cvt_pk_bf16_f32 v101,v158,v159
 v_mfma_f32_16x16x32_bf16 v[80:83],v[40:43],a[160:163],v[80:83]
 v_cvt_pk_bf16_f32 v102,v164,v165
 v_cvt_pk_bf16_f32 v103,v166,v167
 v_mfma_f32_16x16x32_bf16 v[84:87],v[40:43],a[164:167],v[84:87]
 buffer_load_dwordx4 a[32:35],v0,s[12:15],s53 offen sc1
 v_mfma_f32_16x16x32_bf16 v[88:91],v[44:47],a[160:163],v[88:91]
 buffer_store_dwordx4 v[100:103],v0,s[12:15],s60 offen offset:1024 sc1
 v_mfma_f32_16x16x32_bf16 v[92:95],v[44:47],a[164:167],v[92:95]
 s_waitcnt lgkmcnt(4)
 ds_read_b128 v[72:75],v0 offset:3072
 ds_read_b128 v[76:79],v0 offset:4096
 v_mfma_f32_16x16x32_bf16 v[80:83],v[48:51],a[168:171],v[80:83]
 ds_read_b128 v[16:19],v0 offset:10240
 ds_read_b128 v[20:23],v0 offset:11264
 v_mfma_f32_16x16x32_bf16 v[84:87],v[48:51],a[172:175],v[84:87]
 ds_read_b128 v[24:27],v0 offset:17408
 ds_read_b128 v[28:31],v0 offset:18432
 v_mfma_f32_16x16x32_bf16 v[88:91],v[52:55],a[168:171],v[88:91]
 buffer_load_dwordx4 a[36:39],v0,s[12:15],s53 offen offset:1024 sc1
 v_mfma_f32_16x16x32_bf16 v[92:95],v[52:55],a[172:175],v[92:95]
 s_cmp_eq_u32 s69,2
 s_cselect_b32 s53,s68,s65
 s_waitcnt lgkmcnt(8)
 v_mfma_f32_16x16x32_bf16 v[80:83],v[56:59],a[176:179],v[80:83]
 s_add_u32 s65,s65,2048
 ds_read_b128 v[32:35],v0 offset:24576
 ds_read_b128 v[36:39],v0 offset:25600
 v_mfma_f32_16x16x32_bf16 v[84:87],v[56:59],a[180:183],v[84:87]
 ds_read_b128 v[40:43],v0 offset:5120
 ds_read_b128 v[44:47],v0 offset:6144
 v_mfma_f32_16x16x32_bf16 v[88:91],v[60:63],a[176:179],v[88:91]
 buffer_load_dwordx4 a[40:43],v0,s[12:15],s53 offen sc1
 v_mfma_f32_16x16x32_bf16 v[92:95],v[60:63],a[180:183],v[92:95]
 s_waitcnt lgkmcnt(10)
 ds_read_b128 v[48:51],v0 offset:12288
 ds_read_b128 v[52:55],v0 offset:13312
 v_mfma_f32_16x16x32_bf16 v[80:83],v[64:67],a[184:187],v[80:83]
 ds_read_b128 v[56:59],v0 offset:19456
 ds_read_b128 v[60:63],v0 offset:20480
 v_mfma_f32_16x16x32_bf16 v[84:87],v[64:67],a[188:191],v[84:87]
 ds_read_b128 v[64:67],v0 offset:26624
 v_lshlrev_b32 v160,16,v216
 v_mfma_f32_16x16x32_bf16 v[88:91],v[68:71],a[184:187],v[88:91]
 buffer_load_dwordx4 a[44:47],v0,s[12:15],s53 offen offset:1024 sc1
 v_mfma_f32_16x16x32_bf16 v[92:95],v[68:71],a[188:191],v[92:95]
 s_cmp_eq_u32 s69,3
 s_cselect_b32 s53,s68,s65
 s_waitcnt lgkmcnt(13)
 v_mfma_f32_16x16x32_bf16 v[80:83],v[72:75],a[192:195],v[80:83]
 s_add_u32 s65,s65,2048
 ds_read_b128 v[68:71],v0 offset:27648
 v_and_b32 v161,0xffff0000,v216
 v_mfma_f32_16x16x32_bf16 v[84:87],v[72:75],a[196:199],v[84:87]
 v_lshlrev_b32 v162,16,v217
 v_and_b32 v163,0xffff0000,v217
 v_mfma_f32_16x16x32_bf16 v[88:91],v[76:79],a[192:195],v[88:91]
 buffer_load_dwordx4 a[48:51],v0,s[12:15],s53 offen sc1
 v_mfma_f32_16x16x32_bf16 v[92:95],v[76:79],a[196:199],v[92:95]
 s_waitcnt lgkmcnt(12)
 v_lshlrev_b32 v164,16,v218
 v_and_b32 v165,0xffff0000,v218
 v_mfma_f32_16x16x32_bf16 v[80:83],v[16:19],a[200:203],v[80:83]
 v_lshlrev_b32 v166,16,v219
 v_and_b32 v167,0xffff0000,v219
 v_mfma_f32_16x16x32_bf16 v[84:87],v[16:19],a[204:207],v[84:87]
 v_mfma_f32_16x16x32_bf16 v[88:91],v[20:23],a[200:203],v[88:91]
 buffer_load_dwordx4 a[52:55],v0,s[12:15],s53 offen offset:1024 sc1
 v_mfma_f32_16x16x32_bf16 v[92:95],v[20:23],a[204:207],v[92:95]
 s_cmp_eq_u32 s69,4
 s_cselect_b32 s53,s68,s65
 s_waitcnt lgkmcnt(10)
 v_mfma_f32_16x16x32_bf16 v[80:83],v[24:27],a[208:211],v[80:83]
 s_add_u32 s65,s65,2048
 s_waitcnt lgkmcnt(0)
 s_barrier
 ds_read_b64_tr_b16 v[72:73],v124 offset:49152
 v_mfma_f32_16x16x32_bf16 v[84:87],v[24:27],a[212:215],v[84:87]
 ds_read_b64_tr_b16 v[74:75],v124 offset:51200
 ds_read_b64_tr_b16 v[76:77],v125 offset:49152
 v_mfma_f32_16x16x32_bf16 v[88:91],v[28:31],a[208:211],v[88:91]
 buffer_load_dwordx4 a[56:59],v0,s[12:15],s53 offen sc1
 v_mfma_f32_16x16x32_bf16 v[92:95],v[28:31],a[212:215],v[92:95]
 ds_read_b64_tr_b16 v[78:79],v125 offset:51200
 ds_read_b64_tr_b16 v[16:17],v126 offset:49152
 v_mfma_f32_16x16x32_bf16 v[80:83],v[32:35],a[216:219],v[80:83]
 ds_read_b64_tr_b16 v[18:19],v126 offset:51200
 ds_read_b64_tr_b16 v[20:21],v127 offset:49152
 v_mfma_f32_16x16x32_bf16 v[84:87],v[32:35],a[220:223],v[84:87]
 ds_read_b64_tr_b16 v[22:23],v127 offset:51200
 ds_read_b64_tr_b16 v[24:25],v124 offset:53248
 v_mfma_f32_16x16x32_bf16 v[88:91],v[36:39],a[216:219],v[88:91]
 buffer_load_dwordx4 a[60:63],v0,s[12:15],s53 offen offset:1024 sc1
 v_mfma_f32_16x16x32_bf16 v[92:95],v[36:39],a[220:223],v[92:95]
 s_cmp_eq_u32 s69,5
 s_cselect_b32 s53,s68,s65
 v_mfma_f32_16x16x32_bf16 v[80:83],v[40:43],a[224:227],v[80:83]
 s_add_u32 s65,s65,2048
 ds_read_b64_tr_b16 v[26:27],v124 offset:55296
 ds_read_b64_tr_b16 v[28:29],v125 offset:53248
 v_mfma_f32_16x16x32_bf16 v[84:87],v[40:43],a[228:231],v[84:87]
 ds_read_b64_tr_b16 v[30:31],v125 offset:55296
 ds_read_b64_tr_b16 v[32:33],v126 offset:53248
 v_mfma_f32_16x16x32_bf16 v[88:91],v[44:47],a[224:227],v[88:91]
 buffer_load_dwordx4 a[64:67],v0,s[12:15],s53 offen sc1
 v_mfma_f32_16x16x32_bf16 v[92:95],v[44:47],a[228:231],v[92:95]
 ds_read_b64_tr_b16 v[34:35],v126 offset:55296
 ds_read_b64_tr_b16 v[36:37],v127 offset:53248
 v_mfma_f32_16x16x32_bf16 v[80:83],v[48:51],a[232:235],v[80:83]
 ds_read_b64_tr_b16 v[38:39],v127 offset:55296
 ds_read_b64_tr_b16 v[40:41],v124 offset:57344
 v_mfma_f32_16x16x32_bf16 v[84:87],v[48:51],a[236:239],v[84:87]
 ds_read_b64_tr_b16 v[42:43],v124 offset:59392
 ds_read_b64_tr_b16 v[44:45],v125 offset:57344
 v_mfma_f32_16x16x32_bf16 v[88:91],v[52:55],a[232:235],v[88:91]
 buffer_load_dwordx4 a[68:71],v0,s[12:15],s53 offen offset:1024 sc1
 v_mfma_f32_16x16x32_bf16 v[92:95],v[52:55],a[236:239],v[92:95]
 s_cmp_eq_u32 s69,6
 s_cselect_b32 s53,s68,s65
 v_mfma_f32_16x16x32_bf16 v[80:83],v[56:59],a[240:243],v[80:83]
 s_add_u32 s65,s65,2048
 ds_read_b64_tr_b16 v[46:47],v125 offset:59392
 ds_read_b64_tr_b16 v[48:49],v126 offset:57344
 v_mfma_f32_16x16x32_bf16 v[84:87],v[56:59],a[244:247],v[84:87]
 ds_read_b64_tr_b16 v[50:51],v126 offset:59392
 ds_read_b64_tr_b16 v[52:53],v127 offset:57344
 v_mfma_f32_16x16x32_bf16 v[88:91],v[60:63],a[240:243],v[88:91]
 buffer_load_dwordx4 a[72:75],v0,s[12:15],s53 offen sc1
 v_mfma_f32_16x16x32_bf16 v[92:95],v[60:63],a[244:247],v[92:95]
 ds_read_b64_tr_b16 v[54:55],v127 offset:59392
 ds_read_b64_tr_b16 v[56:57],v124 offset:61440
 v_mfma_f32_16x16x32_bf16 v[80:83],v[64:67],a[248:251],v[80:83]
 ds_read_b64_tr_b16 v[58:59],v124 offset:63488
 ds_read_b64_tr_b16 v[60:61],v125 offset:61440
 v_mfma_f32_16x16x32_bf16 v[84:87],v[64:67],a[252:255],v[84:87]
 ds_read_b64_tr_b16 v[62:63],v125 offset:63488
 ds_read_b64_tr_b16 v[64:65],v126 offset:61440
 v_mfma_f32_16x16x32_bf16 v[88:91],v[68:71],a[248:251],v[88:91]
 buffer_load_dwordx4 a[76:79],v0,s[12:15],s53 offen offset:1024 sc1
 v_mfma_f32_16x16x32_bf16 v[92:95],v[68:71],a[252:255],v[92:95]
 s_cmp_eq_u32 s69,7
 s_cselect_b32 s53,s68,s65
.Lwy:
 s_waitcnt lgkmcnt(14)
 v_mfma_f32_16x16x32_bf16 v[160:163],v[72:75],v[112:115],v[160:163]
 s_add_u32 s65,s65,2048
 v_mul_f32 v136,v136,v80
 v_mul_f32 v137,v137,v81
 v_mfma_f32_16x16x32_bf16 v[168:171],v[72:75],v[116:119],v[168:171]
 v_mul_f32 v138,v138,v82
 v_mul_f32 v139,v139,v83
 v_mfma_f32_16x16x32_bf16 v[164:167],v[76:79],v[112:115],v[164:167]
 buffer_load_dwordx4 a[80:83],v0,s[12:15],s53 offen sc1
 v_mfma_f32_16x16x32_bf16 v[172:175],v[76:79],v[116:119],v[172:175]
 v_mul_f32 v144,v144,v88
 v_mul_f32 v145,v145,v89
 v_mfma_f32_16x16x32_bf16 v[176:179],v[16:19],v[112:115],v[176:179]
 v_mul_f32 v146,v146,v90
 v_mul_f32 v147,v147,v91
 v_mfma_f32_16x16x32_bf16 v[184:187],v[16:19],v[116:119],v[184:187]
 v_cvt_pk_bf16_f32 v80,v136,v137
 v_cvt_pk_bf16_f32 v81,v138,v139
 v_mfma_f32_16x16x32_bf16 v[180:183],v[20:23],v[112:115],v[180:183]
 buffer_load_dwordx4 a[84:87],v0,s[12:15],s53 offen offset:1024 sc1
 v_mfma_f32_16x16x32_bf16 v[188:191],v[20:23],v[116:119],v[188:191]
 s_cmp_eq_u32 s69,8
 s_cselect_b32 s53,s68,s65
 s_waitcnt vmcnt(12)
 v_mfma_f32_16x16x32_bf16 v[160:163],v[24:27],a[32:35],v[160:163]
 s_add_u32 s65,s65,2048
 buffer_atomic_add v6,v3,s[12:15],0 offen offset:40 sc1
 v_mfma_f32_16x16x32_bf16 v[168:171],v[24:27],a[36:39],v[168:171]
 v_cvt_pk_bf16_f32 v82,v144,v145
 v_cvt_pk_bf16_f32 v83,v146,v147
 v_mfma_f32_16x16x32_bf16 v[164:167],v[28:31],a[32:35],v[164:167]
 buffer_load_dwordx4 a[88:91],v0,s[12:15],s53 offen sc1
 v_mfma_f32_16x16x32_bf16 v[172:175],v[28:31],a[36:39],v[172:175]
 s_waitcnt lgkmcnt(13)
 buffer_store_dwordx4 v[80:83],v0,s[12:15],s62 offen sc1
 v_mfma_f32_16x16x32_bf16 v[176:179],v[32:35],a[32:35],v[176:179]
 v_mul_f32 v140,v140,v84
 v_mul_f32 v141,v141,v85
 v_mfma_f32_16x16x32_bf16 v[184:187],v[32:35],a[36:39],v[184:187]
 v_mul_f32 v142,v142,v86
 v_mul_f32 v143,v143,v87
 v_mfma_f32_16x16x32_bf16 v[180:183],v[36:39],a[32:35],v[180:183]
 buffer_load_dwordx4 a[92:95],v0,s[12:15],s53 offen offset:1024 sc1
 v_mfma_f32_16x16x32_bf16 v[188:191],v[36:39],a[36:39],v[188:191]
 s_waitcnt vmcnt(14) lgkmcnt(9)
 v_mul_f32 v148,v148,v92
 v_mul_f32 v149,v149,v93
 v_mfma_f32_16x16x32_bf16 v[160:163],v[40:43],a[40:43],v[160:163]
 v_mul_f32 v150,v150,v94
 v_mul_f32 v151,v151,v95
 v_mfma_f32_16x16x32_bf16 v[168:171],v[40:43],a[44:47],v[168:171]
 v_cvt_pk_bf16_f32 v84,v140,v141
 v_cvt_pk_bf16_f32 v85,v142,v143
 v_mfma_f32_16x16x32_bf16 v[164:167],v[44:47],a[40:43],v[164:167]
 ds_read_b64_tr_b16 v[66:67],v126 offset:63488
 ds_read_b64_tr_b16 v[68:69],v127 offset:61440
 v_mfma_f32_16x16x32_bf16 v[172:175],v[44:47],a[44:47],v[172:175]
 s_waitcnt lgkmcnt(7)
 ds_read_b64_tr_b16 v[70:71],v127 offset:63488
 v_cvt_pk_bf16_f32 v86,v148,v149
 v_mfma_f32_16x16x32_bf16 v[176:179],v[48:51],a[40:43],v[176:179]
 s_cmp_eq_u32 s69,9
 s_cselect_b32 s53,s68,s65
 v_cvt_pk_bf16_f32 v87,v150,v151
 v_mfma_f32_16x16x32_bf16 v[184:187],v[48:51],a[44:47],v[184:187]
 s_add_u32 s65,s65,2048
 buffer_store_dwordx4 v[84:87],v0,s[12:15],s62 offen offset:1024 sc1
 v_mfma_f32_16x16x32_bf16 v[180:183],v[52:55],a[40:43],v[180:183]
 buffer_load_dwordx4 a[96:99],v0,s[12:15],s53 offen sc1
 v_mfma_f32_16x16x32_bf16 v[188:191],v[52:55],a[44:47],v[188:191]
 s_waitcnt vmcnt(14) lgkmcnt(4)
 buffer_load_dwordx4 a[100:103],v0,s[12:15],s53 offen offset:1024 sc1
 ds_read_b64_tr_b16 v[72:73],v128
 ds_read_b64_tr_b16 v[74:75],v128 offset:2048
 ds_read_b64_tr_b16 v[76:77],v129
 ds_read_b64_tr_b16 v[78:79],v129 offset:2048
 v_mfma_f32_16x16x32_bf16 v[160:163],v[56:59],a[48:51],v[160:163]
 s_cmp_eq_u32 s69,10
 s_cselect_b32 s53,s68,s65
 ds_read_b64_tr_b16 v[16:17],v130
 v_mfma_f32_16x16x32_bf16 v[168:171],v[56:59],a[52:55],v[168:171]
 s_add_u32 s65,s65,2048
 ds_read_b64_tr_b16 v[18:19],v130 offset:2048
 ds_read_b64_tr_b16 v[20:21],v131
 v_mfma_f32_16x16x32_bf16 v[164:167],v[60:63],a[48:51],v[164:167]
 buffer_load_dwordx4 a[104:107],v0,s[12:15],s53 offen sc1
 v_mfma_f32_16x16x32_bf16 v[172:175],v[60:63],a[52:55],v[172:175]
 s_waitcnt lgkmcnt(7)
 ds_read_b64_tr_b16 v[22:23],v131 offset:2048
 ds_read_b64_tr_b16 v[24:25],v128 offset:4096
 v_mfma_f32_16x16x32_bf16 v[176:179],v[64:67],a[48:51],v[176:179]
 ds_read_b64_tr_b16 v[26:27],v128 offset:6144
 ds_read_b64_tr_b16 v[28:29],v129 offset:4096
 v_mfma_f32_16x16x32_bf16 v[184:187],v[64:67],a[52:55],v[184:187]
 ds_read_b64_tr_b16 v[30:31],v129 offset:6144
 ds_read_b64_tr_b16 v[32:33],v130 offset:4096
 v_mfma_f32_16x16x32_bf16 v[180:183],v[68:71],a[48:51],v[180:183]
 buffer_load_dwordx4 a[108:111],v0,s[12:15],s53 offen offset:1024 sc1
 v_mfma_f32_16x16x32_bf16 v[188:191],v[68:71],a[52:55],v[188:191]
 s_cmp_eq_u32 s69,11
 s_cselect_b32 s53,s68,s65
 s_waitcnt vmcnt(15) lgkmcnt(9)
 v_mfma_f32_16x16x32_bf16 v[160:163],v[72:75],a[56:59],v[160:163]
 s_add_u32 s65,s65,2048
 ds_read_b64_tr_b16 v[34:35],v130 offset:6144
 ds_read_b64_tr_b16 v[36:37],v131 offset:4096
 v_mfma_f32_16x16x32_bf16 v[168:171],v[72:75],a[60:63],v[168:171]
 ds_read_b64_tr_b16 v[38:39],v131 offset:6144
 ds_read_b64_tr_b16 v[40:41],v128 offset:8192
 v_mfma_f32_16x16x32_bf16 v[164:167],v[76:79],a[56:59],v[164:167]
 buffer_load_dwordx4 a[112:115],v0,s[12:15],s53 offen sc1
 v_mfma_f32_16x16x32_bf16 v[172:175],v[76:79],a[60:63],v[172:175]
 s_waitcnt lgkmcnt(9)
 ds_read_b64_tr_b16 v[42:43],v128 offset:10240
 ds_read_b64_tr_b16 v[44:45],v129 offset:8192
 v_mfma_f32_16x16x32_bf16 v[176:179],v[16:19],a[56:59],v[176:179]
 ds_read_b64_tr_b16 v[46:47],v129 offset:10240
 ds_read_b64_tr_b16 v[48:49],v130 offset:8192
 v_mfma_f32_16x16x32_bf16 v[184:187],v[16:19],a[60:63],v[184:187]
 ds_read_b64_tr_b16 v[50:51],v130 offset:10240
 ds_read_b64_tr_b16 v[52:53],v131 offset:8192
 v_mfma_f32_16x16x32_bf16 v[180:183],v[20:23],a[56:59],v[180:183]
 buffer_load_dwordx4 a[116:119],v0,s[12:15],s53 offen offset:1024 sc1
 v_mfma_f32_16x16x32_bf16 v[188:191],v[20:23],a[60:63],v[188:191]
 s_cmp_eq_u32 s69,12
 s_cselect_b32 s53,s68,s65
 s_waitcnt vmcnt(15) lgkmcnt(11)
 v_mfma_f32_16x16x32_bf16 v[160:163],v[24:27],a[64:67],v[160:163]
 s_add_u32 s65,s65,2048
 ds_read_b64_tr_b16 v[54:55],v131 offset:10240
 ds_read_b64_tr_b16 v[56:57],v128 offset:12288
 v_mfma_f32_16x16x32_bf16 v[168:171],v[24:27],a[68:71],v[168:171]
 ds_read_b64_tr_b16 v[58:59],v128 offset:14336
 ds_read_b64_tr_b16 v[60:61],v129 offset:12288
 v_mfma_f32_16x16x32_bf16 v[164:167],v[28:31],a[64:67],v[164:167]
 buffer_load_dwordx4 a[120:123],v0,s[12:15],s53 offen sc1
 v_mfma_f32_16x16x32_bf16 v[172:175],v[28:31],a[68:71],v[172:175]
 s_waitcnt lgkmcnt(11)
 ds_read_b64_tr_b16 v[62:63],v129 offset:14336
 ds_read_b64_tr_b16 v[64:65],v130 offset:12288
 v_mfma_f32_16x16x32_bf16 v[176:179],v[32:35],a[64:67],v[176:179]
 ds_read_b64_tr_b16 v[66:67],v130 offset:14336
 ds_read_b64_tr_b16 v[68:69],v131 offset:12288
 v_mfma_f32_16x16x32_bf16 v[184:187],v[32:35],a[68:71],v[184:187]
 ds_read_b64_tr_b16 v[70:71],v131 offset:14336
 ds_read_b64_tr_b16 v[72:73],v128 offset:16384
 v_mfma_f32_16x16x32_bf16 v[180:183],v[36:39],a[64:67],v[180:183]
 buffer_load_dwordx4 a[124:127],v0,s[12:15],s53 offen offset:1024 sc1
 v_mfma_f32_16x16x32_bf16 v[188:191],v[36:39],a[68:71],v[188:191]
 s_cmp_eq_u32 s69,13
 s_cselect_b32 s53,s68,s65
 s_waitcnt vmcnt(15) lgkmcnt(13)
 v_mfma_f32_16x16x32_bf16 v[160:163],v[40:43],a[72:75],v[160:163]
 s_add_u32 s65,s65,2048
 ds_read_b64_tr_b16 v[74:75],v128 offset:18432
 ds_read_b64_tr_b16 v[76:77],v129 offset:16384
 v_mfma_f32_16x16x32_bf16 v[168:171],v[40:43],a[76:79],v[168:171]
 ds_read_b64_tr_b16 v[78:79],v129 offset:18432
 ds_read_b64_tr_b16 v[16:17],v130 offset:16384
 v_mfma_f32_16x16x32_bf16 v[164:167],v[44:47],a[72:75],v[164:167]
 buffer_load_dwordx4 a[128:131],v0,s[12:15],s53 offen sc1
 v_mfma_f32_16x16x32_bf16 v[172:175],v[44:47],a[76:79],v[172:175]
 s_waitcnt lgkmcnt(13)
 ds_read_b64_tr_b16 v[18:19],v130 offset:18432
 ds_read_b64_tr_b16 v[20:21],v131 offset:16384
 v_mfma_f32_16x16x32_bf16 v[176:179],v[48:51],a[72:75],v[176:179]
 ds_read_b64_tr_b16 v[22:23],v131 offset:18432
 ds_read_b64_tr_b16 v[24:25],v128 offset:20480
 v_mfma_f32_16x16x32_bf16 v[184:187],v[48:51],a[76:79],v[184:187]
 ds_read_b64_tr_b16 v[26:27],v128 offset:22528
 ds_read_b64_tr_b16 v[28:29],v129 offset:20480
 v_mfma_f32_16x16x32_bf16 v[180:183],v[52:55],a[72:75],v[180:183]
 buffer_load_dwordx4 a[132:135],v0,s[12:15],s53 offen offset:1024 sc1
 v_mfma_f32_16x16x32_bf16 v[188:191],v[52:55],a[76:79],v[188:191]
 s_cmp_eq_u32 s69,14
 s_cselect_b32 s53,s68,s65
 s_waitcnt vmcnt(15) lgkmcnt(14)
 v_mfma_f32_16x16x32_bf16 v[160:163],v[56:59],a[80:83],v[160:163]
 s_add_u32 s65,s65,2048
 ds_read_b64_tr_b16 v[30:31],v129 offset:22528
 ds_read_b64_tr_b16 v[32:33],v130 offset:20480
 v_mfma_f32_16x16x32_bf16 v[168:171],v[56:59],a[84:87],v[168:171]
 ds_read_b64_tr_b16 v[34:35],v130 offset:22528
 ds_read_b64_tr_b16 v[36:37],v131 offset:20480
 v_mfma_f32_16x16x32_bf16 v[164:167],v[60:63],a[80:83],v[164:167]
 buffer_load_dwordx4 a[136:139],v0,s[12:15],s53 offen sc1
 v_mfma_f32_16x16x32_bf16 v[172:175],v[60:63],a[84:87],v[172:175]
 s_waitcnt lgkmcnt(14)
 ds_read_b64_tr_b16 v[38:39],v131 offset:22528
 ds_read_b64_tr_b16 v[40:41],v128 offset:24576
 v_mfma_f32_16x16x32_bf16 v[176:179],v[64:67],a[80:83],v[176:179]
 ds_read_b64_tr_b16 v[42:43],v128 offset:26624
 ds_read_b64_tr_b16 v[44:45],v129 offset:24576
 v_mfma_f32_16x16x32_bf16 v[184:187],v[64:67],a[84:87],v[184:187]
 ds_read_b64_tr_b16 v[46:47],v129 offset:26624
 ds_read_b64_tr_b16 v[48:49],v130 offset:24576
 v_mfma_f32_16x16x32_bf16 v[180:183],v[68:71],a[80:83],v[180:183]
 buffer_load_dwordx4 a[140:143],v0,s[12:15],s53 offen offset:1024 sc1
 v_mfma_f32_16x16x32_bf16 v[188:191],v[68:71],a[84:87],v[188:191]
 s_cmp_eq_u32 s69,15
 s_cselect_b32 s53,s68,s65
 s_waitcnt vmcnt(13) lgkmcnt(14)
 v_mfma_f32_16x16x32_bf16 v[160:163],v[72:75],a[88:91],v[160:163]
 s_add_u32 s65,s65,2048
 ds_read_b64_tr_b16 v[50:51],v130 offset:26624
 ds_read_b64_tr_b16 v[52:53],v131 offset:24576
 v_mfma_f32_16x16x32_bf16 v[168:171],v[72:75],a[92:95],v[168:171]
 ds_read_b64_tr_b16 v[54:55],v131 offset:26624
 v_mfma_f32_16x16x32_bf16 v[164:167],v[76:79],a[88:91],v[164:167]
 buffer_load_dwordx4 a[144:147],v0,s[12:15],s53 offen sc1
 v_mfma_f32_16x16x32_bf16 v[172:175],v[76:79],a[92:95],v[172:175]
 s_branch .Lsk19
.Lvs4_0:
 s_branch .Lvb4
.Lsk19:
 s_waitcnt lgkmcnt(14)
 v_mfma_f32_16x16x32_bf16 v[176:179],v[16:19],a[88:91],v[176:179]
 v_mfma_f32_16x16x32_bf16 v[184:187],v[16:19],a[92:95],v[184:187]
 v_mfma_f32_16x16x32_bf16 v[180:183],v[20:23],a[88:91],v[180:183]
 buffer_load_dwordx4 a[148:151],v0,s[12:15],s53 offen offset:1024 sc1
 v_mfma_f32_16x16x32_bf16 v[188:191],v[20:23],a[92:95],v[188:191]
 s_cmp_eq_u32 s69,16
 s_cselect_b32 s53,s68,s65
 s_waitcnt vmcnt(12) lgkmcnt(12)
 v_mfma_f32_16x16x32_bf16 v[160:163],v[24:27],a[96:99],v[160:163]
 s_add_u32 s65,s65,2048
 buffer_atomic_add v6,v3,s[12:15],0 offen offset:44 sc1
 v_mfma_f32_16x16x32_bf16 v[168:171],v[24:27],a[100:103],v[168:171]
 s_waitcnt lgkmcnt(0)
 s_barrier
 ds_read_b64_tr_b16 v[56:57],v120 offset:28672
 ds_read_b64_tr_b16 v[58:59],v120 offset:30720
 v_mfma_f32_16x16x32_bf16 v[164:167],v[28:31],a[96:99],v[164:167]
 buffer_load_dwordx4 a[152:155],v0,s[12:15],s53 offen sc1
 v_mfma_f32_16x16x32_bf16 v[172:175],v[28:31],a[100:103],v[172:175]
 ds_read_b64_tr_b16 v[60:61],v121 offset:28672
 ds_read_b64_tr_b16 v[62:63],v121 offset:30720
 v_mfma_f32_16x16x32_bf16 v[176:179],v[32:35],a[96:99],v[176:179]
 ds_read_b64_tr_b16 v[64:65],v122 offset:28672
 ds_read_b64_tr_b16 v[66:67],v122 offset:30720
 v_mfma_f32_16x16x32_bf16 v[184:187],v[32:35],a[100:103],v[184:187]
 ds_read_b64_tr_b16 v[68:69],v123 offset:28672
 ds_read_b64_tr_b16 v[70:71],v123 offset:30720
 v_mfma_f32_16x16x32_bf16 v[180:183],v[36:39],a[96:99],v[180:183]
 buffer_load_dwordx4 a[156:159],v0,s[12:15],s53 offen offset:1024 sc1
 v_mfma_f32_16x16x32_bf16 v[188:191],v[36:39],a[100:103],v[188:191]
 s_cmp_eq_u32 s69,17
 s_cselect_b32 s53,s68,s65
 s_waitcnt vmcnt(13)
 v_mfma_f32_16x16x32_bf16 v[160:163],v[40:43],a[104:107],v[160:163]
 s_add_u32 s65,s65,2048
 ds_read_b64_tr_b16 v[72:73],v120 offset:32768
 ds_read_b64_tr_b16 v[74:75],v120 offset:34816
 v_mfma_f32_16x16x32_bf16 v[168:171],v[40:43],a[108:111],v[168:171]
 ds_read_b64_tr_b16 v[76:77],v121 offset:32768
 ds_read_b64_tr_b16 v[78:79],v121 offset:34816
 v_mfma_f32_16x16x32_bf16 v[164:167],v[44:47],a[104:107],v[164:167]
 buffer_load_dwordx4 a[160:163],v0,s[12:15],s53 offen sc1
 v_mfma_f32_16x16x32_bf16 v[172:175],v[44:47],a[108:111],v[172:175]
 ds_read_b64_tr_b16 v[16:17],v122 offset:32768
 ds_read_b64_tr_b16 v[18:19],v122 offset:34816
 v_mfma_f32_16x16x32_bf16 v[176:179],v[48:51],a[104:107],v[176:179]
 ds_read_b64_tr_b16 v[20:21],v123 offset:32768
 ds_read_b64_tr_b16 v[22:23],v123 offset:34816
 v_mfma_f32_16x16x32_bf16 v[184:187],v[48:51],a[108:111],v[184:187]
 ds_read_b64_tr_b16 v[24:25],v120 offset:36864
 ds_read_b64_tr_b16 v[26:27],v120 offset:38912
 v_mfma_f32_16x16x32_bf16 v[180:183],v[52:55],a[104:107],v[180:183]
 buffer_load_dwordx4 a[164:167],v0,s[12:15],s53 offen offset:1024 sc1
 v_mfma_f32_16x16x32_bf16 v[188:191],v[52:55],a[108:111],v[188:191]
 s_cmp_eq_u32 s69,18
 s_cselect_b32 s53,s68,s65
 s_waitcnt vmcnt(13) lgkmcnt(14)
 v_mfma_f32_16x16x32_bf16 v[160:163],v[56:59],a[112:115],v[160:163]
 s_add_u32 s65,s65,2048
 ds_read_b64_tr_b16 v[28:29],v121 offset:36864
 ds_read_b64_tr_b16 v[30:31],v121 offset:38912
 v_mfma_f32_16x16x32_bf16 v[168:171],v[56:59],a[116:119],v[168:171]
 ds_read_b64_tr_b16 v[32:33],v122 offset:36864
 ds_read_b64_tr_b16 v[34:35],v122 offset:38912
 v_mfma_f32_16x16x32_bf16 v[164:167],v[60:63],a[112:115],v[164:167]
 v_mov_b32 v7,0
 buffer_atomic_add v7,v3,s[12:15],0 offen offset:40 sc0 sc1
 v_mfma_f32_16x16x32_bf16 v[172:175],v[60:63],a[116:119],v[172:175]
 s_waitcnt lgkmcnt(14)
 buffer_load_dwordx4 a[168:171],v0,s[12:15],s53 offen sc1
 v_mfma_f32_16x16x32_bf16 v[176:179],v[64:67],a[112:115],v[176:179]
 ds_read_b64_tr_b16 v[36:37],v123 offset:36864
 ds_read_b64_tr_b16 v[38:39],v123 offset:38912
 v_mfma_f32_16x16x32_bf16 v[184:187],v[64:67],a[116:119],v[184:187]
 ds_read_b64_tr_b16 v[40:41],v120 offset:40960
 ds_read_b64_tr_b16 v[42:43],v120 offset:43008
 v_mfma_f32_16x16x32_bf16 v[180:183],v[68:71],a[112:115],v[180:183]
 buffer_load_dwordx4 a[172:175],v0,s[12:15],s53 offen offset:1024 sc1
 v_mfma_f32_16x16x32_bf16 v[188:191],v[68:71],a[116:119],v[188:191]
 s_cmp_eq_u32 s69,19
 s_cselect_b32 s53,s68,s65
 s_waitcnt vmcnt(14) lgkmcnt(14)
 v_mfma_f32_16x16x32_bf16 v[160:163],v[72:75],a[120:123],v[160:163]
 s_add_u32 s65,s65,2048
 ds_read_b64_tr_b16 v[44:45],v121 offset:40960
 ds_read_b64_tr_b16 v[46:47],v121 offset:43008
 v_mfma_f32_16x16x32_bf16 v[168:171],v[72:75],a[124:127],v[168:171]
 ds_read_b64_tr_b16 v[48:49],v122 offset:40960
 ds_read_b64_tr_b16 v[50:51],v122 offset:43008
 v_mfma_f32_16x16x32_bf16 v[164:167],v[76:79],a[120:123],v[164:167]
 buffer_load_dwordx4 a[176:179],v0,s[12:15],s53 offen sc1
 v_mfma_f32_16x16x32_bf16 v[172:175],v[76:79],a[124:127],v[172:175]
 s_waitcnt lgkmcnt(14)
 ds_read_b64_tr_b16 v[52:53],v123 offset:40960
 ds_read_b64_tr_b16 v[54:55],v123 offset:43008
 v_mfma_f32_16x16x32_bf16 v[176:179],v[16:19],a[120:123],v[176:179]
 ds_read_b64_tr_b16 v[56:57],v120 offset:45056
 ds_read_b64_tr_b16 v[58:59],v120 offset:47104
 v_mfma_f32_16x16x32_bf16 v[184:187],v[16:19],a[124:127],v[184:187]
 ds_read_b64_tr_b16 v[60:61],v121 offset:45056
 ds_read_b64_tr_b16 v[62:63],v121 offset:47104
 v_mfma_f32_16x16x32_bf16 v[180:183],v[20:23],a[120:123],v[180:183]
 buffer_load_dwordx4 a[180:183],v0,s[12:15],s53 offen offset:1024 sc1
 v_mfma_f32_16x16x32_bf16 v[188:191],v[20:23],a[124:127],v[188:191]
 s_cmp_eq_u32 s69,20
 s_cselect_b32 s53,s68,s65
 s_waitcnt vmcnt(14) lgkmcnt(14)
 v_mfma_f32_16x16x32_bf16 v[160:163],v[24:27],a[128:131],v[160:163]
 s_add_u32 s65,s65,2048
 ds_read_b64_tr_b16 v[64:65],v122 offset:45056
 ds_read_b64_tr_b16 v[66:67],v122 offset:47104
 v_mfma_f32_16x16x32_bf16 v[168:171],v[24:27],a[132:135],v[168:171]
 ds_read_b64_tr_b16 v[68:69],v123 offset:45056
 ds_read_b64_tr_b16 v[70:71],v123 offset:47104
 v_mfma_f32_16x16x32_bf16 v[164:167],v[28:31],a[128:131],v[164:167]
 buffer_load_dwordx4 a[184:187],v0,s[12:15],s53 offen sc1
 v_mfma_f32_16x16x32_bf16 v[172:175],v[28:31],a[132:135],v[172:175]
 s_waitcnt lgkmcnt(14)
 ds_read_b64_tr_b16 v[72:73],v120 offset:49152
 ds_read_b64_tr_b16 v[74:75],v120 offset:51200
 v_mfma_f32_16x16x32_bf16 v[176:179],v[32:35],a[128:131],v[176:179]
 ds_read_b64_tr_b16 v[76:77],v121 offset:49152
 ds_read_b64_tr_b16 v[78:79],v121 offset:51200
 v_mfma_f32_16x16x32_bf16 v[184:187],v[32:35],a[132:135],v[184:187]
 ds_read_b64_tr_b16 v[16:17],v122 offset:49152
 ds_read_b64_tr_b16 v[18:19],v122 offset:51200
 v_mfma_f32_16x16x32_bf16 v[180:183],v[36:39],a[128:131],v[180:183]
 buffer_load_dwordx4 a[188:191],v0,s[12:15],s53 offen offset:1024 sc1
 v_mfma_f32_16x16x32_bf16 v[188:191],v[36:39],a[132:135],v[188:191]
 s_cmp_eq_u32 s69,21
 s_cselect_b32 s53,s68,s65
 s_waitcnt vmcnt(14) lgkmcnt(14)
 v_mfma_f32_16x16x32_bf16 v[160:163],v[40:43],a[136:139],v[160:163]
 s_add_u32 s65,s65,2048
 ds_read_b64_tr_b16 v[20:21],v123 offset:49152
 ds_read_b64_tr_b16 v[22:23],v123 offset:51200
 v_mfma_f32_16x16x32_bf16 v[168:171],v[40:43],a[140:143],v[168:171]
 ds_read_b64_tr_b16 v[24:25],v120 offset:53248
 ds_read_b64_tr_b16 v[26:27],v120 offset:55296
 v_mfma_f32_16x16x32_bf16 v[164:167],v[44:47],a[136:139],v[164:167]
 buffer_load_dwordx4 a[192:195],v0,s[12:15],s53 offen sc1
 v_mfma_f32_16x16x32_bf16 v[172:175],v[44:47],a[140:143],v[172:175]
 ds_read_b64_tr_b16 v[28:29],v121 offset:53248
 ds_read_b64_tr_b16 v[30:31],v121 offset:55296
 v_mfma_f32_16x16x32_bf16 v[176:179],v[48:51],a[136:139],v[176:179]
 ds_read_b64_tr_b16 v[32:33],v122 offset:53248
 ds_read_b64_tr_b16 v[34:35],v122 offset:55296
 v_mfma_f32_16x16x32_bf16 v[184:187],v[48:51],a[140:143],v[184:187]
 ds_read_b64_tr_b16 v[36:37],v123 offset:53248
 ds_read_b64_tr_b16 v[38:39],v123 offset:55296
 v_mfma_f32_16x16x32_bf16 v[180:183],v[52:55],a[136:139],v[180:183]
 buffer_load_dwordx4 a[196:199],v0,s[12:15],s53 offen offset:1024 sc1
 v_mfma_f32_16x16x32_bf16 v[188:191],v[52:55],a[140:143],v[188:191]
 s_cmp_eq_u32 s69,22
 s_cselect_b32 s53,s68,s65
 s_waitcnt vmcnt(14) lgkmcnt(14)
 v_mfma_f32_16x16x32_bf16 v[160:163],v[56:59],a[144:147],v[160:163]
 s_add_u32 s65,s65,2048
 v_mfma_f32_16x16x32_bf16 v[168:171],v[56:59],a[148:151],v[168:171]
 v_mfma_f32_16x16x32_bf16 v[164:167],v[60:63],a[144:147],v[164:167]
 buffer_load_dwordx4 a[200:203],v0,s[12:15],s53 offen sc1
 v_mfma_f32_16x16x32_bf16 v[172:175],v[60:63],a[148:151],v[172:175]
 v_mfma_f32_16x16x32_bf16 v[176:179],v[64:67],a[144:147],v[176:179]
 ds_write_b128 v213,a[0:3] offset:8192
 v_mfma_f32_16x16x32_bf16 v[184:187],v[64:67],a[148:151],v[184:187]
 s_waitcnt lgkmcnt(1)
 s_barrier
 ds_read_b64_tr_b16 v[40:41],v120 offset:57344
 ds_read_b64_tr_b16 v[42:43],v120 offset:59392
 v_mfma_f32_16x16x32_bf16 v[180:183],v[68:71],a[144:147],v[180:183]
 buffer_load_dwordx4 a[204:207],v0,s[12:15],s53 offen offset:1024 sc1
 v_mfma_f32_16x16x32_bf16 v[188:191],v[68:71],a[148:151],v[188:191]
 s_cmp_eq_u32 s69,23
 s_cselect_b32 s53,s68,s65
 s_waitcnt vmcnt(13)
 v_mfma_f32_16x16x32_bf16 v[160:163],v[72:75],a[152:155],v[160:163]
 s_add_u32 s68,s57,49152
 ds_write_b128 v213,a[4:7] offset:12288
 v_mfma_f32_16x16x32_bf16 v[168:171],v[72:75],a[156:159],v[168:171]
 s_mov_b32 s65,s68
 ds_read_b64_tr_b16 v[44:45],v121 offset:57344
 ds_read_b64_tr_b16 v[46:47],v121 offset:59392
 v_mfma_f32_16x16x32_bf16 v[164:167],v[76:79],a[152:155],v[164:167]
 s_add_u32 s65,s65,2048
 buffer_load_dwordx4 a[208:211],v0,s[12:15],s53 offen sc1
 v_mfma_f32_16x16x32_bf16 v[172:175],v[76:79],a[156:159],v[172:175]
 ds_read_b64_tr_b16 v[48:49],v122 offset:57344
 ds_read_b64_tr_b16 v[50:51],v122 offset:59392
 v_mfma_f32_16x16x32_bf16 v[176:179],v[16:19],a[152:155],v[176:179]
 ds_write_b128 v213,a[8:11] offset:16384
 v_mfma_f32_16x16x32_bf16 v[184:187],v[16:19],a[156:159],v[184:187]
 ds_read_b64_tr_b16 v[52:53],v123 offset:57344
 ds_read_b64_tr_b16 v[54:55],v123 offset:59392
 v_mfma_f32_16x16x32_bf16 v[180:183],v[20:23],a[152:155],v[180:183]
 buffer_load_dwordx4 a[212:215],v0,s[12:15],s53 offen offset:1024 sc1
 v_mfma_f32_16x16x32_bf16 v[188:191],v[20:23],a[156:159],v[188:191]
 s_waitcnt vmcnt(12)
 v_readfirstlane_b32 s59,v7
 s_nop 0
 s_cmp_ge_u32 s59,16
 s_cbranch_scc0 .Lseq_slow_26
.Lseq_back_27:
 v_mfma_f32_16x16x32_bf16 v[160:163],v[24:27],a[160:163],v[160:163]
 ds_write_b128 v213,a[12:15] offset:20480
 v_mfma_f32_16x16x32_bf16 v[168:171],v[24:27],a[164:167],v[168:171]
 s_cmp_eq_u32 s45,1
 s_cselect_b32 s53,s68,s65
 ds_read_b64_tr_b16 v[56:57],v120 offset:61440
 v_mfma_f32_16x16x32_bf16 v[164:167],v[28:31],a[160:163],v[164:167]
 s_add_u32 s65,s65,2048
 buffer_load_dwordx4 a[224:227],v0,s[12:15],s53 offen sc1
 v_mfma_f32_16x16x32_bf16 v[172:175],v[28:31],a[164:167],v[172:175]
 ds_read_b64_tr_b16 v[58:59],v120 offset:63488
 ds_read_b64_tr_b16 v[60:61],v121 offset:61440
 v_mfma_f32_16x16x32_bf16 v[176:179],v[32:35],a[160:163],v[176:179]
 ds_write_b128 v213,a[16:19] offset:24576
 v_mfma_f32_16x16x32_bf16 v[184:187],v[32:35],a[164:167],v[184:187]
 ds_read_b64_tr_b16 v[62:63],v121 offset:63488
 ds_read_b64_tr_b16 v[64:65],v122 offset:61440
 v_mfma_f32_16x16x32_bf16 v[180:183],v[36:39],a[160:163],v[180:183]
 buffer_load_dwordx4 a[228:231],v0,s[12:15],s53 offen offset:1024 sc1
 v_mfma_f32_16x16x32_bf16 v[188:191],v[36:39],a[164:167],v[188:191]
 s_cmp_eq_u32 s45,2
 s_cselect_b32 s53,s68,s65
 s_waitcnt vmcnt(12) lgkmcnt(12)
 v_mfma_f32_16x16x32_bf16 v[160:163],v[40:43],a[168:171],v[160:163]
 s_add_u32 s65,s65,2048
 ds_write_b128 v213,a[20:23] offset:28672
 v_mfma_f32_16x16x32_bf16 v[168:171],v[40:43],a[172:175],v[168:171]
 ds_read_b64_tr_b16 v[66:67],v122 offset:63488
 ds_read_b64_tr_b16 v[68:69],v123 offset:61440
 v_mfma_f32_16x16x32_bf16 v[164:167],v[44:47],a[168:171],v[164:167]
 buffer_load_dwordx4 a[232:235],v0,s[12:15],s53 offen sc1
 v_mfma_f32_16x16x32_bf16 v[172:175],v[44:47],a[172:175],v[172:175]
 s_waitcnt lgkmcnt(10)
 ds_read_b64_tr_b16 v[70:71],v123 offset:63488
 ds_read_b64_tr_b16 v[72:73],v124
 v_mfma_f32_16x16x32_bf16 v[176:179],v[48:51],a[168:171],v[176:179]
 ds_write_b128 v213,v[244:247] offset:32768
 v_mfma_f32_16x16x32_bf16 v[184:187],v[48:51],a[172:175],v[184:187]
 ds_read_b64_tr_b16 v[74:75],v124 offset:2048
 ds_read_b64_tr_b16 v[76:77],v125
 v_mfma_f32_16x16x32_bf16 v[180:183],v[52:55],a[168:171],v[180:183]
 buffer_load_dwordx4 a[236:239],v0,s[12:15],s53 offen offset:1024 sc1
 v_mfma_f32_16x16x32_bf16 v[188:191],v[52:55],a[172:175],v[188:191]
 s_waitcnt vmcnt(12) lgkmcnt(9)
 ds_read_b64_tr_b16 v[78:79],v125 offset:2048
 ds_read_b64_tr_b16 v[16:17],v126
 v_mfma_f32_16x16x32_bf16 v[160:163],v[56:59],a[176:179],v[160:163]
 ds_write_b128 v213,v[240:243] offset:36864
 v_mfma_f32_16x16x32_bf16 v[168:171],v[56:59],a[180:183],v[168:171]
 s_cmp_eq_u32 s45,3
 s_cselect_b32 s53,s68,s65
 ds_read_b64_tr_b16 v[18:19],v126 offset:2048
 v_mfma_f32_16x16x32_bf16 v[164:167],v[60:63],a[176:179],v[164:167]
 s_add_u32 s65,s65,2048
 buffer_load_dwordx4 a[240:243],v0,s[12:15],s53 offen sc1
 v_mfma_f32_16x16x32_bf16 v[172:175],v[60:63],a[180:183],v[172:175]
 s_waitcnt lgkmcnt(8)
 ds_read_b64_tr_b16 v[20:21],v127
 ds_read_b64_tr_b16 v[22:23],v127 offset:2048
 v_mfma_f32_16x16x32_bf16 v[176:179],v[64:67],a[176:179],v[176:179]
 ds_write_b128 v213,v[236:239] offset:40960
 v_mfma_f32_16x16x32_bf16 v[184:187],v[64:67],a[180:183],v[184:187]
 ds_read_b64_tr_b16 v[24:25],v124 offset:4096
 ds_read_b64_tr_b16 v[26:27],v124 offset:6144
 v_mfma_f32_16x16x32_bf16 v[180:183],v[68:71],a[176:179],v[180:183]
 buffer_load_dwordx4 a[244:247],v0,s[12:15],s53 offen offset:1024 sc1
 v_mfma_f32_16x16x32_bf16 v[188:191],v[68:71],a[180:183],v[188:191]
 s_waitcnt vmcnt(12) lgkmcnt(8)
 ds_read_b64_tr_b16 v[28:29],v125 offset:4096
 ds_read_b64_tr_b16 v[30:31],v125 offset:6144
 v_mfma_f32_16x16x32_bf16 v[160:163],v[72:75],a[184:187],v[160:163]
 ds_read_b64_tr_b16 v[32:33],v126 offset:4096
 ds_read_b64_tr_b16 v[34:35],v126 offset:6144
 v_mfma_f32_16x16x32_bf16 v[168:171],v[72:75],a[188:191],v[168:171]
 ds_read_b64_tr_b16 v[36:37],v127 offset:4096
 ds_read_b64_tr_b16 v[38:39],v127 offset:6144
 v_mfma_f32_16x16x32_bf16 v[164:167],v[76:79],a[184:187],v[164:167]
 buffer_load_dwordx4 v14,s[12:15],s49 offen sc1 lds
 v_mfma_f32_16x16x32_bf16 v[172:175],v[76:79],a[188:191],v[172:175]
 s_mov_b32 s49,135168
 s_add_u32 m0,s55,4096
 s_waitcnt lgkmcnt(9)
 v_mfma_f32_16x16x32_bf16 v[176:179],v[16:19],a[184:187],v[176:179]
 ds_read_b64_tr_b16 v[40:41],v124 offset:8192
 ds_read_b64_tr_b16 v[42:43],v124 offset:10240
 v_mfma_f32_16x16x32_bf16 v[184:187],v[16:19],a[188:191],v[184:187]
 ds_read_b64_tr_b16 v[44:45],v125 offset:8192
 ds_read_b64_tr_b16 v[46:47],v125 offset:10240
 v_mfma_f32_16x16x32_bf16 v[180:183],v[20:23],a[184:187],v[180:183]
 buffer_load_dwordx4 v14,s[12:15],s49 offen sc1 lds
 v_mfma_f32_16x16x32_bf16 v[188:191],v[20:23],a[188:191],v[188:191]
 s_mov_b32 s49,139264
 s_add_u32 m0,s55,8192
 s_waitcnt vmcnt(12) lgkmcnt(8)
 v_mfma_f32_16x16x32_bf16 v[160:163],v[24:27],a[192:195],v[160:163]
 ds_read_b64_tr_b16 v[48:49],v126 offset:8192
 ds_read_b64_tr_b16 v[50:51],v126 offset:10240
 v_mfma_f32_16x16x32_bf16 v[168:171],v[24:27],a[196:199],v[168:171]
 ds_read_b64_tr_b16 v[52:53],v127 offset:8192
 ds_read_b64_tr_b16 v[54:55],v127 offset:10240
 v_mfma_f32_16x16x32_bf16 v[164:167],v[28:31],a[192:195],v[164:167]
 buffer_load_dwordx4 v14,s[12:15],s49 offen sc1 lds
 v_mfma_f32_16x16x32_bf16 v[172:175],v[28:31],a[196:199],v[172:175]
 s_mov_b32 s49,143360
 s_add_u32 m0,s55,12288
 s_waitcnt lgkmcnt(8)
 v_mfma_f32_16x16x32_bf16 v[176:179],v[32:35],a[192:195],v[176:179]
 buffer_load_dwordx4 v14,s[12:15],s49 offen sc1 lds
 v_mfma_f32_16x16x32_bf16 v[184:187],v[32:35],a[196:199],v[184:187]
 s_mov_b32 s49,147456
 s_add_u32 m0,s55,16384
 s_nop 0
 buffer_load_dwordx4 v14,s[12:15],s49 offen sc1 lds
 s_mov_b32 s49,151552
 s_add_u32 m0,s55,20480
 s_nop 0
 buffer_load_dwordx4 v14,s[12:15],s49 offen sc1 lds
 s_mov_b32 s49,155648
 s_add_u32 m0,s55,24576
 s_nop 0
 buffer_load_dwordx4 v14,s[12:15],s49 offen sc1 lds
 v_mfma_f32_16x16x32_bf16 v[180:183],v[36:39],a[192:195],v[180:183]
 s_cmp_eq_u32 s45,4
 s_cselect_b32 s53,s68,s65
 ds_read_b64_tr_b16 v[56:57],v124 offset:12288
 v_mfma_f32_16x16x32_bf16 v[188:191],v[36:39],a[196:199],v[188:191]
 s_waitcnt vmcnt(15) lgkmcnt(5)
 buffer_load_dwordx4 a[248:251],v0,s[12:15],s53 offen sc1
 buffer_load_dwordx4 a[252:255],v0,s[12:15],s53 offen offset:1024 sc1
 ds_read_b64_tr_b16 v[58:59],v124 offset:14336
 ds_read_b64_tr_b16 v[60:61],v125 offset:12288
 ds_read_b64_tr_b16 v[62:63],v125 offset:14336
 v_mfma_f32_16x16x32_bf16 v[160:163],v[40:43],a[200:203],v[160:163]
 s_add_u32 s65,s65,2048
 s_cmp_eq_u32 s45,5
 s_cselect_b32 s53,s68,s65
 v_mfma_f32_16x16x32_bf16 v[168:171],v[40:43],a[204:207],v[168:171]
 s_add_u32 s65,s65,2048
 ds_read_b64_tr_b16 v[64:65],v126 offset:12288
 ds_read_b64_tr_b16 v[66:67],v126 offset:14336
 v_mfma_f32_16x16x32_bf16 v[164:167],v[44:47],a[200:203],v[164:167]
 s_mov_b32 s49,159744
 buffer_load_dwordx4 a[24:27],v0,s[12:15],s53 offen sc1
 v_mfma_f32_16x16x32_bf16 v[172:175],v[44:47],a[204:207],v[172:175]
 s_waitcnt lgkmcnt(6)
 ds_read_b64_tr_b16 v[68:69],v127 offset:12288
 ds_read_b64_tr_b16 v[70:71],v127 offset:14336
 v_mfma_f32_16x16x32_bf16 v[176:179],v[48:51],a[200:203],v[176:179]
 s_add_u32 m0,s55,114688
 ds_write_b128 v212,v[232:235] offset:28672
 v_mfma_f32_16x16x32_bf16 v[184:187],v[48:51],a[204:207],v[184:187]
 ds_read_b64_tr_b16 v[72:73],v124 offset:16384
 ds_read_b64_tr_b16 v[74:75],v124 offset:18432
 v_mfma_f32_16x16x32_bf16 v[180:183],v[52:55],a[200:203],v[180:183]
 buffer_load_dwordx4 a[28:31],v0,s[12:15],s53 offen offset:1024 sc1
 v_mfma_f32_16x16x32_bf16 v[188:191],v[52:55],a[204:207],v[188:191]
 s_waitcnt vmcnt(17) lgkmcnt(7)
 ds_read_b64_tr_b16 v[76:77],v125 offset:16384
 ds_read_b64_tr_b16 v[78:79],v125 offset:18432
 ds_read_b64_tr_b16 v[16:17],v126 offset:16384
 ds_read_b64_tr_b16 v[18:19],v126 offset:18432
 ds_read_b64_tr_b16 v[20:21],v127 offset:16384
 ds_read_b64_tr_b16 v[22:23],v127 offset:18432
 v_mfma_f32_16x16x32_bf16 v[160:163],v[56:59],a[208:211],v[160:163]
 ds_write_b128 v212,v[208:211] offset:32768
 v_mfma_f32_16x16x32_bf16 v[168:171],v[56:59],a[212:215],v[168:171]
 s_cmp_eq_u32 s45,6
 s_cselect_b32 s53,s68,s65
 s_add_u32 s65,s65,2048
 v_mfma_f32_16x16x32_bf16 v[164:167],v[60:63],a[208:211],v[164:167]
 v_mfma_f32_16x16x32_bf16 v[172:175],v[60:63],a[212:215],v[172:175]
 s_waitcnt lgkmcnt(10)
 v_mfma_f32_16x16x32_bf16 v[176:179],v[64:67],a[208:211],v[176:179]
 ds_write_b128 v212,v[204:207] offset:36864
 v_mfma_f32_16x16x32_bf16 v[184:187],v[64:67],a[212:215],v[184:187]
 v_mov_b32 v7,0
 buffer_atomic_add v7,v3,s[12:15],0 offen offset:44 sc0 sc1
 v_mfma_f32_16x16x32_bf16 v[180:183],v[68:71],a[208:211],v[180:183]
 buffer_load_dwordx4 a[32:35],v0,s[12:15],s53 offen sc1
 v_mfma_f32_16x16x32_bf16 v[188:191],v[68:71],a[212:215],v[188:191]
 s_waitcnt lgkmcnt(2)
 buffer_load_dwordx4 a[36:39],v0,s[12:15],s53 offen offset:1024 sc1
 s_barrier
 ds_read_b64_tr_b16 v[24:25],v124 offset:20480
 ds_read_b64_tr_b16 v[26:27],v124 offset:22528
 ds_read_b64_tr_b16 v[28:29],v125 offset:20480
 ds_read_b64_tr_b16 v[30:31],v125 offset:22528
 v_mfma_f32_16x16x32_bf16 v[160:163],v[72:75],v[96:99],v[160:163]
 ds_write_b128 v212,v[200:203] offset:40960
 v_mfma_f32_16x16x32_bf16 v[168:171],v[72:75],v[100:103],v[168:171]
 s_cmp_eq_u32 s45,7
 s_cselect_b32 s53,s68,s65
 ds_read_b64_tr_b16 v[32:33],v126 offset:20480
 v_mfma_f32_16x16x32_bf16 v[164:167],v[76:79],v[96:99],v[164:167]
 s_add_u32 s65,s65,2048
 buffer_load_dwordx4 a[40:43],v0,s[12:15],s53 offen sc1
 v_mfma_f32_16x16x32_bf16 v[172:175],v[76:79],v[100:103],v[172:175]
 ds_read_b64_tr_b16 v[34:35],v126 offset:22528
 ds_read_b64_tr_b16 v[36:37],v127 offset:20480
 ds_read_b64_tr_b16 v[38:39],v127 offset:22528
 v_mfma_f32_16x16x32_bf16 v[176:179],v[16:19],v[96:99],v[176:179]
 ds_write_b128 v212,v[196:199] offset:45056
 v_mfma_f32_16x16x32_bf16 v[184:187],v[16:19],v[100:103],v[184:187]
 ds_read_b64_tr_b16 v[40:41],v124 offset:24576
 ds_read_b64_tr_b16 v[42:43],v124 offset:26624
 v_mfma_f32_16x16x32_bf16 v[180:183],v[20:23],v[96:99],v[180:183]
 buffer_load_dwordx4 a[44:47],v0,s[12:15],s53 offen offset:1024 sc1
 v_mfma_f32_16x16x32_bf16 v[188:191],v[20:23],v[100:103],v[188:191]
 s_waitcnt vmcnt(20) lgkmcnt(8)
 ds_read_b64_tr_b16 v[44:45],v125 offset:24576
 ds_read_b64_tr_b16 v[46:47],v125 offset:26624
 v_mfma_f32_16x16x32_bf16 v[160:163],v[24:27],a[224:227],v[160:163]
 ds_write_b128 v212,v[192:195] offset:49152
 v_mfma_f32_16x16x32_bf16 v[168:171],v[24:27],a[228:231],v[168:171]
 s_cmp_eq_u32 s45,8
 s_cselect_b32 s53,s68,s65
 ds_read_b64_tr_b16 v[48:49],v126 offset:24576
 v_mfma_f32_16x16x32_bf16 v[164:167],v[28:31],a[224:227],v[164:167]
 s_add_u32 s65,s65,2048
 buffer_load_dwordx4 a[48:51],v0,s[12:15],s53 offen sc1
 v_mfma_f32_16x16x32_bf16 v[172:175],v[28:31],a[228:231],v[172:175]
 s_waitcnt lgkmcnt(7)
 ds_read_b64_tr_b16 v[50:51],v126 offset:26624
 ds_read_b64_tr_b16 v[52:53],v127 offset:24576
 ds_read_b64_tr_b16 v[54:55],v127 offset:26624
 v_mfma_f32_16x16x32_bf16 v[176:179],v[32:35],a[224:227],v[176:179]
 ds_read_b64_tr_b16 v[56:57],v124 offset:28672
 ds_read_b64_tr_b16 v[58:59],v124 offset:30720
 v_mfma_f32_16x16x32_bf16 v[184:187],v[32:35],a[228:231],v[184:187]
 ds_read_b64_tr_b16 v[60:61],v125 offset:28672
 ds_read_b64_tr_b16 v[62:63],v125 offset:30720
 v_mfma_f32_16x16x32_bf16 v[180:183],v[36:39],a[224:227],v[180:183]
 buffer_load_dwordx4 a[52:55],v0,s[12:15],s53 offen offset:1024 sc1
 v_mfma_f32_16x16x32_bf16 v[188:191],v[36:39],a[228:231],v[188:191]
 s_cmp_eq_u32 s45,9
 s_cselect_b32 s53,s68,s65
 s_waitcnt vmcnt(20) lgkmcnt(9)
 v_mfma_f32_16x16x32_bf16 v[160:163],v[40:43],a[232:235],v[160:163]
 s_add_u32 s65,s65,2048
 ds_read_b64_tr_b16 v[64:65],v126 offset:28672
 ds_read_b64_tr_b16 v[66:67],v126 offset:30720
 v_mfma_f32_16x16x32_bf16 v[168:171],v[40:43],a[236:239],v[168:171]
 ds_read_b64_tr_b16 v[68:69],v127 offset:28672
 ds_read_b64_tr_b16 v[70:71],v127 offset:30720
 v_mfma_f32_16x16x32_bf16 v[164:167],v[44:47],a[232:235],v[164:167]
 buffer_load_dwordx4 a[56:59],v0,s[12:15],s53 offen sc1
 v_mfma_f32_16x16x32_bf16 v[172:175],v[44:47],a[236:239],v[172:175]
 s_waitcnt lgkmcnt(8)
 ds_read_b64_tr_b16 v[72:73],v124 offset:32768
 ds_read_b64_tr_b16 v[74:75],v124 offset:34816
 v_mfma_f32_16x16x32_bf16 v[176:179],v[48:51],a[232:235],v[176:179]
 ds_read_b64_tr_b16 v[76:77],v125 offset:32768
 ds_read_b64_tr_b16 v[78:79],v125 offset:34816
 v_mfma_f32_16x16x32_bf16 v[184:187],v[48:51],a[236:239],v[184:187]
 ds_read_b64_tr_b16 v[16:17],v126 offset:32768
 ds_read_b64_tr_b16 v[18:19],v126 offset:34816
 v_mfma_f32_16x16x32_bf16 v[180:183],v[52:55],a[232:235],v[180:183]
 buffer_load_dwordx4 a[60:63],v0,s[12:15],s53 offen offset:1024 sc1
 v_mfma_f32_16x16x32_bf16 v[188:191],v[52:55],a[236:239],v[188:191]
 s_cmp_eq_u32 s45,10
 s_cselect_b32 s53,s68,s65
 s_waitcnt vmcnt(20) lgkmcnt(10)
 v_mfma_f32_16x16x32_bf16 v[160:163],v[56:59],a[240:243],v[160:163]
 s_add_u32 s65,s65,2048
 ds_read_b64_tr_b16 v[20:21],v127 offset:32768
 ds_read_b64_tr_b16 v[22:23],v127 offset:34816
 v_mfma_f32_16x16x32_bf16 v[168:171],v[56:59],a[244:247],v[168:171]
 ds_read_b64_tr_b16 v[24:25],v124 offset:36864
 ds_read_b64_tr_b16 v[26:27],v124 offset:38912
 v_mfma_f32_16x16x32_bf16 v[164:167],v[60:63],a[240:243],v[164:167]
 buffer_load_dwordx4 a[64:67],v0,s[12:15],s53 offen sc1
 v_mfma_f32_16x16x32_bf16 v[172:175],v[60:63],a[244:247],v[172:175]
 s_waitcnt lgkmcnt(10)
 ds_read_b64_tr_b16 v[28:29],v125 offset:36864
 ds_read_b64_tr_b16 v[30:31],v125 offset:38912
 v_mfma_f32_16x16x32_bf16 v[176:179],v[64:67],a[240:243],v[176:179]
 ds_read_b64_tr_b16 v[32:33],v126 offset:36864
 ds_read_b64_tr_b16 v[34:35],v126 offset:38912
 v_mfma_f32_16x16x32_bf16 v[184:187],v[64:67],a[244:247],v[184:187]
 ds_read_b64_tr_b16 v[36:37],v127 offset:36864
 ds_read_b64_tr_b16 v[38:39],v127 offset:38912
 v_mfma_f32_16x16x32_bf16 v[180:183],v[68:71],a[240:243],v[180:183]
 buffer_load_dwordx4 a[68:71],v0,s[12:15],s53 offen offset:1024 sc1
 v_mfma_f32_16x16x32_bf16 v[188:191],v[68:71],a[244:247],v[188:191]
 s_cmp_eq_u32 s45,11
 s_cselect_b32 s53,s68,s65
 s_waitcnt vmcnt(13) lgkmcnt(12)
 v_mfma_f32_16x16x32_bf16 v[160:163],v[72:75],a[248:251],v[160:163]
 s_add_u32 s65,s65,2048
 ds_read_b64_tr_b16 v[40:41],v124 offset:40960
 ds_read_b64_tr_b16 v[42:43],v124 offset:43008
 v_mfma_f32_16x16x32_bf16 v[168:171],v[72:75],a[252:255],v[168:171]
 ds_read_b64_tr_b16 v[44:45],v125 offset:40960
 ds_read_b64_tr_b16 v[46:47],v125 offset:43008
 v_mfma_f32_16x16x32_bf16 v[164:167],v[76:79],a[248:251],v[164:167]
 buffer_load_dwordx4 v14,s[12:15],s49 offen sc1 lds
 v_mfma_f32_16x16x32_bf16 v[172:175],v[76:79],a[252:255],v[172:175]
 s_mov_b32 s49,163840
 s_add_u32 m0,s55,118784
 s_waitcnt lgkmcnt(12)
 v_mfma_f32_16x16x32_bf16 v[176:179],v[16:19],a[248:251],v[176:179]
 buffer_load_dwordx4 v14,s[12:15],s49 offen sc1 lds
 v_mfma_f32_16x16x32_bf16 v[184:187],v[16:19],a[252:255],v[184:187]
 ds_read_b64_tr_b16 v[48:49],v126 offset:40960
 ds_read_b64_tr_b16 v[50:51],v126 offset:43008
 v_mfma_f32_16x16x32_bf16 v[180:183],v[20:23],a[248:251],v[180:183]
 buffer_load_dwordx4 a[72:75],v0,s[12:15],s53 offen sc1
 v_mfma_f32_16x16x32_bf16 v[188:191],v[20:23],a[252:255],v[188:191]
 s_waitcnt vmcnt(14) lgkmcnt(10)
 buffer_load_dwordx4 a[76:79],v0,s[12:15],s53 offen offset:1024 sc1
 v_mfma_f32_16x16x32_bf16 v[160:163],v[24:27],a[24:27],v[160:163]
 s_cmp_eq_u32 s45,12
 s_cselect_b32 s53,s68,s65
 ds_read_b64_tr_b16 v[52:53],v127 offset:40960
 v_mfma_f32_16x16x32_bf16 v[168:171],v[24:27],a[28:31],v[168:171]
 s_add_u32 s65,s65,2048
 ds_read_b64_tr_b16 v[54:55],v127 offset:43008
 ds_read_b64_tr_b16 v[56:57],v124 offset:45056
 v_mfma_f32_16x16x32_bf16 v[164:167],v[28:31],a[24:27],v[164:167]
 s_waitcnt vmcnt(14)
 v_readfirstlane_b32 s59,v7
 s_nop 0
 s_cmp_ge_u32 s59,16
 s_cbranch_scc0 .Lseq_slow_28
.Lseq_back_29:
 v_mfma_f32_16x16x32_bf16 v[172:175],v[28:31],a[28:31],v[172:175]
 s_waitcnt lgkmcnt(9)
 buffer_load_dwordx4 a[80:83],v0,s[12:15],s53 offen sc1
 v_mfma_f32_16x16x32_bf16 v[176:179],v[32:35],a[24:27],v[176:179]
 ds_read_b64_tr_b16 v[58:59],v124 offset:47104
 ds_read_b64_tr_b16 v[60:61],v125 offset:45056
 v_mfma_f32_16x16x32_bf16 v[184:187],v[32:35],a[28:31],v[184:187]
 ds_read_b64_tr_b16 v[62:63],v125 offset:47104
 ds_read_b64_tr_b16 v[64:65],v126 offset:45056
 v_mfma_f32_16x16x32_bf16 v[180:183],v[36:39],a[24:27],v[180:183]
 buffer_load_dwordx4 a[84:87],v0,s[12:15],s53 offen offset:1024 sc1
 v_mfma_f32_16x16x32_bf16 v[188:191],v[36:39],a[28:31],v[188:191]
 s_waitcnt vmcnt(14) lgkmcnt(9)
 ds_read_b64_tr_b16 v[66:67],v126 offset:47104
 ds_read_b64_tr_b16 v[68:69],v127 offset:45056
 ds_read_b64_tr_b16 v[70:71],v127 offset:47104
 v_mfma_f32_16x16x32_bf16 v[160:163],v[40:43],a[32:35],v[160:163]
 s_cmp_eq_u32 s45,13
 s_cselect_b32 s53,s68,s65
 s_add_u32 s65,s65,2048
 v_mfma_f32_16x16x32_bf16 v[168:171],v[40:43],a[36:39],v[168:171]
 v_mfma_f32_16x16x32_bf16 v[164:167],v[44:47],a[32:35],v[164:167]
 buffer_load_dwordx4 a[88:91],v0,s[12:15],s53 offen sc1
 v_mfma_f32_16x16x32_bf16 v[172:175],v[44:47],a[36:39],v[172:175]
 s_waitcnt lgkmcnt(8)
 v_mfma_f32_16x16x32_bf16 v[176:179],v[48:51],a[32:35],v[176:179]
 v_mfma_f32_16x16x32_bf16 v[184:187],v[48:51],a[36:39],v[184:187]
 v_mfma_f32_16x16x32_bf16 v[180:183],v[52:55],a[32:35],v[180:183]
 buffer_load_dwordx4 a[92:95],v0,s[12:15],s53 offen offset:1024 sc1
 v_mfma_f32_16x16x32_bf16 v[188:191],v[52:55],a[36:39],v[188:191]
 s_waitcnt lgkmcnt(0) vmcnt(14)
 s_barrier
 ds_read_b64_tr_b16 v[72:73],v120
 ds_read_b64_tr_b16 v[74:75],v120 offset:2048
 ds_read_b64_tr_b16 v[76:77],v121
 ds_read_b64_tr_b16 v[78:79],v121 offset:2048
 v_mfma_f32_16x16x32_bf16 v[160:163],v[56:59],a[40:43],v[160:163]
 s_branch .Lsk20
.Lvs4_1:
 s_branch .Lvb4
.Lsk20:
 s_cmp_eq_u32 s45,14
 s_cselect_b32 s53,s68,s65
 ds_read_b64_tr_b16 v[16:17],v122
 v_mfma_f32_16x16x32_bf16 v[168:171],v[56:59],a[44:47],v[168:171]
 s_add_u32 s65,s65,2048
 ds_read_b64_tr_b16 v[18:19],v122 offset:2048
 ds_read_b64_tr_b16 v[20:21],v123
 v_mfma_f32_16x16x32_bf16 v[164:167],v[60:63],a[40:43],v[164:167]
 buffer_load_dwordx4 a[96:99],v0,s[12:15],s53 offen sc1
 v_mfma_f32_16x16x32_bf16 v[172:175],v[60:63],a[44:47],v[172:175]
 ds_read_b64_tr_b16 v[22:23],v123 offset:2048
 ds_read_b64_tr_b16 v[24:25],v120 offset:4096
 v_mfma_f32_16x16x32_bf16 v[176:179],v[64:67],a[40:43],v[176:179]
 ds_read_b64_tr_b16 v[26:27],v120 offset:6144
 ds_read_b64_tr_b16 v[28:29],v121 offset:4096
 v_mfma_f32_16x16x32_bf16 v[184:187],v[64:67],a[44:47],v[184:187]
 ds_read_b64_tr_b16 v[30:31],v121 offset:6144
 ds_read_b64_tr_b16 v[32:33],v122 offset:4096
 v_mfma_f32_16x16x32_bf16 v[180:183],v[68:71],a[40:43],v[180:183]
 buffer_load_dwordx4 a[100:103],v0,s[12:15],s53 offen offset:1024 sc1
 v_mfma_f32_16x16x32_bf16 v[188:191],v[68:71],a[44:47],v[188:191]
 s_cmp_eq_u32 s45,15
 s_cselect_b32 s53,s68,s65
 s_waitcnt vmcnt(14) lgkmcnt(9)
 v_mfma_f32_16x16x32_bf16 v[160:163],v[72:75],a[48:51],v[160:163]
 s_add_u32 s68,s57,81920
 ds_read_b64_tr_b16 v[34:35],v122 offset:6144
 ds_read_b64_tr_b16 v[36:37],v123 offset:4096
 v_mfma_f32_16x16x32_bf16 v[168:171],v[72:75],a[52:55],v[168:171]
 s_mov_b32 s65,s68
 ds_read_b64_tr_b16 v[38:39],v123 offset:6144
 ds_read_b64_tr_b16 v[40:41],v120 offset:8192
 v_mfma_f32_16x16x32_bf16 v[164:167],v[76:79],a[48:51],v[164:167]
 s_add_u32 s65,s65,2048
 buffer_load_dwordx4 a[104:107],v0,s[12:15],s53 offen sc1
 v_mfma_f32_16x16x32_bf16 v[172:175],v[76:79],a[52:55],v[172:175]
 s_waitcnt lgkmcnt(9)
 ds_read_b64_tr_b16 v[42:43],v120 offset:10240
 ds_read_b64_tr_b16 v[44:45],v121 offset:8192
 v_mfma_f32_16x16x32_bf16 v[176:179],v[16:19],a[48:51],v[176:179]
 ds_read_b64_tr_b16 v[46:47],v121 offset:10240
 ds_read_b64_tr_b16 v[48:49],v122 offset:8192
 v_mfma_f32_16x16x32_bf16 v[184:187],v[16:19],a[52:55],v[184:187]
 ds_read_b64_tr_b16 v[50:51],v122 offset:10240
 ds_read_b64_tr_b16 v[52:53],v123 offset:8192
 v_mfma_f32_16x16x32_bf16 v[180:183],v[20:23],a[48:51],v[180:183]
 buffer_load_dwordx4 a[108:111],v0,s[12:15],s53 offen offset:1024 sc1
 v_mfma_f32_16x16x32_bf16 v[188:191],v[20:23],a[52:55],v[188:191]
 s_cmp_eq_u32 s45,1
 s_cselect_b32 s53,s68,s65
 s_waitcnt vmcnt(14) lgkmcnt(11)
 v_mfma_f32_16x16x32_bf16 v[160:163],v[24:27],a[56:59],v[160:163]
 s_add_u32 s65,s65,2048
 ds_read_b64_tr_b16 v[54:55],v123 offset:10240
 ds_read_b64_tr_b16 v[56:57],v120 offset:12288
 v_mfma_f32_16x16x32_bf16 v[168:171],v[24:27],a[60:63],v[168:171]
 ds_read_b64_tr_b16 v[58:59],v120 offset:14336
 ds_read_b64_tr_b16 v[60:61],v121 offset:12288
 v_mfma_f32_16x16x32_bf16 v[164:167],v[28:31],a[56:59],v[164:167]
 buffer_load_dwordx4 a[120:123],v0,s[12:15],s53 offen sc1
 v_mfma_f32_16x16x32_bf16 v[172:175],v[28:31],a[60:63],v[172:175]
 s_waitcnt lgkmcnt(11)
 ds_read_b64_tr_b16 v[62:63],v121 offset:14336
 ds_read_b64_tr_b16 v[64:65],v122 offset:12288
 v_mfma_f32_16x16x32_bf16 v[176:179],v[32:35],a[56:59],v[176:179]
 ds_read_b64_tr_b16 v[66:67],v122 offset:14336
 ds_read_b64_tr_b16 v[68:69],v123 offset:12288
 v_mfma_f32_16x16x32_bf16 v[184:187],v[32:35],a[60:63],v[184:187]
 ds_read_b64_tr_b16 v[70:71],v123 offset:14336
 ds_read_b64_tr_b16 v[72:73],v120 offset:16384
 v_mfma_f32_16x16x32_bf16 v[180:183],v[36:39],a[56:59],v[180:183]
 buffer_load_dwordx4 a[124:127],v0,s[12:15],s53 offen offset:1024 sc1
 v_mfma_f32_16x16x32_bf16 v[188:191],v[36:39],a[60:63],v[188:191]
 s_cmp_eq_u32 s45,2
 s_cselect_b32 s53,s68,s65
 s_waitcnt vmcnt(14) lgkmcnt(13)
 v_mfma_f32_16x16x32_bf16 v[160:163],v[40:43],a[64:67],v[160:163]
 s_add_u32 s65,s65,2048
 ds_read_b64_tr_b16 v[74:75],v120 offset:18432
 ds_read_b64_tr_b16 v[76:77],v121 offset:16384
 v_mfma_f32_16x16x32_bf16 v[168:171],v[40:43],a[68:71],v[168:171]
 ds_read_b64_tr_b16 v[78:79],v121 offset:18432
 ds_read_b64_tr_b16 v[16:17],v122 offset:16384
 v_mfma_f32_16x16x32_bf16 v[164:167],v[44:47],a[64:67],v[164:167]
 buffer_load_dwordx4 a[128:131],v0,s[12:15],s53 offen sc1
 v_mfma_f32_16x16x32_bf16 v[172:175],v[44:47],a[68:71],v[172:175]
 s_waitcnt lgkmcnt(13)
 ds_read_b64_tr_b16 v[18:19],v122 offset:18432
 ds_read_b64_tr_b16 v[20:21],v123 offset:16384
 v_mfma_f32_16x16x32_bf16 v[176:179],v[48:51],a[64:67],v[176:179]
 ds_read_b64_tr_b16 v[22:23],v123 offset:18432
 ds_read_b64_tr_b16 v[24:25],v120 offset:20480
 v_mfma_f32_16x16x32_bf16 v[184:187],v[48:51],a[68:71],v[184:187]
 ds_read_b64_tr_b16 v[26:27],v120 offset:22528
 ds_read_b64_tr_b16 v[28:29],v121 offset:20480
 v_mfma_f32_16x16x32_bf16 v[180:183],v[52:55],a[64:67],v[180:183]
 buffer_load_dwordx4 a[132:135],v0,s[12:15],s53 offen offset:1024 sc1
 v_mfma_f32_16x16x32_bf16 v[188:191],v[52:55],a[68:71],v[188:191]
 s_cmp_eq_u32 s45,3
 s_cselect_b32 s53,s68,s65
 s_waitcnt vmcnt(12) lgkmcnt(14)
 v_mfma_f32_16x16x32_bf16 v[160:163],v[56:59],a[72:75],v[160:163]
 s_add_u32 s65,s65,2048
 ds_read_b64_tr_b16 v[30:31],v121 offset:22528
 ds_read_b64_tr_b16 v[32:33],v122 offset:20480
 v_mfma_f32_16x16x32_bf16 v[168:171],v[56:59],a[76:79],v[168:171]
 ds_read_b64_tr_b16 v[34:35],v122 offset:22528
 ds_read_b64_tr_b16 v[36:37],v123 offset:20480
 v_mfma_f32_16x16x32_bf16 v[164:167],v[60:63],a[72:75],v[164:167]
 buffer_load_dwordx4 a[136:139],v0,s[12:15],s53 offen sc1
 v_mfma_f32_16x16x32_bf16 v[172:175],v[60:63],a[76:79],v[172:175]
 s_waitcnt lgkmcnt(14)
 ds_read_b64_tr_b16 v[38:39],v123 offset:22528
 ds_read_b64_tr_b16 v[40:41],v120 offset:24576
 v_mfma_f32_16x16x32_bf16 v[176:179],v[64:67],a[72:75],v[176:179]
 ds_read_b64_tr_b16 v[42:43],v120 offset:26624
 ds_read_b64_tr_b16 v[44:45],v121 offset:24576
 v_mfma_f32_16x16x32_bf16 v[184:187],v[64:67],a[76:79],v[184:187]
 ds_read_b64_tr_b16 v[46:47],v121 offset:26624
 ds_read_b64_tr_b16 v[48:49],v122 offset:24576
 v_mfma_f32_16x16x32_bf16 v[180:183],v[68:71],a[72:75],v[180:183]
 buffer_load_dwordx4 a[140:143],v0,s[12:15],s53 offen offset:1024 sc1
 v_mfma_f32_16x16x32_bf16 v[188:191],v[68:71],a[76:79],v[188:191]
 s_cmp_eq_u32 s45,4
 s_cselect_b32 s53,s68,s65
 s_waitcnt vmcnt(12) lgkmcnt(14)
 v_mfma_f32_16x16x32_bf16 v[160:163],v[72:75],a[80:83],v[160:163]
 s_add_u32 s65,s65,2048
 ds_read_b64_tr_b16 v[50:51],v122 offset:26624
 ds_read_b64_tr_b16 v[52:53],v123 offset:24576
 v_mfma_f32_16x16x32_bf16 v[168:171],v[72:75],a[84:87],v[168:171]
 ds_read_b64_tr_b16 v[54:55],v123 offset:26624
 v_mfma_f32_16x16x32_bf16 v[164:167],v[76:79],a[80:83],v[164:167]
 buffer_load_dwordx4 a[144:147],v0,s[12:15],s53 offen sc1
 v_mfma_f32_16x16x32_bf16 v[172:175],v[76:79],a[84:87],v[172:175]
 s_waitcnt lgkmcnt(14)
 v_mfma_f32_16x16x32_bf16 v[176:179],v[16:19],a[80:83],v[176:179]
 v_mfma_f32_16x16x32_bf16 v[184:187],v[16:19],a[84:87],v[184:187]
 v_mfma_f32_16x16x32_bf16 v[180:183],v[20:23],a[80:83],v[180:183]
 buffer_load_dwordx4 a[148:151],v0,s[12:15],s53 offen offset:1024 sc1
 v_mfma_f32_16x16x32_bf16 v[188:191],v[20:23],a[84:87],v[188:191]
 s_cmp_eq_u32 s45,5
 s_cselect_b32 s53,s68,s65
 s_waitcnt vmcnt(12) lgkmcnt(12)
 v_mfma_f32_16x16x32_bf16 v[160:163],v[24:27],a[88:91],v[160:163]
 s_add_u32 s65,s65,2048
 v_mfma_f32_16x16x32_bf16 v[168:171],v[24:27],a[92:95],v[168:171]
 s_waitcnt lgkmcnt(0)
 s_barrier
 ds_read_b64_tr_b16 v[56:57],v124 offset:49152
 ds_read_b64_tr_b16 v[58:59],v124 offset:51200
 v_mfma_f32_16x16x32_bf16 v[164:167],v[28:31],a[88:91],v[164:167]
 buffer_load_dwordx4 a[152:155],v0,s[12:15],s53 offen sc1
 v_mfma_f32_16x16x32_bf16 v[172:175],v[28:31],a[92:95],v[172:175]
 ds_read_b64_tr_b16 v[60:61],v125 offset:49152
 ds_read_b64_tr_b16 v[62:63],v125 offset:51200
 v_mfma_f32_16x16x32_bf16 v[176:179],v[32:35],a[88:91],v[176:179]
 ds_read_b64_tr_b16 v[64:65],v126 offset:49152
 ds_read_b64_tr_b16 v[66:67],v126 offset:51200
 v_mfma_f32_16x16x32_bf16 v[184:187],v[32:35],a[92:95],v[184:187]
 ds_read_b64_tr_b16 v[68:69],v127 offset:49152
 ds_read_b64_tr_b16 v[70:71],v127 offset:51200
 v_mfma_f32_16x16x32_bf16 v[180:183],v[36:39],a[88:91],v[180:183]
 buffer_load_dwordx4 a[156:159],v0,s[12:15],s53 offen offset:1024 sc1
 v_mfma_f32_16x16x32_bf16 v[188:191],v[36:39],a[92:95],v[188:191]
 s_cmp_eq_u32 s45,6
 s_cselect_b32 s53,s68,s65
 s_waitcnt vmcnt(12)
 v_mfma_f32_16x16x32_bf16 v[160:163],v[40:43],a[96:99],v[160:163]
 s_add_u32 s65,s65,2048
 ds_read_b64_tr_b16 v[72:73],v124 offset:53248
 ds_read_b64_tr_b16 v[74:75],v124 offset:55296
 v_mfma_f32_16x16x32_bf16 v[168:171],v[40:43],a[100:103],v[168:171]
 ds_read_b64_tr_b16 v[76:77],v125 offset:53248
 ds_read_b64_tr_b16 v[78:79],v125 offset:55296
 v_mfma_f32_16x16x32_bf16 v[164:167],v[44:47],a[96:99],v[164:167]
 ds_read_b64_tr_b16 v[16:17],v126 offset:53248
 ds_read_b64_tr_b16 v[18:19],v126 offset:55296
 v_mfma_f32_16x16x32_bf16 v[172:175],v[44:47],a[100:103],v[172:175]
 buffer_load_dwordx4 a[160:163],v0,s[12:15],s53 offen sc1
 v_mfma_f32_16x16x32_bf16 v[176:179],v[48:51],a[96:99],v[176:179]
 ds_read_b64_tr_b16 v[20:21],v127 offset:53248
 ds_read_b64_tr_b16 v[22:23],v127 offset:55296
 v_mfma_f32_16x16x32_bf16 v[184:187],v[48:51],a[100:103],v[184:187]
 ds_read_b64_tr_b16 v[24:25],v124 offset:57344
 ds_read_b64_tr_b16 v[26:27],v124 offset:59392
 v_mfma_f32_16x16x32_bf16 v[180:183],v[52:55],a[96:99],v[180:183]
 ds_read_b64_tr_b16 v[28:29],v125 offset:57344
 ds_read_b64_tr_b16 v[30:31],v125 offset:59392
 v_mfma_f32_16x16x32_bf16 v[188:191],v[52:55],a[100:103],v[188:191]
 s_waitcnt vmcnt(11) lgkmcnt(14)
 buffer_load_dwordx4 a[164:167],v0,s[12:15],s53 offen offset:1024 sc1
 v_mfma_f32_16x16x32_bf16 v[160:163],v[56:59],a[104:107],v[160:163]
 s_cmp_eq_u32 s45,7
 s_cselect_b32 s53,s68,s65
 ds_read_b64_tr_b16 v[32:33],v126 offset:57344
 v_mfma_f32_16x16x32_bf16 v[168:171],v[56:59],a[108:111],v[168:171]
 s_add_u32 s65,s65,2048
 ds_read_b64_tr_b16 v[34:35],v126 offset:59392
 ds_read_b64_tr_b16 v[36:37],v127 offset:57344
 v_mfma_f32_16x16x32_bf16 v[164:167],v[60:63],a[104:107],v[164:167]
 ds_read_b64_tr_b16 v[38:39],v127 offset:59392
 ds_read_b64_tr_b16 v[40:41],v124 offset:61440
 v_mfma_f32_16x16x32_bf16 v[172:175],v[60:63],a[108:111],v[172:175]
 s_waitcnt lgkmcnt(14)
 buffer_load_dwordx4 a[168:171],v0,s[12:15],s53 offen sc1
 v_mfma_f32_16x16x32_bf16 v[176:179],v[64:67],a[104:107],v[176:179]
 ds_read_b64_tr_b16 v[42:43],v124 offset:63488
 ds_read_b64_tr_b16 v[44:45],v125 offset:61440
 v_mfma_f32_16x16x32_bf16 v[184:187],v[64:67],a[108:111],v[184:187]
 ds_read_b64_tr_b16 v[46:47],v125 offset:63488
 ds_read_b64_tr_b16 v[48:49],v126 offset:61440
 v_mfma_f32_16x16x32_bf16 v[180:183],v[68:71],a[104:107],v[180:183]
 ds_read_b64_tr_b16 v[50:51],v126 offset:63488
 ds_read_b64_tr_b16 v[52:53],v127 offset:61440
 v_mfma_f32_16x16x32_bf16 v[188:191],v[68:71],a[108:111],v[188:191]
 s_waitcnt lgkmcnt(14)
 buffer_load_dwordx4 a[172:175],v0,s[12:15],s53 offen offset:1024 sc1
 v_mfma_f32_16x16x32_bf16 v[160:163],v[72:75],v[80:83],v[160:163]
 s_cmp_eq_u32 s45,8
 s_cselect_b32 s53,s68,s65
 ds_read_b64_tr_b16 v[54:55],v127 offset:63488
 v_mfma_f32_16x16x32_bf16 v[168:171],v[72:75],v[84:87],v[168:171]
 s_add_u32 s65,s65,2048
 ds_read_b64_tr_b16 v[56:57],v128
 ds_read_b64_tr_b16 v[58:59],v128 offset:2048
 v_mfma_f32_16x16x32_bf16 v[164:167],v[76:79],v[80:83],v[164:167]
 ds_read_b64_tr_b16 v[60:61],v129
 ds_read_b64_tr_b16 v[62:63],v129 offset:2048
 v_mfma_f32_16x16x32_bf16 v[172:175],v[76:79],v[84:87],v[172:175]
 buffer_load_dwordx4 a[176:179],v0,s[12:15],s53 offen sc1
 v_mfma_f32_16x16x32_bf16 v[176:179],v[16:19],v[80:83],v[176:179]
 ds_read_b64_tr_b16 v[64:65],v130
 ds_read_b64_tr_b16 v[66:67],v130 offset:2048
 v_mfma_f32_16x16x32_bf16 v[184:187],v[16:19],v[84:87],v[184:187]
 ds_read_b64_tr_b16 v[68:69],v131
 ds_read_b64_tr_b16 v[70:71],v131 offset:2048
 v_mfma_f32_16x16x32_bf16 v[180:183],v[20:23],v[80:83],v[180:183]
 ds_read_b64_tr_b16 v[72:73],v128 offset:4096
 ds_read_b64_tr_b16 v[74:75],v128 offset:6144
 v_mfma_f32_16x16x32_bf16 v[188:191],v[20:23],v[84:87],v[188:191]
 s_waitcnt vmcnt(13) lgkmcnt(14)
 buffer_load_dwordx4 a[180:183],v0,s[12:15],s53 offen offset:1024 sc1
 v_mfma_f32_16x16x32_bf16 v[160:163],v[24:27],a[120:123],v[160:163]
 s_cmp_eq_u32 s45,9
 s_cselect_b32 s53,s68,s65
 s_add_u32 s65,s65,2048
 v_mfma_f32_16x16x32_bf16 v[168:171],v[24:27],a[124:127],v[168:171]
 ds_read_b64_tr_b16 v[76:77],v129 offset:4096
 ds_read_b64_tr_b16 v[78:79],v129 offset:6144
 v_mfma_f32_16x16x32_bf16 v[164:167],v[28:31],a[120:123],v[164:167]
 ds_read_b64_tr_b16 v[16:17],v130 offset:4096
 ds_read_b64_tr_b16 v[18:19],v130 offset:6144
 v_mfma_f32_16x16x32_bf16 v[172:175],v[28:31],a[124:127],v[172:175]
 buffer_load_dwordx4 a[184:187],v0,s[12:15],s53 offen sc1
 v_mfma_f32_16x16x32_bf16 v[176:179],v[32:35],a[120:123],v[176:179]
 ds_read_b64_tr_b16 v[20:21],v131 offset:4096
 ds_read_b64_tr_b16 v[22:23],v131 offset:6144
 v_mfma_f32_16x16x32_bf16 v[184:187],v[32:35],a[124:127],v[184:187]
 ds_read_b64_tr_b16 v[24:25],v128 offset:8192
 ds_read_b64_tr_b16 v[26:27],v128 offset:10240
 v_mfma_f32_16x16x32_bf16 v[180:183],v[36:39],a[120:123],v[180:183]
 ds_read_b64_tr_b16 v[28:29],v129 offset:8192
 ds_read_b64_tr_b16 v[30:31],v129 offset:10240
 v_mfma_f32_16x16x32_bf16 v[188:191],v[36:39],a[124:127],v[188:191]
 s_waitcnt vmcnt(13)
 buffer_load_dwordx4 a[188:191],v0,s[12:15],s53 offen offset:1024 sc1
 v_mfma_f32_16x16x32_bf16 v[160:163],v[40:43],a[128:131],v[160:163]
 s_cmp_eq_u32 s45,10
 s_cselect_b32 s53,s68,s65
 s_add_u32 s65,s65,2048
 v_mfma_f32_16x16x32_bf16 v[168:171],v[40:43],a[132:135],v[168:171]
 ds_read_b64_tr_b16 v[32:33],v130 offset:8192
 ds_read_b64_tr_b16 v[34:35],v130 offset:10240
 v_mfma_f32_16x16x32_bf16 v[164:167],v[44:47],a[128:131],v[164:167]
 ds_read_b64_tr_b16 v[36:37],v131 offset:8192
 ds_read_b64_tr_b16 v[38:39],v131 offset:10240
 v_mfma_f32_16x16x32_bf16 v[172:175],v[44:47],a[132:135],v[172:175]
 s_waitcnt lgkmcnt(14)
 buffer_load_dwordx4 a[192:195],v0,s[12:15],s53 offen sc1
 v_mfma_f32_16x16x32_bf16 v[176:179],v[48:51],a[128:131],v[176:179]
 ds_read_b64_tr_b16 v[40:41],v128 offset:12288
 ds_read_b64_tr_b16 v[42:43],v128 offset:14336
 v_mfma_f32_16x16x32_bf16 v[184:187],v[48:51],a[132:135],v[184:187]
 ds_read_b64_tr_b16 v[44:45],v129 offset:12288
 ds_read_b64_tr_b16 v[46:47],v129 offset:14336
 v_mfma_f32_16x16x32_bf16 v[180:183],v[52:55],a[128:131],v[180:183]
 ds_read_b64_tr_b16 v[48:49],v130 offset:12288
 ds_read_b64_tr_b16 v[50:51],v130 offset:14336
 v_mfma_f32_16x16x32_bf16 v[188:191],v[52:55],a[132:135],v[188:191]
 s_waitcnt vmcnt(13)
 buffer_load_dwordx4 a[196:199],v0,s[12:15],s53 offen offset:1024 sc1
 v_mfma_f32_16x16x32_bf16 v[160:163],v[56:59],a[136:139],v[160:163]
 s_cmp_eq_u32 s45,11
 s_cselect_b32 s53,s68,s65
 s_add_u32 s65,s65,2048
 v_mfma_f32_16x16x32_bf16 v[168:171],v[56:59],a[140:143],v[168:171]
 ds_read_b64_tr_b16 v[52:53],v131 offset:12288
 ds_read_b64_tr_b16 v[54:55],v131 offset:14336
 v_mfma_f32_16x16x32_bf16 v[164:167],v[60:63],a[136:139],v[164:167]
 ds_read_b64_tr_b16 v[56:57],v128 offset:16384
 ds_read_b64_tr_b16 v[58:59],v128 offset:18432
 v_mfma_f32_16x16x32_bf16 v[172:175],v[60:63],a[140:143],v[172:175]
 ds_read_b64_tr_b16 v[60:61],v129 offset:16384
 ds_read_b64_tr_b16 v[62:63],v129 offset:18432
 v_mfma_f32_16x16x32_bf16 v[176:179],v[64:67],a[136:139],v[176:179]
 buffer_load_dwordx4 a[200:203],v0,s[12:15],s53 offen sc1
 v_mfma_f32_16x16x32_bf16 v[184:187],v[64:67],a[140:143],v[184:187]
 ds_read_b64_tr_b16 v[64:65],v130 offset:16384
 ds_read_b64_tr_b16 v[66:67],v130 offset:18432
 v_mfma_f32_16x16x32_bf16 v[180:183],v[68:71],a[136:139],v[180:183]
 v_mfma_f32_16x16x32_bf16 v[188:191],v[68:71],a[140:143],v[188:191]
 s_waitcnt vmcnt(13) lgkmcnt(14)
 ds_read_b64_tr_b16 v[68:69],v131 offset:16384
 ds_read_b64_tr_b16 v[70:71],v131 offset:18432
 v_mfma_f32_16x16x32_bf16 v[160:163],v[72:75],a[144:147],v[160:163]
 buffer_load_dwordx4 a[204:207],v0,s[12:15],s53 offen offset:1024 sc1
 v_mfma_f32_16x16x32_bf16 v[168:171],v[72:75],a[148:151],v[168:171]
 s_cmp_eq_u32 s45,12
 s_cselect_b32 s53,s68,s65
 s_add_u32 s65,s65,2048
 v_mfma_f32_16x16x32_bf16 v[164:167],v[76:79],a[144:147],v[164:167]
 ds_read_b64_tr_b16 v[72:73],v128 offset:20480
 ds_read_b64_tr_b16 v[74:75],v128 offset:22528
 v_mfma_f32_16x16x32_bf16 v[172:175],v[76:79],a[148:151],v[172:175]
 ds_read_b64_tr_b16 v[76:77],v129 offset:20480
 ds_read_b64_tr_b16 v[78:79],v129 offset:22528
 v_mfma_f32_16x16x32_bf16 v[176:179],v[16:19],a[144:147],v[176:179]
 buffer_load_dwordx4 a[208:211],v0,s[12:15],s53 offen sc1
 v_mfma_f32_16x16x32_bf16 v[184:187],v[16:19],a[148:151],v[184:187]
 ds_read_b64_tr_b16 v[16:17],v130 offset:20480
 ds_read_b64_tr_b16 v[18:19],v130 offset:22528
 v_mfma_f32_16x16x32_bf16 v[180:183],v[20:23],a[144:147],v[180:183]
 v_mfma_f32_16x16x32_bf16 v[188:191],v[20:23],a[148:151],v[188:191]
 s_waitcnt vmcnt(13)
 ds_read_b64_tr_b16 v[20:21],v131 offset:20480
 ds_read_b64_tr_b16 v[22:23],v131 offset:22528
 v_mfma_f32_16x16x32_bf16 v[160:163],v[24:27],a[152:155],v[160:163]
 buffer_load_dwordx4 a[212:215],v0,s[12:15],s53 offen offset:1024 sc1
 v_mfma_f32_16x16x32_bf16 v[168:171],v[24:27],a[156:159],v[168:171]
 s_cmp_eq_u32 s45,13
 s_cselect_b32 s53,s68,s65
 s_add_u32 s65,s65,2048
 v_mfma_f32_16x16x32_bf16 v[164:167],v[28:31],a[152:155],v[164:167]
 ds_read_b64_tr_b16 v[24:25],v128 offset:24576
 ds_read_b64_tr_b16 v[26:27],v128 offset:26624
 v_mfma_f32_16x16x32_bf16 v[172:175],v[28:31],a[156:159],v[172:175]
 ds_read_b64_tr_b16 v[28:29],v129 offset:24576
 ds_read_b64_tr_b16 v[30:31],v129 offset:26624
 v_mfma_f32_16x16x32_bf16 v[176:179],v[32:35],a[152:155],v[176:179]
 buffer_load_dwordx4 a[216:219],v0,s[12:15],s53 offen sc1
 v_mfma_f32_16x16x32_bf16 v[184:187],v[32:35],a[156:159],v[184:187]
 ds_read_b64_tr_b16 v[32:33],v130 offset:24576
 ds_read_b64_tr_b16 v[34:35],v130 offset:26624
 v_mfma_f32_16x16x32_bf16 v[180:183],v[36:39],a[152:155],v[180:183]
 v_mfma_f32_16x16x32_bf16 v[188:191],v[36:39],a[156:159],v[188:191]
 s_waitcnt vmcnt(13) lgkmcnt(14)
 ds_read_b64_tr_b16 v[36:37],v131 offset:24576
 ds_read_b64_tr_b16 v[38:39],v131 offset:26624
 v_mfma_f32_16x16x32_bf16 v[160:163],v[40:43],a[160:163],v[160:163]
 buffer_load_dwordx4 a[220:223],v0,s[12:15],s53 offen offset:1024 sc1
 v_mfma_f32_16x16x32_bf16 v[168:171],v[40:43],a[164:167],v[168:171]
 s_cmp_eq_u32 s45,14
 s_cselect_b32 s53,s68,s65
 s_add_u32 s65,s65,2048
 v_mfma_f32_16x16x32_bf16 v[164:167],v[44:47],a[160:163],v[164:167]
 v_mfma_f32_16x16x32_bf16 v[172:175],v[44:47],a[164:167],v[172:175]
 v_mfma_f32_16x16x32_bf16 v[176:179],v[48:51],a[160:163],v[176:179]
 buffer_load_dwordx4 a[224:227],v0,s[12:15],s53 offen sc1
 v_mfma_f32_16x16x32_bf16 v[184:187],v[48:51],a[164:167],v[184:187]
 v_mfma_f32_16x16x32_bf16 v[180:183],v[52:55],a[160:163],v[180:183]
 v_mfma_f32_16x16x32_bf16 v[188:191],v[52:55],a[164:167],v[188:191]
 s_waitcnt lgkmcnt(0) vmcnt(13)
 s_barrier
 ds_read_b64_tr_b16 v[40:41],v120 offset:28672
 v_mfma_f32_16x16x32_bf16 v[160:163],v[56:59],a[168:171],v[160:163]
 buffer_load_dwordx4 a[228:231],v0,s[12:15],s53 offen offset:1024 sc1
 v_mfma_f32_16x16x32_bf16 v[168:171],v[56:59],a[172:175],v[168:171]
 s_cmp_eq_u32 s45,15
 s_cselect_b32 s53,s68,s65
 ds_read_b64_tr_b16 v[42:43],v120 offset:30720
 v_mfma_f32_16x16x32_bf16 v[164:167],v[60:63],a[168:171],v[164:167]
 ds_read_b64_tr_b16 v[44:45],v121 offset:28672
 ds_read_b64_tr_b16 v[46:47],v121 offset:30720
 v_mfma_f32_16x16x32_bf16 v[172:175],v[60:63],a[172:175],v[172:175]
 ds_read_b64_tr_b16 v[48:49],v122 offset:28672
 ds_read_b64_tr_b16 v[50:51],v122 offset:30720
 v_mfma_f32_16x16x32_bf16 v[176:179],v[64:67],a[168:171],v[176:179]
 buffer_load_dwordx4 a[232:235],v0,s[12:15],s53 offen sc1
 v_mfma_f32_16x16x32_bf16 v[184:187],v[64:67],a[172:175],v[184:187]
 ds_read_b64_tr_b16 v[52:53],v123 offset:28672
 ds_read_b64_tr_b16 v[54:55],v123 offset:30720
 v_mfma_f32_16x16x32_bf16 v[180:183],v[68:71],a[168:171],v[180:183]
 ds_read_b64_tr_b16 v[56:57],v120 offset:32768
 ds_read_b64_tr_b16 v[58:59],v120 offset:34816
 v_mfma_f32_16x16x32_bf16 v[188:191],v[68:71],a[172:175],v[188:191]
 s_waitcnt vmcnt(13)
 ds_read_b64_tr_b16 v[60:61],v121 offset:32768
 ds_read_b64_tr_b16 v[62:63],v121 offset:34816
 v_mfma_f32_16x16x32_bf16 v[160:163],v[72:75],a[176:179],v[160:163]
 buffer_load_dwordx4 a[236:239],v0,s[12:15],s53 offen offset:1024 sc1
 v_mfma_f32_16x16x32_bf16 v[168:171],v[72:75],a[180:183],v[168:171]
 ds_read_b64_tr_b16 v[64:65],v122 offset:32768
 ds_read_b64_tr_b16 v[66:67],v122 offset:34816
 v_mfma_f32_16x16x32_bf16 v[164:167],v[76:79],a[176:179],v[164:167]
 ds_read_b64_tr_b16 v[68:69],v123 offset:32768
 ds_read_b64_tr_b16 v[70:71],v123 offset:34816
 v_mfma_f32_16x16x32_bf16 v[172:175],v[76:79],a[180:183],v[172:175]
 ds_read_b64_tr_b16 v[72:73],v120 offset:36864
 ds_read_b64_tr_b16 v[74:75],v120 offset:38912
 v_mfma_f32_16x16x32_bf16 v[176:179],v[16:19],a[176:179],v[176:179]
 ds_read_b64_tr_b16 v[76:77],v121 offset:36864
 ds_read_b64_tr_b16 v[78:79],v121 offset:38912
 v_mfma_f32_16x16x32_bf16 v[184:187],v[16:19],a[180:183],v[184:187]
 ds_read_b64_tr_b16 v[16:17],v122 offset:36864
 ds_read_b64_tr_b16 v[18:19],v122 offset:38912
 v_mfma_f32_16x16x32_bf16 v[180:183],v[20:23],a[176:179],v[180:183]
 v_mfma_f32_16x16x32_bf16 v[188:191],v[20:23],a[180:183],v[188:191]
 s_waitcnt vmcnt(12)
 ds_read_b64_tr_b16 v[20:21],v123 offset:36864
 ds_read_b64_tr_b16 v[22:23],v123 offset:38912
 v_mfma_f32_16x16x32_bf16 v[160:163],v[24:27],a[184:187],v[160:163]
 v_mfma_f32_16x16x32_bf16 v[168:171],v[24:27],a[188:191],v[168:171]
 ds_read_b64_tr_b16 v[24:25],v120 offset:40960
 ds_read_b64_tr_b16 v[26:27],v120 offset:43008
 v_mfma_f32_16x16x32_bf16 v[164:167],v[28:31],a[184:187],v[164:167]
 v_mfma_f32_16x16x32_bf16 v[172:175],v[28:31],a[188:191],v[172:175]
 ds_read_b64_tr_b16 v[28:29],v121 offset:40960
 ds_read_b64_tr_b16 v[30:31],v121 offset:43008
 v_mfma_f32_16x16x32_bf16 v[176:179],v[32:35],a[184:187],v[176:179]
 v_mfma_f32_16x16x32_bf16 v[184:187],v[32:35],a[188:191],v[184:187]
 ds_read_b64_tr_b16 v[32:33],v122 offset:40960
 ds_read_b64_tr_b16 v[34:35],v122 offset:43008
 v_mfma_f32_16x16x32_bf16 v[180:183],v[36:39],a[184:187],v[180:183]
 v_mfma_f32_16x16x32_bf16 v[188:191],v[36:39],a[188:191],v[188:191]
 s_waitcnt vmcnt(10) lgkmcnt(14)
 ds_read_b64_tr_b16 v[36:37],v123 offset:40960
 ds_read_b64_tr_b16 v[38:39],v123 offset:43008
 v_mfma_f32_16x16x32_bf16 v[160:163],v[40:43],a[192:195],v[160:163]
 v_mfma_f32_16x16x32_bf16 v[168:171],v[40:43],a[196:199],v[168:171]
 ds_read_b64_tr_b16 v[40:41],v120 offset:45056
 ds_read_b64_tr_b16 v[42:43],v120 offset:47104
 v_mfma_f32_16x16x32_bf16 v[164:167],v[44:47],a[192:195],v[164:167]
 v_mfma_f32_16x16x32_bf16 v[172:175],v[44:47],a[196:199],v[172:175]
 ds_read_b64_tr_b16 v[44:45],v121 offset:45056
 ds_read_b64_tr_b16 v[46:47],v121 offset:47104
 v_mfma_f32_16x16x32_bf16 v[176:179],v[48:51],a[192:195],v[176:179]
 v_mfma_f32_16x16x32_bf16 v[184:187],v[48:51],a[196:199],v[184:187]
 ds_read_b64_tr_b16 v[48:49],v122 offset:45056
 ds_read_b64_tr_b16 v[50:51],v122 offset:47104
 v_mfma_f32_16x16x32_bf16 v[180:183],v[52:55],a[192:195],v[180:183]
 v_mfma_f32_16x16x32_bf16 v[188:191],v[52:55],a[196:199],v[188:191]
 s_waitcnt vmcnt(8)
 ds_read_b64_tr_b16 v[52:53],v123 offset:45056
 ds_read_b64_tr_b16 v[54:55],v123 offset:47104
 v_mfma_f32_16x16x32_bf16 v[160:163],v[56:59],a[200:203],v[160:163]
 v_mfma_f32_16x16x32_bf16 v[168:171],v[56:59],a[204:207],v[168:171]
 ds_read_b64_tr_b16 v[56:57],v120 offset:49152
 ds_read_b64_tr_b16 v[58:59],v120 offset:51200
 v_mfma_f32_16x16x32_bf16 v[164:167],v[60:63],a[200:203],v[164:167]
 v_mfma_f32_16x16x32_bf16 v[172:175],v[60:63],a[204:207],v[172:175]
 ds_read_b64_tr_b16 v[60:61],v121 offset:49152
 ds_read_b64_tr_b16 v[62:63],v121 offset:51200
 v_mfma_f32_16x16x32_bf16 v[176:179],v[64:67],a[200:203],v[176:179]
 v_mfma_f32_16x16x32_bf16 v[184:187],v[64:67],a[204:207],v[184:187]
 ds_read_b64_tr_b16 v[64:65],v122 offset:49152
 ds_read_b64_tr_b16 v[66:67],v122 offset:51200
 v_mfma_f32_16x16x32_bf16 v[180:183],v[68:71],a[200:203],v[180:183]
 v_mfma_f32_16x16x32_bf16 v[188:191],v[68:71],a[204:207],v[188:191]
 s_waitcnt vmcnt(6) lgkmcnt(14)
 ds_read_b64_tr_b16 v[68:69],v123 offset:49152
 ds_read_b64_tr_b16 v[70:71],v123 offset:51200
 v_mfma_f32_16x16x32_bf16 v[160:163],v[72:75],a[208:211],v[160:163]
 v_mfma_f32_16x16x32_bf16 v[168:171],v[72:75],a[212:215],v[168:171]
 v_mfma_f32_16x16x32_bf16 v[164:167],v[76:79],a[208:211],v[164:167]
 v_mfma_f32_16x16x32_bf16 v[172:175],v[76:79],a[212:215],v[172:175]
 v_mfma_f32_16x16x32_bf16 v[176:179],v[16:19],a[208:211],v[176:179]
 v_mfma_f32_16x16x32_bf16 v[184:187],v[16:19],a[212:215],v[184:187]
 v_mfma_f32_16x16x32_bf16 v[180:183],v[20:23],a[208:211],v[180:183]
 v_mfma_f32_16x16x32_bf16 v[188:191],v[20:23],a[212:215],v[188:191]
 s_waitcnt vmcnt(4)
 v_mfma_f32_16x16x32_bf16 v[160:163],v[24:27],a[216:219],v[160:163]
 v_mfma_f32_16x16x32_bf16 v[168:171],v[24:27],a[220:223],v[168:171]
 v_mfma_f32_16x16x32_bf16 v[164:167],v[28:31],a[216:219],v[164:167]
 v_mfma_f32_16x16x32_bf16 v[172:175],v[28:31],a[220:223],v[172:175]
 v_mfma_f32_16x16x32_bf16 v[176:179],v[32:35],a[216:219],v[176:179]
 v_mfma_f32_16x16x32_bf16 v[184:187],v[32:35],a[220:223],v[184:187]
 v_mfma_f32_16x16x32_bf16 v[180:183],v[36:39],a[216:219],v[180:183]
 v_mfma_f32_16x16x32_bf16 v[188:191],v[36:39],a[220:223],v[188:191]
 s_waitcnt vmcnt(2) lgkmcnt(12)
 v_mfma_f32_16x16x32_bf16 v[160:163],v[40:43],a[224:227],v[160:163]
 v_mfma_f32_16x16x32_bf16 v[168:171],v[40:43],a[228:231],v[168:171]
 v_mfma_f32_16x16x32_bf16 v[164:167],v[44:47],a[224:227],v[164:167]
 v_mfma_f32_16x16x32_bf16 v[172:175],v[44:47],a[228:231],v[172:175]
 s_waitcnt lgkmcnt(8)
 v_mfma_f32_16x16x32_bf16 v[176:179],v[48:51],a[224:227],v[176:179]
 v_mfma_f32_16x16x32_bf16 v[184:187],v[48:51],a[228:231],v[184:187]
 v_mfma_f32_16x16x32_bf16 v[180:183],v[52:55],a[224:227],v[180:183]
 v_mfma_f32_16x16x32_bf16 v[188:191],v[52:55],a[228:231],v[188:191]
 s_waitcnt vmcnt(0) lgkmcnt(4)
 v_mfma_f32_16x16x32_bf16 v[160:163],v[56:59],a[232:235],v[160:163]
 v_mfma_f32_16x16x32_bf16 v[168:171],v[56:59],a[236:239],v[168:171]
 v_mfma_f32_16x16x32_bf16 v[164:167],v[60:63],a[232:235],v[164:167]
 v_mfma_f32_16x16x32_bf16 v[172:175],v[60:63],a[236:239],v[172:175]
 s_waitcnt lgkmcnt(0)
 v_mfma_f32_16x16x32_bf16 v[176:179],v[64:67],a[232:235],v[176:179]
 s_nop 2
 v_cvt_pk_bf16_f32 v160,v160,v161
 v_cvt_pk_bf16_f32 v161,v162,v163
 v_mfma_f32_16x16x32_bf16 v[184:187],v[64:67],a[236:239],v[184:187]
 v_cvt_pk_bf16_f32 v168,v168,v169
 v_cvt_pk_bf16_f32 v169,v170,v171
 v_mfma_f32_16x16x32_bf16 v[180:183],v[68:71],a[232:235],v[180:183]
 v_cvt_pk_bf16_f32 v162,v164,v165
 v_cvt_pk_bf16_f32 v163,v166,v167
 v_mfma_f32_16x16x32_bf16 v[188:191],v[68:71],a[236:239],v[188:191]
 v_permlane16_swap_b32 v160,v162
 v_permlane16_swap_b32 v161,v163
 buffer_store_dwordx4 v[160:163],v214,s[40:43],0 offen sc1 nt
 v_cvt_pk_bf16_f32 v170,v172,v173
 v_cvt_pk_bf16_f32 v171,v174,v175
 s_nop 0
 v_permlane16_swap_b32 v168,v170
 v_permlane16_swap_b32 v169,v171
 buffer_store_dwordx4 v[168:171],v214,s[40:43],s52 offen sc1 nt
 v_cvt_pk_bf16_f32 v176,v176,v177
 v_cvt_pk_bf16_f32 v177,v178,v179
 v_cvt_pk_bf16_f32 v178,v180,v181
 v_cvt_pk_bf16_f32 v179,v182,v183
 s_nop 0
 v_permlane16_swap_b32 v176,v178
 v_permlane16_swap_b32 v177,v179
 buffer_store_dwordx4 v[176:179],v214,s[40:43],0 offen offset:64 sc1 nt
 v_cvt_pk_bf16_f32 v184,v184,v185
 v_cvt_pk_bf16_f32 v185,v186,v187
 v_cvt_pk_bf16_f32 v186,v188,v189
 v_cvt_pk_bf16_f32 v187,v190,v191
 s_nop 0
 v_permlane16_swap_b32 v184,v186
 v_permlane16_swap_b32 v185,v187
 buffer_store_dwordx4 v[184:187],v214,s[40:43],s52 offen offset:64 sc1 nt
.Lend:
 s_endpgm
.Lseq_slow_2:
 buffer_load_dword v7,off,s[16:19],0 sc1
 s_waitcnt vmcnt(0)
 v_readfirstlane_b32 s59,v7
 s_nop 0
 s_cmp_ge_u32 s59,1
 s_cbranch_scc1 .Lseq_back_3
 s_sub_u32 s48,s48,1
 s_cmp_gt_i32 s48,0
 s_cbranch_scc1 .Lseq_slow_2
 s_branch .Lseq_back_3
.Lseq_slow_4:
 v_mov_b32 v7,0
 buffer_atomic_add v7,v195,s[12:15],0 offen sc0 sc1
 s_waitcnt vmcnt(0)
 v_readfirstlane_b32 s59,v7
 v_readlane_b32 s3,v7,1
 s_nop 0
 s_min_u32 s59,s59,s3
 s_cmp_ge_u32 s59,16
 s_cbranch_scc1 .Lseq_back_5
 s_sub_u32 s48,s48,1
 s_cmp_gt_i32 s48,0
 s_cbranch_scc1 .Lseq_slow_4
 s_branch .Lseq_back_5
.Lseq_slow_6:
 v_mov_b32 v7,0
 buffer_atomic_add v7,v5,s[12:15],0 offen offset:8 sc0 sc1
 s_waitcnt vmcnt(0)
 v_readfirstlane_b32 s59,v7
 s_nop 0
 s_cmp_ge_u32 s59,32
 s_cbranch_scc1 .Lseq_back_7
 s_sub_u32 s48,s48,1
 s_cmp_gt_i32 s48,0
 s_cbranch_scc1 .Lseq_slow_6
 s_branch .Lseq_back_7
.Lseq_slow_8:
 v_mov_b32 v7,0
 buffer_atomic_add v7,v5,s[12:15],0 offen offset:20 sc0 sc1
 s_waitcnt vmcnt(0)
 v_readfirstlane_b32 s59,v7
 s_nop 0
 s_cmp_ge_u32 s59,128
 s_cbranch_scc1 .Lseq_back_9
 s_sub_u32 s48,s48,1
 s_cmp_gt_i32 s48,0
 s_cbranch_scc1 .Lseq_slow_8
 s_branch .Lseq_back_9
.Lseq_fb_10:
 s_waitcnt vmcnt(0)
 s_lshl_b32 s53,s45,1
 s_add_u32 s53,s53,s60
 s_lshl_b32 s53,s53,18
 s_add_u32 s53,s53,8388608
 s_add_u32 s71,s53,262144
 v_mov_b32 v208,0xff800000
 s_mov_b32 s70,s53
.Lseq_fb_12:
 buffer_load_dwordx4 v[16:19],v0,s[12:15],s70 offen sc1
 buffer_load_dwordx4 v[20:23],v0,s[12:15],s70 offen offset:1024 sc1
 s_add_u32 s70,s70,4096
 s_waitcnt vmcnt(0)
 v_mfma_f32_32x32x16_bf16 v[144:159],v[16:19],a[144:147],0
 v_mfma_f32_32x32x16_bf16 v[144:159],v[20:23],a[148:151],v[144:159]
 s_nop 11
 v_max3_f32 v208,v144,v145,v208
 v_max3_f32 v208,v146,v147,v208
 v_max3_f32 v208,v148,v149,v208
 v_max3_f32 v208,v150,v151,v208
 v_max3_f32 v208,v152,v153,v208
 v_max3_f32 v208,v154,v155,v208
 v_max3_f32 v208,v156,v157,v208
 v_max3_f32 v208,v158,v159,v208
 s_cmp_lg_u32 s70,s71
 s_cbranch_scc1 .Lseq_fb_12
 v_mov_b32 v209,v208
 s_nop 1
 v_permlane32_swap_b32 v208,v209
 v_max_f32 v208,v208,v209
 v_sub_f32 v160,0,v208
 v_mov_b32 v112,0
 v_sub_f32 v161,0,v208
 v_mov_b32 v113,0
 v_sub_f32 v162,0,v208
 v_mov_b32 v114,0
 v_sub_f32 v163,0,v208
 v_mov_b32 v115,0
 v_sub_f32 v164,0,v208
 v_mov_b32 v116,0
 v_sub_f32 v165,0,v208
 v_mov_b32 v117,0
 v_sub_f32 v166,0,v208
 v_mov_b32 v118,0
 v_sub_f32 v167,0,v208
 v_mov_b32 v119,0
 v_sub_f32 v168,0,v208
 v_mov_b32 v120,0
 v_sub_f32 v169,0,v208
 v_mov_b32 v121,0
 v_sub_f32 v170,0,v208
 v_mov_b32 v122,0
 v_sub_f32 v171,0,v208
 v_mov_b32 v123,0
 v_sub_f32 v172,0,v208
 v_mov_b32 v124,0
 v_sub_f32 v173,0,v208
 v_mov_b32 v125,0
 v_sub_f32 v174,0,v208
 v_mov_b32 v126,0
 v_sub_f32 v175,0,v208
 v_mov_b32 v127,0
 v_mov_b32 v192,0
 v_mov_b32 v193,0
 v_mov_b32 v194,0
 v_mov_b32 v195,0
 s_mov_b32 s70,s53
.Lseq_fb_13:
 buffer_load_dwordx4 v[16:19],v0,s[12:15],s70 offen sc1
 buffer_load_dwordx4 v[20:23],v0,s[12:15],s70 offen offset:1024 sc1
 buffer_load_dwordx4 v[24:27],v0,s[12:15],s70 offen offset:2048 sc1
 buffer_load_dwordx4 v[28:31],v0,s[12:15],s70 offen offset:3072 sc1
 s_add_u32 s70,s70,4096
 s_waitcnt vmcnt(0)
 v_mfma_f32_32x32x16_bf16 v[144:159],v[16:19],a[144:147],v[160:175]
 v_mfma_f32_32x32x16_bf16 v[144:159],v[20:23],a[148:151],v[144:159]
 s_nop 11
 v_exp_f32 v144,v144
 v_exp_f32 v145,v145
 v_exp_f32 v146,v146
 v_exp_f32 v147,v147
 v_exp_f32 v148,v148
 v_exp_f32 v149,v149
 v_exp_f32 v150,v150
 v_exp_f32 v151,v151
 v_exp_f32 v152,v152
 v_exp_f32 v153,v153
 v_exp_f32 v154,v154
 v_exp_f32 v155,v155
 v_exp_f32 v156,v156
 v_exp_f32 v157,v157
 v_exp_f32 v158,v158
 v_exp_f32 v159,v159
 v_smfmac_f32_32x32x32_bf16 v[112:127],v[24:27],v[144:151],v200
 v_smfmac_f32_16x16x64_bf16 v[192:195],a[160:163],v[144:151],v200
 s_nop 15
 v_smfmac_f32_32x32x32_bf16 v[112:127],v[28:31],v[152:159],v200
 v_smfmac_f32_16x16x64_bf16 v[192:195],a[160:163],v[152:159],v200
 s_nop 15
 s_cmp_lg_u32 s70,s71
 s_cbranch_scc1 .Lseq_fb_13
 v_mov_b32 v208,0xff800000
 s_mov_b32 s70,s53
.Lseq_fb_14:
 buffer_load_dwordx4 v[16:19],v0,s[12:15],s70 offen sc1
 buffer_load_dwordx4 v[20:23],v0,s[12:15],s70 offen offset:1024 sc1
 s_add_u32 s70,s70,4096
 s_waitcnt vmcnt(0)
 v_mfma_f32_32x32x16_bf16 v[144:159],v[16:19],a[152:155],0
 v_mfma_f32_32x32x16_bf16 v[144:159],v[20:23],a[156:159],v[144:159]
 s_nop 11
 v_max3_f32 v208,v144,v145,v208
 v_max3_f32 v208,v146,v147,v208
 v_max3_f32 v208,v148,v149,v208
 v_max3_f32 v208,v150,v151,v208
 v_max3_f32 v208,v152,v153,v208
 v_max3_f32 v208,v154,v155,v208
 v_max3_f32 v208,v156,v157,v208
 v_max3_f32 v208,v158,v159,v208
 s_cmp_lg_u32 s70,s71
 s_cbranch_scc1 .Lseq_fb_14
 v_mov_b32 v209,v208
 s_nop 1
 v_permlane32_swap_b32 v208,v209
 v_max_f32 v208,v208,v209
 v_sub_f32 v160,0,v208
 v_mov_b32 v128,0
 v_sub_f32 v161,0,v208
 v_mov_b32 v129,0
 v_sub_f32 v162,0,v208
 v_mov_b32 v130,0
 v_sub_f32 v163,0,v208
 v_mov_b32 v131,0
 v_sub_f32 v164,0,v208
 v_mov_b32 v132,0
 v_sub_f32 v165,0,v208
 v_mov_b32 v133,0
 v_sub_f32 v166,0,v208
 v_mov_b32 v134,0
 v_sub_f32 v167,0,v208
 v_mov_b32 v135,0
 v_sub_f32 v168,0,v208
 v_mov_b32 v136,0
 v_sub_f32 v169,0,v208
 v_mov_b32 v137,0
 v_sub_f32 v170,0,v208
 v_mov_b32 v138,0
 v_sub_f32 v171,0,v208
 v_mov_b32 v139,0
 v_sub_f32 v172,0,v208
 v_mov_b32 v140,0
 v_sub_f32 v173,0,v208
 v_mov_b32 v141,0
 v_sub_f32 v174,0,v208
 v_mov_b32 v142,0
 v_sub_f32 v175,0,v208
 v_mov_b32 v143,0
 v_mov_b32 v196,0
 v_mov_b32 v197,0
 v_mov_b32 v198,0
 v_mov_b32 v199,0
 s_mov_b32 s70,s53
.Lseq_fb_15:
 buffer_load_dwordx4 v[16:19],v0,s[12:15],s70 offen sc1
 buffer_load_dwordx4 v[20:23],v0,s[12:15],s70 offen offset:1024 sc1
 buffer_load_dwordx4 v[24:27],v0,s[12:15],s70 offen offset:2048 sc1
 buffer_load_dwordx4 v[28:31],v0,s[12:15],s70 offen offset:3072 sc1
 s_add_u32 s70,s70,4096
 s_waitcnt vmcnt(0)
 v_mfma_f32_32x32x16_bf16 v[144:159],v[16:19],a[152:155],v[160:175]
 v_mfma_f32_32x32x16_bf16 v[144:159],v[20:23],a[156:159],v[144:159]
 s_nop 11
 v_exp_f32 v144,v144
 v_exp_f32 v145,v145
 v_exp_f32 v146,v146
 v_exp_f32 v147,v147
 v_exp_f32 v148,v148
 v_exp_f32 v149,v149
 v_exp_f32 v150,v150
 v_exp_f32 v151,v151
 v_exp_f32 v152,v152
 v_exp_f32 v153,v153
 v_exp_f32 v154,v154
 v_exp_f32 v155,v155
 v_exp_f32 v156,v156
 v_exp_f32 v157,v157
 v_exp_f32 v158,v158
 v_exp_f32 v159,v159
 v_smfmac_f32_32x32x32_bf16 v[128:143],v[24:27],v[144:151],v200
 v_smfmac_f32_16x16x64_bf16 v[196:199],a[160:163],v[144:151],v200
 s_nop 15
 v_smfmac_f32_32x32x32_bf16 v[128:143],v[28:31],v[152:159],v200
 v_smfmac_f32_16x16x64_bf16 v[196:199],a[160:163],v[152:159],v200
 s_nop 15
 s_cmp_lg_u32 s70,s71
 s_cbranch_scc1 .Lseq_fb_15
 v_rcp_f32 v194,v192
 s_nop 0
 v_pk_mul_f32 v[112:113],v[112:113],v[194:195] op_sel_hi:[1,0]
 v_pk_mul_f32 v[114:115],v[114:115],v[194:195] op_sel_hi:[1,0]
 v_pk_mul_f32 v[116:117],v[116:117],v[194:195] op_sel_hi:[1,0]
 v_pk_mul_f32 v[118:119],v[118:119],v[194:195] op_sel_hi:[1,0]
 v_pk_mul_f32 v[120:121],v[120:121],v[194:195] op_sel_hi:[1,0]
 v_pk_mul_f32 v[122:123],v[122:123],v[194:195] op_sel_hi:[1,0]
 v_pk_mul_f32 v[124:125],v[124:125],v[194:195] op_sel_hi:[1,0]
 v_pk_mul_f32 v[126:127],v[126:127],v[194:195] op_sel_hi:[1,0]
 v_cvt_pk_bf16_f32 v80,v112,v113
 v_cvt_pk_bf16_f32 v81,v114,v115
 v_cvt_pk_bf16_f32 v82,v116,v117
 v_cvt_pk_bf16_f32 v83,v118,v119
 buffer_store_dwordx4 v[80:83],v203,s[12:15],s57 offen sc1
 v_cvt_pk_bf16_f32 v84,v120,v121
 v_cvt_pk_bf16_f32 v85,v122,v123
 v_cvt_pk_bf16_f32 v86,v124,v125
 v_cvt_pk_bf16_f32 v87,v126,v127
 buffer_store_dwordx4 v[84:87],v203,s[12:15],s57 offen offset:512 sc1
 v_rcp_f32 v198,v196
 s_nop 0
 v_pk_mul_f32 v[128:129],v[128:129],v[198:199] op_sel_hi:[1,0]
 v_pk_mul_f32 v[130:131],v[130:131],v[198:199] op_sel_hi:[1,0]
 v_pk_mul_f32 v[132:133],v[132:133],v[198:199] op_sel_hi:[1,0]
 v_pk_mul_f32 v[134:135],v[134:135],v[198:199] op_sel_hi:[1,0]
 v_pk_mul_f32 v[136:137],v[136:137],v[198:199] op_sel_hi:[1,0]
 v_pk_mul_f32 v[138:139],v[138:139],v[198:199] op_sel_hi:[1,0]
 v_pk_mul_f32 v[140:141],v[140:141],v[198:199] op_sel_hi:[1,0]
 v_pk_mul_f32 v[142:143],v[142:143],v[198:199] op_sel_hi:[1,0]
 v_cvt_pk_bf16_f32 v96,v128,v129
 v_cvt_pk_bf16_f32 v97,v130,v131
 v_cvt_pk_bf16_f32 v98,v132,v133
 v_cvt_pk_bf16_f32 v99,v134,v135
 buffer_store_dwordx4 v[96:99],v203,s[12:15],s58 offen sc1
 v_cvt_pk_bf16_f32 v100,v136,v137
 v_cvt_pk_bf16_f32 v101,v138,v139
 v_cvt_pk_bf16_f32 v102,v140,v141
 v_cvt_pk_bf16_f32 v103,v142,v143
 buffer_store_dwordx4 v[100:103],v203,s[12:15],s58 offen offset:512 sc1
 s_waitcnt vmcnt(0)
 s_branch .Lseq_fbk_11
.Lseq_slow_18:
 v_mov_b32 v7,0
 buffer_atomic_add v7,v3,s[12:15],0 offen offset:24 sc0 sc1
 s_waitcnt vmcnt(0)
 v_readfirstlane_b32 s59,v7
 s_nop 0
 s_cmp_ge_u32 s59,16
 s_cbranch_scc1 .Lseq_back_19
 s_sub_u32 s48,s48,1
 s_cmp_gt_i32 s48,0
 s_cbranch_scc1 .Lseq_slow_18
 s_branch .Lseq_back_19
.Lseq_slow_20:
 v_mov_b32 v7,0
 buffer_atomic_add v7,v3,s[12:15],0 offen offset:28 sc0 sc1
 s_waitcnt vmcnt(0)
 v_readfirstlane_b32 s59,v7
 s_nop 0
 s_cmp_ge_u32 s59,16
 s_cbranch_scc1 .Lseq_back_21
 s_sub_u32 s48,s48,1
 s_cmp_gt_i32 s48,0
 s_cbranch_scc1 .Lseq_slow_20
 s_branch .Lseq_back_21
.Lseq_slow_22:
 v_mov_b32 v7,0
 buffer_atomic_add v7,v5,s[12:15],0 offen offset:32 sc0 sc1
 s_waitcnt vmcnt(0)
 v_readfirstlane_b32 s59,v7
 s_nop 0
 s_cmp_ge_u32 s59,16
 s_cbranch_scc1 .Lseq_back_23
 s_sub_u32 s48,s48,1
 s_cmp_gt_i32 s48,0
 s_cbranch_scc1 .Lseq_slow_22
 s_branch .Lseq_back_23
.Lseq_slow_24:
 v_mov_b32 v7,0
 buffer_atomic_add v7,v3,s[12:15],0 offen offset:36 sc0 sc1
 s_waitcnt vmcnt(0)
 v_readfirstlane_b32 s59,v7
 s_nop 0
 s_cmp_ge_u32 s59,16
 s_cbranch_scc1 .Lseq_back_25
 s_sub_u32 s48,s48,1
 s_cmp_gt_i32 s48,0
 s_cbranch_scc1 .Lseq_slow_24
 s_branch .Lseq_back_25
.Lseq_slow_26:
 v_mov_b32 v7,0
 buffer_atomic_add v7,v3,s[12:15],0 offen offset:40 sc0 sc1
 s_waitcnt vmcnt(0)
 v_readfirstlane_b32 s59,v7
 s_nop 0
 s_cmp_ge_u32 s59,16
 s_cbranch_scc1 .Lseq_back_27
 s_sub_u32 s48,s48,1
 s_cmp_gt_i32 s48,0
 s_cbranch_scc1 .Lseq_slow_26
 s_branch .Lseq_back_27
.Lseq_slow_28:
 v_mov_b32 v7,0
 buffer_atomic_add v7,v3,s[12:15],0 offen offset:44 sc0 sc1
 s_waitcnt vmcnt(0)
 v_readfirstlane_b32 s59,v7
 s_nop 0
 s_cmp_ge_u32 s59,16
 s_cbranch_scc1 .Lseq_back_29
 s_sub_u32 s48,s48,1
 s_cmp_gt_i32 s48,0
 s_cbranch_scc1 .Lseq_slow_28
 s_branch .Lseq_back_29
.Lcodeend:
 s_endpgm
.section .rodata,"a"
.p2align 6
.amdhsa_kernel sequential_preLN__mha_block__mixer_gmlp__prompt_kernel
  .amdhsa_next_free_vgpr 512
  .amdhsa_next_free_sgpr 72
  .amdhsa_accum_offset 256
  .amdhsa_group_segment_fixed_size 0
  .amdhsa_kernarg_size 88
  .amdhsa_user_sgpr_count 2
  .amdhsa_user_sgpr_kernarg_segment_ptr 1
  .amdhsa_system_sgpr_workgroup_id_x 1
  .amdhsa_float_denorm_mode_32 3
  .amdhsa_ieee_mode 0
  .amdhsa_dx10_clamp 1
.end_amdhsa_kernel
```
